```python
import torch

def _softmax(x, axis=-1):
    return torch.softmax(x, dim=axis)

def _gelu(x):
    return torch.nn.functional.gelu(x, approximate='tanh')

def _silu(x):
    return torch.nn.functional.silu(x)

def _sigmoid(x):
    return torch.sigmoid(x)

def _layernorm(x, axis=-1, eps=1e-05):
    m = x.mean(dim=axis, keepdim=True)
    v = x.var(dim=axis, keepdim=True, unbiased=False)
    return (x - m) / torch.sqrt(v + eps)

def _scatter_add(tgt, idx, src, axis=0):
    return tgt.clone().index_add_(axis, idx, src)

def _segment_sum(src, seg, n):
    out = torch.zeros((n,) + src.shape[1:], dtype=src.dtype)
    return out.index_add_(0, seg, src)

def _pad(x, pw):
    flat = tuple((v for pair in reversed(pw) for v in pair))
    return torch.nn.functional.pad(x, flat)
kernel_name = 'gated_mix__memory_aug_recurrent_mem_tr__glu_gated_swiglu__prompt'

def setup_inputs():

    _w = lambda a: (lambda t: t.to(torch.bfloat16) if t.is_floating_point() else t)(torch.as_tensor(a))

    def _A_setup():
        B, S, Dm = (1, 2048, 1024)
        H, Dh = (32, 128)
        M, seg = (8, 32)
        seg = min(seg, S)
        S = S // seg * seg
        return {'x': _w((lambda *s: torch.randn(*s, dtype=torch.bfloat16) * 0.05)(B, S, Dm)), 'mem0': _w((lambda *s: torch.randn(*s, dtype=torch.bfloat16) * 0.4)(B, M, Dm)), 'Wq': _w((lambda *s: torch.randn(*s, dtype=torch.bfloat16) * 6.4)(Dm, H, Dh) * Dm ** (-0.5)), 'Wk': _w((lambda *s: torch.randn(*s, dtype=torch.bfloat16) * 6.4)(Dm, H, Dh) * Dm ** (-0.5)), 'Wv': _w((lambda *s: torch.randn(*s, dtype=torch.bfloat16) * 0.4)(Dm, H, Dh) * Dm ** (-0.5)), 'Wo': _w((lambda *s: torch.randn(*s, dtype=torch.bfloat16) * 0.4)(H, Dh, Dm) * (H * Dh) ** (-0.5)), 'seg_len': seg}
    _A_in = _A_setup()

    def _B_setup():
        B, S, D, F = (1, 2048, 1024, 3584)
        return {'x': _w((lambda *s: torch.randn(*s, dtype=torch.bfloat16) * 0.05)(B, S, D)), 'w1': _w((lambda *s: torch.randn(*s, dtype=torch.bfloat16) * 1.6)(D, F) * (2.0 / D) ** 0.5), 'w3': _w((lambda *s: torch.randn(*s, dtype=torch.bfloat16) * 1.6)(D, F) * (2.0 / D) ** 0.5), 'w2': _w((lambda *s: torch.randn(*s, dtype=torch.bfloat16) * 1.6)(F, D) * (2.0 / F) ** 0.5)}
    _B_in = _B_setup()
    return {'A_x': _A_in['x'], 'A_mem0': _A_in['mem0'], 'A_Wq': _A_in['Wq'], 'A_Wk': _A_in['Wk'], 'A_Wv': _A_in['Wv'], 'A_Wo': _A_in['Wo'], 'A_seg_len': _A_in['seg_len'], 'B_x': _B_in['x'], 'B_w1': _B_in['w1'], 'B_w3': _B_in['w3'], 'B_w2': _B_in['w2'], 'gate_w': _w((lambda *s: torch.randn(*s, dtype=torch.bfloat16) * 0.05)(1024) * 16.0)}

def reference(A_x, A_mem0, A_Wq, A_Wk, A_Wv, A_Wo, A_seg_len, B_x, B_w1, B_w3, B_w2, gate_w):

    def _A_ref(x, mem0, Wq, Wk, Wv, Wo, seg_len):
        B, S, Dm = x.shape
        H, Dh = (Wq.shape[1], Wq.shape[2])
        M = mem0.shape[1]
        scale = Dh ** (-0.5)
        n_seg = S // seg_len
        L = M + seg_len
        idx = torch.arange(L)
        mask = (idx[:, None] < M) | (idx[:, None] >= idx[None, :])
        mem = mem0
        outs = []
        for s in range(n_seg):
            xs = x[:, s * seg_len:(s + 1) * seg_len, :].clone()
            h = torch.concatenate([mem, xs], axis=1)
            q = torch.einsum('btd,dhe->bhte', h, Wq)
            k = torch.einsum('btd,dhe->bhte', h, Wk)
            v = torch.einsum('btd,dhe->bhte', h, Wv)
            scores = torch.einsum('bhqe,bhke->bhqk', q, k) * scale
            scores = torch.where(mask[None, None], scores, -1000000000.0)
            p = _softmax(scores, axis=-1)
            o = torch.einsum('bhqk,bhke->bhqe', p, v)
            o = torch.einsum('bhte,hed->btd', o, Wo)
            mem = o[:, :M, :].clone()
            outs.append(o[:, M:, :])
        return torch.concatenate(outs, axis=1)

    def _B_ref(x, w1, w3, w2):
        gate = torch.einsum('bsd,df->bsf', x, w1)
        up = torch.einsum('bsd,df->bsf', x, w3)
        h = _silu(gate) * up
        out = torch.einsum('bsf,fd->bsd', h, w2)
        return out
    x = A_x
    g = _sigmoid((x * gate_w).sum(-1, keepdims=True))
    a = _A_ref(x, A_mem0, A_Wq, A_Wk, A_Wv, A_Wo, A_seg_len)
    b = _B_ref(x, B_w1, B_w3, B_w2)
    return g * a + (1 - g) * b
```

```asm
; @launch grid=(256,1,1) block=(256,1,1) lds=163840
.amdgcn_target "amdgcn-amd-amdhsa--gfx950"
.text
.globl gated_mix__memory_aug_recurrent_mem_tr__glu_gated_swiglu__prompt_kernel
.p2align 8
.type gated_mix__memory_aug_recurrent_mem_tr__glu_gated_swiglu__prompt_kernel,@function
gated_mix__memory_aug_recurrent_mem_tr__glu_gated_swiglu__prompt_kernel:
  s_cmp_ge_u32 s2, 256
  s_cbranch_scc1 L_end
  s_load_dwordx16 s[64:79], s[0:1], 0
  s_load_dwordx8 s[80:87], s[0:1], 64
  s_load_dwordx4 s[88:91], s[0:1], 96
  s_load_dwordx2 s[92:93], s[0:1], 112
  s_getreg_b32 s94, hwreg(HW_REG_XCC_ID)
  s_and_b32 s94, s94, 7
  v_lshrrev_b32 v2, 6, v0
  v_and_b32 v1, 63, v0
  s_nop 0
  v_readfirstlane_b32 s95, v2
  s_mov_b32 s101, 0
  s_getpc_b64 s[96:97]
L_pc0:
  v_lshlrev_b32 v4, 7, v0
  global_load_dword a254, v4, s[96:97]
  v_add_u32 v4, 0x8000, v4
  v_min_u32 v4, L_end-L_pc0, v4
  global_load_dword a255, v4, s[96:97]
  v_add_u32 v4, 0x8000, v4
  v_min_u32 v4, L_end-L_pc0, v4
  global_load_dword a253, v4, s[96:97]
  s_waitcnt lgkmcnt(0)
  s_mov_b32 s4, s92
  s_mov_b32 s5, s93
  s_mov_b32 s6, 0x10000000
  s_mov_b32 s7, 0x20000
  s_mov_b32 s8, s90
  s_mov_b32 s9, s91
  s_mov_b32 s10, 0x100
  s_mov_b32 s11, 0x20000
  s_cmp_ge_u32 s94, 4
  s_cbranch_scc1 G_entry
  s_cmp_lg_u32 s95, 0
  s_cbranch_scc1 L_tk
  s_add_u32 s97, s94, 32
  s_lshl_b32 s97, s97, 2
  v_mov_b32 v2, 1
  v_mov_b32 v3, s97
  s_mov_b64 exec, 1
  buffer_atomic_add v2, v3, s[8:11], 0 offen sc0
  s_waitcnt vmcnt(0)
  v_mov_b32 v3, 163776
  ds_write_b32 v3, v2
  s_waitcnt lgkmcnt(0)
  s_mov_b64 exec, -1
  v_readfirstlane_b32 s97, v2
  s_cmp_lg_u32 s97, 16
  s_cbranch_scc1 L_tk
  v_mov_b32 v4, 1
  v_mov_b32 v5, 144
  s_mov_b64 exec, 1
  buffer_atomic_add v4, v5, s[8:11], 0 offen sc0
  s_waitcnt vmcnt(0)
  s_mov_b64 exec, -1
  v_readfirstlane_b32 s97, v4
  s_cmp_lg_u32 s97, 0
  s_cbranch_scc1 EC_1
  v_mov_b32 v6, 0
  v_mov_b32 v7, 0
  v_mov_b32 v8, 0
  v_mov_b32 v9, 0
  v_lshlrev_b32 v5, 4, v1
  s_mov_b32 s97, 0x7600000
  buffer_store_dwordx4 v[6:9], v5, s[4:7], s97 offen offset:0 sc1
  buffer_store_dwordx4 v[6:9], v5, s[4:7], s97 offen offset:1024 sc1
  buffer_store_dwordx4 v[6:9], v5, s[4:7], s97 offen offset:2048 sc1
  buffer_store_dwordx4 v[6:9], v5, s[4:7], s97 offen offset:3072 sc1
  s_mov_b32 s97, 0x7601000
  buffer_store_dwordx4 v[6:9], v5, s[4:7], s97 offen offset:0 sc1
  buffer_store_dwordx4 v[6:9], v5, s[4:7], s97 offen offset:1024 sc1
  buffer_store_dwordx4 v[6:9], v5, s[4:7], s97 offen offset:2048 sc1
  buffer_store_dwordx4 v[6:9], v5, s[4:7], s97 offen offset:3072 sc1
  s_mov_b32 s97, 0x7602000
  buffer_store_dwordx4 v[6:9], v5, s[4:7], s97 offen offset:0 sc1
  buffer_store_dwordx4 v[6:9], v5, s[4:7], s97 offen offset:1024 sc1
  buffer_store_dwordx4 v[6:9], v5, s[4:7], s97 offen offset:2048 sc1
  buffer_store_dwordx4 v[6:9], v5, s[4:7], s97 offen offset:3072 sc1
  s_mov_b32 s97, 0x7603000
  buffer_store_dwordx4 v[6:9], v5, s[4:7], s97 offen offset:0 sc1
  buffer_store_dwordx4 v[6:9], v5, s[4:7], s97 offen offset:1024 sc1
  buffer_store_dwordx4 v[6:9], v5, s[4:7], s97 offen offset:2048 sc1
  buffer_store_dwordx4 v[6:9], v5, s[4:7], s97 offen offset:3072 sc1
  s_mov_b32 s97, 0x7604000
  buffer_store_dwordx4 v[6:9], v5, s[4:7], s97 offen offset:0 sc1
  buffer_store_dwordx4 v[6:9], v5, s[4:7], s97 offen offset:1024 sc1
  buffer_store_dwordx4 v[6:9], v5, s[4:7], s97 offen offset:2048 sc1
  buffer_store_dwordx4 v[6:9], v5, s[4:7], s97 offen offset:3072 sc1
  s_mov_b32 s97, 0x7605000
  buffer_store_dwordx4 v[6:9], v5, s[4:7], s97 offen offset:0 sc1
  buffer_store_dwordx4 v[6:9], v5, s[4:7], s97 offen offset:1024 sc1
  buffer_store_dwordx4 v[6:9], v5, s[4:7], s97 offen offset:2048 sc1
  buffer_store_dwordx4 v[6:9], v5, s[4:7], s97 offen offset:3072 sc1
  s_mov_b32 s97, 0x7606000
  buffer_store_dwordx4 v[6:9], v5, s[4:7], s97 offen offset:0 sc1
  buffer_store_dwordx4 v[6:9], v5, s[4:7], s97 offen offset:1024 sc1
  buffer_store_dwordx4 v[6:9], v5, s[4:7], s97 offen offset:2048 sc1
  buffer_store_dwordx4 v[6:9], v5, s[4:7], s97 offen offset:3072 sc1
  s_mov_b32 s97, 0x7607000
  buffer_store_dwordx4 v[6:9], v5, s[4:7], s97 offen offset:0 sc1
  buffer_store_dwordx4 v[6:9], v5, s[4:7], s97 offen offset:1024 sc1
  buffer_store_dwordx4 v[6:9], v5, s[4:7], s97 offen offset:2048 sc1
  buffer_store_dwordx4 v[6:9], v5, s[4:7], s97 offen offset:3072 sc1
  s_waitcnt vmcnt(0)
  v_mov_b32 v4, 1
  v_mov_b32 v5, 148
  s_mov_b64 exec, 1
  buffer_store_dword v4, v5, s[8:11], 0 offen sc1
  s_mov_b64 exec, -1
EC_1:
L_tk:
  s_barrier
  v_mov_b32 v3, 163776
  ds_read_b32 v2, v3
  s_waitcnt lgkmcnt(0)
  v_readfirstlane_b32 s96, v2
  s_barrier
  s_cmp_ge_u32 s96, 32
  s_cbranch_scc1 G_entry
L_chain:
  v_lshlrev_b32 v2, 4, v1
  s_and_b32 s12, s96, 7
  s_lshl_b32 s56, s94, 3
  s_add_u32 s56, s56, s12
  s_lshl_b32 s13, s94, 22
  s_add_u32 s13, s13, 0x6000000
  s_cmp_ge_u32 s96, 16
  s_cbranch_scc1 R_entry
  s_cmp_ge_u32 s96, 8
  s_cbranch_scc1 B_entry
A_entry:
  s_and_b32 s34, s95, 1
  s_lshr_b32 s35, s95, 1
  v_and_b32 v13, 2, v1
  v_mov_b32 v3, 0x4444
  v_mov_b32 v14, 0xeeee
  v_cmp_ne_u32 vcc, 0, v13
  s_nop 1
  v_cndmask_b32 v3, v3, v14, vcc
  v_bfe_u32 v13, v1, 2, 3
  v_lshrrev_b32 v14, 5, v1
  v_lshlrev_b32 v14, 4, v14
  v_add_u32 v14, v14, v13
  v_lshlrev_b32 v14, 8, v14
  v_and_b32 v15, 3, v1
  v_lshlrev_b32 v15, 3, v15
  v_add_u32 v14, v14, v15
  s_lshl_b32 s15, s95, 1
  v_xor_b32 v15, s15, v13
  v_lshlrev_b32 v15, 5, v15
  v_add_u32 v4, v14, v15
  s_add_u32 s15, s15, 1
  v_xor_b32 v15, s15, v13
  v_lshlrev_b32 v15, 5, v15
  v_add_u32 v5, v14, v15
  s_lshl_b32 s15, s95, 13
  v_add_u32 v6, s15, v2
  v_add_u32 v7, 65536, v6
  v_add_u32 v8, 98304, v2
  v_and_b32 v13, 15, v1
  v_lshrrev_b32 v14, 4, v1
  v_lshrrev_b32 v15, 2, v13
  v_xor_b32 v15, v15, v14
  v_lshlrev_b32 v15, 3, v15
  v_lshl_add_u32 v9, v13, 5, v15
  s_lshl_b32 s15, s95, 10
  s_add_u32 s15, s15, 147456
  v_add_u32 v9, s15, v9
  v_xor_b32 v15, v1, v14
  v_lshlrev_b32 v10, 3, v15
  v_add_u32 v10, 147456, v10
  v_and_b32 v15, 2, v1
  v_cmp_eq_u32 s[40:41], 0, v15
  v_lshlrev_b32 v15, 2, v14
  v_add_u32 v15, 0, v15
  v_cmp_le_u32 s[42:43], v15, v13
  v_lshlrev_b32 v15, 2, v14
  v_add_u32 v15, 1, v15
  v_cmp_le_u32 s[44:45], v15, v13
  v_lshlrev_b32 v15, 2, v14
  v_add_u32 v15, 2, v15
  v_cmp_le_u32 s[46:47], v15, v13
  v_lshlrev_b32 v15, 2, v14
  v_add_u32 v15, 3, v15
  v_cmp_le_u32 s[48:49], v15, v13
  s_and_b32 s31, s12, 3
  s_lshr_b32 s32, s12, 2
  s_cmp_lg_u32 s95, 0
  s_cbranch_scc1 A_px
  v_bfe_u32 v15, v1, 3, 1
  v_lshlrev_b32 v11, 8, v15
  v_and_b32 v15, 7, v1
  v_lshl_add_u32 v11, v15, 4, v11
  v_lshl_add_u32 v11, v14, 2, v11
  v_bfe_u32 v15, v1, 2, 2
  v_lshlrev_b32 v12, 5, v15
  v_and_b32 v15, 1, v1
  v_lshl_add_u32 v12, v15, 4, v12
  v_lshl_add_u32 v12, v14, 2, v12
  s_lshl_b32 s33, s32, 7
  s_lshl_b32 s15, s31, 8
  s_add_u32 s15, s15, s33
  s_add_u32 s15, s15, 69632
  v_add_u32 v12, s15, v12
  s_lshl_b32 s15, s31, 10
  s_add_u32 s15, s15, s33
  s_add_u32 s15, s15, 65536
  v_add_u32 v11, s15, v11
  s_branch A_p_done
A_px:
  s_sub_u32 s33, s95, 1
  s_and_b32 s33, s33, 1
  s_lshl_b32 s15, s33, 3
  s_add_u32 s15, s15, s12
  s_lshl_b32 s15, s15, 10
  s_add_u32 s15, s15, 131072
  v_add_u32 v11, s15, v2
  s_lshl_b32 s15, s33, 1
  s_add_u32 s15, s15, s32
  s_lshl_b32 s15, s15, 10
  s_lshl_b32 s31, s31, 2
  s_add_u32 s15, s15, s31
  s_add_u32 s15, s15, 147456
  v_add_u32 v12, s15, v2
A_p_done:
  s_mov_b32 s36, 0x3e0293ee
  s_mov_b32 s37, 0xbe0293ee
  v_mov_b32 v88, -1
  v_mov_b32 v89, -1
  v_mov_b32 v90, -1
  v_mov_b32 v91, -1
  s_cmp_eq_u32 s95, 3
  s_cbranch_scc1 A_clr_done
  s_cmp_lg_u32 s95, 0
  s_cbranch_scc1 A_clr_x
  s_add_u32 s31, s13, 0
  buffer_store_dword v88, v11, s[4:7], s31 offen sc1
  buffer_store_dword v89, v11, s[4:7], s31 offen offset:512 sc1
  s_mov_b64 exec, s[40:41]
  buffer_store_dword v88, v12, s[4:7], s31 offen sc1
  s_mov_b64 exec, -1
  s_add_u32 s31, s13, 8192
  buffer_store_dword v88, v11, s[4:7], s31 offen sc1
  buffer_store_dword v89, v11, s[4:7], s31 offen offset:512 sc1
  s_mov_b64 exec, s[40:41]
  buffer_store_dword v88, v12, s[4:7], s31 offen sc1
  s_mov_b64 exec, -1
  s_add_u32 s31, s13, 16384
  buffer_store_dword v88, v11, s[4:7], s31 offen sc1
  buffer_store_dword v89, v11, s[4:7], s31 offen offset:512 sc1
  s_mov_b64 exec, s[40:41]
  buffer_store_dword v88, v12, s[4:7], s31 offen sc1
  s_mov_b64 exec, -1
  s_add_u32 s31, s13, 24576
  buffer_store_dword v88, v11, s[4:7], s31 offen sc1
  buffer_store_dword v89, v11, s[4:7], s31 offen offset:512 sc1
  s_mov_b64 exec, s[40:41]
  buffer_store_dword v88, v12, s[4:7], s31 offen sc1
  s_mov_b64 exec, -1
  s_branch A_clr_done
A_clr_x:
  s_add_u32 s31, s13, 0
  buffer_store_dwordx4 v[88:91], v11, s[4:7], s31 offen sc1
  buffer_store_dword v88, v12, s[4:7], s31 offen sc1
  s_add_u32 s31, s13, 32768
  buffer_store_dwordx4 v[88:91], v11, s[4:7], s31 offen sc1
  buffer_store_dword v88, v12, s[4:7], s31 offen sc1
  s_add_u32 s31, s13, 65536
  buffer_store_dwordx4 v[88:91], v11, s[4:7], s31 offen sc1
  buffer_store_dword v88, v12, s[4:7], s31 offen sc1
  s_add_u32 s31, s13, 98304
  buffer_store_dwordx4 v[88:91], v11, s[4:7], s31 offen sc1
  buffer_store_dword v88, v12, s[4:7], s31 offen sc1
A_clr_done:
  v_lshrrev_b32 v13, 4, v1
  s_lshl_b32 s15, s34, 2
  v_add_u32 v17, s15, v13
  v_bfe_u32 v14, v1, 1, 3
  v_xor_b32 v14, v14, v17
  v_lshlrev_b32 v14, 5, v14
  v_and_b32 v15, 1, v1
  v_lshlrev_b32 v15, 4, v15
  v_add_u32 v18, v14, v15
  v_lshrrev_b32 v13, 2, v17
  v_lshlrev_b32 v13, 3, v13
  v_and_b32 v14, 3, v17
  v_add_u32 v13, v13, v14
  v_lshlrev_b32 v13, 13, v13
  v_add_u32 v16, v13, v18
  s_lshl_b32 s15, s56, 8
  v_add_u32 v16, s15, v16
  s_mov_b32 s20, 0
  s_mov_b32 s21, 32768
  s_mov_b32 s22, 131072
  s_mov_b32 s23, 163840
  s_mov_b32 s24, 262144
  s_mov_b32 s25, 294912
  s_mov_b32 s26, 393216
  s_mov_b32 s27, 425984
  s_mov_b32 s28, 524288
  s_mov_b32 s29, 524288
  s_cmp_eq_u32 s35, 0
  s_cselect_b64 s[16:17], s[68:69], s[70:71]
  s_mov_b32 s18, 0x800000
  s_mov_b32 s19, 0x20000
  s_branch AB_load
A_loaded:
  s_mov_b32 s14, -1
  v_bfe_u32 v13, v1, 2, 2
  v_lshlrev_b32 v4, 6, v13
  v_and_b32 v13, 1, v1
  v_lshl_add_u32 v4, v13, 5, v4
  v_lshrrev_b32 v13, 4, v1
  v_lshl_add_u32 v4, v13, 3, v4
  v_bfe_u32 v13, v1, 1, 1
  v_lshl_add_u32 v4, v13, 2, v4
  s_lshl_b32 s15, s95, 9
  s_add_u32 s15, s15, 153600
  v_add_u32 v4, s15, v4
  v_bfe_u32 v13, v1, 5, 1
  v_lshlrev_b32 v5, 9, v13
  v_bfe_u32 v13, v1, 3, 1
  v_lshl_add_u32 v5, v13, 8, v5
  v_bfe_u32 v13, v1, 4, 1
  v_lshl_add_u32 v5, v13, 7, v5
  v_bfe_u32 v13, v1, 2, 1
  v_lshl_add_u32 v5, v13, 5, v5
  v_and_b32 v13, 3, v1
  v_lshl_add_u32 v5, v13, 3, v5
  v_add_u32 v5, 153600, v5
  v_mov_b64 v[72:73], 0
  ds_write_b64 v9, v[72:73]
  ds_write_b64 v9, v[72:73] offset:512
  s_waitcnt lgkmcnt(0)
  s_add_u32 s15, s92, 0x71fffff
  s_and_b32 s15, s15, 0xffe00000
  s_sub_u32 s52, s15, s92
  s_lshl_b32 s15, s94, 16
  s_add_u32 s52, s52, s15
  s_lshr_b32 s15, s12, 2
  s_lshl_b32 s15, s15, 14
  s_add_u32 s52, s52, s15
  s_and_b32 s15, s12, 3
  s_mul_i32 s15, s15, 2048
  s_add_u32 s52, s52, s15
  v_mov_b32 v15, 151552
  s_cmp_lg_u32 s95, 3
  s_cbranch_scc1 IW_2
  v_mov_b32 v14, 160
W_3:
  buffer_load_dword v13, v14, s[8:11], 0 offen sc1
  s_waitcnt vmcnt(0)
  v_readfirstlane_b32 s97, v13
  s_and_b32 s97, s97, 0xffff
  s_cmp_eq_u32 s97, 0x80
  s_cbranch_scc1 WE_4
  s_add_u32 s101, s101, 1
  s_cmp_gt_u32 s101, 262144
  s_cbranch_scc1 L_abort
  s_sleep 16
  s_branch W_3
WE_4:
  v_mov_b32 v14, 148
W_5:
  buffer_load_dword v13, v14, s[8:11], 0 offen sc1
  s_waitcnt vmcnt(0)
  v_readfirstlane_b32 s97, v13
  s_and_b32 s97, s97, 0x1
  s_cmp_eq_u32 s97, 0x1
  s_cbranch_scc1 WE_6
  s_add_u32 s101, s101, 1
  s_cmp_gt_u32 s101, 262144
  s_cbranch_scc1 L_abort
  s_sleep 16
  s_branch W_5
WE_6:
  v_mov_b32 v14, 164
  buffer_load_dwordx2 v[88:89], v14, s[8:11], 0 offen sc1
  s_waitcnt vmcnt(0)
  ds_write_b64 v15, v[88:89]
  s_waitcnt lgkmcnt(0)
IW_2:
  s_barrier
  ds_read_b64 v[88:89], v15
  s_waitcnt lgkmcnt(0)
  v_readfirstlane_b32 s98, v88
  v_readfirstlane_b32 s97, v89
  s_cmp_lg_u32 s97, 0
  s_cbranch_scc1 A_slow
  s_and_b32 s15, s98, 2
  s_lshl_b32 s15, s15, 12
  s_add_u32 s30, s52, s15
  s_add_u32 s30, s30, 2097152
  s_and_b32 s15, s98, 1
  s_lshl_b32 s15, s15, 13
  s_add_u32 s52, s52, s15
  s_cmp_eq_u32 s95, 1
  s_cbranch_scc1 Af_w1
  s_cmp_eq_u32 s95, 2
  s_cbranch_scc1 Af_w2
  s_cmp_eq_u32 s95, 3
  s_cbranch_scc1 Af_w3
Af_w0:
  ds_read_b128 v[48:51], v6 offset:0
  ds_read_b128 v[52:55], v6 offset:1024
  ds_read_b128 v[56:59], v6 offset:2048
  ds_read_b128 v[60:63], v6 offset:3072
  ds_read_b128 v[64:67], v6 offset:4096
  ds_read_b128 v[68:71], v6 offset:5120
  v_mov_b64 v[72:73], 0
  v_mov_b64 v[74:75], 0
  v_mov_b64 v[76:77], 0
  v_mov_b64 v[78:79], 0
  v_mov_b64 v[80:81], 0
  v_mov_b64 v[82:83], 0
  v_mov_b64 v[84:85], 0
  v_mov_b64 v[86:87], 0
  s_and_b32 s55, s14, 3
  s_lshl_b32 s31, s55, 14
  s_add_u32 s31, s31, s13
  s_add_u32 s15, s31, 8192
  s_add_u32 s31, s31, 0
  s_add_u32 s32, s15, 4096
  s_and_b32 s50, s14, 1
  s_lshl_b32 s50, s50, 14
  v_add_u32 v15, s50, v8
  s_lshl_b32 s54, s55, 13
  s_add_u32 s54, s54, s13
  v_mov_b32 v14, 0xf149f2ca
  v_mov_b64 v[90:91], 0
  v_cndmask_b32 v88, v14, 0, s[40:41]
  v_cndmask_b32 v89, v14, 0, s[40:41]
  s_mov_b32 m0, 98304
  s_waitcnt lgkmcnt(0)
  buffer_load_dwordx4 v[16:19], v2, s[4:7], s15 offen offset:0 sc1
  buffer_load_dwordx4 v[20:23], v2, s[4:7], s32 offen offset:0 sc1
  s_sleep 2
P_7:
  buffer_load_dwordx4 v[16:19], v2, s[4:7], s15 offen offset:0 sc1
  buffer_load_dwordx4 v[20:23], v2, s[4:7], s32 offen offset:0 sc1
  s_add_u32 s101, s101, 1
  s_cmp_gt_u32 s101, 262144
  s_cbranch_scc1 L_abort
  s_waitcnt vmcnt(3)
  v_max3_u32 v13, v16, v17, v18
  v_max_u32 v13, v13, v19
  s_waitcnt vmcnt(2)
  v_max3_u32 v13, v13, v20, v21
  v_max3_u32 v13, v13, v22, v23
  v_cmp_eq_u32 vcc, -1, v13
  s_cbranch_vccnz P_7
  ds_write_b128 v8, v[16:19] offset:8192
  v_smfmac_f32_16x16x64_bf16 v[72:75], v[16:19], a[96:103], v3
  ds_write_b128 v8, v[20:23] offset:12288
  v_smfmac_f32_16x16x64_bf16 v[76:79], v[16:19], a[104:111], v3
  buffer_load_dwordx4 v2, s[4:7], s31 offen offset:0 sc1 lds
  v_smfmac_f32_16x16x64_bf16 v[80:83], v[16:19], a[112:119], v3
  buffer_load_dwordx4 v2, s[4:7], s31 offen offset:1024 sc1 lds
  v_smfmac_f32_16x16x64_bf16 v[84:87], v[16:19], a[120:127], v3
  v_smfmac_f32_16x16x64_bf16 v[72:75], v[20:23], a[224:231], v3
  s_waitcnt lgkmcnt(0)
  s_barrier
  ds_read_b128 v[32:35], v8 offset:9216
  ds_read_b128 v[36:39], v8 offset:13312
  v_smfmac_f32_16x16x64_bf16 v[76:79], v[20:23], a[232:239], v3
  ds_read_b128 v[40:43], v8 offset:10240
  v_smfmac_f32_16x16x64_bf16 v[80:83], v[20:23], a[240:247], v3
  ds_read_b128 v[44:47], v8 offset:11264
  v_smfmac_f32_16x16x64_bf16 v[84:87], v[20:23], a[248:255], v3
  s_waitcnt lgkmcnt(3)
  v_smfmac_f32_16x16x64_bf16 v[72:75], v[32:35], a[128:135], v3
  v_smfmac_f32_16x16x64_bf16 v[76:79], v[32:35], a[136:143], v3
  s_waitcnt lgkmcnt(2)
  v_smfmac_f32_16x16x64_bf16 v[72:75], v[36:39], v[48:55], v3
  ds_read_b128 v[48:51], v6 offset:6144
  v_smfmac_f32_16x16x64_bf16 v[80:83], v[32:35], a[144:151], v3
  ds_read_b128 v[52:55], v6 offset:7168
  v_smfmac_f32_16x16x64_bf16 v[84:87], v[32:35], a[152:159], v3
  ds_read_b128 v[32:35], v8 offset:14336
  v_smfmac_f32_16x16x64_bf16 v[76:79], v[36:39], v[56:63], v3
  ds_read_b128 v[56:59], v6 offset:32768
  s_waitcnt lgkmcnt(5)
  v_smfmac_f32_16x16x64_bf16 v[72:75], v[40:43], a[160:167], v3
  ds_read_b128 v[60:63], v6 offset:33792
  v_smfmac_f32_16x16x64_bf16 v[76:79], v[40:43], a[168:175], v3
  v_smfmac_f32_16x16x64_bf16 v[80:83], v[36:39], v[64:71], v3
  ds_read_b128 v[64:67], v6 offset:34816
  v_smfmac_f32_16x16x64_bf16 v[80:83], v[40:43], a[176:183], v3
  ds_read_b128 v[68:71], v6 offset:35840
  v_smfmac_f32_16x16x64_bf16 v[84:87], v[40:43], a[184:191], v3
  ds_read_b128 v[40:43], v8 offset:15360
  s_waitcnt lgkmcnt(6)
  v_smfmac_f32_16x16x64_bf16 v[84:87], v[36:39], v[48:55], v3
  ds_read_b128 v[48:51], v6 offset:36864
  s_waitcnt vmcnt(0)
  ds_read_b128 v[24:27], v8 offset:0
  ds_read_b128 v[28:31], v8 offset:1024
  v_smfmac_f32_16x16x64_bf16 v[72:75], v[44:47], a[192:199], v3
  ds_read_b128 v[52:55], v6 offset:37888
  v_smfmac_f32_16x16x64_bf16 v[76:79], v[44:47], a[200:207], v3
  s_waitcnt lgkmcnt(9)
  s_waitcnt lgkmcnt(7)
  v_smfmac_f32_16x16x64_bf16 v[72:75], v[32:35], v[56:63], v3
  ds_read_b128 v[56:59], v6 offset:38912
  v_smfmac_f32_16x16x64_bf16 v[80:83], v[44:47], a[208:215], v3
  ds_read_b128 v[60:63], v6 offset:39936
  s_waitcnt lgkmcnt(3)
  v_max3_u32 v13, v24, v25, v26
  v_max3_u32 v14, v27, v28, v29
  v_max3_u32 v14, v14, v30, v31
  v_max_u32 v13, v13, v14
  v_cmp_eq_u32 vcc, -1, v13
  s_cbranch_vccz F2O_8
F2R_9:
  buffer_load_dwordx4 v2, s[4:7], s31 offen offset:0 sc1 lds
  buffer_load_dwordx4 v2, s[4:7], s31 offen offset:1024 sc1 lds
  s_add_u32 s101, s101, 1
  s_cmp_gt_u32 s101, 262144
  s_cbranch_scc1 L_abort
  s_waitcnt vmcnt(0)
  ds_read_b128 v[24:27], v8 offset:0
  ds_read_b128 v[28:31], v8 offset:1024
  s_waitcnt lgkmcnt(0)
  v_max3_u32 v13, v24, v25, v26
  v_max3_u32 v14, v27, v28, v29
  v_max3_u32 v14, v14, v30, v31
  v_max_u32 v13, v13, v14
  v_cmp_eq_u32 vcc, -1, v13
  s_cbranch_vccnz F2R_9
F2O_8:
  s_barrier
  ds_read_b128 v[36:39], v8 offset:2048
  v_smfmac_f32_16x16x64_bf16 v[84:87], v[44:47], a[216:223], v3
  ds_read_b128 v[16:19], v8 offset:3072
  v_smfmac_f32_16x16x64_bf16 v[76:79], v[32:35], v[64:71], v3
  ds_read_b128 v[64:67], v7 offset:0
  v_smfmac_f32_16x16x64_bf16 v[72:75], v[24:27], v[96:103], v3
  ds_read_b128 v[68:71], v7 offset:1024
  v_smfmac_f32_16x16x64_bf16 v[76:79], v[24:27], v[104:111], v3
  s_waitcnt lgkmcnt(6)
  v_smfmac_f32_16x16x64_bf16 v[80:83], v[32:35], v[48:55], v3
  ds_read_b128 v[48:51], v7 offset:2048
  v_smfmac_f32_16x16x64_bf16 v[80:83], v[24:27], v[112:119], v3
  ds_read_b128 v[52:55], v7 offset:3072
  v_smfmac_f32_16x16x64_bf16 v[84:87], v[24:27], v[120:127], v3
  ds_read_b128 v[24:27], v8 offset:4096
  s_waitcnt lgkmcnt(7)
  v_smfmac_f32_16x16x64_bf16 v[84:87], v[32:35], v[56:63], v3
  ds_read_b128 v[56:59], v7 offset:4096
  v_smfmac_f32_16x16x64_bf16 v[72:75], v[28:31], v[128:135], v3
  ds_read_b128 v[60:63], v7 offset:5120
  v_smfmac_f32_16x16x64_bf16 v[76:79], v[28:31], v[136:143], v3
  ds_read_b128 v[32:35], v8 offset:5120
  s_waitcnt lgkmcnt(6)
  v_smfmac_f32_16x16x64_bf16 v[72:75], v[40:43], v[64:71], v3
  ds_read_b128 v[64:67], v7 offset:6144
  v_smfmac_f32_16x16x64_bf16 v[80:83], v[28:31], v[144:151], v3
  ds_read_b128 v[68:71], v7 offset:7168
  v_smfmac_f32_16x16x64_bf16 v[84:87], v[28:31], v[152:159], v3
  ds_read_b128 v[28:31], v8 offset:6144
  s_waitcnt lgkmcnt(7)
  v_smfmac_f32_16x16x64_bf16 v[76:79], v[40:43], v[48:55], v3
  ds_read_b128 v[48:51], v15 offset:16384
  v_smfmac_f32_16x16x64_bf16 v[72:75], v[36:39], v[160:167], v3
  ds_read_b128 v[52:55], v15 offset:17408
  v_smfmac_f32_16x16x64_bf16 v[76:79], v[36:39], v[168:175], v3
  s_waitcnt lgkmcnt(6)
  v_smfmac_f32_16x16x64_bf16 v[80:83], v[40:43], v[56:63], v3
  ds_read_b128 v[56:59], v15 offset:20480
  v_smfmac_f32_16x16x64_bf16 v[80:83], v[36:39], v[176:183], v3
  ds_read_b128 v[60:63], v15 offset:21504
  v_smfmac_f32_16x16x64_bf16 v[84:87], v[36:39], v[184:191], v3
  ds_read_b128 v[36:39], v8 offset:7168
  s_waitcnt lgkmcnt(6)
  v_smfmac_f32_16x16x64_bf16 v[84:87], v[40:43], v[64:71], v3
  ds_read_b128 v[40:43], v15 offset:18432
  v_smfmac_f32_16x16x64_bf16 v[72:75], v[16:19], v[192:199], v3
  ds_read_b128 v[44:47], v15 offset:19456
  v_smfmac_f32_16x16x64_bf16 v[76:79], v[16:19], v[200:207], v3
  v_smfmac_f32_16x16x64_bf16 v[80:83], v[16:19], v[208:215], v3
  v_smfmac_f32_16x16x64_bf16 v[84:87], v[16:19], v[216:223], v3
  ds_read_b128 v[16:19], v15 offset:22528
  v_smfmac_f32_16x16x64_bf16 v[72:75], v[24:27], v[224:231], v3
  ds_read_b128 v[20:23], v15 offset:23552
  v_smfmac_f32_16x16x64_bf16 v[76:79], v[24:27], v[232:239], v3
  v_smfmac_f32_16x16x64_bf16 v[72:75], v[32:35], a[0:7], v3
  v_smfmac_f32_16x16x64_bf16 v[76:79], v[32:35], a[8:15], v3
  s_waitcnt lgkmcnt(9)
  v_smfmac_f32_16x16x64_bf16 v[72:75], v[28:31], a[32:39], v3
  v_smfmac_f32_16x16x64_bf16 v[76:79], v[28:31], a[40:47], v3
  s_waitcnt lgkmcnt(4)
  v_smfmac_f32_16x16x64_bf16 v[72:75], v[36:39], a[64:71], v3
  v_smfmac_f32_16x16x64_bf16 v[76:79], v[36:39], a[72:79], v3
  v_smfmac_f32_16x16x64_bf16 v[80:83], v[24:27], v[240:247], v3
  v_smfmac_f32_16x16x64_bf16 v[84:87], v[24:27], v[248:255], v3
  v_smfmac_f32_16x16x64_bf16 v[80:83], v[32:35], a[16:23], v3
  s_nop 4
  v_add_f32 v72, v72, v74
  v_add_f32 v73, v73, v75
  v_add_f32 v76, v76, v78
  v_add_f32 v77, v77, v79
  v_cvt_pk_bf16_f32 v72, v72, v73
  v_cvt_pk_bf16_f32 v76, v76, v77
  ds_write2_b32 v4, v72, v76 offset0:0 offset1:64
  v_smfmac_f32_16x16x64_bf16 v[84:87], v[32:35], a[24:31], v3
  v_smfmac_f32_16x16x64_bf16 v[80:83], v[28:31], a[48:55], v3
  v_smfmac_f32_16x16x64_bf16 v[84:87], v[28:31], a[56:63], v3
  v_smfmac_f32_16x16x64_bf16 v[80:83], v[36:39], a[80:87], v3
  v_smfmac_f32_16x16x64_bf16 v[84:87], v[36:39], a[88:95], v3
  s_waitcnt lgkmcnt(0)
  s_barrier
  ds_read_b64_tr_b16 v[72:73], v5 offset:0
  ds_read_b64_tr_b16 v[74:75], v5 offset:64
  ds_read_b64_tr_b16 v[76:77], v5 offset:1024
  ds_read_b64_tr_b16 v[78:79], v5 offset:1088
  s_nop 0
  v_pk_add_f32 v[80:81], v[80:81], v[82:83]
  v_pk_add_f32 v[84:85], v[84:85], v[86:87]
  v_cvt_pk_bf16_f32 v80, v80, v81
  v_cvt_pk_bf16_f32 v84, v84, v85
  ds_write2_b32 v9, v80, v84 offset0:0 offset1:128
  v_mov_b64 v[64:65], 0
  v_mov_b64 v[66:67], 0
  v_mov_b64 v[68:69], 0
  v_mov_b64 v[70:71], 0
  s_nop 0
  s_waitcnt lgkmcnt(1)
  v_smfmac_f32_16x16x64_bf16 v[64:67], v[72:75], v[48:55], v3
  v_smfmac_f32_16x16x64_bf16 v[68:71], v[72:75], v[56:63], v3
  v_smfmac_f32_16x16x64_bf16 v[64:67], v[76:79], v[40:47], v3
  v_smfmac_f32_16x16x64_bf16 v[68:71], v[76:79], v[16:23], v3
  s_waitcnt lgkmcnt(0)
  s_barrier
Af_w0_att:
  ds_read_b64_tr_b16 v[24:25], v10 offset:0
  ds_read_b64_tr_b16 v[26:27], v10 offset:512
  ds_read_b64_tr_b16 v[28:29], v10 offset:1024
  ds_read_b64_tr_b16 v[30:31], v10 offset:1536
  ds_read_b64_tr_b16 v[32:33], v10 offset:2048
  ds_read_b64_tr_b16 v[34:35], v10 offset:2560
  ds_read_b64_tr_b16 v[36:37], v10 offset:3072
  ds_read_b64_tr_b16 v[38:39], v10 offset:3584
  v_pk_add_f32 v[64:65], v[64:65], v[66:67]
  v_pk_add_f32 v[68:69], v[68:69], v[70:71]
  s_waitcnt lgkmcnt(4)
  v_smfmac_f32_16x16x64_bf16 v[88:91], v[72:75], v[24:31], v3
  s_waitcnt lgkmcnt(0)
  v_smfmac_f32_16x16x64_bf16 v[88:91], v[76:79], v[32:39], v3
  s_nop 7
  v_pk_add_f32 v[88:89], v[88:89], v[90:91]
  v_max3_f32 v92, v64, v68, v88
  v_max3_f32 v93, v65, v69, v89
  s_nop 0
  v_max_f32_dpp v92, v92, v92 row_ror:8 row_mask:0xf bank_mask:0xf
  v_max_f32_dpp v93, v93, v93 row_ror:8 row_mask:0xf bank_mask:0xf
  s_nop 0
  v_max_f32_dpp v92, v92, v92 row_ror:4 row_mask:0xf bank_mask:0xf
  v_max_f32_dpp v93, v93, v93 row_ror:4 row_mask:0xf bank_mask:0xf
  s_nop 0
  v_max_f32_dpp v92, v92, v92 row_ror:2 row_mask:0xf bank_mask:0xf
  v_max_f32_dpp v93, v93, v93 row_ror:2 row_mask:0xf bank_mask:0xf
  s_nop 0
  v_max_f32_dpp v92, v92, v92 row_ror:1 row_mask:0xf bank_mask:0xf
  v_max_f32_dpp v93, v93, v93 row_ror:1 row_mask:0xf bank_mask:0xf
  v_pk_mul_f32 v[92:93], v[92:93], s[36:37] op_sel:[0,1]
  v_pk_fma_f32 v[64:65], v[64:65], s[36:37], v[92:93] op_sel_hi:[1,0,1]
  v_pk_fma_f32 v[68:69], v[68:69], s[36:37], v[92:93] op_sel_hi:[1,0,1]
  v_pk_fma_f32 v[88:89], v[88:89], s[36:37], v[92:93] op_sel_hi:[1,0,1]
  v_exp_f32 v64, v64
  v_exp_f32 v65, v65
  v_exp_f32 v68, v68
  v_exp_f32 v69, v69
  v_exp_f32 v88, v88
  v_exp_f32 v89, v89
  v_pk_add_f32 v[92:93], v[64:65], v[68:69]
  v_pk_add_f32 v[92:93], v[92:93], v[88:89]
  s_nop 0
  s_nop 0
  v_add_f32_dpp v92, v92, v92 row_ror:8 row_mask:0xf bank_mask:0xf
  v_add_f32_dpp v93, v93, v93 row_ror:8 row_mask:0xf bank_mask:0xf
  s_nop 0
  v_add_f32_dpp v92, v92, v92 row_ror:4 row_mask:0xf bank_mask:0xf
  v_add_f32_dpp v93, v93, v93 row_ror:4 row_mask:0xf bank_mask:0xf
  s_nop 0
  v_add_f32_dpp v92, v92, v92 row_ror:2 row_mask:0xf bank_mask:0xf
  v_add_f32_dpp v93, v93, v93 row_ror:2 row_mask:0xf bank_mask:0xf
  s_nop 0
  v_add_f32_dpp v92, v92, v92 row_ror:1 row_mask:0xf bank_mask:0xf
  v_add_f32_dpp v93, v93, v93 row_ror:1 row_mask:0xf bank_mask:0xf
  v_rcp_f32 v92, v92
  v_rcp_f32 v93, v93
  s_nop 0
  v_pk_mul_f32 v[64:65], v[64:65], v[92:93]
  v_pk_mul_f32 v[68:69], v[68:69], v[92:93]
  v_pk_mul_f32 v[88:89], v[88:89], v[92:93]
  v_cvt_pk_bf16_f32 v24, v64, v65
  v_cvt_pk_bf16_f32 v25, v68, v69
  v_cvt_pk_bf16_f32 v26, v88, v89
  buffer_store_dword v24, v11, s[4:7], s54 offen
  buffer_store_dword v25, v11, s[4:7], s54 offen offset:512
  s_mov_b64 exec, s[40:41]
  buffer_store_dword v26, v12, s[4:7], s54 offen
  s_mov_b64 exec, -1
  s_barrier
  v_mov_b64 v[32:33], -1
  s_xor_b32 s54, s54, 16384
  s_mov_b32 s100, 7
SL_10:
  s_sleep 1
  s_sub_u32 s100, s100, 1
  s_cmp_lg_u32 s100, 0
  s_cbranch_scc1 SL_10
  buffer_store_dword v32, v11, s[4:7], s54 offen
  buffer_store_dword v33, v11, s[4:7], s54 offen offset:512
  s_mov_b64 exec, s[40:41]
  buffer_store_dword v32, v12, s[4:7], s54 offen
  s_mov_b64 exec, -1
  v_mov_b64 v[72:73], -1
  v_mov_b64 v[74:75], -1
  s_xor_b32 s31, s55, 2
  s_lshl_b32 s31, s31, 19
  s_add_u32 s15, s31, s52
  buffer_store_dwordx4 v[72:75], v2, s[4:7], s15 offen offset:0 sc1
  buffer_store_dwordx4 v[72:75], v2, s[4:7], s15 offen offset:1024 sc1
  s_nop 1
  s_add_u32 s14, s14, 1
  s_cmp_eq_u32 s14, 0
  s_cbranch_scc1 Af_w0_z
  s_mov_b32 s100, 13
SL_11:
  s_sleep 1
  s_sub_u32 s100, s100, 1
  s_cmp_lg_u32 s100, 0
  s_cbranch_scc1 SL_11
  s_cmp_lt_i32 s14, 64
  s_cbranch_scc1 Af_w0
  s_branch L_end
Af_w0_z:
  s_mov_b32 s55, 0
  s_and_b32 s50, s14, 1
  s_lshl_b32 s50, s50, 14
  v_add_u32 v15, s50, v8
  s_lshl_b32 s54, s55, 13
  s_add_u32 s54, s54, s13
  v_mov_b32 v14, 0xf149f2ca
  v_mov_b64 v[90:91], 0
  v_cndmask_b32 v88, v14, 0, s[40:41]
  v_cndmask_b32 v89, v14, 0, s[40:41]
  s_waitcnt vmcnt(0)
  s_barrier
  ds_read_b128 v[48:51], v15 offset:16384
  ds_read_b128 v[52:55], v15 offset:17408
  ds_read_b128 v[56:59], v15 offset:20480
  ds_read_b128 v[60:63], v15 offset:21504
  ds_read_b128 v[40:43], v15 offset:18432
  ds_read_b128 v[44:47], v15 offset:19456
  ds_read_b128 v[16:19], v15 offset:22528
  ds_read_b128 v[20:23], v15 offset:23552
  v_mov_b64 v[64:65], 0
  v_mov_b64 v[66:67], 0
  v_mov_b64 v[68:69], 0
  v_mov_b64 v[70:71], 0
  ds_read_b64_tr_b16 v[72:73], v5 offset:0
  ds_read_b64_tr_b16 v[74:75], v5 offset:64
  ds_read_b64_tr_b16 v[76:77], v5 offset:1024
  ds_read_b64_tr_b16 v[78:79], v5 offset:1088
  s_waitcnt lgkmcnt(0)
  v_smfmac_f32_16x16x64_bf16 v[64:67], v[72:75], v[48:55], v3
  v_smfmac_f32_16x16x64_bf16 v[68:71], v[72:75], v[56:63], v3
  v_smfmac_f32_16x16x64_bf16 v[64:67], v[76:79], v[40:47], v3
  v_smfmac_f32_16x16x64_bf16 v[68:71], v[76:79], v[16:23], v3
  s_waitcnt lgkmcnt(0)
  s_branch Af_w0_att
Af_w1:
  ds_read_b128 v[48:51], v6 offset:0
  ds_read_b128 v[52:55], v6 offset:1024
  ds_read_b128 v[56:59], v6 offset:2048
  ds_read_b128 v[60:63], v6 offset:3072
  ds_read_b128 v[64:67], v6 offset:4096
  ds_read_b128 v[68:71], v6 offset:5120
  v_mov_b64 v[72:73], 0
  v_mov_b64 v[74:75], 0
  v_mov_b64 v[76:77], 0
  v_mov_b64 v[78:79], 0
  v_mov_b64 v[80:81], 0
  v_mov_b64 v[82:83], 0
  v_mov_b64 v[84:85], 0
  v_mov_b64 v[86:87], 0
  s_and_b32 s55, s14, 3
  s_lshl_b32 s31, s55, 14
  s_add_u32 s31, s31, s13
  s_add_u32 s15, s31, 9216
  s_add_u32 s31, s31, 2048
  s_add_u32 s32, s15, 4096
  s_and_b32 s50, s14, 1
  s_lshl_b32 s50, s50, 14
  v_add_u32 v15, s50, v8
  s_lshl_b32 s54, s55, 15
  s_add_u32 s54, s54, s13
  s_mov_b32 m0, 100352
  s_waitcnt lgkmcnt(0)
  buffer_load_dwordx4 v[16:19], v2, s[4:7], s15 offen offset:0 sc1
  buffer_load_dwordx4 v[20:23], v2, s[4:7], s32 offen offset:0 sc1
  s_sleep 2
P_12:
  buffer_load_dwordx4 v[16:19], v2, s[4:7], s15 offen offset:0 sc1
  buffer_load_dwordx4 v[20:23], v2, s[4:7], s32 offen offset:0 sc1
  s_add_u32 s101, s101, 1
  s_cmp_gt_u32 s101, 262144
  s_cbranch_scc1 L_abort
  s_waitcnt vmcnt(3)
  v_max3_u32 v13, v16, v17, v18
  v_max_u32 v13, v13, v19
  s_waitcnt vmcnt(2)
  v_max3_u32 v13, v13, v20, v21
  v_max3_u32 v13, v13, v22, v23
  v_cmp_eq_u32 vcc, -1, v13
  s_cbranch_vccnz P_12
  ds_write_b128 v8, v[16:19] offset:9216
  v_smfmac_f32_16x16x64_bf16 v[72:75], v[16:19], a[128:135], v3
  ds_write_b128 v8, v[20:23] offset:13312
  v_smfmac_f32_16x16x64_bf16 v[76:79], v[16:19], a[136:143], v3
  buffer_load_dwordx4 v2, s[4:7], s31 offen offset:0 sc1 lds
  v_smfmac_f32_16x16x64_bf16 v[72:75], v[20:23], v[48:55], v3
  ds_read_b128 v[48:51], v6 offset:6144
  buffer_load_dwordx4 v2, s[4:7], s31 offen offset:1024 sc1 lds
  v_smfmac_f32_16x16x64_bf16 v[80:83], v[16:19], a[144:151], v3
  ds_read_b128 v[52:55], v6 offset:7168
  v_smfmac_f32_16x16x64_bf16 v[84:87], v[16:19], a[152:159], v3
  s_waitcnt lgkmcnt(2)
  s_barrier
  ds_read_b128 v[32:35], v8 offset:8192
  ds_read_b128 v[36:39], v8 offset:10240
  v_smfmac_f32_16x16x64_bf16 v[76:79], v[20:23], v[56:63], v3
  ds_read_b128 v[40:43], v8 offset:14336
  s_waitcnt lgkmcnt(2)
  v_smfmac_f32_16x16x64_bf16 v[72:75], v[32:35], a[96:103], v3
  ds_read_b128 v[56:59], v6 offset:32768
  v_smfmac_f32_16x16x64_bf16 v[76:79], v[32:35], a[104:111], v3
  ds_read_b128 v[60:63], v6 offset:33792
  v_smfmac_f32_16x16x64_bf16 v[80:83], v[20:23], v[64:71], v3
  ds_read_b128 v[64:67], v6 offset:34816
  v_smfmac_f32_16x16x64_bf16 v[80:83], v[32:35], a[112:119], v3
  ds_read_b128 v[68:71], v6 offset:35840
  v_smfmac_f32_16x16x64_bf16 v[84:87], v[32:35], a[120:127], v3
  ds_read_b128 v[44:47], v8 offset:11264
  v_smfmac_f32_16x16x64_bf16 v[84:87], v[20:23], v[48:55], v3
  ds_read_b128 v[48:51], v6 offset:36864
  s_waitcnt lgkmcnt(7)
  v_smfmac_f32_16x16x64_bf16 v[72:75], v[36:39], a[160:167], v3
  ds_read_b128 v[52:55], v6 offset:37888
  v_smfmac_f32_16x16x64_bf16 v[76:79], v[36:39], a[168:175], v3
  ds_read_b128 v[32:35], v8 offset:12288
  s_waitcnt lgkmcnt(8)
  s_waitcnt lgkmcnt(6)
  v_smfmac_f32_16x16x64_bf16 v[72:75], v[40:43], v[56:63], v3
  ds_read_b128 v[56:59], v6 offset:38912
  v_smfmac_f32_16x16x64_bf16 v[80:83], v[36:39], a[176:183], v3
  ds_read_b128 v[60:63], v6 offset:39936
  v_smfmac_f32_16x16x64_bf16 v[84:87], v[36:39], a[184:191], v3
  ds_read_b128 v[36:39], v8 offset:15360
  s_waitcnt lgkmcnt(7)
  v_smfmac_f32_16x16x64_bf16 v[76:79], v[40:43], v[64:71], v3
  ds_read_b128 v[64:67], v7 offset:0
  s_waitcnt lgkmcnt(7)
  v_smfmac_f32_16x16x64_bf16 v[72:75], v[44:47], a[192:199], v3
  ds_read_b128 v[68:71], v7 offset:1024
  v_smfmac_f32_16x16x64_bf16 v[76:79], v[44:47], a[200:207], v3
  s_waitcnt vmcnt(0)
  ds_read_b128 v[24:27], v8 offset:2048
  ds_read_b128 v[28:31], v8 offset:3072
  s_waitcnt lgkmcnt(8)
  v_smfmac_f32_16x16x64_bf16 v[80:83], v[40:43], v[48:55], v3
  ds_read_b128 v[48:51], v7 offset:2048
  v_smfmac_f32_16x16x64_bf16 v[80:83], v[44:47], a[208:215], v3
  ds_read_b128 v[52:55], v7 offset:3072
  v_smfmac_f32_16x16x64_bf16 v[84:87], v[44:47], a[216:223], v3
  s_waitcnt lgkmcnt(7)
  v_smfmac_f32_16x16x64_bf16 v[84:87], v[40:43], v[56:63], v3
  ds_read_b128 v[56:59], v7 offset:4096
  s_waitcnt lgkmcnt(3)
  v_max3_u32 v13, v24, v25, v26
  v_max3_u32 v14, v27, v28, v29
  v_max3_u32 v14, v14, v30, v31
  v_max_u32 v13, v13, v14
  v_cmp_eq_u32 vcc, -1, v13
  s_cbranch_vccz F2O_13
F2R_14:
  buffer_load_dwordx4 v2, s[4:7], s31 offen offset:0 sc1 lds
  buffer_load_dwordx4 v2, s[4:7], s31 offen offset:1024 sc1 lds
  s_add_u32 s101, s101, 1
  s_cmp_gt_u32 s101, 262144
  s_cbranch_scc1 L_abort
  s_waitcnt vmcnt(0)
  ds_read_b128 v[24:27], v8 offset:2048
  ds_read_b128 v[28:31], v8 offset:3072
  s_waitcnt lgkmcnt(0)
  v_max3_u32 v13, v24, v25, v26
  v_max3_u32 v14, v27, v28, v29
  v_max3_u32 v14, v14, v30, v31
  v_max_u32 v13, v13, v14
  v_cmp_eq_u32 vcc, -1, v13
  s_cbranch_vccnz F2R_14
F2O_13:
  s_barrier
  ds_read_b128 v[60:63], v7 offset:5120
  v_smfmac_f32_16x16x64_bf16 v[72:75], v[32:35], a[224:231], v3
  ds_read_b128 v[16:19], v8 offset:0
  v_smfmac_f32_16x16x64_bf16 v[76:79], v[32:35], a[232:239], v3
  ds_read_b128 v[20:23], v8 offset:1024
  v_smfmac_f32_16x16x64_bf16 v[72:75], v[36:39], v[64:71], v3
  ds_read_b128 v[64:67], v7 offset:6144
  v_smfmac_f32_16x16x64_bf16 v[80:83], v[32:35], a[240:247], v3
  ds_read_b128 v[68:71], v7 offset:7168
  v_smfmac_f32_16x16x64_bf16 v[84:87], v[32:35], a[248:255], v3
  ds_read_b128 v[44:47], v8 offset:4096
  s_waitcnt lgkmcnt(7)
  v_smfmac_f32_16x16x64_bf16 v[76:79], v[36:39], v[48:55], v3
  ds_read_b128 v[40:43], v8 offset:5120
  v_smfmac_f32_16x16x64_bf16 v[72:75], v[24:27], v[160:167], v3
  ds_read_b128 v[32:35], v8 offset:6144
  v_smfmac_f32_16x16x64_bf16 v[76:79], v[24:27], v[168:175], v3
  ds_read_b128 v[48:51], v15 offset:16384
  s_waitcnt lgkmcnt(8)
  v_smfmac_f32_16x16x64_bf16 v[80:83], v[36:39], v[56:63], v3
  ds_read_b128 v[52:55], v15 offset:17408
  v_smfmac_f32_16x16x64_bf16 v[80:83], v[24:27], v[176:183], v3
  ds_read_b128 v[56:59], v15 offset:20480
  v_smfmac_f32_16x16x64_bf16 v[84:87], v[24:27], v[184:191], v3
  ds_read_b128 v[60:63], v15 offset:21504
  s_waitcnt lgkmcnt(7)
  v_smfmac_f32_16x16x64_bf16 v[84:87], v[36:39], v[64:71], v3
  ds_read_b128 v[36:39], v8 offset:7168
  v_smfmac_f32_16x16x64_bf16 v[72:75], v[28:31], v[192:199], v3
  v_smfmac_f32_16x16x64_bf16 v[76:79], v[28:31], v[200:207], v3
  v_smfmac_f32_16x16x64_bf16 v[80:83], v[28:31], v[208:215], v3
  v_smfmac_f32_16x16x64_bf16 v[84:87], v[28:31], v[216:223], v3
  ds_read_b128 v[24:27], v15 offset:18432
  v_smfmac_f32_16x16x64_bf16 v[72:75], v[16:19], v[96:103], v3
  ds_read_b128 v[28:31], v15 offset:19456
  v_smfmac_f32_16x16x64_bf16 v[76:79], v[16:19], v[104:111], v3
  v_smfmac_f32_16x16x64_bf16 v[80:83], v[16:19], v[112:119], v3
  v_smfmac_f32_16x16x64_bf16 v[84:87], v[16:19], v[120:127], v3
  v_smfmac_f32_16x16x64_bf16 v[72:75], v[20:23], v[128:135], v3
  v_smfmac_f32_16x16x64_bf16 v[76:79], v[20:23], v[136:143], v3
  v_smfmac_f32_16x16x64_bf16 v[80:83], v[20:23], v[144:151], v3
  v_smfmac_f32_16x16x64_bf16 v[84:87], v[20:23], v[152:159], v3
  ds_read_b128 v[16:19], v15 offset:22528
  s_waitcnt lgkmcnt(10)
  v_smfmac_f32_16x16x64_bf16 v[72:75], v[44:47], v[224:231], v3
  ds_read_b128 v[20:23], v15 offset:23552
  v_smfmac_f32_16x16x64_bf16 v[76:79], v[44:47], v[232:239], v3
  s_waitcnt lgkmcnt(10)
  v_smfmac_f32_16x16x64_bf16 v[72:75], v[40:43], a[0:7], v3
  v_smfmac_f32_16x16x64_bf16 v[76:79], v[40:43], a[8:15], v3
  s_waitcnt lgkmcnt(9)
  v_smfmac_f32_16x16x64_bf16 v[72:75], v[32:35], a[32:39], v3
  v_smfmac_f32_16x16x64_bf16 v[76:79], v[32:35], a[40:47], v3
  s_waitcnt lgkmcnt(4)
  v_smfmac_f32_16x16x64_bf16 v[72:75], v[36:39], a[64:71], v3
  v_smfmac_f32_16x16x64_bf16 v[76:79], v[36:39], a[72:79], v3
  v_smfmac_f32_16x16x64_bf16 v[80:83], v[44:47], v[240:247], v3
  v_smfmac_f32_16x16x64_bf16 v[84:87], v[44:47], v[248:255], v3
  v_smfmac_f32_16x16x64_bf16 v[80:83], v[40:43], a[16:23], v3
  s_nop 4
  v_add_f32 v72, v72, v74
  v_add_f32 v73, v73, v75
  v_add_f32 v76, v76, v78
  v_add_f32 v77, v77, v79
  v_cvt_pk_bf16_f32 v72, v72, v73
  v_cvt_pk_bf16_f32 v76, v76, v77
  ds_write2_b32 v4, v72, v76 offset0:0 offset1:64
  v_smfmac_f32_16x16x64_bf16 v[84:87], v[40:43], a[24:31], v3
  v_smfmac_f32_16x16x64_bf16 v[80:83], v[32:35], a[48:55], v3
  v_smfmac_f32_16x16x64_bf16 v[84:87], v[32:35], a[56:63], v3
  v_smfmac_f32_16x16x64_bf16 v[80:83], v[36:39], a[80:87], v3
  v_smfmac_f32_16x16x64_bf16 v[84:87], v[36:39], a[88:95], v3
  s_waitcnt lgkmcnt(0)
  s_barrier
  s_nop 4
  v_pk_add_f32 v[80:81], v[80:81], v[82:83]
  v_pk_add_f32 v[84:85], v[84:85], v[86:87]
  v_cvt_pk_bf16_f32 v80, v80, v81
  v_cvt_pk_bf16_f32 v84, v84, v85
  ds_write2_b32 v9, v80, v84 offset0:0 offset1:128
  s_waitcnt lgkmcnt(0)
  s_barrier
Af_w1_att:
  ds_read_b64_tr_b16 v[32:33], v10 offset:0
  ds_read_b64_tr_b16 v[34:35], v10 offset:512
  ds_read_b64_tr_b16 v[36:37], v10 offset:1024
  ds_read_b64_tr_b16 v[38:39], v10 offset:1536
  ds_read_b64_tr_b16 v[40:41], v10 offset:2048
  ds_read_b64_tr_b16 v[42:43], v10 offset:2560
  ds_read_b64_tr_b16 v[44:45], v10 offset:3072
  ds_read_b64_tr_b16 v[46:47], v10 offset:3584
  ds_read_b128 v[72:75], v15 offset:24576
  ds_read_b128 v[76:79], v15 offset:25600
  ds_read_b128 v[80:83], v15 offset:26624
  ds_read_b128 v[84:87], v15 offset:27648
  v_mov_b32 v14, 0xf149f2ca
  v_cndmask_b32 v64, v14, 0, s[42:43]
  v_cndmask_b32 v65, v14, 0, s[44:45]
  v_cndmask_b32 v66, v14, 0, s[46:47]
  v_cndmask_b32 v67, v14, 0, s[48:49]
  s_nop 1
  s_waitcnt lgkmcnt(10)
  s_waitcnt lgkmcnt(3)
  v_mfma_f32_16x16x32_bf16 v[64:67], v[48:51], v[72:75], v[64:67]
  v_mfma_f32_16x16x32_bf16 v[88:91], v[32:35], v[72:75], 0
  s_waitcnt lgkmcnt(2)
  v_mfma_f32_16x16x32_bf16 v[64:67], v[52:55], v[76:79], v[64:67]
  v_mfma_f32_16x16x32_bf16 v[88:91], v[36:39], v[76:79], v[88:91]
  s_waitcnt lgkmcnt(1)
  v_mfma_f32_16x16x32_bf16 v[64:67], v[24:27], v[80:83], v[64:67]
  v_mfma_f32_16x16x32_bf16 v[88:91], v[40:43], v[80:83], v[88:91]
  s_waitcnt lgkmcnt(0)
  v_mfma_f32_16x16x32_bf16 v[64:67], v[28:31], v[84:87], v[64:67]
  v_mfma_f32_16x16x32_bf16 v[88:91], v[44:47], v[84:87], v[88:91]
  s_nop 6
  v_max3_f32 v92, v64, v65, v66
  v_max3_f32 v93, v67, v88, v89
  v_max_f32 v92, v92, v93
  v_mov_b32 v93, v92
  s_nop 1
  v_permlane32_swap_b32 v92, v93
  v_max_f32 v92, v92, v93
  v_mov_b32 v93, v92
  s_nop 1
  v_permlane16_swap_b32 v92, v93
  v_max_f32 v92, v92, v93
  v_mul_f32 v92, s37, v92
  v_pk_fma_f32 v[64:65], v[64:65], s[36:37], v[92:93] op_sel_hi:[1,0,0]
  v_pk_fma_f32 v[66:67], v[66:67], s[36:37], v[92:93] op_sel_hi:[1,0,0]
  v_pk_fma_f32 v[88:89], v[88:89], s[36:37], v[92:93] op_sel_hi:[1,0,0]
  v_exp_f32 v64, v64
  v_exp_f32 v65, v65
  v_exp_f32 v66, v66
  v_exp_f32 v67, v67
  v_exp_f32 v88, v88
  v_exp_f32 v89, v89
  v_pk_add_f32 v[92:93], v[64:65], v[66:67]
  v_pk_add_f32 v[92:93], v[92:93], v[88:89]
  v_add_f32 v92, v92, v93
  v_mov_b32 v93, v92
  s_nop 1
  v_permlane32_swap_b32 v92, v93
  v_add_f32 v92, v92, v93
  v_mov_b32 v93, v92
  s_nop 1
  v_permlane16_swap_b32 v92, v93
  v_add_f32 v92, v92, v93
  v_rcp_f32 v92, v92
  s_nop 0
  v_pk_mul_f32 v[64:65], v[64:65], v[92:93] op_sel_hi:[1,0]
  v_pk_mul_f32 v[66:67], v[66:67], v[92:93] op_sel_hi:[1,0]
  v_pk_mul_f32 v[88:89], v[88:89], v[92:93] op_sel_hi:[1,0]
  v_cvt_pk_bf16_f32 v32, v64, v65
  v_cvt_pk_bf16_f32 v33, v66, v67
  v_mov_b64 v[34:35], 0
  v_cvt_pk_bf16_f32 v36, v88, v89
  buffer_store_dwordx4 v[32:35], v11, s[4:7], s54 offen
  buffer_store_dword v36, v12, s[4:7], s54 offen
  s_barrier
  v_mov_b64 v[40:41], -1
  v_mov_b64 v[42:43], -1
  s_xor_b32 s54, s54, 65536
  s_mov_b32 s100, 7
SL_15:
  s_sleep 1
  s_sub_u32 s100, s100, 1
  s_cmp_lg_u32 s100, 0
  s_cbranch_scc1 SL_15
  buffer_store_dwordx4 v[40:43], v11, s[4:7], s54 offen
  buffer_store_dword v40, v12, s[4:7], s54 offen
  s_add_u32 s14, s14, 1
  s_cmp_eq_u32 s14, 0
  s_cbranch_scc1 Af_w1_z
  s_mov_b32 s100, 13
SL_16:
  s_sleep 1
  s_sub_u32 s100, s100, 1
  s_cmp_lg_u32 s100, 0
  s_cbranch_scc1 SL_16
  s_cmp_lt_i32 s14, 64
  s_cbranch_scc1 Af_w1
  s_branch L_end
Af_w1_z:
  s_mov_b32 s55, 0
  s_and_b32 s50, s14, 1
  s_lshl_b32 s50, s50, 14
  v_add_u32 v15, s50, v8
  s_lshl_b32 s54, s55, 15
  s_add_u32 s54, s54, s13
  s_waitcnt vmcnt(0)
  s_barrier
  ds_read_b128 v[48:51], v15 offset:16384
  ds_read_b128 v[52:55], v15 offset:17408
  ds_read_b128 v[56:59], v15 offset:20480
  ds_read_b128 v[60:63], v15 offset:21504
  ds_read_b128 v[24:27], v15 offset:18432
  ds_read_b128 v[28:31], v15 offset:19456
  ds_read_b128 v[16:19], v15 offset:22528
  ds_read_b128 v[20:23], v15 offset:23552
  s_waitcnt lgkmcnt(0)
  s_branch Af_w1_att
Af_w2:
  ds_read_b128 v[48:51], v6 offset:32768
  ds_read_b128 v[52:55], v6 offset:33792
  ds_read_b128 v[56:59], v6 offset:34816
  ds_read_b128 v[60:63], v6 offset:35840
  ds_read_b128 v[64:67], v6 offset:36864
  ds_read_b128 v[68:71], v6 offset:37888
  v_mov_b64 v[72:73], 0
  v_mov_b64 v[74:75], 0
  v_mov_b64 v[76:77], 0
  v_mov_b64 v[78:79], 0
  v_mov_b64 v[80:81], 0
  v_mov_b64 v[82:83], 0
  v_mov_b64 v[84:85], 0
  v_mov_b64 v[86:87], 0
  s_and_b32 s55, s14, 3
  s_lshl_b32 s31, s55, 14
  s_add_u32 s31, s31, s13
  s_add_u32 s15, s31, 10240
  s_add_u32 s31, s31, 4096
  s_add_u32 s32, s15, 4096
  s_and_b32 s50, s14, 1
  s_lshl_b32 s50, s50, 14
  v_add_u32 v15, s50, v8
  s_lshl_b32 s54, s55, 15
  s_add_u32 s54, s54, s13
  s_mov_b32 m0, 102400
  s_waitcnt lgkmcnt(0)
  buffer_load_dwordx4 v[16:19], v2, s[4:7], s15 offen offset:0 sc1
  buffer_load_dwordx4 v[20:23], v2, s[4:7], s32 offen offset:0 sc1
  s_sleep 2
P_17:
  buffer_load_dwordx4 v[16:19], v2, s[4:7], s15 offen offset:0 sc1
  buffer_load_dwordx4 v[20:23], v2, s[4:7], s32 offen offset:0 sc1
  s_add_u32 s101, s101, 1
  s_cmp_gt_u32 s101, 262144
  s_cbranch_scc1 L_abort
  s_waitcnt vmcnt(3)
  v_max3_u32 v13, v16, v17, v18
  v_max_u32 v13, v13, v19
  s_waitcnt vmcnt(2)
  v_max3_u32 v13, v13, v20, v21
  v_max3_u32 v13, v13, v22, v23
  v_cmp_eq_u32 vcc, -1, v13
  s_cbranch_vccnz P_17
  ds_write_b128 v8, v[16:19] offset:10240
  v_smfmac_f32_16x16x64_bf16 v[72:75], v[16:19], a[160:167], v3
  ds_write_b128 v8, v[20:23] offset:14336
  v_smfmac_f32_16x16x64_bf16 v[76:79], v[16:19], a[168:175], v3
  buffer_load_dwordx4 v2, s[4:7], s31 offen offset:0 sc1 lds
  v_smfmac_f32_16x16x64_bf16 v[72:75], v[20:23], v[48:55], v3
  ds_read_b128 v[48:51], v6 offset:38912
  buffer_load_dwordx4 v2, s[4:7], s31 offen offset:1024 sc1 lds
  v_smfmac_f32_16x16x64_bf16 v[80:83], v[16:19], a[176:183], v3
  ds_read_b128 v[52:55], v6 offset:39936
  v_smfmac_f32_16x16x64_bf16 v[84:87], v[16:19], a[184:191], v3
  s_waitcnt lgkmcnt(2)
  s_barrier
  ds_read_b128 v[32:35], v8 offset:8192
  ds_read_b128 v[36:39], v8 offset:9216
  v_smfmac_f32_16x16x64_bf16 v[76:79], v[20:23], v[56:63], v3
  ds_read_b128 v[40:43], v8 offset:13312
  s_waitcnt lgkmcnt(2)
  v_smfmac_f32_16x16x64_bf16 v[72:75], v[32:35], a[96:103], v3
  ds_read_b128 v[56:59], v6 offset:0
  v_smfmac_f32_16x16x64_bf16 v[76:79], v[32:35], a[104:111], v3
  ds_read_b128 v[60:63], v6 offset:1024
  v_smfmac_f32_16x16x64_bf16 v[80:83], v[20:23], v[64:71], v3
  ds_read_b128 v[64:67], v6 offset:2048
  v_smfmac_f32_16x16x64_bf16 v[80:83], v[32:35], a[112:119], v3
  ds_read_b128 v[68:71], v6 offset:3072
  v_smfmac_f32_16x16x64_bf16 v[84:87], v[32:35], a[120:127], v3
  ds_read_b128 v[44:47], v8 offset:11264
  v_smfmac_f32_16x16x64_bf16 v[84:87], v[20:23], v[48:55], v3
  ds_read_b128 v[48:51], v6 offset:4096
  s_waitcnt lgkmcnt(7)
  v_smfmac_f32_16x16x64_bf16 v[72:75], v[36:39], a[128:135], v3
  ds_read_b128 v[52:55], v6 offset:5120
  v_smfmac_f32_16x16x64_bf16 v[76:79], v[36:39], a[136:143], v3
  ds_read_b128 v[32:35], v8 offset:12288
  s_waitcnt lgkmcnt(8)
  s_waitcnt lgkmcnt(6)
  v_smfmac_f32_16x16x64_bf16 v[72:75], v[40:43], v[56:63], v3
  ds_read_b128 v[56:59], v6 offset:6144
  v_smfmac_f32_16x16x64_bf16 v[80:83], v[36:39], a[144:151], v3
  ds_read_b128 v[60:63], v6 offset:7168
  v_smfmac_f32_16x16x64_bf16 v[84:87], v[36:39], a[152:159], v3
  ds_read_b128 v[36:39], v8 offset:15360
  s_waitcnt lgkmcnt(7)
  v_smfmac_f32_16x16x64_bf16 v[76:79], v[40:43], v[64:71], v3
  ds_read_b128 v[64:67], v7 offset:0
  s_waitcnt lgkmcnt(7)
  v_smfmac_f32_16x16x64_bf16 v[72:75], v[44:47], a[192:199], v3
  ds_read_b128 v[68:71], v7 offset:1024
  v_smfmac_f32_16x16x64_bf16 v[76:79], v[44:47], a[200:207], v3
  s_waitcnt vmcnt(0)
  ds_read_b128 v[24:27], v8 offset:4096
  ds_read_b128 v[28:31], v8 offset:5120
  s_waitcnt lgkmcnt(8)
  v_smfmac_f32_16x16x64_bf16 v[80:83], v[40:43], v[48:55], v3
  ds_read_b128 v[48:51], v7 offset:2048
  v_smfmac_f32_16x16x64_bf16 v[80:83], v[44:47], a[208:215], v3
  ds_read_b128 v[52:55], v7 offset:3072
  v_smfmac_f32_16x16x64_bf16 v[84:87], v[44:47], a[216:223], v3
  s_waitcnt lgkmcnt(7)
  v_smfmac_f32_16x16x64_bf16 v[84:87], v[40:43], v[56:63], v3
  ds_read_b128 v[56:59], v7 offset:4096
  s_waitcnt lgkmcnt(3)
  v_max3_u32 v13, v24, v25, v26
  v_max3_u32 v14, v27, v28, v29
  v_max3_u32 v14, v14, v30, v31
  v_max_u32 v13, v13, v14
  v_cmp_eq_u32 vcc, -1, v13
  s_cbranch_vccz F2O_18
F2R_19:
  buffer_load_dwordx4 v2, s[4:7], s31 offen offset:0 sc1 lds
  buffer_load_dwordx4 v2, s[4:7], s31 offen offset:1024 sc1 lds
  s_add_u32 s101, s101, 1
  s_cmp_gt_u32 s101, 262144
  s_cbranch_scc1 L_abort
  s_waitcnt vmcnt(0)
  ds_read_b128 v[24:27], v8 offset:4096
  ds_read_b128 v[28:31], v8 offset:5120
  s_waitcnt lgkmcnt(0)
  v_max3_u32 v13, v24, v25, v26
  v_max3_u32 v14, v27, v28, v29
  v_max3_u32 v14, v14, v30, v31
  v_max_u32 v13, v13, v14
  v_cmp_eq_u32 vcc, -1, v13
  s_cbranch_vccnz F2R_19
F2O_18:
  s_barrier
  ds_read_b128 v[60:63], v7 offset:5120
  v_smfmac_f32_16x16x64_bf16 v[72:75], v[32:35], a[224:231], v3
  ds_read_b128 v[16:19], v8 offset:0
  v_smfmac_f32_16x16x64_bf16 v[76:79], v[32:35], a[232:239], v3
  ds_read_b128 v[20:23], v8 offset:1024
  v_smfmac_f32_16x16x64_bf16 v[72:75], v[36:39], v[64:71], v3
  ds_read_b128 v[64:67], v7 offset:6144
  v_smfmac_f32_16x16x64_bf16 v[80:83], v[32:35], a[240:247], v3
  ds_read_b128 v[68:71], v7 offset:7168
  v_smfmac_f32_16x16x64_bf16 v[84:87], v[32:35], a[248:255], v3
  ds_read_b128 v[44:47], v8 offset:2048
  s_waitcnt lgkmcnt(7)
  v_smfmac_f32_16x16x64_bf16 v[76:79], v[36:39], v[48:55], v3
  ds_read_b128 v[40:43], v8 offset:3072
  v_smfmac_f32_16x16x64_bf16 v[72:75], v[24:27], v[224:231], v3
  ds_read_b128 v[32:35], v8 offset:6144
  v_smfmac_f32_16x16x64_bf16 v[76:79], v[24:27], v[232:239], v3
  ds_read_b128 v[48:51], v15 offset:16384
  s_waitcnt lgkmcnt(8)
  v_smfmac_f32_16x16x64_bf16 v[80:83], v[36:39], v[56:63], v3
  ds_read_b128 v[52:55], v15 offset:17408
  v_smfmac_f32_16x16x64_bf16 v[80:83], v[24:27], v[240:247], v3
  ds_read_b128 v[56:59], v15 offset:20480
  v_smfmac_f32_16x16x64_bf16 v[84:87], v[24:27], v[248:255], v3
  ds_read_b128 v[60:63], v15 offset:21504
  s_waitcnt lgkmcnt(7)
  v_smfmac_f32_16x16x64_bf16 v[84:87], v[36:39], v[64:71], v3
  ds_read_b128 v[36:39], v8 offset:7168
  v_smfmac_f32_16x16x64_bf16 v[72:75], v[28:31], a[0:7], v3
  v_smfmac_f32_16x16x64_bf16 v[76:79], v[28:31], a[8:15], v3
  v_smfmac_f32_16x16x64_bf16 v[80:83], v[28:31], a[16:23], v3
  v_smfmac_f32_16x16x64_bf16 v[84:87], v[28:31], a[24:31], v3
  ds_read_b128 v[24:27], v15 offset:18432
  v_smfmac_f32_16x16x64_bf16 v[72:75], v[16:19], v[96:103], v3
  ds_read_b128 v[28:31], v15 offset:19456
  v_smfmac_f32_16x16x64_bf16 v[76:79], v[16:19], v[104:111], v3
  v_smfmac_f32_16x16x64_bf16 v[80:83], v[16:19], v[112:119], v3
  v_smfmac_f32_16x16x64_bf16 v[84:87], v[16:19], v[120:127], v3
  v_smfmac_f32_16x16x64_bf16 v[72:75], v[20:23], v[128:135], v3
  v_smfmac_f32_16x16x64_bf16 v[76:79], v[20:23], v[136:143], v3
  v_smfmac_f32_16x16x64_bf16 v[80:83], v[20:23], v[144:151], v3
  v_smfmac_f32_16x16x64_bf16 v[84:87], v[20:23], v[152:159], v3
  ds_read_b128 v[16:19], v15 offset:22528
  s_waitcnt lgkmcnt(10)
  v_smfmac_f32_16x16x64_bf16 v[72:75], v[44:47], v[160:167], v3
  ds_read_b128 v[20:23], v15 offset:23552
  v_smfmac_f32_16x16x64_bf16 v[76:79], v[44:47], v[168:175], v3
  s_waitcnt lgkmcnt(10)
  v_smfmac_f32_16x16x64_bf16 v[72:75], v[40:43], v[192:199], v3
  v_smfmac_f32_16x16x64_bf16 v[76:79], v[40:43], v[200:207], v3
  s_waitcnt lgkmcnt(9)
  v_smfmac_f32_16x16x64_bf16 v[72:75], v[32:35], a[32:39], v3
  v_smfmac_f32_16x16x64_bf16 v[76:79], v[32:35], a[40:47], v3
  s_waitcnt lgkmcnt(4)
  v_smfmac_f32_16x16x64_bf16 v[72:75], v[36:39], a[64:71], v3
  v_smfmac_f32_16x16x64_bf16 v[76:79], v[36:39], a[72:79], v3
  v_smfmac_f32_16x16x64_bf16 v[80:83], v[44:47], v[176:183], v3
  v_smfmac_f32_16x16x64_bf16 v[84:87], v[44:47], v[184:191], v3
  v_smfmac_f32_16x16x64_bf16 v[80:83], v[40:43], v[208:215], v3
  s_nop 4
  v_add_f32 v72, v72, v74
  v_add_f32 v73, v73, v75
  v_add_f32 v76, v76, v78
  v_add_f32 v77, v77, v79
  v_cvt_pk_bf16_f32 v72, v72, v73
  v_cvt_pk_bf16_f32 v76, v76, v77
  ds_write2_b32 v4, v72, v76 offset0:0 offset1:64
  v_smfmac_f32_16x16x64_bf16 v[84:87], v[40:43], v[216:223], v3
  v_smfmac_f32_16x16x64_bf16 v[80:83], v[32:35], a[48:55], v3
  v_smfmac_f32_16x16x64_bf16 v[84:87], v[32:35], a[56:63], v3
  v_smfmac_f32_16x16x64_bf16 v[80:83], v[36:39], a[80:87], v3
  v_smfmac_f32_16x16x64_bf16 v[84:87], v[36:39], a[88:95], v3
  s_waitcnt lgkmcnt(0)
  s_barrier
  s_nop 4
  v_pk_add_f32 v[80:81], v[80:81], v[82:83]
  v_pk_add_f32 v[84:85], v[84:85], v[86:87]
  v_cvt_pk_bf16_f32 v80, v80, v81
  v_cvt_pk_bf16_f32 v84, v84, v85
  ds_write2_b32 v9, v80, v84 offset0:0 offset1:128
  s_waitcnt lgkmcnt(0)
  s_barrier
Af_w2_att:
  ds_read_b64_tr_b16 v[32:33], v10 offset:0
  ds_read_b64_tr_b16 v[34:35], v10 offset:512
  ds_read_b64_tr_b16 v[36:37], v10 offset:1024
  ds_read_b64_tr_b16 v[38:39], v10 offset:1536
  ds_read_b64_tr_b16 v[40:41], v10 offset:2048
  ds_read_b64_tr_b16 v[42:43], v10 offset:2560
  ds_read_b64_tr_b16 v[44:45], v10 offset:3072
  ds_read_b64_tr_b16 v[46:47], v10 offset:3584
  ds_read_b128 v[72:75], v15 offset:28672
  ds_read_b128 v[76:79], v15 offset:29696
  ds_read_b128 v[80:83], v15 offset:30720
  ds_read_b128 v[84:87], v15 offset:31744
  v_mov_b32 v14, 0xf149f2ca
  v_cndmask_b32 v68, v14, 0, s[42:43]
  v_cndmask_b32 v69, v14, 0, s[44:45]
  v_cndmask_b32 v70, v14, 0, s[46:47]
  v_cndmask_b32 v71, v14, 0, s[48:49]
  s_nop 1
  s_waitcnt lgkmcnt(10)
  s_waitcnt lgkmcnt(3)
  v_mfma_f32_16x16x32_bf16 v[64:67], v[48:51], v[72:75], 0
  v_mfma_f32_16x16x32_bf16 v[68:71], v[56:59], v[72:75], v[68:71]
  v_mfma_f32_16x16x32_bf16 v[88:91], v[32:35], v[72:75], 0
  s_waitcnt lgkmcnt(2)
  v_mfma_f32_16x16x32_bf16 v[64:67], v[52:55], v[76:79], v[64:67]
  v_mfma_f32_16x16x32_bf16 v[68:71], v[60:63], v[76:79], v[68:71]
  v_mfma_f32_16x16x32_bf16 v[88:91], v[36:39], v[76:79], v[88:91]
  s_waitcnt lgkmcnt(1)
  v_mfma_f32_16x16x32_bf16 v[64:67], v[24:27], v[80:83], v[64:67]
  v_mfma_f32_16x16x32_bf16 v[68:71], v[16:19], v[80:83], v[68:71]
  v_mfma_f32_16x16x32_bf16 v[88:91], v[40:43], v[80:83], v[88:91]
  s_waitcnt lgkmcnt(0)
  v_mfma_f32_16x16x32_bf16 v[64:67], v[28:31], v[84:87], v[64:67]
  v_mfma_f32_16x16x32_bf16 v[68:71], v[20:23], v[84:87], v[68:71]
  v_mfma_f32_16x16x32_bf16 v[88:91], v[44:47], v[84:87], v[88:91]
  s_nop 5
  v_max3_f32 v92, v64, v65, v66
  v_max3_f32 v93, v67, v68, v69
  v_max3_f32 v92, v92, v70, v71
  v_max3_f32 v93, v93, v88, v89
  v_max_f32 v92, v92, v93
  v_mov_b32 v93, v92
  s_nop 1
  v_permlane32_swap_b32 v92, v93
  v_max_f32 v92, v92, v93
  v_mov_b32 v93, v92
  s_nop 1
  v_permlane16_swap_b32 v92, v93
  v_max_f32 v92, v92, v93
  v_mul_f32 v92, s37, v92
  v_pk_fma_f32 v[64:65], v[64:65], s[36:37], v[92:93] op_sel_hi:[1,0,0]
  v_pk_fma_f32 v[66:67], v[66:67], s[36:37], v[92:93] op_sel_hi:[1,0,0]
  v_pk_fma_f32 v[68:69], v[68:69], s[36:37], v[92:93] op_sel_hi:[1,0,0]
  v_pk_fma_f32 v[70:71], v[70:71], s[36:37], v[92:93] op_sel_hi:[1,0,0]
  v_pk_fma_f32 v[88:89], v[88:89], s[36:37], v[92:93] op_sel_hi:[1,0,0]
  v_exp_f32 v64, v64
  v_exp_f32 v65, v65
  v_exp_f32 v66, v66
  v_exp_f32 v67, v67
  v_exp_f32 v68, v68
  v_exp_f32 v69, v69
  v_exp_f32 v70, v70
  v_exp_f32 v71, v71
  v_exp_f32 v88, v88
  v_exp_f32 v89, v89
  v_pk_add_f32 v[92:93], v[64:65], v[66:67]
  v_pk_add_f32 v[92:93], v[92:93], v[68:69]
  v_pk_add_f32 v[92:93], v[92:93], v[70:71]
  v_pk_add_f32 v[92:93], v[92:93], v[88:89]
  v_add_f32 v92, v92, v93
  v_mov_b32 v93, v92
  s_nop 1
  v_permlane32_swap_b32 v92, v93
  v_add_f32 v92, v92, v93
  v_mov_b32 v93, v92
  s_nop 1
  v_permlane16_swap_b32 v92, v93
  v_add_f32 v92, v92, v93
  v_rcp_f32 v92, v92
  s_nop 0
  v_pk_mul_f32 v[64:65], v[64:65], v[92:93] op_sel_hi:[1,0]
  v_pk_mul_f32 v[66:67], v[66:67], v[92:93] op_sel_hi:[1,0]
  v_pk_mul_f32 v[68:69], v[68:69], v[92:93] op_sel_hi:[1,0]
  v_pk_mul_f32 v[70:71], v[70:71], v[92:93] op_sel_hi:[1,0]
  v_pk_mul_f32 v[88:89], v[88:89], v[92:93] op_sel_hi:[1,0]
  v_cvt_pk_bf16_f32 v32, v64, v65
  v_cvt_pk_bf16_f32 v33, v66, v67
  v_cvt_pk_bf16_f32 v34, v68, v69
  v_cvt_pk_bf16_f32 v35, v70, v71
  v_cvt_pk_bf16_f32 v36, v88, v89
  buffer_store_dwordx4 v[32:35], v11, s[4:7], s54 offen
  buffer_store_dword v36, v12, s[4:7], s54 offen
  s_barrier
  v_mov_b64 v[40:41], -1
  v_mov_b64 v[42:43], -1
  s_xor_b32 s54, s54, 65536
  s_mov_b32 s100, 7
SL_20:
  s_sleep 1
  s_sub_u32 s100, s100, 1
  s_cmp_lg_u32 s100, 0
  s_cbranch_scc1 SL_20
  buffer_store_dwordx4 v[40:43], v11, s[4:7], s54 offen
  buffer_store_dword v40, v12, s[4:7], s54 offen
  s_add_u32 s14, s14, 1
  s_cmp_eq_u32 s14, 0
  s_cbranch_scc1 Af_w2_z
  s_mov_b32 s100, 13
SL_21:
  s_sleep 1
  s_sub_u32 s100, s100, 1
  s_cmp_lg_u32 s100, 0
  s_cbranch_scc1 SL_21
  s_cmp_lt_i32 s14, 64
  s_cbranch_scc1 Af_w2
  s_branch L_end
Af_w2_z:
  s_mov_b32 s55, 0
  s_and_b32 s50, s14, 1
  s_lshl_b32 s50, s50, 14
  v_add_u32 v15, s50, v8
  s_lshl_b32 s54, s55, 15
  s_add_u32 s54, s54, s13
  s_waitcnt vmcnt(0)
  s_barrier
  ds_read_b128 v[48:51], v15 offset:16384
  ds_read_b128 v[52:55], v15 offset:17408
  ds_read_b128 v[56:59], v15 offset:20480
  ds_read_b128 v[60:63], v15 offset:21504
  ds_read_b128 v[24:27], v15 offset:18432
  ds_read_b128 v[28:31], v15 offset:19456
  ds_read_b128 v[16:19], v15 offset:22528
  ds_read_b128 v[20:23], v15 offset:23552
  s_waitcnt lgkmcnt(0)
  s_branch Af_w2_att
Af_w3:
  ds_read_b128 v[48:51], v7 offset:0
  ds_read_b128 v[52:55], v7 offset:1024
  ds_read_b128 v[56:59], v7 offset:2048
  ds_read_b128 v[60:63], v7 offset:3072
  ds_read_b128 v[64:67], v7 offset:4096
  ds_read_b128 v[68:71], v7 offset:5120
  v_mov_b64 v[72:73], 0
  v_mov_b64 v[74:75], 0
  v_mov_b64 v[76:77], 0
  v_mov_b64 v[78:79], 0
  v_mov_b64 v[80:81], 0
  v_mov_b64 v[82:83], 0
  v_mov_b64 v[84:85], 0
  v_mov_b64 v[86:87], 0
  s_and_b32 s55, s14, 3
  s_lshl_b32 s31, s55, 14
  s_add_u32 s31, s31, s13
  s_add_u32 s15, s31, 11264
  s_add_u32 s31, s31, 6144
  s_add_u32 s32, s15, 4096
  s_and_b32 s50, s14, 1
  s_lshl_b32 s50, s50, 14
  v_add_u32 v15, s50, v8
  s_lshl_b32 s54, s55, 15
  s_add_u32 s54, s54, s13
  s_mov_b32 m0, 104448
  s_waitcnt lgkmcnt(0)
  buffer_load_dwordx4 v[16:19], v2, s[4:7], s15 offen offset:0 sc1
  buffer_load_dwordx4 v[20:23], v2, s[4:7], s32 offen offset:0 sc1
  s_sleep 2
P_22:
  buffer_load_dwordx4 v[16:19], v2, s[4:7], s15 offen offset:0 sc1
  buffer_load_dwordx4 v[20:23], v2, s[4:7], s32 offen offset:0 sc1
  s_add_u32 s101, s101, 1
  s_cmp_gt_u32 s101, 262144
  s_cbranch_scc1 L_abort
  s_waitcnt vmcnt(3)
  v_max3_u32 v13, v16, v17, v18
  v_max_u32 v13, v13, v19
  s_waitcnt vmcnt(2)
  v_max3_u32 v13, v13, v20, v21
  v_max3_u32 v13, v13, v22, v23
  v_cmp_eq_u32 vcc, -1, v13
  s_cbranch_vccnz P_22
  ds_write_b128 v8, v[16:19] offset:11264
  v_smfmac_f32_16x16x64_bf16 v[72:75], v[16:19], a[192:199], v3
  ds_write_b128 v8, v[20:23] offset:15360
  v_smfmac_f32_16x16x64_bf16 v[76:79], v[16:19], a[200:207], v3
  buffer_load_dwordx4 v2, s[4:7], s31 offen offset:0 sc1 lds
  v_smfmac_f32_16x16x64_bf16 v[72:75], v[20:23], v[48:55], v3
  ds_read_b128 v[48:51], v7 offset:6144
  buffer_load_dwordx4 v2, s[4:7], s31 offen offset:1024 sc1 lds
  v_smfmac_f32_16x16x64_bf16 v[80:83], v[16:19], a[208:215], v3
  ds_read_b128 v[52:55], v7 offset:7168
  v_smfmac_f32_16x16x64_bf16 v[84:87], v[16:19], a[216:223], v3
  s_waitcnt lgkmcnt(2)
  s_barrier
  ds_read_b128 v[32:35], v8 offset:8192
  ds_read_b128 v[36:39], v8 offset:9216
  v_smfmac_f32_16x16x64_bf16 v[76:79], v[20:23], v[56:63], v3
  ds_read_b128 v[40:43], v8 offset:13312
  s_waitcnt lgkmcnt(2)
  v_smfmac_f32_16x16x64_bf16 v[72:75], v[32:35], a[96:103], v3
  ds_read_b128 v[56:59], v6 offset:0
  v_smfmac_f32_16x16x64_bf16 v[76:79], v[32:35], a[104:111], v3
  ds_read_b128 v[60:63], v6 offset:1024
  v_smfmac_f32_16x16x64_bf16 v[80:83], v[20:23], v[64:71], v3
  ds_read_b128 v[64:67], v6 offset:2048
  v_smfmac_f32_16x16x64_bf16 v[80:83], v[32:35], a[112:119], v3
  ds_read_b128 v[68:71], v6 offset:3072
  v_smfmac_f32_16x16x64_bf16 v[84:87], v[32:35], a[120:127], v3
  ds_read_b128 v[44:47], v8 offset:10240
  v_smfmac_f32_16x16x64_bf16 v[84:87], v[20:23], v[48:55], v3
  ds_read_b128 v[48:51], v6 offset:4096
  s_waitcnt lgkmcnt(7)
  v_smfmac_f32_16x16x64_bf16 v[72:75], v[36:39], a[128:135], v3
  ds_read_b128 v[52:55], v6 offset:5120
  v_smfmac_f32_16x16x64_bf16 v[76:79], v[36:39], a[136:143], v3
  ds_read_b128 v[32:35], v8 offset:12288
  s_waitcnt lgkmcnt(8)
  s_waitcnt lgkmcnt(6)
  v_smfmac_f32_16x16x64_bf16 v[72:75], v[40:43], v[56:63], v3
  ds_read_b128 v[56:59], v6 offset:6144
  v_smfmac_f32_16x16x64_bf16 v[80:83], v[36:39], a[144:151], v3
  ds_read_b128 v[60:63], v6 offset:7168
  v_smfmac_f32_16x16x64_bf16 v[84:87], v[36:39], a[152:159], v3
  ds_read_b128 v[36:39], v8 offset:14336
  s_waitcnt lgkmcnt(7)
  v_smfmac_f32_16x16x64_bf16 v[76:79], v[40:43], v[64:71], v3
  ds_read_b128 v[64:67], v6 offset:32768
  s_waitcnt lgkmcnt(7)
  v_smfmac_f32_16x16x64_bf16 v[72:75], v[44:47], a[160:167], v3
  ds_read_b128 v[68:71], v6 offset:33792
  v_smfmac_f32_16x16x64_bf16 v[76:79], v[44:47], a[168:175], v3
  s_waitcnt vmcnt(0)
  ds_read_b128 v[24:27], v8 offset:6144
  ds_read_b128 v[28:31], v8 offset:7168
  s_waitcnt lgkmcnt(8)
  v_smfmac_f32_16x16x64_bf16 v[80:83], v[40:43], v[48:55], v3
  ds_read_b128 v[48:51], v6 offset:34816
  v_smfmac_f32_16x16x64_bf16 v[80:83], v[44:47], a[176:183], v3
  ds_read_b128 v[52:55], v6 offset:35840
  v_smfmac_f32_16x16x64_bf16 v[84:87], v[44:47], a[184:191], v3
  s_waitcnt lgkmcnt(7)
  v_smfmac_f32_16x16x64_bf16 v[84:87], v[40:43], v[56:63], v3
  ds_read_b128 v[56:59], v6 offset:36864
  s_waitcnt lgkmcnt(3)
  v_max3_u32 v13, v24, v25, v26
  v_max3_u32 v14, v27, v28, v29
  v_max3_u32 v14, v14, v30, v31
  v_max_u32 v13, v13, v14
  v_cmp_eq_u32 vcc, -1, v13
  s_cbranch_vccz F2O_23
F2R_24:
  buffer_load_dwordx4 v2, s[4:7], s31 offen offset:0 sc1 lds
  buffer_load_dwordx4 v2, s[4:7], s31 offen offset:1024 sc1 lds
  s_add_u32 s101, s101, 1
  s_cmp_gt_u32 s101, 262144
  s_cbranch_scc1 L_abort
  s_waitcnt vmcnt(0)
  ds_read_b128 v[24:27], v8 offset:6144
  ds_read_b128 v[28:31], v8 offset:7168
  s_waitcnt lgkmcnt(0)
  v_max3_u32 v13, v24, v25, v26
  v_max3_u32 v14, v27, v28, v29
  v_max3_u32 v14, v14, v30, v31
  v_max_u32 v13, v13, v14
  v_cmp_eq_u32 vcc, -1, v13
  s_cbranch_vccnz F2R_24
F2O_23:
  s_barrier
  ds_read_b128 v[60:63], v6 offset:37888
  v_smfmac_f32_16x16x64_bf16 v[72:75], v[32:35], a[224:231], v3
  ds_read_b128 v[16:19], v8 offset:0
  v_smfmac_f32_16x16x64_bf16 v[76:79], v[32:35], a[232:239], v3
  ds_read_b128 v[20:23], v8 offset:1024
  v_smfmac_f32_16x16x64_bf16 v[72:75], v[36:39], v[64:71], v3
  ds_read_b128 v[64:67], v6 offset:38912
  v_smfmac_f32_16x16x64_bf16 v[80:83], v[32:35], a[240:247], v3
  ds_read_b128 v[68:71], v6 offset:39936
  v_smfmac_f32_16x16x64_bf16 v[84:87], v[32:35], a[248:255], v3
  ds_read_b128 v[44:47], v8 offset:2048
  s_waitcnt lgkmcnt(7)
  v_smfmac_f32_16x16x64_bf16 v[76:79], v[36:39], v[48:55], v3
  ds_read_b128 v[40:43], v8 offset:3072
  v_smfmac_f32_16x16x64_bf16 v[72:75], v[24:27], a[32:39], v3
  ds_read_b128 v[32:35], v8 offset:4096
  v_smfmac_f32_16x16x64_bf16 v[76:79], v[24:27], a[40:47], v3
  s_waitcnt lgkmcnt(7)
  v_smfmac_f32_16x16x64_bf16 v[80:83], v[36:39], v[56:63], v3
  v_smfmac_f32_16x16x64_bf16 v[80:83], v[24:27], a[48:55], v3
  v_smfmac_f32_16x16x64_bf16 v[84:87], v[24:27], a[56:63], v3
  s_waitcnt lgkmcnt(3)
  v_smfmac_f32_16x16x64_bf16 v[84:87], v[36:39], v[64:71], v3
  ds_read_b128 v[36:39], v8 offset:5120
  v_smfmac_f32_16x16x64_bf16 v[72:75], v[28:31], a[64:71], v3
  v_smfmac_f32_16x16x64_bf16 v[76:79], v[28:31], a[72:79], v3
  v_smfmac_f32_16x16x64_bf16 v[80:83], v[28:31], a[80:87], v3
  v_smfmac_f32_16x16x64_bf16 v[84:87], v[28:31], a[88:95], v3
  v_smfmac_f32_16x16x64_bf16 v[72:75], v[16:19], v[96:103], v3
  v_smfmac_f32_16x16x64_bf16 v[76:79], v[16:19], v[104:111], v3
  v_smfmac_f32_16x16x64_bf16 v[80:83], v[16:19], v[112:119], v3
  v_smfmac_f32_16x16x64_bf16 v[84:87], v[16:19], v[120:127], v3
  v_smfmac_f32_16x16x64_bf16 v[72:75], v[20:23], v[128:135], v3
  v_smfmac_f32_16x16x64_bf16 v[76:79], v[20:23], v[136:143], v3
  v_smfmac_f32_16x16x64_bf16 v[80:83], v[20:23], v[144:151], v3
  v_smfmac_f32_16x16x64_bf16 v[84:87], v[20:23], v[152:159], v3
  s_waitcnt lgkmcnt(3)
  v_smfmac_f32_16x16x64_bf16 v[72:75], v[44:47], v[160:167], v3
  v_smfmac_f32_16x16x64_bf16 v[76:79], v[44:47], v[168:175], v3
  s_waitcnt lgkmcnt(2)
  v_smfmac_f32_16x16x64_bf16 v[72:75], v[40:43], v[192:199], v3
  v_smfmac_f32_16x16x64_bf16 v[76:79], v[40:43], v[200:207], v3
  s_waitcnt lgkmcnt(1)
  v_smfmac_f32_16x16x64_bf16 v[72:75], v[32:35], v[224:231], v3
  v_smfmac_f32_16x16x64_bf16 v[76:79], v[32:35], v[232:239], v3
  s_waitcnt lgkmcnt(0)
  v_smfmac_f32_16x16x64_bf16 v[72:75], v[36:39], a[0:7], v3
  v_smfmac_f32_16x16x64_bf16 v[76:79], v[36:39], a[8:15], v3
  v_smfmac_f32_16x16x64_bf16 v[80:83], v[44:47], v[176:183], v3
  v_smfmac_f32_16x16x64_bf16 v[84:87], v[44:47], v[184:191], v3
  v_smfmac_f32_16x16x64_bf16 v[80:83], v[40:43], v[208:215], v3
  s_nop 4
  v_add_f32 v72, v72, v74
  v_add_f32 v73, v73, v75
  v_add_f32 v76, v76, v78
  v_add_f32 v77, v77, v79
  v_cvt_pk_bf16_f32 v72, v72, v73
  v_cvt_pk_bf16_f32 v76, v76, v77
  ds_write2_b32 v4, v72, v76 offset0:0 offset1:64
  v_smfmac_f32_16x16x64_bf16 v[84:87], v[40:43], v[216:223], v3
  v_smfmac_f32_16x16x64_bf16 v[80:83], v[32:35], v[240:247], v3
  v_smfmac_f32_16x16x64_bf16 v[84:87], v[32:35], v[248:255], v3
  v_smfmac_f32_16x16x64_bf16 v[80:83], v[36:39], a[16:23], v3
  v_smfmac_f32_16x16x64_bf16 v[84:87], v[36:39], a[24:31], v3
  s_waitcnt lgkmcnt(0)
  s_barrier
  s_nop 4
  v_pk_add_f32 v[80:81], v[80:81], v[82:83]
  v_pk_add_f32 v[84:85], v[84:85], v[86:87]
  v_cvt_pk_bf16_f32 v80, v80, v81
  v_cvt_pk_bf16_f32 v84, v84, v85
  ds_write2_b32 v9, v80, v84 offset0:0 offset1:128
  s_waitcnt lgkmcnt(0)
  s_barrier
Af_w3_att:
  s_barrier
  s_nop 1
  s_xor_b32 s33, s55, 2
  s_cmp_lt_i32 s14, 2
  s_cbranch_scc1 AC_25
  s_lshl_b32 s15, s33, 16
  s_lshl_b32 s32, s12, 13
  s_add_u32 s15, s15, s32
  s_add_u32 s15, s15, s13
  s_add_u32 s15, s15, 262144
  s_add_u32 s31, s15, 4096
  buffer_load_dwordx4 v[16:19], v2, s[4:7], s15 offen offset:0 sc1
  buffer_load_dwordx4 v[20:23], v2, s[4:7], s15 offen offset:1024 sc1
  buffer_load_dwordx4 v[24:27], v2, s[4:7], s15 offen offset:2048 sc1
  buffer_load_dwordx4 v[28:31], v2, s[4:7], s15 offen offset:3072 sc1
  buffer_load_dwordx4 v[32:35], v2, s[4:7], s31 offen offset:0 sc1
  buffer_load_dwordx4 v[36:39], v2, s[4:7], s31 offen offset:1024 sc1
  buffer_load_dwordx4 v[40:43], v2, s[4:7], s31 offen offset:2048 sc1
  buffer_load_dwordx4 v[44:47], v2, s[4:7], s31 offen offset:3072 sc1
  s_sub_u32 s15, s14, 2
  s_lshl_b32 s15, s15, 16
  s_add_u32 s15, s15, s32
  s_lshl_b32 s31, s94, 22
  s_add_u32 s15, s15, s31
  s_add_u32 s15, s15, 0x4800000
  s_add_u32 s31, s15, 4096
  s_waitcnt vmcnt(7)
  buffer_store_dwordx4 v[16:19], v2, s[4:7], s15 offen offset:0 sc1
  s_waitcnt vmcnt(7)
  buffer_store_dwordx4 v[20:23], v2, s[4:7], s15 offen offset:1024 sc1
  s_waitcnt vmcnt(7)
  buffer_store_dwordx4 v[24:27], v2, s[4:7], s15 offen offset:2048 sc1
  s_waitcnt vmcnt(7)
  buffer_store_dwordx4 v[28:31], v2, s[4:7], s15 offen offset:3072 sc1
  s_waitcnt vmcnt(7)
  buffer_store_dwordx4 v[32:35], v2, s[4:7], s31 offen offset:0 sc1
  s_waitcnt vmcnt(7)
  buffer_store_dwordx4 v[36:39], v2, s[4:7], s31 offen offset:1024 sc1
  s_waitcnt vmcnt(7)
  buffer_store_dwordx4 v[40:43], v2, s[4:7], s31 offen offset:2048 sc1
  s_waitcnt vmcnt(7)
  buffer_store_dwordx4 v[44:47], v2, s[4:7], s31 offen offset:3072 sc1
AC_25:
  s_cmp_lg_u32 s55, 2
  s_cbranch_scc1 AF_26
  s_cmp_lt_i32 s14, 6
  s_cbranch_scc1 AF_26
  s_sub_u32 s15, s14, 6
  s_lshl_b32 s15, s15, 9
  s_lshl_b32 s31, s56, 2
  s_add_u32 s15, s15, s31
  s_add_u32 s15, s15, 0x7600300
  s_mov_b64 exec, 1
  buffer_store_dword v3, v2, s[4:7], s15 offen sc1
  s_mov_b64 exec, -1
AF_26:
  s_add_u32 s53, s14, 1
  s_cmp_ge_u32 s53, 64
  s_cbranch_scc1 AN_27
  s_and_b32 s15, s53, 3
  s_cmp_lg_u32 s15, 0
  s_cbranch_scc1 QD_28
  s_lshr_b32 s15, s53, 2
  s_lshl_b32 s15, s15, 11
  s_lshr_b32 s97, s56, 1
  s_lshl_b32 s97, s97, 2
  s_add_u32 s15, s15, s97
  s_add_u32 s15, s15, 0x7600000
  v_lshlrev_b32 v14, 6, v1
  s_mov_b32 exec_lo, 0x3
  s_mov_b32 exec_hi, 0x0
F_29:
  buffer_load_dword v13, v14, s[4:7], s15 offen sc1
  s_waitcnt vmcnt(0)
  v_cmp_eq_u32 vcc, 0, v13
  s_cbranch_vccz FE_30
  s_add_u32 s101, s101, 1
  s_cmp_gt_u32 s101, 262144
  s_cbranch_scc1 L_abort
  s_sleep 2
  s_branch F_29
FE_30:
  s_mov_b64 exec, -1
QD_28:
  s_and_b32 s31, s53, 1
  s_lshl_b32 s31, s31, 14
  s_add_u32 s31, s31, 114688
  s_lshl_b32 s15, s53, 18
  s_lshl_b32 s32, s56, 12
  s_add_u32 s15, s15, s32
  s_add_u32 s32, s15, 0x1000000
  s_add_u32 m0, s31, 0
  s_nop 0
  buffer_load_dwordx4 v2, s[4:7], s32 offen offset:0 sc1 nt lds
  buffer_load_dwordx4 v2, s[4:7], s32 offen offset:1024 sc1 nt lds
  buffer_load_dwordx4 v2, s[4:7], s32 offen offset:2048 sc1 nt lds
  buffer_load_dwordx4 v2, s[4:7], s32 offen offset:3072 sc1 nt lds
  s_add_u32 s32, s15, 0x1020000
  s_add_u32 m0, s31, 4096
  s_nop 0
  buffer_load_dwordx4 v2, s[4:7], s32 offen offset:0 sc1 nt lds
  buffer_load_dwordx4 v2, s[4:7], s32 offen offset:1024 sc1 nt lds
  buffer_load_dwordx4 v2, s[4:7], s32 offen offset:2048 sc1 nt lds
  buffer_load_dwordx4 v2, s[4:7], s32 offen offset:3072 sc1 nt lds
  s_add_u32 s32, s15, 0x0
  s_add_u32 m0, s31, 8192
  s_nop 0
  buffer_load_dwordx4 v2, s[4:7], s32 offen offset:0 sc1 nt lds
  buffer_load_dwordx4 v2, s[4:7], s32 offen offset:1024 sc1 nt lds
  buffer_load_dwordx4 v2, s[4:7], s32 offen offset:2048 sc1 nt lds
  buffer_load_dwordx4 v2, s[4:7], s32 offen offset:3072 sc1 nt lds
  s_add_u32 s32, s15, 0x20000
  s_add_u32 m0, s31, 12288
  s_nop 0
  buffer_load_dwordx4 v2, s[4:7], s32 offen offset:0 sc1 nt lds
  buffer_load_dwordx4 v2, s[4:7], s32 offen offset:1024 sc1 nt lds
  buffer_load_dwordx4 v2, s[4:7], s32 offen offset:2048 sc1 nt lds
  buffer_load_dwordx4 v2, s[4:7], s32 offen offset:3072 sc1 nt lds
AN_27:
  s_add_u32 s14, s14, 1
  s_cmp_eq_u32 s14, 0
  s_cbranch_scc1 Af_w3_z
  s_mov_b32 s100, 7
SL_31:
  s_sleep 1
  s_sub_u32 s100, s100, 1
  s_cmp_lg_u32 s100, 0
  s_cbranch_scc1 SL_31
  s_cmp_lt_i32 s14, 64
  s_cbranch_scc1 Af_w3
  s_branch L_end
Af_w3_z:
  s_mov_b32 s55, 0
  s_and_b32 s50, s14, 1
  s_lshl_b32 s50, s50, 14
  v_add_u32 v15, s50, v8
  s_lshl_b32 s54, s55, 15
  s_add_u32 s54, s54, s13
  s_waitcnt vmcnt(0)
  s_barrier
  s_waitcnt lgkmcnt(0)
  s_branch Af_w3_att
A_slow:
  s_and_b32 s15, s98, 2
  s_lshl_b32 s15, s15, 12
  s_add_u32 s30, s52, s15
  s_add_u32 s30, s30, 2097152
  s_and_b32 s15, s98, 1
  s_lshl_b32 s15, s15, 13
  s_add_u32 s52, s52, s15
  s_cmp_eq_u32 s95, 1
  s_cbranch_scc1 As_w1
  s_cmp_eq_u32 s95, 2
  s_cbranch_scc1 As_w2
  s_cmp_eq_u32 s95, 3
  s_cbranch_scc1 As_w3
As_w0:
  ds_read_b128 v[48:51], v6 offset:0
  ds_read_b128 v[52:55], v6 offset:1024
  ds_read_b128 v[56:59], v6 offset:2048
  ds_read_b128 v[60:63], v6 offset:3072
  ds_read_b128 v[64:67], v6 offset:4096
  ds_read_b128 v[68:71], v6 offset:5120
  v_mov_b64 v[72:73], 0
  v_mov_b64 v[74:75], 0
  v_mov_b64 v[76:77], 0
  v_mov_b64 v[78:79], 0
  v_mov_b64 v[80:81], 0
  v_mov_b64 v[82:83], 0
  v_mov_b64 v[84:85], 0
  v_mov_b64 v[86:87], 0
  s_and_b32 s55, s14, 3
  s_lshl_b32 s31, s55, 14
  s_add_u32 s31, s31, s13
  s_add_u32 s15, s31, 8192
  s_add_u32 s31, s31, 0
  s_add_u32 s32, s15, 4096
  s_and_b32 s50, s14, 1
  s_lshl_b32 s50, s50, 14
  v_add_u32 v15, s50, v8
  s_lshl_b32 s54, s55, 13
  s_add_u32 s54, s54, s13
  v_mov_b32 v14, 0xf149f2ca
  v_mov_b64 v[90:91], 0
  v_cndmask_b32 v88, v14, 0, s[40:41]
  v_cndmask_b32 v89, v14, 0, s[40:41]
  s_mov_b32 m0, 98304
  s_waitcnt lgkmcnt(0)
  buffer_load_dwordx4 v[16:19], v2, s[4:7], s15 offen offset:0 sc1
  buffer_load_dwordx4 v[20:23], v2, s[4:7], s32 offen offset:0 sc1
  s_sleep 2
P_32:
  buffer_load_dwordx4 v[16:19], v2, s[4:7], s15 offen offset:0 sc1
  buffer_load_dwordx4 v[20:23], v2, s[4:7], s32 offen offset:0 sc1
  s_add_u32 s101, s101, 1
  s_cmp_gt_u32 s101, 262144
  s_cbranch_scc1 L_abort
  s_waitcnt vmcnt(3)
  v_max3_u32 v13, v16, v17, v18
  v_max_u32 v13, v13, v19
  s_waitcnt vmcnt(2)
  v_max3_u32 v13, v13, v20, v21
  v_max3_u32 v13, v13, v22, v23
  v_cmp_eq_u32 vcc, -1, v13
  s_cbranch_vccnz P_32
  ds_write_b128 v8, v[16:19] offset:8192
  v_smfmac_f32_16x16x64_bf16 v[72:75], v[16:19], a[96:103], v3
  ds_write_b128 v8, v[20:23] offset:12288
  v_smfmac_f32_16x16x64_bf16 v[76:79], v[16:19], a[104:111], v3
  buffer_load_dwordx4 v2, s[4:7], s31 offen offset:0 sc1 lds
  v_smfmac_f32_16x16x64_bf16 v[80:83], v[16:19], a[112:119], v3
  buffer_load_dwordx4 v2, s[4:7], s31 offen offset:1024 sc1 lds
  v_smfmac_f32_16x16x64_bf16 v[84:87], v[16:19], a[120:127], v3
  v_smfmac_f32_16x16x64_bf16 v[72:75], v[20:23], a[224:231], v3
  s_waitcnt lgkmcnt(0)
  s_barrier
  ds_read_b128 v[32:35], v8 offset:9216
  ds_read_b128 v[36:39], v8 offset:13312
  v_smfmac_f32_16x16x64_bf16 v[76:79], v[20:23], a[232:239], v3
  ds_read_b128 v[40:43], v8 offset:10240
  v_smfmac_f32_16x16x64_bf16 v[80:83], v[20:23], a[240:247], v3
  ds_read_b128 v[44:47], v8 offset:11264
  v_smfmac_f32_16x16x64_bf16 v[84:87], v[20:23], a[248:255], v3
  s_waitcnt lgkmcnt(3)
  v_smfmac_f32_16x16x64_bf16 v[72:75], v[32:35], a[128:135], v3
  v_smfmac_f32_16x16x64_bf16 v[76:79], v[32:35], a[136:143], v3
  s_waitcnt lgkmcnt(2)
  v_smfmac_f32_16x16x64_bf16 v[72:75], v[36:39], v[48:55], v3
  ds_read_b128 v[48:51], v6 offset:6144
  v_smfmac_f32_16x16x64_bf16 v[80:83], v[32:35], a[144:151], v3
  ds_read_b128 v[52:55], v6 offset:7168
  v_smfmac_f32_16x16x64_bf16 v[84:87], v[32:35], a[152:159], v3
  ds_read_b128 v[32:35], v8 offset:14336
  v_smfmac_f32_16x16x64_bf16 v[76:79], v[36:39], v[56:63], v3
  ds_read_b128 v[56:59], v6 offset:32768
  s_waitcnt lgkmcnt(5)
  v_smfmac_f32_16x16x64_bf16 v[72:75], v[40:43], a[160:167], v3
  ds_read_b128 v[60:63], v6 offset:33792
  v_smfmac_f32_16x16x64_bf16 v[76:79], v[40:43], a[168:175], v3
  v_smfmac_f32_16x16x64_bf16 v[80:83], v[36:39], v[64:71], v3
  ds_read_b128 v[64:67], v6 offset:34816
  v_smfmac_f32_16x16x64_bf16 v[80:83], v[40:43], a[176:183], v3
  ds_read_b128 v[68:71], v6 offset:35840
  v_smfmac_f32_16x16x64_bf16 v[84:87], v[40:43], a[184:191], v3
  ds_read_b128 v[40:43], v8 offset:15360
  s_waitcnt lgkmcnt(6)
  v_smfmac_f32_16x16x64_bf16 v[84:87], v[36:39], v[48:55], v3
  ds_read_b128 v[48:51], v6 offset:36864
  s_waitcnt vmcnt(0)
  ds_read_b128 v[24:27], v8 offset:0
  ds_read_b128 v[28:31], v8 offset:1024
  v_smfmac_f32_16x16x64_bf16 v[72:75], v[44:47], a[192:199], v3
  ds_read_b128 v[52:55], v6 offset:37888
  v_smfmac_f32_16x16x64_bf16 v[76:79], v[44:47], a[200:207], v3
  s_waitcnt lgkmcnt(9)
  s_waitcnt lgkmcnt(7)
  v_smfmac_f32_16x16x64_bf16 v[72:75], v[32:35], v[56:63], v3
  ds_read_b128 v[56:59], v6 offset:38912
  v_smfmac_f32_16x16x64_bf16 v[80:83], v[44:47], a[208:215], v3
  ds_read_b128 v[60:63], v6 offset:39936
  s_waitcnt lgkmcnt(3)
  v_max3_u32 v13, v24, v25, v26
  v_max3_u32 v14, v27, v28, v29
  v_max3_u32 v14, v14, v30, v31
  v_max_u32 v13, v13, v14
  v_cmp_eq_u32 vcc, -1, v13
  s_cbranch_vccz F2O_33
F2R_34:
  buffer_load_dwordx4 v2, s[4:7], s31 offen offset:0 sc1 lds
  buffer_load_dwordx4 v2, s[4:7], s31 offen offset:1024 sc1 lds
  s_add_u32 s101, s101, 1
  s_cmp_gt_u32 s101, 262144
  s_cbranch_scc1 L_abort
  s_waitcnt vmcnt(0)
  ds_read_b128 v[24:27], v8 offset:0
  ds_read_b128 v[28:31], v8 offset:1024
  s_waitcnt lgkmcnt(0)
  v_max3_u32 v13, v24, v25, v26
  v_max3_u32 v14, v27, v28, v29
  v_max3_u32 v14, v14, v30, v31
  v_max_u32 v13, v13, v14
  v_cmp_eq_u32 vcc, -1, v13
  s_cbranch_vccnz F2R_34
F2O_33:
  s_barrier
  ds_read_b128 v[36:39], v8 offset:2048
  v_smfmac_f32_16x16x64_bf16 v[84:87], v[44:47], a[216:223], v3
  ds_read_b128 v[16:19], v8 offset:3072
  v_smfmac_f32_16x16x64_bf16 v[76:79], v[32:35], v[64:71], v3
  ds_read_b128 v[64:67], v7 offset:0
  v_smfmac_f32_16x16x64_bf16 v[72:75], v[24:27], v[96:103], v3
  ds_read_b128 v[68:71], v7 offset:1024
  v_smfmac_f32_16x16x64_bf16 v[76:79], v[24:27], v[104:111], v3
  s_waitcnt lgkmcnt(6)
  v_smfmac_f32_16x16x64_bf16 v[80:83], v[32:35], v[48:55], v3
  ds_read_b128 v[48:51], v7 offset:2048
  v_smfmac_f32_16x16x64_bf16 v[80:83], v[24:27], v[112:119], v3
  ds_read_b128 v[52:55], v7 offset:3072
  v_smfmac_f32_16x16x64_bf16 v[84:87], v[24:27], v[120:127], v3
  ds_read_b128 v[24:27], v8 offset:4096
  s_waitcnt lgkmcnt(7)
  v_smfmac_f32_16x16x64_bf16 v[84:87], v[32:35], v[56:63], v3
  ds_read_b128 v[56:59], v7 offset:4096
  v_smfmac_f32_16x16x64_bf16 v[72:75], v[28:31], v[128:135], v3
  ds_read_b128 v[60:63], v7 offset:5120
  v_smfmac_f32_16x16x64_bf16 v[76:79], v[28:31], v[136:143], v3
  ds_read_b128 v[32:35], v8 offset:5120
  s_waitcnt lgkmcnt(6)
  v_smfmac_f32_16x16x64_bf16 v[72:75], v[40:43], v[64:71], v3
  ds_read_b128 v[64:67], v7 offset:6144
  v_smfmac_f32_16x16x64_bf16 v[80:83], v[28:31], v[144:151], v3
  ds_read_b128 v[68:71], v7 offset:7168
  v_smfmac_f32_16x16x64_bf16 v[84:87], v[28:31], v[152:159], v3
  ds_read_b128 v[28:31], v8 offset:6144
  s_waitcnt lgkmcnt(7)
  v_smfmac_f32_16x16x64_bf16 v[76:79], v[40:43], v[48:55], v3
  ds_read_b128 v[48:51], v15 offset:16384
  v_smfmac_f32_16x16x64_bf16 v[72:75], v[36:39], v[160:167], v3
  ds_read_b128 v[52:55], v15 offset:17408
  v_smfmac_f32_16x16x64_bf16 v[76:79], v[36:39], v[168:175], v3
  s_waitcnt lgkmcnt(6)
  v_smfmac_f32_16x16x64_bf16 v[80:83], v[40:43], v[56:63], v3
  ds_read_b128 v[56:59], v15 offset:20480
  v_smfmac_f32_16x16x64_bf16 v[80:83], v[36:39], v[176:183], v3
  ds_read_b128 v[60:63], v15 offset:21504
  v_smfmac_f32_16x16x64_bf16 v[84:87], v[36:39], v[184:191], v3
  ds_read_b128 v[36:39], v8 offset:7168
  s_waitcnt lgkmcnt(6)
  v_smfmac_f32_16x16x64_bf16 v[84:87], v[40:43], v[64:71], v3
  ds_read_b128 v[40:43], v15 offset:18432
  v_smfmac_f32_16x16x64_bf16 v[72:75], v[16:19], v[192:199], v3
  ds_read_b128 v[44:47], v15 offset:19456
  v_smfmac_f32_16x16x64_bf16 v[76:79], v[16:19], v[200:207], v3
  v_smfmac_f32_16x16x64_bf16 v[80:83], v[16:19], v[208:215], v3
  v_smfmac_f32_16x16x64_bf16 v[84:87], v[16:19], v[216:223], v3
  ds_read_b128 v[16:19], v15 offset:22528
  v_smfmac_f32_16x16x64_bf16 v[72:75], v[24:27], v[224:231], v3
  ds_read_b128 v[20:23], v15 offset:23552
  v_smfmac_f32_16x16x64_bf16 v[76:79], v[24:27], v[232:239], v3
  v_smfmac_f32_16x16x64_bf16 v[72:75], v[32:35], a[0:7], v3
  v_smfmac_f32_16x16x64_bf16 v[76:79], v[32:35], a[8:15], v3
  s_waitcnt lgkmcnt(9)
  v_smfmac_f32_16x16x64_bf16 v[72:75], v[28:31], a[32:39], v3
  v_smfmac_f32_16x16x64_bf16 v[76:79], v[28:31], a[40:47], v3
  s_waitcnt lgkmcnt(4)
  v_smfmac_f32_16x16x64_bf16 v[72:75], v[36:39], a[64:71], v3
  v_smfmac_f32_16x16x64_bf16 v[76:79], v[36:39], a[72:79], v3
  v_smfmac_f32_16x16x64_bf16 v[80:83], v[24:27], v[240:247], v3
  v_smfmac_f32_16x16x64_bf16 v[84:87], v[24:27], v[248:255], v3
  v_smfmac_f32_16x16x64_bf16 v[80:83], v[32:35], a[16:23], v3
  s_nop 4
  v_add_f32 v72, v72, v74
  v_add_f32 v73, v73, v75
  v_add_f32 v76, v76, v78
  v_add_f32 v77, v77, v79
  v_cvt_pk_bf16_f32 v72, v72, v73
  v_cvt_pk_bf16_f32 v76, v76, v77
  ds_write2_b32 v4, v72, v76 offset0:0 offset1:64
  v_smfmac_f32_16x16x64_bf16 v[84:87], v[32:35], a[24:31], v3
  v_smfmac_f32_16x16x64_bf16 v[80:83], v[28:31], a[48:55], v3
  v_smfmac_f32_16x16x64_bf16 v[84:87], v[28:31], a[56:63], v3
  v_smfmac_f32_16x16x64_bf16 v[80:83], v[36:39], a[80:87], v3
  v_smfmac_f32_16x16x64_bf16 v[84:87], v[36:39], a[88:95], v3
  s_waitcnt lgkmcnt(0)
  s_barrier
  ds_read_b64_tr_b16 v[72:73], v5 offset:0
  ds_read_b64_tr_b16 v[74:75], v5 offset:64
  ds_read_b64_tr_b16 v[76:77], v5 offset:1024
  ds_read_b64_tr_b16 v[78:79], v5 offset:1088
  s_nop 0
  v_pk_add_f32 v[80:81], v[80:81], v[82:83]
  v_pk_add_f32 v[84:85], v[84:85], v[86:87]
  v_cvt_pk_bf16_f32 v80, v80, v81
  v_cvt_pk_bf16_f32 v84, v84, v85
  ds_write2_b32 v9, v80, v84 offset0:0 offset1:128
  v_mov_b64 v[64:65], 0
  v_mov_b64 v[66:67], 0
  v_mov_b64 v[68:69], 0
  v_mov_b64 v[70:71], 0
  s_nop 0
  s_waitcnt lgkmcnt(1)
  v_smfmac_f32_16x16x64_bf16 v[64:67], v[72:75], v[48:55], v3
  v_smfmac_f32_16x16x64_bf16 v[68:71], v[72:75], v[56:63], v3
  v_smfmac_f32_16x16x64_bf16 v[64:67], v[76:79], v[40:47], v3
  v_smfmac_f32_16x16x64_bf16 v[68:71], v[76:79], v[16:23], v3
  s_waitcnt lgkmcnt(0)
  s_barrier
As_w0_att:
  ds_read_b64_tr_b16 v[24:25], v10 offset:0
  ds_read_b64_tr_b16 v[26:27], v10 offset:512
  ds_read_b64_tr_b16 v[28:29], v10 offset:1024
  ds_read_b64_tr_b16 v[30:31], v10 offset:1536
  ds_read_b64_tr_b16 v[32:33], v10 offset:2048
  ds_read_b64_tr_b16 v[34:35], v10 offset:2560
  ds_read_b64_tr_b16 v[36:37], v10 offset:3072
  ds_read_b64_tr_b16 v[38:39], v10 offset:3584
  v_pk_add_f32 v[64:65], v[64:65], v[66:67]
  v_pk_add_f32 v[68:69], v[68:69], v[70:71]
  s_waitcnt lgkmcnt(4)
  v_smfmac_f32_16x16x64_bf16 v[88:91], v[72:75], v[24:31], v3
  s_waitcnt lgkmcnt(0)
  v_smfmac_f32_16x16x64_bf16 v[88:91], v[76:79], v[32:39], v3
  s_nop 7
  v_pk_add_f32 v[88:89], v[88:89], v[90:91]
  v_max3_f32 v92, v64, v68, v88
  v_max3_f32 v93, v65, v69, v89
  s_nop 0
  v_max_f32_dpp v92, v92, v92 row_ror:8 row_mask:0xf bank_mask:0xf
  v_max_f32_dpp v93, v93, v93 row_ror:8 row_mask:0xf bank_mask:0xf
  s_nop 0
  v_max_f32_dpp v92, v92, v92 row_ror:4 row_mask:0xf bank_mask:0xf
  v_max_f32_dpp v93, v93, v93 row_ror:4 row_mask:0xf bank_mask:0xf
  s_nop 0
  v_max_f32_dpp v92, v92, v92 row_ror:2 row_mask:0xf bank_mask:0xf
  v_max_f32_dpp v93, v93, v93 row_ror:2 row_mask:0xf bank_mask:0xf
  s_nop 0
  v_max_f32_dpp v92, v92, v92 row_ror:1 row_mask:0xf bank_mask:0xf
  v_max_f32_dpp v93, v93, v93 row_ror:1 row_mask:0xf bank_mask:0xf
  v_pk_mul_f32 v[92:93], v[92:93], s[36:37] op_sel:[0,1]
  v_pk_fma_f32 v[64:65], v[64:65], s[36:37], v[92:93] op_sel_hi:[1,0,1]
  v_pk_fma_f32 v[68:69], v[68:69], s[36:37], v[92:93] op_sel_hi:[1,0,1]
  v_pk_fma_f32 v[88:89], v[88:89], s[36:37], v[92:93] op_sel_hi:[1,0,1]
  v_exp_f32 v64, v64
  v_exp_f32 v65, v65
  v_exp_f32 v68, v68
  v_exp_f32 v69, v69
  v_exp_f32 v88, v88
  v_exp_f32 v89, v89
  v_pk_add_f32 v[92:93], v[64:65], v[68:69]
  v_pk_add_f32 v[92:93], v[92:93], v[88:89]
  s_nop 0
  s_nop 0
  v_add_f32_dpp v92, v92, v92 row_ror:8 row_mask:0xf bank_mask:0xf
  v_add_f32_dpp v93, v93, v93 row_ror:8 row_mask:0xf bank_mask:0xf
  s_nop 0
  v_add_f32_dpp v92, v92, v92 row_ror:4 row_mask:0xf bank_mask:0xf
  v_add_f32_dpp v93, v93, v93 row_ror:4 row_mask:0xf bank_mask:0xf
  s_nop 0
  v_add_f32_dpp v92, v92, v92 row_ror:2 row_mask:0xf bank_mask:0xf
  v_add_f32_dpp v93, v93, v93 row_ror:2 row_mask:0xf bank_mask:0xf
  s_nop 0
  v_add_f32_dpp v92, v92, v92 row_ror:1 row_mask:0xf bank_mask:0xf
  v_add_f32_dpp v93, v93, v93 row_ror:1 row_mask:0xf bank_mask:0xf
  v_rcp_f32 v92, v92
  v_rcp_f32 v93, v93
  s_nop 0
  v_pk_mul_f32 v[64:65], v[64:65], v[92:93]
  v_pk_mul_f32 v[68:69], v[68:69], v[92:93]
  v_pk_mul_f32 v[88:89], v[88:89], v[92:93]
  v_cvt_pk_bf16_f32 v24, v64, v65
  v_cvt_pk_bf16_f32 v25, v68, v69
  v_cvt_pk_bf16_f32 v26, v88, v89
  buffer_store_dword v24, v11, s[4:7], s54 offen sc1
  buffer_store_dword v25, v11, s[4:7], s54 offen offset:512 sc1
  s_mov_b64 exec, s[40:41]
  buffer_store_dword v26, v12, s[4:7], s54 offen sc1
  s_mov_b64 exec, -1
  s_barrier
  v_mov_b64 v[32:33], -1
  s_xor_b32 s54, s54, 16384
  s_mov_b32 s100, 7
SL_35:
  s_sleep 1
  s_sub_u32 s100, s100, 1
  s_cmp_lg_u32 s100, 0
  s_cbranch_scc1 SL_35
  buffer_store_dword v32, v11, s[4:7], s54 offen sc1
  buffer_store_dword v33, v11, s[4:7], s54 offen offset:512 sc1
  s_mov_b64 exec, s[40:41]
  buffer_store_dword v32, v12, s[4:7], s54 offen sc1
  s_mov_b64 exec, -1
  v_mov_b64 v[72:73], -1
  v_mov_b64 v[74:75], -1
  s_xor_b32 s31, s55, 2
  s_lshl_b32 s31, s31, 19
  s_add_u32 s15, s31, s52
  buffer_store_dwordx4 v[72:75], v2, s[4:7], s15 offen offset:0 sc1
  buffer_store_dwordx4 v[72:75], v2, s[4:7], s15 offen offset:1024 sc1
  s_nop 1
  s_add_u32 s14, s14, 1
  s_cmp_eq_u32 s14, 0
  s_cbranch_scc1 As_w0_z
  s_mov_b32 s100, 13
SL_36:
  s_sleep 1
  s_sub_u32 s100, s100, 1
  s_cmp_lg_u32 s100, 0
  s_cbranch_scc1 SL_36
  s_cmp_lt_i32 s14, 64
  s_cbranch_scc1 As_w0
  s_branch L_end
As_w0_z:
  s_mov_b32 s55, 0
  s_and_b32 s50, s14, 1
  s_lshl_b32 s50, s50, 14
  v_add_u32 v15, s50, v8
  s_lshl_b32 s54, s55, 13
  s_add_u32 s54, s54, s13
  v_mov_b32 v14, 0xf149f2ca
  v_mov_b64 v[90:91], 0
  v_cndmask_b32 v88, v14, 0, s[40:41]
  v_cndmask_b32 v89, v14, 0, s[40:41]
  s_waitcnt vmcnt(0)
  s_barrier
  ds_read_b128 v[48:51], v15 offset:16384
  ds_read_b128 v[52:55], v15 offset:17408
  ds_read_b128 v[56:59], v15 offset:20480
  ds_read_b128 v[60:63], v15 offset:21504
  ds_read_b128 v[40:43], v15 offset:18432
  ds_read_b128 v[44:47], v15 offset:19456
  ds_read_b128 v[16:19], v15 offset:22528
  ds_read_b128 v[20:23], v15 offset:23552
  v_mov_b64 v[64:65], 0
  v_mov_b64 v[66:67], 0
  v_mov_b64 v[68:69], 0
  v_mov_b64 v[70:71], 0
  ds_read_b64_tr_b16 v[72:73], v5 offset:0
  ds_read_b64_tr_b16 v[74:75], v5 offset:64
  ds_read_b64_tr_b16 v[76:77], v5 offset:1024
  ds_read_b64_tr_b16 v[78:79], v5 offset:1088
  s_waitcnt lgkmcnt(0)
  v_smfmac_f32_16x16x64_bf16 v[64:67], v[72:75], v[48:55], v3
  v_smfmac_f32_16x16x64_bf16 v[68:71], v[72:75], v[56:63], v3
  v_smfmac_f32_16x16x64_bf16 v[64:67], v[76:79], v[40:47], v3
  v_smfmac_f32_16x16x64_bf16 v[68:71], v[76:79], v[16:23], v3
  s_waitcnt lgkmcnt(0)
  s_branch As_w0_att
As_w1:
  ds_read_b128 v[48:51], v6 offset:0
  ds_read_b128 v[52:55], v6 offset:1024
  ds_read_b128 v[56:59], v6 offset:2048
  ds_read_b128 v[60:63], v6 offset:3072
  ds_read_b128 v[64:67], v6 offset:4096
  ds_read_b128 v[68:71], v6 offset:5120
  v_mov_b64 v[72:73], 0
  v_mov_b64 v[74:75], 0
  v_mov_b64 v[76:77], 0
  v_mov_b64 v[78:79], 0
  v_mov_b64 v[80:81], 0
  v_mov_b64 v[82:83], 0
  v_mov_b64 v[84:85], 0
  v_mov_b64 v[86:87], 0
  s_and_b32 s55, s14, 3
  s_lshl_b32 s31, s55, 14
  s_add_u32 s31, s31, s13
  s_add_u32 s15, s31, 9216
  s_add_u32 s31, s31, 2048
  s_add_u32 s32, s15, 4096
  s_and_b32 s50, s14, 1
  s_lshl_b32 s50, s50, 14
  v_add_u32 v15, s50, v8
  s_lshl_b32 s54, s55, 15
  s_add_u32 s54, s54, s13
  s_mov_b32 m0, 100352
  s_waitcnt lgkmcnt(0)
  buffer_load_dwordx4 v[16:19], v2, s[4:7], s15 offen offset:0 sc1
  buffer_load_dwordx4 v[20:23], v2, s[4:7], s32 offen offset:0 sc1
  s_sleep 2
P_37:
  buffer_load_dwordx4 v[16:19], v2, s[4:7], s15 offen offset:0 sc1
  buffer_load_dwordx4 v[20:23], v2, s[4:7], s32 offen offset:0 sc1
  s_add_u32 s101, s101, 1
  s_cmp_gt_u32 s101, 262144
  s_cbranch_scc1 L_abort
  s_waitcnt vmcnt(3)
  v_max3_u32 v13, v16, v17, v18
  v_max_u32 v13, v13, v19
  s_waitcnt vmcnt(2)
  v_max3_u32 v13, v13, v20, v21
  v_max3_u32 v13, v13, v22, v23
  v_cmp_eq_u32 vcc, -1, v13
  s_cbranch_vccnz P_37
  ds_write_b128 v8, v[16:19] offset:9216
  v_smfmac_f32_16x16x64_bf16 v[72:75], v[16:19], a[128:135], v3
  ds_write_b128 v8, v[20:23] offset:13312
  v_smfmac_f32_16x16x64_bf16 v[76:79], v[16:19], a[136:143], v3
  buffer_load_dwordx4 v2, s[4:7], s31 offen offset:0 sc1 lds
  v_smfmac_f32_16x16x64_bf16 v[72:75], v[20:23], v[48:55], v3
  ds_read_b128 v[48:51], v6 offset:6144
  buffer_load_dwordx4 v2, s[4:7], s31 offen offset:1024 sc1 lds
  v_smfmac_f32_16x16x64_bf16 v[80:83], v[16:19], a[144:151], v3
  ds_read_b128 v[52:55], v6 offset:7168
  v_smfmac_f32_16x16x64_bf16 v[84:87], v[16:19], a[152:159], v3
  s_waitcnt lgkmcnt(2)
  s_barrier
  ds_read_b128 v[32:35], v8 offset:8192
  ds_read_b128 v[36:39], v8 offset:10240
  v_smfmac_f32_16x16x64_bf16 v[76:79], v[20:23], v[56:63], v3
  ds_read_b128 v[40:43], v8 offset:14336
  s_waitcnt lgkmcnt(2)
  v_smfmac_f32_16x16x64_bf16 v[72:75], v[32:35], a[96:103], v3
  ds_read_b128 v[56:59], v6 offset:32768
  v_smfmac_f32_16x16x64_bf16 v[76:79], v[32:35], a[104:111], v3
  ds_read_b128 v[60:63], v6 offset:33792
  v_smfmac_f32_16x16x64_bf16 v[80:83], v[20:23], v[64:71], v3
  ds_read_b128 v[64:67], v6 offset:34816
  v_smfmac_f32_16x16x64_bf16 v[80:83], v[32:35], a[112:119], v3
  ds_read_b128 v[68:71], v6 offset:35840
  v_smfmac_f32_16x16x64_bf16 v[84:87], v[32:35], a[120:127], v3
  ds_read_b128 v[44:47], v8 offset:11264
  v_smfmac_f32_16x16x64_bf16 v[84:87], v[20:23], v[48:55], v3
  ds_read_b128 v[48:51], v6 offset:36864
  s_waitcnt lgkmcnt(7)
  v_smfmac_f32_16x16x64_bf16 v[72:75], v[36:39], a[160:167], v3
  ds_read_b128 v[52:55], v6 offset:37888
  v_smfmac_f32_16x16x64_bf16 v[76:79], v[36:39], a[168:175], v3
  ds_read_b128 v[32:35], v8 offset:12288
  s_waitcnt lgkmcnt(8)
  s_waitcnt lgkmcnt(6)
  v_smfmac_f32_16x16x64_bf16 v[72:75], v[40:43], v[56:63], v3
  ds_read_b128 v[56:59], v6 offset:38912
  v_smfmac_f32_16x16x64_bf16 v[80:83], v[36:39], a[176:183], v3
  ds_read_b128 v[60:63], v6 offset:39936
  v_smfmac_f32_16x16x64_bf16 v[84:87], v[36:39], a[184:191], v3
  ds_read_b128 v[36:39], v8 offset:15360
  s_waitcnt lgkmcnt(7)
  v_smfmac_f32_16x16x64_bf16 v[76:79], v[40:43], v[64:71], v3
  ds_read_b128 v[64:67], v7 offset:0
  s_waitcnt lgkmcnt(7)
  v_smfmac_f32_16x16x64_bf16 v[72:75], v[44:47], a[192:199], v3
  ds_read_b128 v[68:71], v7 offset:1024
  v_smfmac_f32_16x16x64_bf16 v[76:79], v[44:47], a[200:207], v3
  s_waitcnt vmcnt(0)
  ds_read_b128 v[24:27], v8 offset:2048
  ds_read_b128 v[28:31], v8 offset:3072
  s_waitcnt lgkmcnt(8)
  v_smfmac_f32_16x16x64_bf16 v[80:83], v[40:43], v[48:55], v3
  ds_read_b128 v[48:51], v7 offset:2048
  v_smfmac_f32_16x16x64_bf16 v[80:83], v[44:47], a[208:215], v3
  ds_read_b128 v[52:55], v7 offset:3072
  v_smfmac_f32_16x16x64_bf16 v[84:87], v[44:47], a[216:223], v3
  s_waitcnt lgkmcnt(7)
  v_smfmac_f32_16x16x64_bf16 v[84:87], v[40:43], v[56:63], v3
  ds_read_b128 v[56:59], v7 offset:4096
  s_waitcnt lgkmcnt(3)
  v_max3_u32 v13, v24, v25, v26
  v_max3_u32 v14, v27, v28, v29
  v_max3_u32 v14, v14, v30, v31
  v_max_u32 v13, v13, v14
  v_cmp_eq_u32 vcc, -1, v13
  s_cbranch_vccz F2O_38
F2R_39:
  buffer_load_dwordx4 v2, s[4:7], s31 offen offset:0 sc1 lds
  buffer_load_dwordx4 v2, s[4:7], s31 offen offset:1024 sc1 lds
  s_add_u32 s101, s101, 1
  s_cmp_gt_u32 s101, 262144
  s_cbranch_scc1 L_abort
  s_waitcnt vmcnt(0)
  ds_read_b128 v[24:27], v8 offset:2048
  ds_read_b128 v[28:31], v8 offset:3072
  s_waitcnt lgkmcnt(0)
  v_max3_u32 v13, v24, v25, v26
  v_max3_u32 v14, v27, v28, v29
  v_max3_u32 v14, v14, v30, v31
  v_max_u32 v13, v13, v14
  v_cmp_eq_u32 vcc, -1, v13
  s_cbranch_vccnz F2R_39
F2O_38:
  s_barrier
  ds_read_b128 v[60:63], v7 offset:5120
  v_smfmac_f32_16x16x64_bf16 v[72:75], v[32:35], a[224:231], v3
  ds_read_b128 v[16:19], v8 offset:0
  v_smfmac_f32_16x16x64_bf16 v[76:79], v[32:35], a[232:239], v3
  ds_read_b128 v[20:23], v8 offset:1024
  v_smfmac_f32_16x16x64_bf16 v[72:75], v[36:39], v[64:71], v3
  ds_read_b128 v[64:67], v7 offset:6144
  v_smfmac_f32_16x16x64_bf16 v[80:83], v[32:35], a[240:247], v3
  ds_read_b128 v[68:71], v7 offset:7168
  v_smfmac_f32_16x16x64_bf16 v[84:87], v[32:35], a[248:255], v3
  ds_read_b128 v[44:47], v8 offset:4096
  s_waitcnt lgkmcnt(7)
  v_smfmac_f32_16x16x64_bf16 v[76:79], v[36:39], v[48:55], v3
  ds_read_b128 v[40:43], v8 offset:5120
  v_smfmac_f32_16x16x64_bf16 v[72:75], v[24:27], v[160:167], v3
  ds_read_b128 v[32:35], v8 offset:6144
  v_smfmac_f32_16x16x64_bf16 v[76:79], v[24:27], v[168:175], v3
  ds_read_b128 v[48:51], v15 offset:16384
  s_waitcnt lgkmcnt(8)
  v_smfmac_f32_16x16x64_bf16 v[80:83], v[36:39], v[56:63], v3
  ds_read_b128 v[52:55], v15 offset:17408
  v_smfmac_f32_16x16x64_bf16 v[80:83], v[24:27], v[176:183], v3
  ds_read_b128 v[56:59], v15 offset:20480
  v_smfmac_f32_16x16x64_bf16 v[84:87], v[24:27], v[184:191], v3
  ds_read_b128 v[60:63], v15 offset:21504
  s_waitcnt lgkmcnt(7)
  v_smfmac_f32_16x16x64_bf16 v[84:87], v[36:39], v[64:71], v3
  ds_read_b128 v[36:39], v8 offset:7168
  v_smfmac_f32_16x16x64_bf16 v[72:75], v[28:31], v[192:199], v3
  v_smfmac_f32_16x16x64_bf16 v[76:79], v[28:31], v[200:207], v3
  v_smfmac_f32_16x16x64_bf16 v[80:83], v[28:31], v[208:215], v3
  v_smfmac_f32_16x16x64_bf16 v[84:87], v[28:31], v[216:223], v3
  ds_read_b128 v[24:27], v15 offset:18432
  v_smfmac_f32_16x16x64_bf16 v[72:75], v[16:19], v[96:103], v3
  ds_read_b128 v[28:31], v15 offset:19456
  v_smfmac_f32_16x16x64_bf16 v[76:79], v[16:19], v[104:111], v3
  v_smfmac_f32_16x16x64_bf16 v[80:83], v[16:19], v[112:119], v3
  v_smfmac_f32_16x16x64_bf16 v[84:87], v[16:19], v[120:127], v3
  v_smfmac_f32_16x16x64_bf16 v[72:75], v[20:23], v[128:135], v3
  v_smfmac_f32_16x16x64_bf16 v[76:79], v[20:23], v[136:143], v3
  v_smfmac_f32_16x16x64_bf16 v[80:83], v[20:23], v[144:151], v3
  v_smfmac_f32_16x16x64_bf16 v[84:87], v[20:23], v[152:159], v3
  ds_read_b128 v[16:19], v15 offset:22528
  s_waitcnt lgkmcnt(10)
  v_smfmac_f32_16x16x64_bf16 v[72:75], v[44:47], v[224:231], v3
  ds_read_b128 v[20:23], v15 offset:23552
  v_smfmac_f32_16x16x64_bf16 v[76:79], v[44:47], v[232:239], v3
  s_waitcnt lgkmcnt(10)
  v_smfmac_f32_16x16x64_bf16 v[72:75], v[40:43], a[0:7], v3
  v_smfmac_f32_16x16x64_bf16 v[76:79], v[40:43], a[8:15], v3
  s_waitcnt lgkmcnt(9)
  v_smfmac_f32_16x16x64_bf16 v[72:75], v[32:35], a[32:39], v3
  v_smfmac_f32_16x16x64_bf16 v[76:79], v[32:35], a[40:47], v3
  s_waitcnt lgkmcnt(4)
  v_smfmac_f32_16x16x64_bf16 v[72:75], v[36:39], a[64:71], v3
  v_smfmac_f32_16x16x64_bf16 v[76:79], v[36:39], a[72:79], v3
  v_smfmac_f32_16x16x64_bf16 v[80:83], v[44:47], v[240:247], v3
  v_smfmac_f32_16x16x64_bf16 v[84:87], v[44:47], v[248:255], v3
  v_smfmac_f32_16x16x64_bf16 v[80:83], v[40:43], a[16:23], v3
  s_nop 4
  v_add_f32 v72, v72, v74
  v_add_f32 v73, v73, v75
  v_add_f32 v76, v76, v78
  v_add_f32 v77, v77, v79
  v_cvt_pk_bf16_f32 v72, v72, v73
  v_cvt_pk_bf16_f32 v76, v76, v77
  ds_write2_b32 v4, v72, v76 offset0:0 offset1:64
  v_smfmac_f32_16x16x64_bf16 v[84:87], v[40:43], a[24:31], v3
  v_smfmac_f32_16x16x64_bf16 v[80:83], v[32:35], a[48:55], v3
  v_smfmac_f32_16x16x64_bf16 v[84:87], v[32:35], a[56:63], v3
  v_smfmac_f32_16x16x64_bf16 v[80:83], v[36:39], a[80:87], v3
  v_smfmac_f32_16x16x64_bf16 v[84:87], v[36:39], a[88:95], v3
  s_waitcnt lgkmcnt(0)
  s_barrier
  s_nop 4
  v_pk_add_f32 v[80:81], v[80:81], v[82:83]
  v_pk_add_f32 v[84:85], v[84:85], v[86:87]
  v_cvt_pk_bf16_f32 v80, v80, v81
  v_cvt_pk_bf16_f32 v84, v84, v85
  ds_write2_b32 v9, v80, v84 offset0:0 offset1:128
  s_waitcnt lgkmcnt(0)
  s_barrier
As_w1_att:
  ds_read_b64_tr_b16 v[32:33], v10 offset:0
  ds_read_b64_tr_b16 v[34:35], v10 offset:512
  ds_read_b64_tr_b16 v[36:37], v10 offset:1024
  ds_read_b64_tr_b16 v[38:39], v10 offset:1536
  ds_read_b64_tr_b16 v[40:41], v10 offset:2048
  ds_read_b64_tr_b16 v[42:43], v10 offset:2560
  ds_read_b64_tr_b16 v[44:45], v10 offset:3072
  ds_read_b64_tr_b16 v[46:47], v10 offset:3584
  ds_read_b128 v[72:75], v15 offset:24576
  ds_read_b128 v[76:79], v15 offset:25600
  ds_read_b128 v[80:83], v15 offset:26624
  ds_read_b128 v[84:87], v15 offset:27648
  v_mov_b32 v14, 0xf149f2ca
  v_cndmask_b32 v64, v14, 0, s[42:43]
  v_cndmask_b32 v65, v14, 0, s[44:45]
  v_cndmask_b32 v66, v14, 0, s[46:47]
  v_cndmask_b32 v67, v14, 0, s[48:49]
  s_nop 1
  s_waitcnt lgkmcnt(10)
  s_waitcnt lgkmcnt(3)
  v_mfma_f32_16x16x32_bf16 v[64:67], v[48:51], v[72:75], v[64:67]
  v_mfma_f32_16x16x32_bf16 v[88:91], v[32:35], v[72:75], 0
  s_waitcnt lgkmcnt(2)
  v_mfma_f32_16x16x32_bf16 v[64:67], v[52:55], v[76:79], v[64:67]
  v_mfma_f32_16x16x32_bf16 v[88:91], v[36:39], v[76:79], v[88:91]
  s_waitcnt lgkmcnt(1)
  v_mfma_f32_16x16x32_bf16 v[64:67], v[24:27], v[80:83], v[64:67]
  v_mfma_f32_16x16x32_bf16 v[88:91], v[40:43], v[80:83], v[88:91]
  s_waitcnt lgkmcnt(0)
  v_mfma_f32_16x16x32_bf16 v[64:67], v[28:31], v[84:87], v[64:67]
  v_mfma_f32_16x16x32_bf16 v[88:91], v[44:47], v[84:87], v[88:91]
  s_nop 6
  v_max3_f32 v92, v64, v65, v66
  v_max3_f32 v93, v67, v88, v89
  v_max_f32 v92, v92, v93
  v_mov_b32 v93, v92
  s_nop 1
  v_permlane32_swap_b32 v92, v93
  v_max_f32 v92, v92, v93
  v_mov_b32 v93, v92
  s_nop 1
  v_permlane16_swap_b32 v92, v93
  v_max_f32 v92, v92, v93
  v_mul_f32 v92, s37, v92
  v_pk_fma_f32 v[64:65], v[64:65], s[36:37], v[92:93] op_sel_hi:[1,0,0]
  v_pk_fma_f32 v[66:67], v[66:67], s[36:37], v[92:93] op_sel_hi:[1,0,0]
  v_pk_fma_f32 v[88:89], v[88:89], s[36:37], v[92:93] op_sel_hi:[1,0,0]
  v_exp_f32 v64, v64
  v_exp_f32 v65, v65
  v_exp_f32 v66, v66
  v_exp_f32 v67, v67
  v_exp_f32 v88, v88
  v_exp_f32 v89, v89
  v_pk_add_f32 v[92:93], v[64:65], v[66:67]
  v_pk_add_f32 v[92:93], v[92:93], v[88:89]
  v_add_f32 v92, v92, v93
  v_mov_b32 v93, v92
  s_nop 1
  v_permlane32_swap_b32 v92, v93
  v_add_f32 v92, v92, v93
  v_mov_b32 v93, v92
  s_nop 1
  v_permlane16_swap_b32 v92, v93
  v_add_f32 v92, v92, v93
  v_rcp_f32 v92, v92
  s_nop 0
  v_pk_mul_f32 v[64:65], v[64:65], v[92:93] op_sel_hi:[1,0]
  v_pk_mul_f32 v[66:67], v[66:67], v[92:93] op_sel_hi:[1,0]
  v_pk_mul_f32 v[88:89], v[88:89], v[92:93] op_sel_hi:[1,0]
  v_cvt_pk_bf16_f32 v32, v64, v65
  v_cvt_pk_bf16_f32 v33, v66, v67
  v_mov_b64 v[34:35], 0
  v_cvt_pk_bf16_f32 v36, v88, v89
  buffer_store_dwordx4 v[32:35], v11, s[4:7], s54 offen sc1
  buffer_store_dword v36, v12, s[4:7], s54 offen sc1
  s_barrier
  v_mov_b64 v[40:41], -1
  v_mov_b64 v[42:43], -1
  s_xor_b32 s54, s54, 65536
  s_mov_b32 s100, 7
SL_40:
  s_sleep 1
  s_sub_u32 s100, s100, 1
  s_cmp_lg_u32 s100, 0
  s_cbranch_scc1 SL_40
  buffer_store_dwordx4 v[40:43], v11, s[4:7], s54 offen sc1
  buffer_store_dword v40, v12, s[4:7], s54 offen sc1
  s_add_u32 s14, s14, 1
  s_cmp_eq_u32 s14, 0
  s_cbranch_scc1 As_w1_z
  s_mov_b32 s100, 13
SL_41:
  s_sleep 1
  s_sub_u32 s100, s100, 1
  s_cmp_lg_u32 s100, 0
  s_cbranch_scc1 SL_41
  s_cmp_lt_i32 s14, 64
  s_cbranch_scc1 As_w1
  s_branch L_end
As_w1_z:
  s_mov_b32 s55, 0
  s_and_b32 s50, s14, 1
  s_lshl_b32 s50, s50, 14
  v_add_u32 v15, s50, v8
  s_lshl_b32 s54, s55, 15
  s_add_u32 s54, s54, s13
  s_waitcnt vmcnt(0)
  s_barrier
  ds_read_b128 v[48:51], v15 offset:16384
  ds_read_b128 v[52:55], v15 offset:17408
  ds_read_b128 v[56:59], v15 offset:20480
  ds_read_b128 v[60:63], v15 offset:21504
  ds_read_b128 v[24:27], v15 offset:18432
  ds_read_b128 v[28:31], v15 offset:19456
  ds_read_b128 v[16:19], v15 offset:22528
  ds_read_b128 v[20:23], v15 offset:23552
  s_waitcnt lgkmcnt(0)
  s_branch As_w1_att
As_w2:
  ds_read_b128 v[48:51], v6 offset:32768
  ds_read_b128 v[52:55], v6 offset:33792
  ds_read_b128 v[56:59], v6 offset:34816
  ds_read_b128 v[60:63], v6 offset:35840
  ds_read_b128 v[64:67], v6 offset:36864
  ds_read_b128 v[68:71], v6 offset:37888
  v_mov_b64 v[72:73], 0
  v_mov_b64 v[74:75], 0
  v_mov_b64 v[76:77], 0
  v_mov_b64 v[78:79], 0
  v_mov_b64 v[80:81], 0
  v_mov_b64 v[82:83], 0
  v_mov_b64 v[84:85], 0
  v_mov_b64 v[86:87], 0
  s_and_b32 s55, s14, 3
  s_lshl_b32 s31, s55, 14
  s_add_u32 s31, s31, s13
  s_add_u32 s15, s31, 10240
  s_add_u32 s31, s31, 4096
  s_add_u32 s32, s15, 4096
  s_and_b32 s50, s14, 1
  s_lshl_b32 s50, s50, 14
  v_add_u32 v15, s50, v8
  s_lshl_b32 s54, s55, 15
  s_add_u32 s54, s54, s13
  s_mov_b32 m0, 102400
  s_waitcnt lgkmcnt(0)
  buffer_load_dwordx4 v[16:19], v2, s[4:7], s15 offen offset:0 sc1
  buffer_load_dwordx4 v[20:23], v2, s[4:7], s32 offen offset:0 sc1
  s_sleep 2
P_42:
  buffer_load_dwordx4 v[16:19], v2, s[4:7], s15 offen offset:0 sc1
  buffer_load_dwordx4 v[20:23], v2, s[4:7], s32 offen offset:0 sc1
  s_add_u32 s101, s101, 1
  s_cmp_gt_u32 s101, 262144
  s_cbranch_scc1 L_abort
  s_waitcnt vmcnt(3)
  v_max3_u32 v13, v16, v17, v18
  v_max_u32 v13, v13, v19
  s_waitcnt vmcnt(2)
  v_max3_u32 v13, v13, v20, v21
  v_max3_u32 v13, v13, v22, v23
  v_cmp_eq_u32 vcc, -1, v13
  s_cbranch_vccnz P_42
  ds_write_b128 v8, v[16:19] offset:10240
  v_smfmac_f32_16x16x64_bf16 v[72:75], v[16:19], a[160:167], v3
  ds_write_b128 v8, v[20:23] offset:14336
  v_smfmac_f32_16x16x64_bf16 v[76:79], v[16:19], a[168:175], v3
  buffer_load_dwordx4 v2, s[4:7], s31 offen offset:0 sc1 lds
  v_smfmac_f32_16x16x64_bf16 v[72:75], v[20:23], v[48:55], v3
  ds_read_b128 v[48:51], v6 offset:38912
  buffer_load_dwordx4 v2, s[4:7], s31 offen offset:1024 sc1 lds
  v_smfmac_f32_16x16x64_bf16 v[80:83], v[16:19], a[176:183], v3
  ds_read_b128 v[52:55], v6 offset:39936
  v_smfmac_f32_16x16x64_bf16 v[84:87], v[16:19], a[184:191], v3
  s_waitcnt lgkmcnt(2)
  s_barrier
  ds_read_b128 v[32:35], v8 offset:8192
  ds_read_b128 v[36:39], v8 offset:9216
  v_smfmac_f32_16x16x64_bf16 v[76:79], v[20:23], v[56:63], v3
  ds_read_b128 v[40:43], v8 offset:13312
  s_waitcnt lgkmcnt(2)
  v_smfmac_f32_16x16x64_bf16 v[72:75], v[32:35], a[96:103], v3
  ds_read_b128 v[56:59], v6 offset:0
  v_smfmac_f32_16x16x64_bf16 v[76:79], v[32:35], a[104:111], v3
  ds_read_b128 v[60:63], v6 offset:1024
  v_smfmac_f32_16x16x64_bf16 v[80:83], v[20:23], v[64:71], v3
  ds_read_b128 v[64:67], v6 offset:2048
  v_smfmac_f32_16x16x64_bf16 v[80:83], v[32:35], a[112:119], v3
  ds_read_b128 v[68:71], v6 offset:3072
  v_smfmac_f32_16x16x64_bf16 v[84:87], v[32:35], a[120:127], v3
  ds_read_b128 v[44:47], v8 offset:11264
  v_smfmac_f32_16x16x64_bf16 v[84:87], v[20:23], v[48:55], v3
  ds_read_b128 v[48:51], v6 offset:4096
  s_waitcnt lgkmcnt(7)
  v_smfmac_f32_16x16x64_bf16 v[72:75], v[36:39], a[128:135], v3
  ds_read_b128 v[52:55], v6 offset:5120
  v_smfmac_f32_16x16x64_bf16 v[76:79], v[36:39], a[136:143], v3
  ds_read_b128 v[32:35], v8 offset:12288
  s_waitcnt lgkmcnt(8)
  s_waitcnt lgkmcnt(6)
  v_smfmac_f32_16x16x64_bf16 v[72:75], v[40:43], v[56:63], v3
  ds_read_b128 v[56:59], v6 offset:6144
  v_smfmac_f32_16x16x64_bf16 v[80:83], v[36:39], a[144:151], v3
  ds_read_b128 v[60:63], v6 offset:7168
  v_smfmac_f32_16x16x64_bf16 v[84:87], v[36:39], a[152:159], v3
  ds_read_b128 v[36:39], v8 offset:15360
  s_waitcnt lgkmcnt(7)
  v_smfmac_f32_16x16x64_bf16 v[76:79], v[40:43], v[64:71], v3
  ds_read_b128 v[64:67], v7 offset:0
  s_waitcnt lgkmcnt(7)
  v_smfmac_f32_16x16x64_bf16 v[72:75], v[44:47], a[192:199], v3
  ds_read_b128 v[68:71], v7 offset:1024
  v_smfmac_f32_16x16x64_bf16 v[76:79], v[44:47], a[200:207], v3
  s_waitcnt vmcnt(0)
  ds_read_b128 v[24:27], v8 offset:4096
  ds_read_b128 v[28:31], v8 offset:5120
  s_waitcnt lgkmcnt(8)
  v_smfmac_f32_16x16x64_bf16 v[80:83], v[40:43], v[48:55], v3
  ds_read_b128 v[48:51], v7 offset:2048
  v_smfmac_f32_16x16x64_bf16 v[80:83], v[44:47], a[208:215], v3
  ds_read_b128 v[52:55], v7 offset:3072
  v_smfmac_f32_16x16x64_bf16 v[84:87], v[44:47], a[216:223], v3
  s_waitcnt lgkmcnt(7)
  v_smfmac_f32_16x16x64_bf16 v[84:87], v[40:43], v[56:63], v3
  ds_read_b128 v[56:59], v7 offset:4096
  s_waitcnt lgkmcnt(3)
  v_max3_u32 v13, v24, v25, v26
  v_max3_u32 v14, v27, v28, v29
  v_max3_u32 v14, v14, v30, v31
  v_max_u32 v13, v13, v14
  v_cmp_eq_u32 vcc, -1, v13
  s_cbranch_vccz F2O_43
F2R_44:
  buffer_load_dwordx4 v2, s[4:7], s31 offen offset:0 sc1 lds
  buffer_load_dwordx4 v2, s[4:7], s31 offen offset:1024 sc1 lds
  s_add_u32 s101, s101, 1
  s_cmp_gt_u32 s101, 262144
  s_cbranch_scc1 L_abort
  s_waitcnt vmcnt(0)
  ds_read_b128 v[24:27], v8 offset:4096
  ds_read_b128 v[28:31], v8 offset:5120
  s_waitcnt lgkmcnt(0)
  v_max3_u32 v13, v24, v25, v26
  v_max3_u32 v14, v27, v28, v29
  v_max3_u32 v14, v14, v30, v31
  v_max_u32 v13, v13, v14
  v_cmp_eq_u32 vcc, -1, v13
  s_cbranch_vccnz F2R_44
F2O_43:
  s_barrier
  ds_read_b128 v[60:63], v7 offset:5120
  v_smfmac_f32_16x16x64_bf16 v[72:75], v[32:35], a[224:231], v3
  ds_read_b128 v[16:19], v8 offset:0
  v_smfmac_f32_16x16x64_bf16 v[76:79], v[32:35], a[232:239], v3
  ds_read_b128 v[20:23], v8 offset:1024
  v_smfmac_f32_16x16x64_bf16 v[72:75], v[36:39], v[64:71], v3
  ds_read_b128 v[64:67], v7 offset:6144
  v_smfmac_f32_16x16x64_bf16 v[80:83], v[32:35], a[240:247], v3
  ds_read_b128 v[68:71], v7 offset:7168
  v_smfmac_f32_16x16x64_bf16 v[84:87], v[32:35], a[248:255], v3
  ds_read_b128 v[44:47], v8 offset:2048
  s_waitcnt lgkmcnt(7)
  v_smfmac_f32_16x16x64_bf16 v[76:79], v[36:39], v[48:55], v3
  ds_read_b128 v[40:43], v8 offset:3072
  v_smfmac_f32_16x16x64_bf16 v[72:75], v[24:27], v[224:231], v3
  ds_read_b128 v[32:35], v8 offset:6144
  v_smfmac_f32_16x16x64_bf16 v[76:79], v[24:27], v[232:239], v3
  ds_read_b128 v[48:51], v15 offset:16384
  s_waitcnt lgkmcnt(8)
  v_smfmac_f32_16x16x64_bf16 v[80:83], v[36:39], v[56:63], v3
  ds_read_b128 v[52:55], v15 offset:17408
  v_smfmac_f32_16x16x64_bf16 v[80:83], v[24:27], v[240:247], v3
  ds_read_b128 v[56:59], v15 offset:20480
  v_smfmac_f32_16x16x64_bf16 v[84:87], v[24:27], v[248:255], v3
  ds_read_b128 v[60:63], v15 offset:21504
  s_waitcnt lgkmcnt(7)
  v_smfmac_f32_16x16x64_bf16 v[84:87], v[36:39], v[64:71], v3
  ds_read_b128 v[36:39], v8 offset:7168
  v_smfmac_f32_16x16x64_bf16 v[72:75], v[28:31], a[0:7], v3
  v_smfmac_f32_16x16x64_bf16 v[76:79], v[28:31], a[8:15], v3
  v_smfmac_f32_16x16x64_bf16 v[80:83], v[28:31], a[16:23], v3
  v_smfmac_f32_16x16x64_bf16 v[84:87], v[28:31], a[24:31], v3
  ds_read_b128 v[24:27], v15 offset:18432
  v_smfmac_f32_16x16x64_bf16 v[72:75], v[16:19], v[96:103], v3
  ds_read_b128 v[28:31], v15 offset:19456
  v_smfmac_f32_16x16x64_bf16 v[76:79], v[16:19], v[104:111], v3
  v_smfmac_f32_16x16x64_bf16 v[80:83], v[16:19], v[112:119], v3
  v_smfmac_f32_16x16x64_bf16 v[84:87], v[16:19], v[120:127], v3
  v_smfmac_f32_16x16x64_bf16 v[72:75], v[20:23], v[128:135], v3
  v_smfmac_f32_16x16x64_bf16 v[76:79], v[20:23], v[136:143], v3
  v_smfmac_f32_16x16x64_bf16 v[80:83], v[20:23], v[144:151], v3
  v_smfmac_f32_16x16x64_bf16 v[84:87], v[20:23], v[152:159], v3
  ds_read_b128 v[16:19], v15 offset:22528
  s_waitcnt lgkmcnt(10)
  v_smfmac_f32_16x16x64_bf16 v[72:75], v[44:47], v[160:167], v3
  ds_read_b128 v[20:23], v15 offset:23552
  v_smfmac_f32_16x16x64_bf16 v[76:79], v[44:47], v[168:175], v3
  s_waitcnt lgkmcnt(10)
  v_smfmac_f32_16x16x64_bf16 v[72:75], v[40:43], v[192:199], v3
  v_smfmac_f32_16x16x64_bf16 v[76:79], v[40:43], v[200:207], v3
  s_waitcnt lgkmcnt(9)
  v_smfmac_f32_16x16x64_bf16 v[72:75], v[32:35], a[32:39], v3
  v_smfmac_f32_16x16x64_bf16 v[76:79], v[32:35], a[40:47], v3
  s_waitcnt lgkmcnt(4)
  v_smfmac_f32_16x16x64_bf16 v[72:75], v[36:39], a[64:71], v3
  v_smfmac_f32_16x16x64_bf16 v[76:79], v[36:39], a[72:79], v3
  v_smfmac_f32_16x16x64_bf16 v[80:83], v[44:47], v[176:183], v3
  v_smfmac_f32_16x16x64_bf16 v[84:87], v[44:47], v[184:191], v3
  v_smfmac_f32_16x16x64_bf16 v[80:83], v[40:43], v[208:215], v3
  s_nop 4
  v_add_f32 v72, v72, v74
  v_add_f32 v73, v73, v75
  v_add_f32 v76, v76, v78
  v_add_f32 v77, v77, v79
  v_cvt_pk_bf16_f32 v72, v72, v73
  v_cvt_pk_bf16_f32 v76, v76, v77
  ds_write2_b32 v4, v72, v76 offset0:0 offset1:64
  v_smfmac_f32_16x16x64_bf16 v[84:87], v[40:43], v[216:223], v3
  v_smfmac_f32_16x16x64_bf16 v[80:83], v[32:35], a[48:55], v3
  v_smfmac_f32_16x16x64_bf16 v[84:87], v[32:35], a[56:63], v3
  v_smfmac_f32_16x16x64_bf16 v[80:83], v[36:39], a[80:87], v3
  v_smfmac_f32_16x16x64_bf16 v[84:87], v[36:39], a[88:95], v3
  s_waitcnt lgkmcnt(0)
  s_barrier
  s_nop 4
  v_pk_add_f32 v[80:81], v[80:81], v[82:83]
  v_pk_add_f32 v[84:85], v[84:85], v[86:87]
  v_cvt_pk_bf16_f32 v80, v80, v81
  v_cvt_pk_bf16_f32 v84, v84, v85
  ds_write2_b32 v9, v80, v84 offset0:0 offset1:128
  s_waitcnt lgkmcnt(0)
  s_barrier
As_w2_att:
  ds_read_b64_tr_b16 v[32:33], v10 offset:0
  ds_read_b64_tr_b16 v[34:35], v10 offset:512
  ds_read_b64_tr_b16 v[36:37], v10 offset:1024
  ds_read_b64_tr_b16 v[38:39], v10 offset:1536
  ds_read_b64_tr_b16 v[40:41], v10 offset:2048
  ds_read_b64_tr_b16 v[42:43], v10 offset:2560
  ds_read_b64_tr_b16 v[44:45], v10 offset:3072
  ds_read_b64_tr_b16 v[46:47], v10 offset:3584
  ds_read_b128 v[72:75], v15 offset:28672
  ds_read_b128 v[76:79], v15 offset:29696
  ds_read_b128 v[80:83], v15 offset:30720
  ds_read_b128 v[84:87], v15 offset:31744
  v_mov_b32 v14, 0xf149f2ca
  v_cndmask_b32 v68, v14, 0, s[42:43]
  v_cndmask_b32 v69, v14, 0, s[44:45]
  v_cndmask_b32 v70, v14, 0, s[46:47]
  v_cndmask_b32 v71, v14, 0, s[48:49]
  s_nop 1
  s_waitcnt lgkmcnt(10)
  s_waitcnt lgkmcnt(3)
  v_mfma_f32_16x16x32_bf16 v[64:67], v[48:51], v[72:75], 0
  v_mfma_f32_16x16x32_bf16 v[68:71], v[56:59], v[72:75], v[68:71]
  v_mfma_f32_16x16x32_bf16 v[88:91], v[32:35], v[72:75], 0
  s_waitcnt lgkmcnt(2)
  v_mfma_f32_16x16x32_bf16 v[64:67], v[52:55], v[76:79], v[64:67]
  v_mfma_f32_16x16x32_bf16 v[68:71], v[60:63], v[76:79], v[68:71]
  v_mfma_f32_16x16x32_bf16 v[88:91], v[36:39], v[76:79], v[88:91]
  s_waitcnt lgkmcnt(1)
  v_mfma_f32_16x16x32_bf16 v[64:67], v[24:27], v[80:83], v[64:67]
  v_mfma_f32_16x16x32_bf16 v[68:71], v[16:19], v[80:83], v[68:71]
  v_mfma_f32_16x16x32_bf16 v[88:91], v[40:43], v[80:83], v[88:91]
  s_waitcnt lgkmcnt(0)
  v_mfma_f32_16x16x32_bf16 v[64:67], v[28:31], v[84:87], v[64:67]
  v_mfma_f32_16x16x32_bf16 v[68:71], v[20:23], v[84:87], v[68:71]
  v_mfma_f32_16x16x32_bf16 v[88:91], v[44:47], v[84:87], v[88:91]
  s_nop 5
  v_max3_f32 v92, v64, v65, v66
  v_max3_f32 v93, v67, v68, v69
  v_max3_f32 v92, v92, v70, v71
  v_max3_f32 v93, v93, v88, v89
  v_max_f32 v92, v92, v93
  v_mov_b32 v93, v92
  s_nop 1
  v_permlane32_swap_b32 v92, v93
  v_max_f32 v92, v92, v93
  v_mov_b32 v93, v92
  s_nop 1
  v_permlane16_swap_b32 v92, v93
  v_max_f32 v92, v92, v93
  v_mul_f32 v92, s37, v92
  v_pk_fma_f32 v[64:65], v[64:65], s[36:37], v[92:93] op_sel_hi:[1,0,0]
  v_pk_fma_f32 v[66:67], v[66:67], s[36:37], v[92:93] op_sel_hi:[1,0,0]
  v_pk_fma_f32 v[68:69], v[68:69], s[36:37], v[92:93] op_sel_hi:[1,0,0]
  v_pk_fma_f32 v[70:71], v[70:71], s[36:37], v[92:93] op_sel_hi:[1,0,0]
  v_pk_fma_f32 v[88:89], v[88:89], s[36:37], v[92:93] op_sel_hi:[1,0,0]
  v_exp_f32 v64, v64
  v_exp_f32 v65, v65
  v_exp_f32 v66, v66
  v_exp_f32 v67, v67
  v_exp_f32 v68, v68
  v_exp_f32 v69, v69
  v_exp_f32 v70, v70
  v_exp_f32 v71, v71
  v_exp_f32 v88, v88
  v_exp_f32 v89, v89
  v_pk_add_f32 v[92:93], v[64:65], v[66:67]
  v_pk_add_f32 v[92:93], v[92:93], v[68:69]
  v_pk_add_f32 v[92:93], v[92:93], v[70:71]
  v_pk_add_f32 v[92:93], v[92:93], v[88:89]
  v_add_f32 v92, v92, v93
  v_mov_b32 v93, v92
  s_nop 1
  v_permlane32_swap_b32 v92, v93
  v_add_f32 v92, v92, v93
  v_mov_b32 v93, v92
  s_nop 1
  v_permlane16_swap_b32 v92, v93
  v_add_f32 v92, v92, v93
  v_rcp_f32 v92, v92
  s_nop 0
  v_pk_mul_f32 v[64:65], v[64:65], v[92:93] op_sel_hi:[1,0]
  v_pk_mul_f32 v[66:67], v[66:67], v[92:93] op_sel_hi:[1,0]
  v_pk_mul_f32 v[68:69], v[68:69], v[92:93] op_sel_hi:[1,0]
  v_pk_mul_f32 v[70:71], v[70:71], v[92:93] op_sel_hi:[1,0]
  v_pk_mul_f32 v[88:89], v[88:89], v[92:93] op_sel_hi:[1,0]
  v_cvt_pk_bf16_f32 v32, v64, v65
  v_cvt_pk_bf16_f32 v33, v66, v67
  v_cvt_pk_bf16_f32 v34, v68, v69
  v_cvt_pk_bf16_f32 v35, v70, v71
  v_cvt_pk_bf16_f32 v36, v88, v89
  buffer_store_dwordx4 v[32:35], v11, s[4:7], s54 offen sc1
  buffer_store_dword v36, v12, s[4:7], s54 offen sc1
  s_barrier
  v_mov_b64 v[40:41], -1
  v_mov_b64 v[42:43], -1
  s_xor_b32 s54, s54, 65536
  s_mov_b32 s100, 7
SL_45:
  s_sleep 1
  s_sub_u32 s100, s100, 1
  s_cmp_lg_u32 s100, 0
  s_cbranch_scc1 SL_45
  buffer_store_dwordx4 v[40:43], v11, s[4:7], s54 offen sc1
  buffer_store_dword v40, v12, s[4:7], s54 offen sc1
  s_add_u32 s14, s14, 1
  s_cmp_eq_u32 s14, 0
  s_cbranch_scc1 As_w2_z
  s_mov_b32 s100, 13
SL_46:
  s_sleep 1
  s_sub_u32 s100, s100, 1
  s_cmp_lg_u32 s100, 0
  s_cbranch_scc1 SL_46
  s_cmp_lt_i32 s14, 64
  s_cbranch_scc1 As_w2
  s_branch L_end
As_w2_z:
  s_mov_b32 s55, 0
  s_and_b32 s50, s14, 1
  s_lshl_b32 s50, s50, 14
  v_add_u32 v15, s50, v8
  s_lshl_b32 s54, s55, 15
  s_add_u32 s54, s54, s13
  s_waitcnt vmcnt(0)
  s_barrier
  ds_read_b128 v[48:51], v15 offset:16384
  ds_read_b128 v[52:55], v15 offset:17408
  ds_read_b128 v[56:59], v15 offset:20480
  ds_read_b128 v[60:63], v15 offset:21504
  ds_read_b128 v[24:27], v15 offset:18432
  ds_read_b128 v[28:31], v15 offset:19456
  ds_read_b128 v[16:19], v15 offset:22528
  ds_read_b128 v[20:23], v15 offset:23552
  s_waitcnt lgkmcnt(0)
  s_branch As_w2_att
As_w3:
  ds_read_b128 v[48:51], v7 offset:0
  ds_read_b128 v[52:55], v7 offset:1024
  ds_read_b128 v[56:59], v7 offset:2048
  ds_read_b128 v[60:63], v7 offset:3072
  ds_read_b128 v[64:67], v7 offset:4096
  ds_read_b128 v[68:71], v7 offset:5120
  v_mov_b64 v[72:73], 0
  v_mov_b64 v[74:75], 0
  v_mov_b64 v[76:77], 0
  v_mov_b64 v[78:79], 0
  v_mov_b64 v[80:81], 0
  v_mov_b64 v[82:83], 0
  v_mov_b64 v[84:85], 0
  v_mov_b64 v[86:87], 0
  s_and_b32 s55, s14, 3
  s_lshl_b32 s31, s55, 14
  s_add_u32 s31, s31, s13
  s_add_u32 s15, s31, 11264
  s_add_u32 s31, s31, 6144
  s_add_u32 s32, s15, 4096
  s_and_b32 s50, s14, 1
  s_lshl_b32 s50, s50, 14
  v_add_u32 v15, s50, v8
  s_lshl_b32 s54, s55, 15
  s_add_u32 s54, s54, s13
  s_mov_b32 m0, 104448
  s_waitcnt lgkmcnt(0)
  buffer_load_dwordx4 v[16:19], v2, s[4:7], s15 offen offset:0 sc1
  buffer_load_dwordx4 v[20:23], v2, s[4:7], s32 offen offset:0 sc1
  s_sleep 2
P_47:
  buffer_load_dwordx4 v[16:19], v2, s[4:7], s15 offen offset:0 sc1
  buffer_load_dwordx4 v[20:23], v2, s[4:7], s32 offen offset:0 sc1
  s_add_u32 s101, s101, 1
  s_cmp_gt_u32 s101, 262144
  s_cbranch_scc1 L_abort
  s_waitcnt vmcnt(3)
  v_max3_u32 v13, v16, v17, v18
  v_max_u32 v13, v13, v19
  s_waitcnt vmcnt(2)
  v_max3_u32 v13, v13, v20, v21
  v_max3_u32 v13, v13, v22, v23
  v_cmp_eq_u32 vcc, -1, v13
  s_cbranch_vccnz P_47
  ds_write_b128 v8, v[16:19] offset:11264
  v_smfmac_f32_16x16x64_bf16 v[72:75], v[16:19], a[192:199], v3
  ds_write_b128 v8, v[20:23] offset:15360
  v_smfmac_f32_16x16x64_bf16 v[76:79], v[16:19], a[200:207], v3
  buffer_load_dwordx4 v2, s[4:7], s31 offen offset:0 sc1 lds
  v_smfmac_f32_16x16x64_bf16 v[72:75], v[20:23], v[48:55], v3
  ds_read_b128 v[48:51], v7 offset:6144
  buffer_load_dwordx4 v2, s[4:7], s31 offen offset:1024 sc1 lds
  v_smfmac_f32_16x16x64_bf16 v[80:83], v[16:19], a[208:215], v3
  ds_read_b128 v[52:55], v7 offset:7168
  v_smfmac_f32_16x16x64_bf16 v[84:87], v[16:19], a[216:223], v3
  s_waitcnt lgkmcnt(2)
  s_barrier
  ds_read_b128 v[32:35], v8 offset:8192
  ds_read_b128 v[36:39], v8 offset:9216
  v_smfmac_f32_16x16x64_bf16 v[76:79], v[20:23], v[56:63], v3
  ds_read_b128 v[40:43], v8 offset:13312
  s_waitcnt lgkmcnt(2)
  v_smfmac_f32_16x16x64_bf16 v[72:75], v[32:35], a[96:103], v3
  ds_read_b128 v[56:59], v6 offset:0
  v_smfmac_f32_16x16x64_bf16 v[76:79], v[32:35], a[104:111], v3
  ds_read_b128 v[60:63], v6 offset:1024
  v_smfmac_f32_16x16x64_bf16 v[80:83], v[20:23], v[64:71], v3
  ds_read_b128 v[64:67], v6 offset:2048
  v_smfmac_f32_16x16x64_bf16 v[80:83], v[32:35], a[112:119], v3
  ds_read_b128 v[68:71], v6 offset:3072
  v_smfmac_f32_16x16x64_bf16 v[84:87], v[32:35], a[120:127], v3
  ds_read_b128 v[44:47], v8 offset:10240
  v_smfmac_f32_16x16x64_bf16 v[84:87], v[20:23], v[48:55], v3
  ds_read_b128 v[48:51], v6 offset:4096
  s_waitcnt lgkmcnt(7)
  v_smfmac_f32_16x16x64_bf16 v[72:75], v[36:39], a[128:135], v3
  ds_read_b128 v[52:55], v6 offset:5120
  v_smfmac_f32_16x16x64_bf16 v[76:79], v[36:39], a[136:143], v3
  ds_read_b128 v[32:35], v8 offset:12288
  s_waitcnt lgkmcnt(8)
  s_waitcnt lgkmcnt(6)
  v_smfmac_f32_16x16x64_bf16 v[72:75], v[40:43], v[56:63], v3
  ds_read_b128 v[56:59], v6 offset:6144
  v_smfmac_f32_16x16x64_bf16 v[80:83], v[36:39], a[144:151], v3
  ds_read_b128 v[60:63], v6 offset:7168
  v_smfmac_f32_16x16x64_bf16 v[84:87], v[36:39], a[152:159], v3
  ds_read_b128 v[36:39], v8 offset:14336
  s_waitcnt lgkmcnt(7)
  v_smfmac_f32_16x16x64_bf16 v[76:79], v[40:43], v[64:71], v3
  ds_read_b128 v[64:67], v6 offset:32768
  s_waitcnt lgkmcnt(7)
  v_smfmac_f32_16x16x64_bf16 v[72:75], v[44:47], a[160:167], v3
  ds_read_b128 v[68:71], v6 offset:33792
  v_smfmac_f32_16x16x64_bf16 v[76:79], v[44:47], a[168:175], v3
  s_waitcnt vmcnt(0)
  ds_read_b128 v[24:27], v8 offset:6144
  ds_read_b128 v[28:31], v8 offset:7168
  s_waitcnt lgkmcnt(8)
  v_smfmac_f32_16x16x64_bf16 v[80:83], v[40:43], v[48:55], v3
  ds_read_b128 v[48:51], v6 offset:34816
  v_smfmac_f32_16x16x64_bf16 v[80:83], v[44:47], a[176:183], v3
  ds_read_b128 v[52:55], v6 offset:35840
  v_smfmac_f32_16x16x64_bf16 v[84:87], v[44:47], a[184:191], v3
  s_waitcnt lgkmcnt(7)
  v_smfmac_f32_16x16x64_bf16 v[84:87], v[40:43], v[56:63], v3
  ds_read_b128 v[56:59], v6 offset:36864
  s_waitcnt lgkmcnt(3)
  v_max3_u32 v13, v24, v25, v26
  v_max3_u32 v14, v27, v28, v29
  v_max3_u32 v14, v14, v30, v31
  v_max_u32 v13, v13, v14
  v_cmp_eq_u32 vcc, -1, v13
  s_cbranch_vccz F2O_48
F2R_49:
  buffer_load_dwordx4 v2, s[4:7], s31 offen offset:0 sc1 lds
  buffer_load_dwordx4 v2, s[4:7], s31 offen offset:1024 sc1 lds
  s_add_u32 s101, s101, 1
  s_cmp_gt_u32 s101, 262144
  s_cbranch_scc1 L_abort
  s_waitcnt vmcnt(0)
  ds_read_b128 v[24:27], v8 offset:6144
  ds_read_b128 v[28:31], v8 offset:7168
  s_waitcnt lgkmcnt(0)
  v_max3_u32 v13, v24, v25, v26
  v_max3_u32 v14, v27, v28, v29
  v_max3_u32 v14, v14, v30, v31
  v_max_u32 v13, v13, v14
  v_cmp_eq_u32 vcc, -1, v13
  s_cbranch_vccnz F2R_49
F2O_48:
  s_barrier
  ds_read_b128 v[60:63], v6 offset:37888
  v_smfmac_f32_16x16x64_bf16 v[72:75], v[32:35], a[224:231], v3
  ds_read_b128 v[16:19], v8 offset:0
  v_smfmac_f32_16x16x64_bf16 v[76:79], v[32:35], a[232:239], v3
  ds_read_b128 v[20:23], v8 offset:1024
  v_smfmac_f32_16x16x64_bf16 v[72:75], v[36:39], v[64:71], v3
  ds_read_b128 v[64:67], v6 offset:38912
  v_smfmac_f32_16x16x64_bf16 v[80:83], v[32:35], a[240:247], v3
  ds_read_b128 v[68:71], v6 offset:39936
  v_smfmac_f32_16x16x64_bf16 v[84:87], v[32:35], a[248:255], v3
  ds_read_b128 v[44:47], v8 offset:2048
  s_waitcnt lgkmcnt(7)
  v_smfmac_f32_16x16x64_bf16 v[76:79], v[36:39], v[48:55], v3
  ds_read_b128 v[40:43], v8 offset:3072
  v_smfmac_f32_16x16x64_bf16 v[72:75], v[24:27], a[32:39], v3
  ds_read_b128 v[32:35], v8 offset:4096
  v_smfmac_f32_16x16x64_bf16 v[76:79], v[24:27], a[40:47], v3
  s_waitcnt lgkmcnt(7)
  v_smfmac_f32_16x16x64_bf16 v[80:83], v[36:39], v[56:63], v3
  v_smfmac_f32_16x16x64_bf16 v[80:83], v[24:27], a[48:55], v3
  v_smfmac_f32_16x16x64_bf16 v[84:87], v[24:27], a[56:63], v3
  s_waitcnt lgkmcnt(3)
  v_smfmac_f32_16x16x64_bf16 v[84:87], v[36:39], v[64:71], v3
  ds_read_b128 v[36:39], v8 offset:5120
  v_smfmac_f32_16x16x64_bf16 v[72:75], v[28:31], a[64:71], v3
  v_smfmac_f32_16x16x64_bf16 v[76:79], v[28:31], a[72:79], v3
  v_smfmac_f32_16x16x64_bf16 v[80:83], v[28:31], a[80:87], v3
  v_smfmac_f32_16x16x64_bf16 v[84:87], v[28:31], a[88:95], v3
  v_smfmac_f32_16x16x64_bf16 v[72:75], v[16:19], v[96:103], v3
  v_smfmac_f32_16x16x64_bf16 v[76:79], v[16:19], v[104:111], v3
  v_smfmac_f32_16x16x64_bf16 v[80:83], v[16:19], v[112:119], v3
  v_smfmac_f32_16x16x64_bf16 v[84:87], v[16:19], v[120:127], v3
  v_smfmac_f32_16x16x64_bf16 v[72:75], v[20:23], v[128:135], v3
  v_smfmac_f32_16x16x64_bf16 v[76:79], v[20:23], v[136:143], v3
  v_smfmac_f32_16x16x64_bf16 v[80:83], v[20:23], v[144:151], v3
  v_smfmac_f32_16x16x64_bf16 v[84:87], v[20:23], v[152:159], v3
  s_waitcnt lgkmcnt(3)
  v_smfmac_f32_16x16x64_bf16 v[72:75], v[44:47], v[160:167], v3
  v_smfmac_f32_16x16x64_bf16 v[76:79], v[44:47], v[168:175], v3
  s_waitcnt lgkmcnt(2)
  v_smfmac_f32_16x16x64_bf16 v[72:75], v[40:43], v[192:199], v3
  v_smfmac_f32_16x16x64_bf16 v[76:79], v[40:43], v[200:207], v3
  s_waitcnt lgkmcnt(1)
  v_smfmac_f32_16x16x64_bf16 v[72:75], v[32:35], v[224:231], v3
  v_smfmac_f32_16x16x64_bf16 v[76:79], v[32:35], v[232:239], v3
  s_waitcnt lgkmcnt(0)
  v_smfmac_f32_16x16x64_bf16 v[72:75], v[36:39], a[0:7], v3
  v_smfmac_f32_16x16x64_bf16 v[76:79], v[36:39], a[8:15], v3
  v_smfmac_f32_16x16x64_bf16 v[80:83], v[44:47], v[176:183], v3
  v_smfmac_f32_16x16x64_bf16 v[84:87], v[44:47], v[184:191], v3
  v_smfmac_f32_16x16x64_bf16 v[80:83], v[40:43], v[208:215], v3
  s_nop 4
  v_add_f32 v72, v72, v74
  v_add_f32 v73, v73, v75
  v_add_f32 v76, v76, v78
  v_add_f32 v77, v77, v79
  v_cvt_pk_bf16_f32 v72, v72, v73
  v_cvt_pk_bf16_f32 v76, v76, v77
  ds_write2_b32 v4, v72, v76 offset0:0 offset1:64
  v_smfmac_f32_16x16x64_bf16 v[84:87], v[40:43], v[216:223], v3
  v_smfmac_f32_16x16x64_bf16 v[80:83], v[32:35], v[240:247], v3
  v_smfmac_f32_16x16x64_bf16 v[84:87], v[32:35], v[248:255], v3
  v_smfmac_f32_16x16x64_bf16 v[80:83], v[36:39], a[16:23], v3
  v_smfmac_f32_16x16x64_bf16 v[84:87], v[36:39], a[24:31], v3
  s_waitcnt lgkmcnt(0)
  s_barrier
  s_nop 4
  v_pk_add_f32 v[80:81], v[80:81], v[82:83]
  v_pk_add_f32 v[84:85], v[84:85], v[86:87]
  v_cvt_pk_bf16_f32 v80, v80, v81
  v_cvt_pk_bf16_f32 v84, v84, v85
  ds_write2_b32 v9, v80, v84 offset0:0 offset1:128
  s_waitcnt lgkmcnt(0)
  s_barrier
As_w3_att:
  s_barrier
  s_nop 1
  s_xor_b32 s33, s55, 2
  s_cmp_lt_i32 s14, 2
  s_cbranch_scc1 AC_50
  s_lshl_b32 s15, s33, 16
  s_lshl_b32 s32, s12, 13
  s_add_u32 s15, s15, s32
  s_add_u32 s15, s15, s13
  s_add_u32 s15, s15, 262144
  s_add_u32 s31, s15, 4096
  buffer_load_dwordx4 v[16:19], v2, s[4:7], s15 offen offset:0 sc1
  buffer_load_dwordx4 v[20:23], v2, s[4:7], s15 offen offset:1024 sc1
  buffer_load_dwordx4 v[24:27], v2, s[4:7], s15 offen offset:2048 sc1
  buffer_load_dwordx4 v[28:31], v2, s[4:7], s15 offen offset:3072 sc1
  buffer_load_dwordx4 v[32:35], v2, s[4:7], s31 offen offset:0 sc1
  buffer_load_dwordx4 v[36:39], v2, s[4:7], s31 offen offset:1024 sc1
  buffer_load_dwordx4 v[40:43], v2, s[4:7], s31 offen offset:2048 sc1
  buffer_load_dwordx4 v[44:47], v2, s[4:7], s31 offen offset:3072 sc1
  s_sub_u32 s15, s14, 2
  s_lshl_b32 s15, s15, 16
  s_add_u32 s15, s15, s32
  s_lshl_b32 s31, s94, 22
  s_add_u32 s15, s15, s31
  s_add_u32 s15, s15, 0x4800000
  s_add_u32 s31, s15, 4096
  s_waitcnt vmcnt(7)
  buffer_store_dwordx4 v[16:19], v2, s[4:7], s15 offen offset:0 sc1
  s_waitcnt vmcnt(7)
  buffer_store_dwordx4 v[20:23], v2, s[4:7], s15 offen offset:1024 sc1
  s_waitcnt vmcnt(7)
  buffer_store_dwordx4 v[24:27], v2, s[4:7], s15 offen offset:2048 sc1
  s_waitcnt vmcnt(7)
  buffer_store_dwordx4 v[28:31], v2, s[4:7], s15 offen offset:3072 sc1
  s_waitcnt vmcnt(7)
  buffer_store_dwordx4 v[32:35], v2, s[4:7], s31 offen offset:0 sc1
  s_waitcnt vmcnt(7)
  buffer_store_dwordx4 v[36:39], v2, s[4:7], s31 offen offset:1024 sc1
  s_waitcnt vmcnt(7)
  buffer_store_dwordx4 v[40:43], v2, s[4:7], s31 offen offset:2048 sc1
  s_waitcnt vmcnt(7)
  buffer_store_dwordx4 v[44:47], v2, s[4:7], s31 offen offset:3072 sc1
AC_50:
  s_cmp_lg_u32 s55, 2
  s_cbranch_scc1 AF_51
  s_cmp_lt_i32 s14, 6
  s_cbranch_scc1 AF_51
  s_sub_u32 s15, s14, 6
  s_lshl_b32 s15, s15, 9
  s_lshl_b32 s31, s56, 2
  s_add_u32 s15, s15, s31
  s_add_u32 s15, s15, 0x7600300
  s_mov_b64 exec, 1
  buffer_store_dword v3, v2, s[4:7], s15 offen sc1
  s_mov_b64 exec, -1
AF_51:
  s_add_u32 s53, s14, 1
  s_cmp_ge_u32 s53, 64
  s_cbranch_scc1 AN_52
  s_and_b32 s15, s53, 3
  s_cmp_lg_u32 s15, 0
  s_cbranch_scc1 QD_53
  s_lshr_b32 s15, s53, 2
  s_lshl_b32 s15, s15, 11
  s_lshr_b32 s97, s56, 1
  s_lshl_b32 s97, s97, 2
  s_add_u32 s15, s15, s97
  s_add_u32 s15, s15, 0x7600000
  v_lshlrev_b32 v14, 6, v1
  s_mov_b32 exec_lo, 0x3
  s_mov_b32 exec_hi, 0x0
F_54:
  buffer_load_dword v13, v14, s[4:7], s15 offen sc1
  s_waitcnt vmcnt(0)
  v_cmp_eq_u32 vcc, 0, v13
  s_cbranch_vccz FE_55
  s_add_u32 s101, s101, 1
  s_cmp_gt_u32 s101, 262144
  s_cbranch_scc1 L_abort
  s_sleep 2
  s_branch F_54
FE_55:
  s_mov_b64 exec, -1
QD_53:
  s_and_b32 s31, s53, 1
  s_lshl_b32 s31, s31, 14
  s_add_u32 s31, s31, 114688
  s_lshl_b32 s15, s53, 18
  s_lshl_b32 s32, s56, 12
  s_add_u32 s15, s15, s32
  s_add_u32 s32, s15, 0x1000000
  s_add_u32 m0, s31, 0
  s_nop 0
  buffer_load_dwordx4 v2, s[4:7], s32 offen offset:0 sc1 nt lds
  buffer_load_dwordx4 v2, s[4:7], s32 offen offset:1024 sc1 nt lds
  buffer_load_dwordx4 v2, s[4:7], s32 offen offset:2048 sc1 nt lds
  buffer_load_dwordx4 v2, s[4:7], s32 offen offset:3072 sc1 nt lds
  s_add_u32 s32, s15, 0x1020000
  s_add_u32 m0, s31, 4096
  s_nop 0
  buffer_load_dwordx4 v2, s[4:7], s32 offen offset:0 sc1 nt lds
  buffer_load_dwordx4 v2, s[4:7], s32 offen offset:1024 sc1 nt lds
  buffer_load_dwordx4 v2, s[4:7], s32 offen offset:2048 sc1 nt lds
  buffer_load_dwordx4 v2, s[4:7], s32 offen offset:3072 sc1 nt lds
  s_add_u32 s32, s15, 0x0
  s_add_u32 m0, s31, 8192
  s_nop 0
  buffer_load_dwordx4 v2, s[4:7], s32 offen offset:0 sc1 nt lds
  buffer_load_dwordx4 v2, s[4:7], s32 offen offset:1024 sc1 nt lds
  buffer_load_dwordx4 v2, s[4:7], s32 offen offset:2048 sc1 nt lds
  buffer_load_dwordx4 v2, s[4:7], s32 offen offset:3072 sc1 nt lds
  s_add_u32 s32, s15, 0x20000
  s_add_u32 m0, s31, 12288
  s_nop 0
  buffer_load_dwordx4 v2, s[4:7], s32 offen offset:0 sc1 nt lds
  buffer_load_dwordx4 v2, s[4:7], s32 offen offset:1024 sc1 nt lds
  buffer_load_dwordx4 v2, s[4:7], s32 offen offset:2048 sc1 nt lds
  buffer_load_dwordx4 v2, s[4:7], s32 offen offset:3072 sc1 nt lds
AN_52:
  s_add_u32 s14, s14, 1
  s_cmp_eq_u32 s14, 0
  s_cbranch_scc1 As_w3_z
  s_mov_b32 s100, 7
SL_56:
  s_sleep 1
  s_sub_u32 s100, s100, 1
  s_cmp_lg_u32 s100, 0
  s_cbranch_scc1 SL_56
  s_cmp_lt_i32 s14, 64
  s_cbranch_scc1 As_w3
  s_branch L_end
As_w3_z:
  s_mov_b32 s55, 0
  s_and_b32 s50, s14, 1
  s_lshl_b32 s50, s50, 14
  v_add_u32 v15, s50, v8
  s_lshl_b32 s54, s55, 15
  s_add_u32 s54, s54, s13
  s_waitcnt vmcnt(0)
  s_barrier
  s_waitcnt lgkmcnt(0)
  s_branch As_w3_att
B_entry:
  s_and_b32 s34, s95, 1
  s_lshr_b32 s35, s95, 1
  v_and_b32 v13, 2, v1
  v_mov_b32 v3, 0x4444
  v_mov_b32 v14, 0xeeee
  v_cmp_ne_u32 vcc, 0, v13
  s_nop 1
  v_cndmask_b32 v3, v3, v14, vcc
  v_bfe_u32 v13, v1, 2, 3
  v_lshrrev_b32 v14, 5, v1
  v_lshlrev_b32 v14, 4, v14
  v_add_u32 v14, v14, v13
  v_lshlrev_b32 v14, 8, v14
  v_and_b32 v15, 3, v1
  v_lshlrev_b32 v15, 3, v15
  v_add_u32 v14, v14, v15
  s_lshl_b32 s15, s95, 1
  v_xor_b32 v15, s15, v13
  v_lshlrev_b32 v15, 5, v15
  v_add_u32 v4, v14, v15
  s_add_u32 s15, s15, 1
  v_xor_b32 v15, s15, v13
  v_lshlrev_b32 v15, 5, v15
  v_add_u32 v5, v14, v15
  s_lshl_b32 s15, s95, 13
  v_add_u32 v6, s15, v2
  v_add_u32 v7, 65536, v6
  v_add_u32 v8, 98304, v2
  v_and_b32 v13, 15, v1
  v_lshlrev_b32 v11, 5, v13
  v_lshrrev_b32 v13, 4, v1
  v_lshl_add_u32 v11, v13, 3, v11
  s_lshl_b32 s15, s95, 9
  s_lshl_b32 s31, s12, 11
  s_add_u32 s15, s15, s31
  s_add_u32 s15, s15, 524288
  v_add_u32 v11, s15, v11
  s_lshl_b32 s15, s95, 14
  s_lshl_b32 s31, s12, 10
  s_add_u32 s15, s15, s31
  s_add_u32 s15, s15, 2097152
  v_add_u32 v12, s15, v2
  v_bfe_u32 v13, v1, 1, 3
  v_lshlrev_b32 v10, 11, v13
  v_and_b32 v13, 1, v1
  v_lshl_add_u32 v10, v13, 8, v10
  s_lshl_b32 s15, s95, 9
  s_add_u32 s15, s15, 0
  v_add_u32 v10, s15, v10
  v_mov_b64 v[88:89], -1
  s_add_u32 s15, s13, 0
  buffer_store_dwordx2 v[88:89], v11, s[4:7], s15 offen sc1
  s_add_u32 s15, s13, 16384
  buffer_store_dwordx2 v[88:89], v11, s[4:7], s15 offen sc1
  s_add_u32 s15, s13, 32768
  buffer_store_dwordx2 v[88:89], v11, s[4:7], s15 offen sc1
  s_add_u32 s15, s13, 49152
  buffer_store_dwordx2 v[88:89], v11, s[4:7], s15 offen sc1
  s_lshl_b32 s38, s95, 3
  s_add_u32 s38, s38, s12
  s_lshl_b32 s38, s38, 2
  s_add_u32 s38, s38, s13
  s_add_u32 s38, s38, 98304
  s_mov_b64 exec, 1
  buffer_store_dword v2, v2, s[4:7], s38 offen sc1
  s_mov_b64 exec, -1
  v_lshrrev_b32 v13, 4, v1
  s_lshl_b32 s15, s34, 2
  v_add_u32 v17, s15, v13
  v_bfe_u32 v14, v1, 1, 3
  v_xor_b32 v14, v14, v17
  v_lshlrev_b32 v14, 5, v14
  v_and_b32 v15, 1, v1
  v_lshlrev_b32 v15, 4, v15
  v_add_u32 v18, v14, v15
  v_lshrrev_b32 v13, 2, v17
  v_lshlrev_b32 v13, 3, v13
  v_and_b32 v14, 3, v17
  v_add_u32 v13, v13, v14
  v_lshlrev_b32 v13, 13, v13
  v_add_u32 v16, v13, v18
  s_lshl_b32 s15, s56, 8
  v_add_u32 v16, s15, v16
  s_mov_b32 s20, 0
  s_mov_b32 s21, 32768
  s_mov_b32 s22, 131072
  s_mov_b32 s23, 163840
  s_mov_b32 s24, 262144
  s_mov_b32 s25, 294912
  s_mov_b32 s26, 393216
  s_mov_b32 s27, 425984
  s_mov_b32 s28, 524288
  s_mov_b32 s29, 524288
  s_lshl_b32 s15, s35, 19
  v_add_u32 v16, s15, v16
  s_mov_b32 s28, 1048576
  s_mov_b32 s29, 1048576
  s_mov_b32 s16, s72
  s_mov_b32 s17, s73
  s_mov_b32 s18, 0x800000
  s_mov_b32 s19, 0x20000
AB_load:
  s_lshl_b32 s30, s35, 14
  s_lshl_b32 s15, s34, 10
  s_add_u32 s30, s30, s15
  s_add_u32 m0, s30, 65536
  s_nop 0
  buffer_load_dwordx4 v16, s[16:19], s20 offen lds
  s_add_u32 m0, s30, 67584
  s_nop 0
  buffer_load_dwordx4 v16, s[16:19], s21 offen lds
  s_add_u32 m0, s30, 69632
  s_nop 0
  buffer_load_dwordx4 v16, s[16:19], s22 offen lds
  s_add_u32 m0, s30, 71680
  s_nop 0
  buffer_load_dwordx4 v16, s[16:19], s23 offen lds
  s_add_u32 m0, s30, 73728
  s_nop 0
  buffer_load_dwordx4 v16, s[16:19], s24 offen lds
  s_add_u32 m0, s30, 75776
  s_nop 0
  buffer_load_dwordx4 v16, s[16:19], s25 offen lds
  s_add_u32 m0, s30, 77824
  s_nop 0
  buffer_load_dwordx4 v16, s[16:19], s26 offen lds
  s_add_u32 m0, s30, 79872
  s_nop 0
  buffer_load_dwordx4 v16, s[16:19], s27 offen lds
  v_add_u32 v16, s28, v16
  s_add_u32 m0, s30, 98304
  s_nop 0
  buffer_load_dwordx4 v16, s[16:19], s20 offen lds
  s_add_u32 m0, s30, 100352
  s_nop 0
  buffer_load_dwordx4 v16, s[16:19], s21 offen lds
  s_add_u32 m0, s30, 102400
  s_nop 0
  buffer_load_dwordx4 v16, s[16:19], s22 offen lds
  s_add_u32 m0, s30, 104448
  s_nop 0
  buffer_load_dwordx4 v16, s[16:19], s23 offen lds
  s_add_u32 m0, s30, 106496
  s_nop 0
  buffer_load_dwordx4 v16, s[16:19], s24 offen lds
  s_add_u32 m0, s30, 108544
  s_nop 0
  buffer_load_dwordx4 v16, s[16:19], s25 offen lds
  s_add_u32 m0, s30, 110592
  s_nop 0
  buffer_load_dwordx4 v16, s[16:19], s26 offen lds
  s_add_u32 m0, s30, 112640
  s_nop 0
  buffer_load_dwordx4 v16, s[16:19], s27 offen lds
  v_add_u32 v16, s29, v16
  s_add_u32 m0, s30, 131072
  s_nop 0
  buffer_load_dwordx4 v16, s[16:19], s20 offen lds
  s_add_u32 m0, s30, 133120
  s_nop 0
  buffer_load_dwordx4 v16, s[16:19], s21 offen lds
  s_add_u32 m0, s30, 135168
  s_nop 0
  buffer_load_dwordx4 v16, s[16:19], s22 offen lds
  s_add_u32 m0, s30, 137216
  s_nop 0
  buffer_load_dwordx4 v16, s[16:19], s23 offen lds
  s_add_u32 m0, s30, 139264
  s_nop 0
  buffer_load_dwordx4 v16, s[16:19], s24 offen lds
  s_add_u32 m0, s30, 141312
  s_nop 0
  buffer_load_dwordx4 v16, s[16:19], s25 offen lds
  s_add_u32 m0, s30, 143360
  s_nop 0
  buffer_load_dwordx4 v16, s[16:19], s26 offen lds
  s_add_u32 m0, s30, 145408
  s_nop 0
  buffer_load_dwordx4 v16, s[16:19], s27 offen lds
  v_add_u32 v16, s28, v16
  s_add_u32 m0, s30, 0
  s_nop 0
  buffer_load_dwordx4 v16, s[16:19], s20 offen lds
  s_add_u32 m0, s30, 2048
  s_nop 0
  buffer_load_dwordx4 v16, s[16:19], s21 offen lds
  s_add_u32 m0, s30, 4096
  s_nop 0
  buffer_load_dwordx4 v16, s[16:19], s22 offen lds
  s_add_u32 m0, s30, 6144
  s_nop 0
  buffer_load_dwordx4 v16, s[16:19], s23 offen lds
  s_add_u32 m0, s30, 8192
  s_nop 0
  buffer_load_dwordx4 v16, s[16:19], s24 offen lds
  s_add_u32 m0, s30, 10240
  s_nop 0
  buffer_load_dwordx4 v16, s[16:19], s25 offen lds
  s_add_u32 m0, s30, 12288
  s_nop 0
  buffer_load_dwordx4 v16, s[16:19], s26 offen lds
  s_add_u32 m0, s30, 14336
  s_nop 0
  buffer_load_dwordx4 v16, s[16:19], s27 offen lds
  v_add_u32 v16, s29, v16
  s_waitcnt vmcnt(24)
  s_barrier
  s_cmp_lg_u32 s95, 0
  s_cbranch_scc1 IS_57
  v_mov_b32 v13, 1
  v_mov_b32 v14, 160
  s_mov_b64 exec, 1
  buffer_atomic_add v13, v14, s[8:11], 0 offen
  s_mov_b64 exec, -1
IS_57:
  s_add_u32 m0, s30, 32768
  s_nop 0
  buffer_load_dwordx4 v16, s[16:19], s20 offen lds
  s_add_u32 m0, s30, 34816
  s_nop 0
  buffer_load_dwordx4 v16, s[16:19], s21 offen lds
  s_add_u32 m0, s30, 36864
  s_nop 0
  buffer_load_dwordx4 v16, s[16:19], s22 offen lds
  s_add_u32 m0, s30, 38912
  s_nop 0
  buffer_load_dwordx4 v16, s[16:19], s23 offen lds
  s_add_u32 m0, s30, 40960
  s_nop 0
  buffer_load_dwordx4 v16, s[16:19], s24 offen lds
  s_add_u32 m0, s30, 43008
  s_nop 0
  buffer_load_dwordx4 v16, s[16:19], s25 offen lds
  s_add_u32 m0, s30, 45056
  s_nop 0
  buffer_load_dwordx4 v16, s[16:19], s26 offen lds
  s_add_u32 m0, s30, 47104
  s_nop 0
  buffer_load_dwordx4 v16, s[16:19], s27 offen lds
  v_add_u32 v16, s28, v16
  v_add_u32 v20, 65536, v4
  v_add_u32 v21, 65536, v5
  ds_read_b64_tr_b16 v[96:97], v20 offset:0
  ds_read_b64_tr_b16 v[98:99], v20 offset:2048
  ds_read_b64_tr_b16 v[100:101], v20 offset:8192
  ds_read_b64_tr_b16 v[102:103], v20 offset:10240
  ds_read_b64_tr_b16 v[104:105], v21 offset:0
  ds_read_b64_tr_b16 v[106:107], v21 offset:2048
  ds_read_b64_tr_b16 v[108:109], v21 offset:8192
  ds_read_b64_tr_b16 v[110:111], v21 offset:10240
  ds_read_b64_tr_b16 v[112:113], v20 offset:16384
  ds_read_b64_tr_b16 v[114:115], v20 offset:18432
  ds_read_b64_tr_b16 v[116:117], v20 offset:24576
  ds_read_b64_tr_b16 v[118:119], v20 offset:26624
  ds_read_b64_tr_b16 v[120:121], v21 offset:16384
  ds_read_b64_tr_b16 v[122:123], v21 offset:18432
  ds_read_b64_tr_b16 v[124:125], v21 offset:24576
  ds_read_b64_tr_b16 v[126:127], v21 offset:26624
  s_waitcnt lgkmcnt(0)
  s_waitcnt vmcnt(24)
  s_barrier
  s_add_u32 m0, s30, 65536
  s_nop 0
  buffer_load_dwordx4 v16, s[16:19], s20 offen lds
  s_add_u32 m0, s30, 67584
  s_nop 0
  buffer_load_dwordx4 v16, s[16:19], s21 offen lds
  s_add_u32 m0, s30, 69632
  s_nop 0
  buffer_load_dwordx4 v16, s[16:19], s22 offen lds
  s_add_u32 m0, s30, 71680
  s_nop 0
  buffer_load_dwordx4 v16, s[16:19], s23 offen lds
  s_add_u32 m0, s30, 73728
  s_nop 0
  buffer_load_dwordx4 v16, s[16:19], s24 offen lds
  s_add_u32 m0, s30, 75776
  s_nop 0
  buffer_load_dwordx4 v16, s[16:19], s25 offen lds
  s_add_u32 m0, s30, 77824
  s_nop 0
  buffer_load_dwordx4 v16, s[16:19], s26 offen lds
  s_add_u32 m0, s30, 79872
  s_nop 0
  buffer_load_dwordx4 v16, s[16:19], s27 offen lds
  v_add_u32 v16, s29, v16
  v_add_u32 v20, 98304, v4
  v_add_u32 v21, 98304, v5
  ds_read_b64_tr_b16 v[128:129], v20 offset:0
  ds_read_b64_tr_b16 v[130:131], v20 offset:2048
  ds_read_b64_tr_b16 v[132:133], v20 offset:8192
  ds_read_b64_tr_b16 v[134:135], v20 offset:10240
  ds_read_b64_tr_b16 v[136:137], v21 offset:0
  ds_read_b64_tr_b16 v[138:139], v21 offset:2048
  ds_read_b64_tr_b16 v[140:141], v21 offset:8192
  ds_read_b64_tr_b16 v[142:143], v21 offset:10240
  ds_read_b64_tr_b16 v[144:145], v20 offset:16384
  ds_read_b64_tr_b16 v[146:147], v20 offset:18432
  ds_read_b64_tr_b16 v[148:149], v20 offset:24576
  ds_read_b64_tr_b16 v[150:151], v20 offset:26624
  ds_read_b64_tr_b16 v[152:153], v21 offset:16384
  ds_read_b64_tr_b16 v[154:155], v21 offset:18432
  ds_read_b64_tr_b16 v[156:157], v21 offset:24576
  ds_read_b64_tr_b16 v[158:159], v21 offset:26624
  s_waitcnt lgkmcnt(0)
  s_waitcnt vmcnt(24)
  s_barrier
  s_add_u32 m0, s30, 98304
  s_nop 0
  buffer_load_dwordx4 v16, s[16:19], s20 offen lds
  s_add_u32 m0, s30, 100352
  s_nop 0
  buffer_load_dwordx4 v16, s[16:19], s21 offen lds
  s_add_u32 m0, s30, 102400
  s_nop 0
  buffer_load_dwordx4 v16, s[16:19], s22 offen lds
  s_add_u32 m0, s30, 104448
  s_nop 0
  buffer_load_dwordx4 v16, s[16:19], s23 offen lds
  s_add_u32 m0, s30, 106496
  s_nop 0
  buffer_load_dwordx4 v16, s[16:19], s24 offen lds
  s_add_u32 m0, s30, 108544
  s_nop 0
  buffer_load_dwordx4 v16, s[16:19], s25 offen lds
  s_add_u32 m0, s30, 110592
  s_nop 0
  buffer_load_dwordx4 v16, s[16:19], s26 offen lds
  s_add_u32 m0, s30, 112640
  s_nop 0
  buffer_load_dwordx4 v16, s[16:19], s27 offen lds
  v_add_u32 v16, s28, v16
  v_add_u32 v20, 131072, v4
  v_add_u32 v21, 131072, v5
  ds_read_b64_tr_b16 v[160:161], v20 offset:0
  ds_read_b64_tr_b16 v[162:163], v20 offset:2048
  ds_read_b64_tr_b16 v[164:165], v20 offset:8192
  ds_read_b64_tr_b16 v[166:167], v20 offset:10240
  ds_read_b64_tr_b16 v[168:169], v21 offset:0
  ds_read_b64_tr_b16 v[170:171], v21 offset:2048
  ds_read_b64_tr_b16 v[172:173], v21 offset:8192
  ds_read_b64_tr_b16 v[174:175], v21 offset:10240
  ds_read_b64_tr_b16 v[176:177], v20 offset:16384
  ds_read_b64_tr_b16 v[178:179], v20 offset:18432
  ds_read_b64_tr_b16 v[180:181], v20 offset:24576
  ds_read_b64_tr_b16 v[182:183], v20 offset:26624
  ds_read_b64_tr_b16 v[184:185], v21 offset:16384
  ds_read_b64_tr_b16 v[186:187], v21 offset:18432
  ds_read_b64_tr_b16 v[188:189], v21 offset:24576
  ds_read_b64_tr_b16 v[190:191], v21 offset:26624
  s_waitcnt lgkmcnt(0)
  s_waitcnt vmcnt(24)
  s_barrier
  s_add_u32 m0, s30, 131072
  s_nop 0
  buffer_load_dwordx4 v16, s[16:19], s20 offen lds
  s_add_u32 m0, s30, 133120
  s_nop 0
  buffer_load_dwordx4 v16, s[16:19], s21 offen lds
  s_add_u32 m0, s30, 135168
  s_nop 0
  buffer_load_dwordx4 v16, s[16:19], s22 offen lds
  s_add_u32 m0, s30, 137216
  s_nop 0
  buffer_load_dwordx4 v16, s[16:19], s23 offen lds
  s_add_u32 m0, s30, 139264
  s_nop 0
  buffer_load_dwordx4 v16, s[16:19], s24 offen lds
  s_add_u32 m0, s30, 141312
  s_nop 0
  buffer_load_dwordx4 v16, s[16:19], s25 offen lds
  s_add_u32 m0, s30, 143360
  s_nop 0
  buffer_load_dwordx4 v16, s[16:19], s26 offen lds
  s_add_u32 m0, s30, 145408
  s_nop 0
  buffer_load_dwordx4 v16, s[16:19], s27 offen lds
  v_add_u32 v16, s29, v16
  v_add_u32 v20, 0, v4
  v_add_u32 v21, 0, v5
  ds_read_b64_tr_b16 v[192:193], v20 offset:0
  ds_read_b64_tr_b16 v[194:195], v20 offset:2048
  ds_read_b64_tr_b16 v[196:197], v20 offset:8192
  ds_read_b64_tr_b16 v[198:199], v20 offset:10240
  ds_read_b64_tr_b16 v[200:201], v21 offset:0
  ds_read_b64_tr_b16 v[202:203], v21 offset:2048
  ds_read_b64_tr_b16 v[204:205], v21 offset:8192
  ds_read_b64_tr_b16 v[206:207], v21 offset:10240
  ds_read_b64_tr_b16 v[208:209], v20 offset:16384
  ds_read_b64_tr_b16 v[210:211], v20 offset:18432
  ds_read_b64_tr_b16 v[212:213], v20 offset:24576
  ds_read_b64_tr_b16 v[214:215], v20 offset:26624
  ds_read_b64_tr_b16 v[216:217], v21 offset:16384
  ds_read_b64_tr_b16 v[218:219], v21 offset:18432
  ds_read_b64_tr_b16 v[220:221], v21 offset:24576
  ds_read_b64_tr_b16 v[222:223], v21 offset:26624
  s_waitcnt lgkmcnt(0)
  s_waitcnt vmcnt(24)
  s_barrier
  s_cmp_lt_u32 s96, 8
  s_cbranch_scc1 AB_same
  v_lshlrev_b32 v13, 11, v17
  v_add_u32 v16, v13, v18
  s_lshl_b32 s15, s56, 18
  s_lshl_b32 s31, s35, 17
  s_add_u32 s15, s15, s31
  v_add_u32 v16, s15, v16
  s_mov_b32 s20, 0
  s_mov_b32 s21, 32768
  s_mov_b32 s22, 16384
  s_mov_b32 s23, 49152
  s_mov_b32 s24, 65536
  s_mov_b32 s25, 98304
  s_mov_b32 s26, 81920
  s_mov_b32 s27, 114688
  s_mov_b32 s28, 256
  s_mov_b32 s29, 256
  s_mov_b64 s[16:17], s[74:75]
AB_same:
  s_add_u32 m0, s30, 0
  s_nop 0
  buffer_load_dwordx4 v16, s[16:19], s20 offen lds
  s_add_u32 m0, s30, 2048
  s_nop 0
  buffer_load_dwordx4 v16, s[16:19], s21 offen lds
  s_add_u32 m0, s30, 4096
  s_nop 0
  buffer_load_dwordx4 v16, s[16:19], s22 offen lds
  s_add_u32 m0, s30, 6144
  s_nop 0
  buffer_load_dwordx4 v16, s[16:19], s23 offen lds
  s_add_u32 m0, s30, 8192
  s_nop 0
  buffer_load_dwordx4 v16, s[16:19], s24 offen lds
  s_add_u32 m0, s30, 10240
  s_nop 0
  buffer_load_dwordx4 v16, s[16:19], s25 offen lds
  s_add_u32 m0, s30, 12288
  s_nop 0
  buffer_load_dwordx4 v16, s[16:19], s26 offen lds
  s_add_u32 m0, s30, 14336
  s_nop 0
  buffer_load_dwordx4 v16, s[16:19], s27 offen lds
  v_add_u32 v16, s28, v16
  v_add_u32 v20, 32768, v4
  v_add_u32 v21, 32768, v5
  ds_read_b64_tr_b16 v[224:225], v20 offset:0
  ds_read_b64_tr_b16 v[226:227], v20 offset:2048
  ds_read_b64_tr_b16 v[228:229], v20 offset:8192
  ds_read_b64_tr_b16 v[230:231], v20 offset:10240
  ds_read_b64_tr_b16 v[232:233], v21 offset:0
  ds_read_b64_tr_b16 v[234:235], v21 offset:2048
  ds_read_b64_tr_b16 v[236:237], v21 offset:8192
  ds_read_b64_tr_b16 v[238:239], v21 offset:10240
  ds_read_b64_tr_b16 v[240:241], v20 offset:16384
  ds_read_b64_tr_b16 v[242:243], v20 offset:18432
  ds_read_b64_tr_b16 v[244:245], v20 offset:24576
  ds_read_b64_tr_b16 v[246:247], v20 offset:26624
  ds_read_b64_tr_b16 v[248:249], v21 offset:16384
  ds_read_b64_tr_b16 v[250:251], v21 offset:18432
  ds_read_b64_tr_b16 v[252:253], v21 offset:24576
  ds_read_b64_tr_b16 v[254:255], v21 offset:26624
  s_waitcnt lgkmcnt(0)
  s_waitcnt vmcnt(24)
  s_barrier
  s_add_u32 m0, s30, 32768
  s_nop 0
  buffer_load_dwordx4 v16, s[16:19], s20 offen lds
  s_add_u32 m0, s30, 34816
  s_nop 0
  buffer_load_dwordx4 v16, s[16:19], s21 offen lds
  s_add_u32 m0, s30, 36864
  s_nop 0
  buffer_load_dwordx4 v16, s[16:19], s22 offen lds
  s_add_u32 m0, s30, 38912
  s_nop 0
  buffer_load_dwordx4 v16, s[16:19], s23 offen lds
  s_add_u32 m0, s30, 40960
  s_nop 0
  buffer_load_dwordx4 v16, s[16:19], s24 offen lds
  s_add_u32 m0, s30, 43008
  s_nop 0
  buffer_load_dwordx4 v16, s[16:19], s25 offen lds
  s_add_u32 m0, s30, 45056
  s_nop 0
  buffer_load_dwordx4 v16, s[16:19], s26 offen lds
  s_add_u32 m0, s30, 47104
  s_nop 0
  buffer_load_dwordx4 v16, s[16:19], s27 offen lds
  v_add_u32 v16, s29, v16
  v_add_u32 v20, 65536, v4
  v_add_u32 v21, 65536, v5
  ds_read_b64_tr_b16 a[0:1], v20 offset:0
  ds_read_b64_tr_b16 a[2:3], v20 offset:2048
  ds_read_b64_tr_b16 a[4:5], v20 offset:8192
  ds_read_b64_tr_b16 a[6:7], v20 offset:10240
  ds_read_b64_tr_b16 a[8:9], v21 offset:0
  ds_read_b64_tr_b16 a[10:11], v21 offset:2048
  ds_read_b64_tr_b16 a[12:13], v21 offset:8192
  ds_read_b64_tr_b16 a[14:15], v21 offset:10240
  ds_read_b64_tr_b16 a[16:17], v20 offset:16384
  ds_read_b64_tr_b16 a[18:19], v20 offset:18432
  ds_read_b64_tr_b16 a[20:21], v20 offset:24576
  ds_read_b64_tr_b16 a[22:23], v20 offset:26624
  ds_read_b64_tr_b16 a[24:25], v21 offset:16384
  ds_read_b64_tr_b16 a[26:27], v21 offset:18432
  ds_read_b64_tr_b16 a[28:29], v21 offset:24576
  ds_read_b64_tr_b16 a[30:31], v21 offset:26624
  s_waitcnt lgkmcnt(0)
  s_waitcnt vmcnt(24)
  s_barrier
  s_add_u32 m0, s30, 65536
  s_nop 0
  buffer_load_dwordx4 v16, s[16:19], s20 offen lds
  s_add_u32 m0, s30, 67584
  s_nop 0
  buffer_load_dwordx4 v16, s[16:19], s21 offen lds
  s_add_u32 m0, s30, 69632
  s_nop 0
  buffer_load_dwordx4 v16, s[16:19], s22 offen lds
  s_add_u32 m0, s30, 71680
  s_nop 0
  buffer_load_dwordx4 v16, s[16:19], s23 offen lds
  s_add_u32 m0, s30, 73728
  s_nop 0
  buffer_load_dwordx4 v16, s[16:19], s24 offen lds
  s_add_u32 m0, s30, 75776
  s_nop 0
  buffer_load_dwordx4 v16, s[16:19], s25 offen lds
  s_add_u32 m0, s30, 77824
  s_nop 0
  buffer_load_dwordx4 v16, s[16:19], s26 offen lds
  s_add_u32 m0, s30, 79872
  s_nop 0
  buffer_load_dwordx4 v16, s[16:19], s27 offen lds
  v_add_u32 v16, s28, v16
  v_add_u32 v20, 98304, v4
  v_add_u32 v21, 98304, v5
  ds_read_b64_tr_b16 a[32:33], v20 offset:0
  ds_read_b64_tr_b16 a[34:35], v20 offset:2048
  ds_read_b64_tr_b16 a[36:37], v20 offset:8192
  ds_read_b64_tr_b16 a[38:39], v20 offset:10240
  ds_read_b64_tr_b16 a[40:41], v21 offset:0
  ds_read_b64_tr_b16 a[42:43], v21 offset:2048
  ds_read_b64_tr_b16 a[44:45], v21 offset:8192
  ds_read_b64_tr_b16 a[46:47], v21 offset:10240
  ds_read_b64_tr_b16 a[48:49], v20 offset:16384
  ds_read_b64_tr_b16 a[50:51], v20 offset:18432
  ds_read_b64_tr_b16 a[52:53], v20 offset:24576
  ds_read_b64_tr_b16 a[54:55], v20 offset:26624
  ds_read_b64_tr_b16 a[56:57], v21 offset:16384
  ds_read_b64_tr_b16 a[58:59], v21 offset:18432
  ds_read_b64_tr_b16 a[60:61], v21 offset:24576
  ds_read_b64_tr_b16 a[62:63], v21 offset:26624
  s_waitcnt lgkmcnt(0)
  s_waitcnt vmcnt(24)
  s_barrier
  s_add_u32 m0, s30, 98304
  s_nop 0
  buffer_load_dwordx4 v16, s[16:19], s20 offen lds
  s_add_u32 m0, s30, 100352
  s_nop 0
  buffer_load_dwordx4 v16, s[16:19], s21 offen lds
  s_add_u32 m0, s30, 102400
  s_nop 0
  buffer_load_dwordx4 v16, s[16:19], s22 offen lds
  s_add_u32 m0, s30, 104448
  s_nop 0
  buffer_load_dwordx4 v16, s[16:19], s23 offen lds
  s_add_u32 m0, s30, 106496
  s_nop 0
  buffer_load_dwordx4 v16, s[16:19], s24 offen lds
  s_add_u32 m0, s30, 108544
  s_nop 0
  buffer_load_dwordx4 v16, s[16:19], s25 offen lds
  s_add_u32 m0, s30, 110592
  s_nop 0
  buffer_load_dwordx4 v16, s[16:19], s26 offen lds
  s_add_u32 m0, s30, 112640
  s_nop 0
  buffer_load_dwordx4 v16, s[16:19], s27 offen lds
  v_add_u32 v16, s29, v16
  v_add_u32 v20, 131072, v4
  v_add_u32 v21, 131072, v5
  ds_read_b64_tr_b16 a[64:65], v20 offset:0
  ds_read_b64_tr_b16 a[66:67], v20 offset:2048
  ds_read_b64_tr_b16 a[68:69], v20 offset:8192
  ds_read_b64_tr_b16 a[70:71], v20 offset:10240
  ds_read_b64_tr_b16 a[72:73], v21 offset:0
  ds_read_b64_tr_b16 a[74:75], v21 offset:2048
  ds_read_b64_tr_b16 a[76:77], v21 offset:8192
  ds_read_b64_tr_b16 a[78:79], v21 offset:10240
  ds_read_b64_tr_b16 a[80:81], v20 offset:16384
  ds_read_b64_tr_b16 a[82:83], v20 offset:18432
  ds_read_b64_tr_b16 a[84:85], v20 offset:24576
  ds_read_b64_tr_b16 a[86:87], v20 offset:26624
  ds_read_b64_tr_b16 a[88:89], v21 offset:16384
  ds_read_b64_tr_b16 a[90:91], v21 offset:18432
  ds_read_b64_tr_b16 a[92:93], v21 offset:24576
  ds_read_b64_tr_b16 a[94:95], v21 offset:26624
  s_waitcnt lgkmcnt(0)
  s_waitcnt vmcnt(24)
  s_barrier
  s_add_u32 m0, s30, 131072
  s_nop 0
  buffer_load_dwordx4 v16, s[16:19], s20 offen lds
  s_add_u32 m0, s30, 133120
  s_nop 0
  buffer_load_dwordx4 v16, s[16:19], s21 offen lds
  s_add_u32 m0, s30, 135168
  s_nop 0
  buffer_load_dwordx4 v16, s[16:19], s22 offen lds
  s_add_u32 m0, s30, 137216
  s_nop 0
  buffer_load_dwordx4 v16, s[16:19], s23 offen lds
  s_add_u32 m0, s30, 139264
  s_nop 0
  buffer_load_dwordx4 v16, s[16:19], s24 offen lds
  s_add_u32 m0, s30, 141312
  s_nop 0
  buffer_load_dwordx4 v16, s[16:19], s25 offen lds
  s_add_u32 m0, s30, 143360
  s_nop 0
  buffer_load_dwordx4 v16, s[16:19], s26 offen lds
  s_add_u32 m0, s30, 145408
  s_nop 0
  buffer_load_dwordx4 v16, s[16:19], s27 offen lds
  v_add_u32 v16, s28, v16
  v_add_u32 v20, 0, v4
  v_add_u32 v21, 0, v5
  ds_read_b64_tr_b16 a[96:97], v20 offset:0
  ds_read_b64_tr_b16 a[98:99], v20 offset:2048
  ds_read_b64_tr_b16 a[100:101], v20 offset:8192
  ds_read_b64_tr_b16 a[102:103], v20 offset:10240
  ds_read_b64_tr_b16 a[104:105], v21 offset:0
  ds_read_b64_tr_b16 a[106:107], v21 offset:2048
  ds_read_b64_tr_b16 a[108:109], v21 offset:8192
  ds_read_b64_tr_b16 a[110:111], v21 offset:10240
  ds_read_b64_tr_b16 a[112:113], v20 offset:16384
  ds_read_b64_tr_b16 a[114:115], v20 offset:18432
  ds_read_b64_tr_b16 a[116:117], v20 offset:24576
  ds_read_b64_tr_b16 a[118:119], v20 offset:26624
  ds_read_b64_tr_b16 a[120:121], v21 offset:16384
  ds_read_b64_tr_b16 a[122:123], v21 offset:18432
  ds_read_b64_tr_b16 a[124:125], v21 offset:24576
  ds_read_b64_tr_b16 a[126:127], v21 offset:26624
  s_waitcnt lgkmcnt(0)
  s_waitcnt vmcnt(24)
  s_barrier
  s_add_u32 m0, s30, 0
  s_nop 0
  buffer_load_dwordx4 v16, s[16:19], s20 offen lds
  s_add_u32 m0, s30, 2048
  s_nop 0
  buffer_load_dwordx4 v16, s[16:19], s21 offen lds
  s_add_u32 m0, s30, 4096
  s_nop 0
  buffer_load_dwordx4 v16, s[16:19], s22 offen lds
  s_add_u32 m0, s30, 6144
  s_nop 0
  buffer_load_dwordx4 v16, s[16:19], s23 offen lds
  s_add_u32 m0, s30, 8192
  s_nop 0
  buffer_load_dwordx4 v16, s[16:19], s24 offen lds
  s_add_u32 m0, s30, 10240
  s_nop 0
  buffer_load_dwordx4 v16, s[16:19], s25 offen lds
  s_add_u32 m0, s30, 12288
  s_nop 0
  buffer_load_dwordx4 v16, s[16:19], s26 offen lds
  s_add_u32 m0, s30, 14336
  s_nop 0
  buffer_load_dwordx4 v16, s[16:19], s27 offen lds
  v_add_u32 v16, s29, v16
  v_add_u32 v20, 32768, v4
  v_add_u32 v21, 32768, v5
  ds_read_b64_tr_b16 a[128:129], v20 offset:0
  ds_read_b64_tr_b16 a[130:131], v20 offset:2048
  ds_read_b64_tr_b16 a[132:133], v20 offset:8192
  ds_read_b64_tr_b16 a[134:135], v20 offset:10240
  ds_read_b64_tr_b16 a[136:137], v21 offset:0
  ds_read_b64_tr_b16 a[138:139], v21 offset:2048
  ds_read_b64_tr_b16 a[140:141], v21 offset:8192
  ds_read_b64_tr_b16 a[142:143], v21 offset:10240
  ds_read_b64_tr_b16 a[144:145], v20 offset:16384
  ds_read_b64_tr_b16 a[146:147], v20 offset:18432
  ds_read_b64_tr_b16 a[148:149], v20 offset:24576
  ds_read_b64_tr_b16 a[150:151], v20 offset:26624
  ds_read_b64_tr_b16 a[152:153], v21 offset:16384
  ds_read_b64_tr_b16 a[154:155], v21 offset:18432
  ds_read_b64_tr_b16 a[156:157], v21 offset:24576
  ds_read_b64_tr_b16 a[158:159], v21 offset:26624
  s_waitcnt lgkmcnt(0)
  s_waitcnt vmcnt(24)
  s_barrier
  s_add_u32 m0, s30, 32768
  s_nop 0
  buffer_load_dwordx4 v16, s[16:19], s20 offen lds
  s_add_u32 m0, s30, 34816
  s_nop 0
  buffer_load_dwordx4 v16, s[16:19], s21 offen lds
  s_add_u32 m0, s30, 36864
  s_nop 0
  buffer_load_dwordx4 v16, s[16:19], s22 offen lds
  s_add_u32 m0, s30, 38912
  s_nop 0
  buffer_load_dwordx4 v16, s[16:19], s23 offen lds
  s_add_u32 m0, s30, 40960
  s_nop 0
  buffer_load_dwordx4 v16, s[16:19], s24 offen lds
  s_add_u32 m0, s30, 43008
  s_nop 0
  buffer_load_dwordx4 v16, s[16:19], s25 offen lds
  s_add_u32 m0, s30, 45056
  s_nop 0
  buffer_load_dwordx4 v16, s[16:19], s26 offen lds
  s_add_u32 m0, s30, 47104
  s_nop 0
  buffer_load_dwordx4 v16, s[16:19], s27 offen lds
  v_add_u32 v16, s28, v16
  v_add_u32 v20, 65536, v4
  v_add_u32 v21, 65536, v5
  ds_read_b64_tr_b16 a[160:161], v20 offset:0
  ds_read_b64_tr_b16 a[162:163], v20 offset:2048
  ds_read_b64_tr_b16 a[164:165], v20 offset:8192
  ds_read_b64_tr_b16 a[166:167], v20 offset:10240
  ds_read_b64_tr_b16 a[168:169], v21 offset:0
  ds_read_b64_tr_b16 a[170:171], v21 offset:2048
  ds_read_b64_tr_b16 a[172:173], v21 offset:8192
  ds_read_b64_tr_b16 a[174:175], v21 offset:10240
  ds_read_b64_tr_b16 a[176:177], v20 offset:16384
  ds_read_b64_tr_b16 a[178:179], v20 offset:18432
  ds_read_b64_tr_b16 a[180:181], v20 offset:24576
  ds_read_b64_tr_b16 a[182:183], v20 offset:26624
  ds_read_b64_tr_b16 a[184:185], v21 offset:16384
  ds_read_b64_tr_b16 a[186:187], v21 offset:18432
  ds_read_b64_tr_b16 a[188:189], v21 offset:24576
  ds_read_b64_tr_b16 a[190:191], v21 offset:26624
  s_waitcnt lgkmcnt(0)
  s_waitcnt vmcnt(24)
  s_barrier
  s_add_u32 m0, s30, 65536
  s_nop 0
  buffer_load_dwordx4 v16, s[16:19], s20 offen lds
  s_add_u32 m0, s30, 67584
  s_nop 0
  buffer_load_dwordx4 v16, s[16:19], s21 offen lds
  s_add_u32 m0, s30, 69632
  s_nop 0
  buffer_load_dwordx4 v16, s[16:19], s22 offen lds
  s_add_u32 m0, s30, 71680
  s_nop 0
  buffer_load_dwordx4 v16, s[16:19], s23 offen lds
  s_add_u32 m0, s30, 73728
  s_nop 0
  buffer_load_dwordx4 v16, s[16:19], s24 offen lds
  s_add_u32 m0, s30, 75776
  s_nop 0
  buffer_load_dwordx4 v16, s[16:19], s25 offen lds
  s_add_u32 m0, s30, 77824
  s_nop 0
  buffer_load_dwordx4 v16, s[16:19], s26 offen lds
  s_add_u32 m0, s30, 79872
  s_nop 0
  buffer_load_dwordx4 v16, s[16:19], s27 offen lds
  v_add_u32 v16, s29, v16
  v_add_u32 v20, 98304, v4
  v_add_u32 v21, 98304, v5
  ds_read_b64_tr_b16 a[192:193], v20 offset:0
  ds_read_b64_tr_b16 a[194:195], v20 offset:2048
  ds_read_b64_tr_b16 a[196:197], v20 offset:8192
  ds_read_b64_tr_b16 a[198:199], v20 offset:10240
  ds_read_b64_tr_b16 a[200:201], v21 offset:0
  ds_read_b64_tr_b16 a[202:203], v21 offset:2048
  ds_read_b64_tr_b16 a[204:205], v21 offset:8192
  ds_read_b64_tr_b16 a[206:207], v21 offset:10240
  ds_read_b64_tr_b16 a[208:209], v20 offset:16384
  ds_read_b64_tr_b16 a[210:211], v20 offset:18432
  ds_read_b64_tr_b16 a[212:213], v20 offset:24576
  ds_read_b64_tr_b16 a[214:215], v20 offset:26624
  ds_read_b64_tr_b16 a[216:217], v21 offset:16384
  ds_read_b64_tr_b16 a[218:219], v21 offset:18432
  ds_read_b64_tr_b16 a[220:221], v21 offset:24576
  ds_read_b64_tr_b16 a[222:223], v21 offset:26624
  s_waitcnt lgkmcnt(0)
  s_waitcnt vmcnt(24)
  s_barrier
  v_add_u32 v20, 131072, v4
  v_add_u32 v21, 131072, v5
  ds_read_b64_tr_b16 a[224:225], v20 offset:0
  ds_read_b64_tr_b16 a[226:227], v20 offset:2048
  ds_read_b64_tr_b16 a[228:229], v20 offset:8192
  ds_read_b64_tr_b16 a[230:231], v20 offset:10240
  ds_read_b64_tr_b16 a[232:233], v21 offset:0
  ds_read_b64_tr_b16 a[234:235], v21 offset:2048
  ds_read_b64_tr_b16 a[236:237], v21 offset:8192
  ds_read_b64_tr_b16 a[238:239], v21 offset:10240
  ds_read_b64_tr_b16 a[240:241], v20 offset:16384
  ds_read_b64_tr_b16 a[242:243], v20 offset:18432
  ds_read_b64_tr_b16 a[244:245], v20 offset:24576
  ds_read_b64_tr_b16 a[246:247], v20 offset:26624
  ds_read_b64_tr_b16 a[248:249], v21 offset:16384
  ds_read_b64_tr_b16 a[250:251], v21 offset:18432
  ds_read_b64_tr_b16 a[252:253], v21 offset:24576
  ds_read_b64_tr_b16 a[254:255], v21 offset:26624
  s_waitcnt lgkmcnt(0)
  s_waitcnt vmcnt(0)
  s_barrier
  v_add_u32 v20, 0, v4
  v_add_u32 v21, 0, v5
  ds_read_b64_tr_b16 v[32:33], v20 offset:0
  ds_read_b64_tr_b16 v[34:35], v20 offset:2048
  ds_read_b64_tr_b16 v[36:37], v20 offset:8192
  ds_read_b64_tr_b16 v[38:39], v20 offset:10240
  ds_read_b64_tr_b16 v[40:41], v21 offset:0
  ds_read_b64_tr_b16 v[42:43], v21 offset:2048
  ds_read_b64_tr_b16 v[44:45], v21 offset:8192
  ds_read_b64_tr_b16 v[46:47], v21 offset:10240
  ds_read_b64_tr_b16 v[48:49], v20 offset:16384
  ds_read_b64_tr_b16 v[50:51], v20 offset:18432
  ds_read_b64_tr_b16 v[52:53], v20 offset:24576
  ds_read_b64_tr_b16 v[54:55], v20 offset:26624
  ds_read_b64_tr_b16 v[56:57], v21 offset:16384
  ds_read_b64_tr_b16 v[58:59], v21 offset:18432
  ds_read_b64_tr_b16 v[60:61], v21 offset:24576
  ds_read_b64_tr_b16 v[62:63], v21 offset:26624
  s_waitcnt lgkmcnt(0)
  s_barrier
  v_add_u32 v20, 0, v6
  ds_write_b128 v20, v[32:35] offset:0
  ds_write_b128 v20, v[36:39] offset:1024
  ds_write_b128 v20, v[40:43] offset:2048
  ds_write_b128 v20, v[44:47] offset:3072
  ds_write_b128 v20, v[48:51] offset:4096
  ds_write_b128 v20, v[52:55] offset:5120
  ds_write_b128 v20, v[56:59] offset:6144
  ds_write_b128 v20, v[60:63] offset:7168
  s_waitcnt lgkmcnt(0)
  v_add_u32 v20, 32768, v4
  v_add_u32 v21, 32768, v5
  ds_read_b64_tr_b16 v[32:33], v20 offset:0
  ds_read_b64_tr_b16 v[34:35], v20 offset:2048
  ds_read_b64_tr_b16 v[36:37], v20 offset:8192
  ds_read_b64_tr_b16 v[38:39], v20 offset:10240
  ds_read_b64_tr_b16 v[40:41], v21 offset:0
  ds_read_b64_tr_b16 v[42:43], v21 offset:2048
  ds_read_b64_tr_b16 v[44:45], v21 offset:8192
  ds_read_b64_tr_b16 v[46:47], v21 offset:10240
  ds_read_b64_tr_b16 v[48:49], v20 offset:16384
  ds_read_b64_tr_b16 v[50:51], v20 offset:18432
  ds_read_b64_tr_b16 v[52:53], v20 offset:24576
  ds_read_b64_tr_b16 v[54:55], v20 offset:26624
  ds_read_b64_tr_b16 v[56:57], v21 offset:16384
  ds_read_b64_tr_b16 v[58:59], v21 offset:18432
  ds_read_b64_tr_b16 v[60:61], v21 offset:24576
  ds_read_b64_tr_b16 v[62:63], v21 offset:26624
  s_waitcnt lgkmcnt(0)
  s_barrier
  v_add_u32 v20, 32768, v6
  ds_write_b128 v20, v[32:35] offset:0
  ds_write_b128 v20, v[36:39] offset:1024
  ds_write_b128 v20, v[40:43] offset:2048
  ds_write_b128 v20, v[44:47] offset:3072
  ds_write_b128 v20, v[48:51] offset:4096
  ds_write_b128 v20, v[52:55] offset:5120
  ds_write_b128 v20, v[56:59] offset:6144
  ds_write_b128 v20, v[60:63] offset:7168
  s_waitcnt lgkmcnt(0)
  v_add_u32 v20, 65536, v4
  v_add_u32 v21, 65536, v5
  ds_read_b64_tr_b16 v[32:33], v20 offset:0
  ds_read_b64_tr_b16 v[34:35], v20 offset:2048
  ds_read_b64_tr_b16 v[36:37], v20 offset:8192
  ds_read_b64_tr_b16 v[38:39], v20 offset:10240
  ds_read_b64_tr_b16 v[40:41], v21 offset:0
  ds_read_b64_tr_b16 v[42:43], v21 offset:2048
  ds_read_b64_tr_b16 v[44:45], v21 offset:8192
  ds_read_b64_tr_b16 v[46:47], v21 offset:10240
  ds_read_b64_tr_b16 v[48:49], v20 offset:16384
  ds_read_b64_tr_b16 v[50:51], v20 offset:18432
  ds_read_b64_tr_b16 v[52:53], v20 offset:24576
  ds_read_b64_tr_b16 v[54:55], v20 offset:26624
  ds_read_b64_tr_b16 v[56:57], v21 offset:16384
  ds_read_b64_tr_b16 v[58:59], v21 offset:18432
  ds_read_b64_tr_b16 v[60:61], v21 offset:24576
  ds_read_b64_tr_b16 v[62:63], v21 offset:26624
  s_waitcnt lgkmcnt(0)
  s_barrier
  v_add_u32 v20, 65536, v6
  ds_write_b128 v20, v[32:35] offset:0
  ds_write_b128 v20, v[36:39] offset:1024
  ds_write_b128 v20, v[40:43] offset:2048
  ds_write_b128 v20, v[44:47] offset:3072
  ds_write_b128 v20, v[48:51] offset:4096
  ds_write_b128 v20, v[52:55] offset:5120
  ds_write_b128 v20, v[56:59] offset:6144
  ds_write_b128 v20, v[60:63] offset:7168
  s_waitcnt lgkmcnt(0)
  s_cmp_lt_u32 s96, 8
  s_cbranch_scc1 A_loaded
  s_mov_b32 s14, -3
  v_mov_b32 v4, 0
  v_mov_b32 v5, 0
  s_lshl_b32 s40, s56, 12
  s_lshl_b32 s15, s35, 17
  s_add_u32 s40, s40, s15
  s_lshl_b32 s15, s34, 11
  s_add_u32 s40, s40, s15
  s_add_u32 s40, s40, 0x2000000
  s_lshr_b32 s41, s56, 1
  s_lshl_b32 s41, s41, 2
  s_add_u32 s41, s41, 0x7600080
  s_lshl_b32 s42, s95, 11
  s_add_u32 s42, s42, 114688
  v_mov_b32 v15, 151552
  s_cmp_lg_u32 s95, 3
  s_cbranch_scc1 IW_58
  v_mov_b32 v14, 160
W_59:
  buffer_load_dword v13, v14, s[8:11], 0 offen sc1
  s_waitcnt vmcnt(0)
  v_readfirstlane_b32 s97, v13
  s_and_b32 s97, s97, 0xffff
  s_cmp_eq_u32 s97, 0x80
  s_cbranch_scc1 WE_60
  s_add_u32 s101, s101, 1
  s_cmp_gt_u32 s101, 262144
  s_cbranch_scc1 L_abort
  s_sleep 16
  s_branch W_59
WE_60:
  v_mov_b32 v14, 148
W_61:
  buffer_load_dword v13, v14, s[8:11], 0 offen sc1
  s_waitcnt vmcnt(0)
  v_readfirstlane_b32 s97, v13
  s_and_b32 s97, s97, 0x1
  s_cmp_eq_u32 s97, 0x1
  s_cbranch_scc1 WE_62
  s_add_u32 s101, s101, 1
  s_cmp_gt_u32 s101, 262144
  s_cbranch_scc1 L_abort
  s_sleep 16
  s_branch W_61
WE_62:
  v_mov_b32 v14, 164
  buffer_load_dwordx2 v[88:89], v14, s[8:11], 0 offen sc1
  s_waitcnt vmcnt(0)
  ds_write_b64 v15, v[88:89]
  s_waitcnt lgkmcnt(0)
IW_58:
  s_barrier
  ds_read_b64 v[88:89], v15
  s_waitcnt lgkmcnt(0)
  v_readfirstlane_b32 s98, v88
  v_readfirstlane_b32 s97, v89
  s_cmp_lg_u32 s97, 0
  s_cbranch_scc1 B_slow
  s_mov_b32 s39, -1
Bf_top:
  s_cmp_eq_u32 s95, 1
  s_cbranch_scc1 Bf_w1
  s_cmp_eq_u32 s95, 2
  s_cbranch_scc1 Bf_w2
  s_cmp_eq_u32 s95, 3
  s_cbranch_scc1 Bf_w3
Bf_w0:
  v_mov_b64 v[72:73], 0
  v_mov_b64 v[74:75], 0
  v_mov_b64 v[76:77], 0
  v_mov_b64 v[78:79], 0
  s_and_b32 s55, s39, 3
  s_lshl_b32 s31, s55, 14
  s_add_u32 s31, s31, s13
  s_add_u32 s15, s31, 8192
  s_add_u32 s31, s31, 0
  s_add_u32 s32, s15, 4096
  s_lshl_b32 s54, s55, 14
  s_add_u32 s54, s54, s13
  s_mov_b32 m0, 98304
  s_waitcnt lgkmcnt(0)
  buffer_load_dwordx4 v[16:19], v2, s[4:7], s15 offen offset:0 sc1
  buffer_load_dwordx4 v[20:23], v2, s[4:7], s32 offen offset:0 sc1
  s_sleep 2
P_63:
  buffer_load_dwordx4 v[16:19], v2, s[4:7], s15 offen offset:0 sc1
  buffer_load_dwordx4 v[20:23], v2, s[4:7], s32 offen offset:0 sc1
  s_add_u32 s101, s101, 1
  s_cmp_gt_u32 s101, 262144
  s_cbranch_scc1 L_abort
  s_waitcnt vmcnt(3)
  v_max3_u32 v13, v16, v17, v18
  v_max_u32 v13, v13, v19
  s_waitcnt vmcnt(2)
  v_max3_u32 v13, v13, v20, v21
  v_max3_u32 v13, v13, v22, v23
  v_cmp_eq_u32 vcc, -1, v13
  s_cbranch_vccnz P_63
  ds_write_b128 v8, v[16:19] offset:8192
  v_smfmac_f32_16x16x64_bf16 v[72:75], v[16:19], v[224:231], v3
  ds_write_b128 v8, v[20:23] offset:12288
  v_smfmac_f32_16x16x64_bf16 v[76:79], v[16:19], v[232:239], v3
  buffer_load_dwordx4 v2, s[4:7], s31 offen offset:0 sc1 lds
  v_smfmac_f32_16x16x64_bf16 v[72:75], v[20:23], a[32:39], v3
  buffer_load_dwordx4 v2, s[4:7], s31 offen offset:1024 sc1 lds
  s_waitcnt lgkmcnt(0)
  s_barrier
  ds_read_b128 v[32:35], v8 offset:9216
  ds_read_b128 v[36:39], v8 offset:10240
  v_smfmac_f32_16x16x64_bf16 v[76:79], v[20:23], a[40:47], v3
  ds_read_b128 v[40:43], v8 offset:11264
  s_waitcnt lgkmcnt(2)
  v_smfmac_f32_16x16x64_bf16 v[72:75], v[32:35], v[240:247], v3
  ds_read_b128 v[44:47], v8 offset:13312
  v_smfmac_f32_16x16x64_bf16 v[76:79], v[32:35], v[248:255], v3
  ds_read_b128 v[32:35], v8 offset:14336
  s_waitcnt lgkmcnt(3)
  v_smfmac_f32_16x16x64_bf16 v[72:75], v[36:39], a[0:7], v3
  v_smfmac_f32_16x16x64_bf16 v[76:79], v[36:39], a[8:15], v3
  ds_read_b128 v[36:39], v8 offset:15360
  s_waitcnt lgkmcnt(3)
  v_smfmac_f32_16x16x64_bf16 v[72:75], v[40:43], a[16:23], v3
  v_smfmac_f32_16x16x64_bf16 v[76:79], v[40:43], a[24:31], v3
  s_waitcnt lgkmcnt(2)
  v_smfmac_f32_16x16x64_bf16 v[72:75], v[44:47], a[48:55], v3
  v_smfmac_f32_16x16x64_bf16 v[76:79], v[44:47], a[56:63], v3
  s_waitcnt vmcnt(0)
  ds_read_b128 v[24:27], v8 offset:0
  ds_read_b128 v[28:31], v8 offset:1024
  s_waitcnt lgkmcnt(3)
  v_smfmac_f32_16x16x64_bf16 v[72:75], v[32:35], a[64:71], v3
  v_smfmac_f32_16x16x64_bf16 v[76:79], v[32:35], a[72:79], v3
  s_waitcnt lgkmcnt(2)
  v_smfmac_f32_16x16x64_bf16 v[72:75], v[36:39], a[80:87], v3
  v_smfmac_f32_16x16x64_bf16 v[76:79], v[36:39], a[88:95], v3
  s_waitcnt lgkmcnt(0)
  v_max3_u32 v13, v24, v25, v26
  v_max3_u32 v14, v27, v28, v29
  v_max3_u32 v14, v14, v30, v31
  v_max_u32 v13, v13, v14
  v_cmp_eq_u32 vcc, -1, v13
  s_cbranch_vccz F2O_64
F2R_65:
  buffer_load_dwordx4 v2, s[4:7], s31 offen offset:0 sc1 lds
  buffer_load_dwordx4 v2, s[4:7], s31 offen offset:1024 sc1 lds
  s_add_u32 s101, s101, 1
  s_cmp_gt_u32 s101, 262144
  s_cbranch_scc1 L_abort
  s_waitcnt vmcnt(0)
  ds_read_b128 v[24:27], v8 offset:0
  ds_read_b128 v[28:31], v8 offset:1024
  s_waitcnt lgkmcnt(0)
  v_max3_u32 v13, v24, v25, v26
  v_max3_u32 v14, v27, v28, v29
  v_max3_u32 v14, v14, v30, v31
  v_max_u32 v13, v13, v14
  v_cmp_eq_u32 vcc, -1, v13
  s_cbranch_vccnz F2R_65
F2O_64:
  s_barrier
  ds_read_b128 v[40:43], v8 offset:2048
  ds_read_b128 v[44:47], v8 offset:3072
  v_smfmac_f32_16x16x64_bf16 v[72:75], v[24:27], v[96:103], v3
  ds_read_b128 v[16:19], v8 offset:4096
  v_smfmac_f32_16x16x64_bf16 v[76:79], v[24:27], v[104:111], v3
  ds_read_b128 v[20:23], v8 offset:5120
  v_smfmac_f32_16x16x64_bf16 v[72:75], v[28:31], v[112:119], v3
  ds_read_b128 v[32:35], v8 offset:6144
  v_smfmac_f32_16x16x64_bf16 v[76:79], v[28:31], v[120:127], v3
  ds_read_b128 v[36:39], v8 offset:7168
  s_waitcnt lgkmcnt(5)
  v_smfmac_f32_16x16x64_bf16 v[72:75], v[40:43], v[128:135], v3
  v_smfmac_f32_16x16x64_bf16 v[76:79], v[40:43], v[136:143], v3
  s_waitcnt lgkmcnt(4)
  v_smfmac_f32_16x16x64_bf16 v[72:75], v[44:47], v[144:151], v3
  v_smfmac_f32_16x16x64_bf16 v[76:79], v[44:47], v[152:159], v3
  s_waitcnt lgkmcnt(3)
  v_smfmac_f32_16x16x64_bf16 v[72:75], v[16:19], v[160:167], v3
  v_smfmac_f32_16x16x64_bf16 v[76:79], v[16:19], v[168:175], v3
  s_waitcnt lgkmcnt(2)
  v_smfmac_f32_16x16x64_bf16 v[72:75], v[20:23], v[176:183], v3
  v_smfmac_f32_16x16x64_bf16 v[76:79], v[20:23], v[184:191], v3
  s_waitcnt lgkmcnt(1)
  v_smfmac_f32_16x16x64_bf16 v[72:75], v[32:35], v[192:199], v3
  v_smfmac_f32_16x16x64_bf16 v[76:79], v[32:35], v[200:207], v3
  s_waitcnt lgkmcnt(0)
  v_smfmac_f32_16x16x64_bf16 v[72:75], v[36:39], v[208:215], v3
  v_smfmac_f32_16x16x64_bf16 v[76:79], v[36:39], v[216:223], v3
  s_branch Bf_pub
Bf_w1:
  v_mov_b64 v[72:73], 0
  v_mov_b64 v[74:75], 0
  v_mov_b64 v[76:77], 0
  v_mov_b64 v[78:79], 0
  s_and_b32 s55, s39, 3
  s_lshl_b32 s31, s55, 14
  s_add_u32 s31, s31, s13
  s_add_u32 s15, s31, 9216
  s_add_u32 s31, s31, 2048
  s_add_u32 s32, s15, 4096
  s_lshl_b32 s54, s55, 14
  s_add_u32 s54, s54, s13
  s_mov_b32 m0, 100352
  s_waitcnt lgkmcnt(0)
  buffer_load_dwordx4 v[16:19], v2, s[4:7], s15 offen offset:0 sc1
  buffer_load_dwordx4 v[20:23], v2, s[4:7], s32 offen offset:0 sc1
  s_sleep 2
P_66:
  buffer_load_dwordx4 v[16:19], v2, s[4:7], s15 offen offset:0 sc1
  buffer_load_dwordx4 v[20:23], v2, s[4:7], s32 offen offset:0 sc1
  s_add_u32 s101, s101, 1
  s_cmp_gt_u32 s101, 262144
  s_cbranch_scc1 L_abort
  s_waitcnt vmcnt(3)
  v_max3_u32 v13, v16, v17, v18
  v_max_u32 v13, v13, v19
  s_waitcnt vmcnt(2)
  v_max3_u32 v13, v13, v20, v21
  v_max3_u32 v13, v13, v22, v23
  v_cmp_eq_u32 vcc, -1, v13
  s_cbranch_vccnz P_66
  ds_write_b128 v8, v[16:19] offset:9216
  v_smfmac_f32_16x16x64_bf16 v[72:75], v[16:19], v[240:247], v3
  ds_write_b128 v8, v[20:23] offset:13312
  v_smfmac_f32_16x16x64_bf16 v[76:79], v[16:19], v[248:255], v3
  buffer_load_dwordx4 v2, s[4:7], s31 offen offset:0 sc1 lds
  v_smfmac_f32_16x16x64_bf16 v[72:75], v[20:23], a[48:55], v3
  buffer_load_dwordx4 v2, s[4:7], s31 offen offset:1024 sc1 lds
  s_waitcnt lgkmcnt(0)
  s_barrier
  ds_read_b128 v[32:35], v8 offset:8192
  ds_read_b128 v[36:39], v8 offset:10240
  v_smfmac_f32_16x16x64_bf16 v[76:79], v[20:23], a[56:63], v3
  ds_read_b128 v[40:43], v8 offset:11264
  s_waitcnt lgkmcnt(2)
  v_smfmac_f32_16x16x64_bf16 v[72:75], v[32:35], v[224:231], v3
  ds_read_b128 v[44:47], v8 offset:12288
  v_smfmac_f32_16x16x64_bf16 v[76:79], v[32:35], v[232:239], v3
  ds_read_b128 v[32:35], v8 offset:14336
  s_waitcnt lgkmcnt(3)
  v_smfmac_f32_16x16x64_bf16 v[72:75], v[36:39], a[0:7], v3
  v_smfmac_f32_16x16x64_bf16 v[76:79], v[36:39], a[8:15], v3
  ds_read_b128 v[36:39], v8 offset:15360
  s_waitcnt lgkmcnt(3)
  v_smfmac_f32_16x16x64_bf16 v[72:75], v[40:43], a[16:23], v3
  v_smfmac_f32_16x16x64_bf16 v[76:79], v[40:43], a[24:31], v3
  s_waitcnt lgkmcnt(2)
  v_smfmac_f32_16x16x64_bf16 v[72:75], v[44:47], a[32:39], v3
  v_smfmac_f32_16x16x64_bf16 v[76:79], v[44:47], a[40:47], v3
  s_waitcnt vmcnt(0)
  ds_read_b128 v[24:27], v8 offset:2048
  ds_read_b128 v[28:31], v8 offset:3072
  s_waitcnt lgkmcnt(3)
  v_smfmac_f32_16x16x64_bf16 v[72:75], v[32:35], a[64:71], v3
  v_smfmac_f32_16x16x64_bf16 v[76:79], v[32:35], a[72:79], v3
  s_waitcnt lgkmcnt(2)
  v_smfmac_f32_16x16x64_bf16 v[72:75], v[36:39], a[80:87], v3
  v_smfmac_f32_16x16x64_bf16 v[76:79], v[36:39], a[88:95], v3
  s_waitcnt lgkmcnt(0)
  v_max3_u32 v13, v24, v25, v26
  v_max3_u32 v14, v27, v28, v29
  v_max3_u32 v14, v14, v30, v31
  v_max_u32 v13, v13, v14
  v_cmp_eq_u32 vcc, -1, v13
  s_cbranch_vccz F2O_67
F2R_68:
  buffer_load_dwordx4 v2, s[4:7], s31 offen offset:0 sc1 lds
  buffer_load_dwordx4 v2, s[4:7], s31 offen offset:1024 sc1 lds
  s_add_u32 s101, s101, 1
  s_cmp_gt_u32 s101, 262144
  s_cbranch_scc1 L_abort
  s_waitcnt vmcnt(0)
  ds_read_b128 v[24:27], v8 offset:2048
  ds_read_b128 v[28:31], v8 offset:3072
  s_waitcnt lgkmcnt(0)
  v_max3_u32 v13, v24, v25, v26
  v_max3_u32 v14, v27, v28, v29
  v_max3_u32 v14, v14, v30, v31
  v_max_u32 v13, v13, v14
  v_cmp_eq_u32 vcc, -1, v13
  s_cbranch_vccnz F2R_68
F2O_67:
  s_barrier
  ds_read_b128 v[40:43], v8 offset:0
  ds_read_b128 v[44:47], v8 offset:1024
  v_smfmac_f32_16x16x64_bf16 v[72:75], v[24:27], v[128:135], v3
  ds_read_b128 v[16:19], v8 offset:4096
  v_smfmac_f32_16x16x64_bf16 v[76:79], v[24:27], v[136:143], v3
  ds_read_b128 v[20:23], v8 offset:5120
  v_smfmac_f32_16x16x64_bf16 v[72:75], v[28:31], v[144:151], v3
  ds_read_b128 v[32:35], v8 offset:6144
  v_smfmac_f32_16x16x64_bf16 v[76:79], v[28:31], v[152:159], v3
  ds_read_b128 v[36:39], v8 offset:7168
  s_waitcnt lgkmcnt(5)
  v_smfmac_f32_16x16x64_bf16 v[72:75], v[40:43], v[96:103], v3
  v_smfmac_f32_16x16x64_bf16 v[76:79], v[40:43], v[104:111], v3
  s_waitcnt lgkmcnt(4)
  v_smfmac_f32_16x16x64_bf16 v[72:75], v[44:47], v[112:119], v3
  v_smfmac_f32_16x16x64_bf16 v[76:79], v[44:47], v[120:127], v3
  s_waitcnt lgkmcnt(3)
  v_smfmac_f32_16x16x64_bf16 v[72:75], v[16:19], v[160:167], v3
  v_smfmac_f32_16x16x64_bf16 v[76:79], v[16:19], v[168:175], v3
  s_waitcnt lgkmcnt(2)
  v_smfmac_f32_16x16x64_bf16 v[72:75], v[20:23], v[176:183], v3
  v_smfmac_f32_16x16x64_bf16 v[76:79], v[20:23], v[184:191], v3
  s_waitcnt lgkmcnt(1)
  v_smfmac_f32_16x16x64_bf16 v[72:75], v[32:35], v[192:199], v3
  v_smfmac_f32_16x16x64_bf16 v[76:79], v[32:35], v[200:207], v3
  s_waitcnt lgkmcnt(0)
  v_smfmac_f32_16x16x64_bf16 v[72:75], v[36:39], v[208:215], v3
  v_smfmac_f32_16x16x64_bf16 v[76:79], v[36:39], v[216:223], v3
  s_branch Bf_pub
Bf_w2:
  v_mov_b64 v[72:73], 0
  v_mov_b64 v[74:75], 0
  v_mov_b64 v[76:77], 0
  v_mov_b64 v[78:79], 0
  s_and_b32 s55, s39, 3
  s_lshl_b32 s31, s55, 14
  s_add_u32 s31, s31, s13
  s_add_u32 s15, s31, 10240
  s_add_u32 s31, s31, 4096
  s_add_u32 s32, s15, 4096
  s_lshl_b32 s54, s55, 14
  s_add_u32 s54, s54, s13
  s_mov_b32 m0, 102400
  s_waitcnt lgkmcnt(0)
  buffer_load_dwordx4 v[16:19], v2, s[4:7], s15 offen offset:0 sc1
  buffer_load_dwordx4 v[20:23], v2, s[4:7], s32 offen offset:0 sc1
  s_sleep 2
P_69:
  buffer_load_dwordx4 v[16:19], v2, s[4:7], s15 offen offset:0 sc1
  buffer_load_dwordx4 v[20:23], v2, s[4:7], s32 offen offset:0 sc1
  s_add_u32 s101, s101, 1
  s_cmp_gt_u32 s101, 262144
  s_cbranch_scc1 L_abort
  s_waitcnt vmcnt(3)
  v_max3_u32 v13, v16, v17, v18
  v_max_u32 v13, v13, v19
  s_waitcnt vmcnt(2)
  v_max3_u32 v13, v13, v20, v21
  v_max3_u32 v13, v13, v22, v23
  v_cmp_eq_u32 vcc, -1, v13
  s_cbranch_vccnz P_69
  ds_write_b128 v8, v[16:19] offset:10240
  v_smfmac_f32_16x16x64_bf16 v[72:75], v[16:19], a[0:7], v3
  ds_write_b128 v8, v[20:23] offset:14336
  v_smfmac_f32_16x16x64_bf16 v[76:79], v[16:19], a[8:15], v3
  buffer_load_dwordx4 v2, s[4:7], s31 offen offset:0 sc1 lds
  v_smfmac_f32_16x16x64_bf16 v[72:75], v[20:23], a[64:71], v3
  buffer_load_dwordx4 v2, s[4:7], s31 offen offset:1024 sc1 lds
  s_waitcnt lgkmcnt(0)
  s_barrier
  ds_read_b128 v[32:35], v8 offset:8192
  ds_read_b128 v[36:39], v8 offset:9216
  v_smfmac_f32_16x16x64_bf16 v[76:79], v[20:23], a[72:79], v3
  ds_read_b128 v[40:43], v8 offset:11264
  s_waitcnt lgkmcnt(2)
  v_smfmac_f32_16x16x64_bf16 v[72:75], v[32:35], v[224:231], v3
  ds_read_b128 v[44:47], v8 offset:12288
  v_smfmac_f32_16x16x64_bf16 v[76:79], v[32:35], v[232:239], v3
  ds_read_b128 v[32:35], v8 offset:13312
  s_waitcnt lgkmcnt(3)
  v_smfmac_f32_16x16x64_bf16 v[72:75], v[36:39], v[240:247], v3
  v_smfmac_f32_16x16x64_bf16 v[76:79], v[36:39], v[248:255], v3
  ds_read_b128 v[36:39], v8 offset:15360
  s_waitcnt lgkmcnt(3)
  v_smfmac_f32_16x16x64_bf16 v[72:75], v[40:43], a[16:23], v3
  v_smfmac_f32_16x16x64_bf16 v[76:79], v[40:43], a[24:31], v3
  s_waitcnt lgkmcnt(2)
  v_smfmac_f32_16x16x64_bf16 v[72:75], v[44:47], a[32:39], v3
  v_smfmac_f32_16x16x64_bf16 v[76:79], v[44:47], a[40:47], v3
  s_waitcnt vmcnt(0)
  ds_read_b128 v[24:27], v8 offset:4096
  ds_read_b128 v[28:31], v8 offset:5120
  s_waitcnt lgkmcnt(3)
  v_smfmac_f32_16x16x64_bf16 v[72:75], v[32:35], a[48:55], v3
  v_smfmac_f32_16x16x64_bf16 v[76:79], v[32:35], a[56:63], v3
  s_waitcnt lgkmcnt(2)
  v_smfmac_f32_16x16x64_bf16 v[72:75], v[36:39], a[80:87], v3
  v_smfmac_f32_16x16x64_bf16 v[76:79], v[36:39], a[88:95], v3
  s_waitcnt lgkmcnt(0)
  v_max3_u32 v13, v24, v25, v26
  v_max3_u32 v14, v27, v28, v29
  v_max3_u32 v14, v14, v30, v31
  v_max_u32 v13, v13, v14
  v_cmp_eq_u32 vcc, -1, v13
  s_cbranch_vccz F2O_70
F2R_71:
  buffer_load_dwordx4 v2, s[4:7], s31 offen offset:0 sc1 lds
  buffer_load_dwordx4 v2, s[4:7], s31 offen offset:1024 sc1 lds
  s_add_u32 s101, s101, 1
  s_cmp_gt_u32 s101, 262144
  s_cbranch_scc1 L_abort
  s_waitcnt vmcnt(0)
  ds_read_b128 v[24:27], v8 offset:4096
  ds_read_b128 v[28:31], v8 offset:5120
  s_waitcnt lgkmcnt(0)
  v_max3_u32 v13, v24, v25, v26
  v_max3_u32 v14, v27, v28, v29
  v_max3_u32 v14, v14, v30, v31
  v_max_u32 v13, v13, v14
  v_cmp_eq_u32 vcc, -1, v13
  s_cbranch_vccnz F2R_71
F2O_70:
  s_barrier
  ds_read_b128 v[40:43], v8 offset:0
  ds_read_b128 v[44:47], v8 offset:1024
  v_smfmac_f32_16x16x64_bf16 v[72:75], v[24:27], v[160:167], v3
  ds_read_b128 v[16:19], v8 offset:2048
  v_smfmac_f32_16x16x64_bf16 v[76:79], v[24:27], v[168:175], v3
  ds_read_b128 v[20:23], v8 offset:3072
  v_smfmac_f32_16x16x64_bf16 v[72:75], v[28:31], v[176:183], v3
  ds_read_b128 v[32:35], v8 offset:6144
  v_smfmac_f32_16x16x64_bf16 v[76:79], v[28:31], v[184:191], v3
  ds_read_b128 v[36:39], v8 offset:7168
  s_waitcnt lgkmcnt(5)
  v_smfmac_f32_16x16x64_bf16 v[72:75], v[40:43], v[96:103], v3
  v_smfmac_f32_16x16x64_bf16 v[76:79], v[40:43], v[104:111], v3
  s_waitcnt lgkmcnt(4)
  v_smfmac_f32_16x16x64_bf16 v[72:75], v[44:47], v[112:119], v3
  v_smfmac_f32_16x16x64_bf16 v[76:79], v[44:47], v[120:127], v3
  s_waitcnt lgkmcnt(3)
  v_smfmac_f32_16x16x64_bf16 v[72:75], v[16:19], v[128:135], v3
  v_smfmac_f32_16x16x64_bf16 v[76:79], v[16:19], v[136:143], v3
  s_waitcnt lgkmcnt(2)
  v_smfmac_f32_16x16x64_bf16 v[72:75], v[20:23], v[144:151], v3
  v_smfmac_f32_16x16x64_bf16 v[76:79], v[20:23], v[152:159], v3
  s_waitcnt lgkmcnt(1)
  v_smfmac_f32_16x16x64_bf16 v[72:75], v[32:35], v[192:199], v3
  v_smfmac_f32_16x16x64_bf16 v[76:79], v[32:35], v[200:207], v3
  s_waitcnt lgkmcnt(0)
  v_smfmac_f32_16x16x64_bf16 v[72:75], v[36:39], v[208:215], v3
  v_smfmac_f32_16x16x64_bf16 v[76:79], v[36:39], v[216:223], v3
  s_branch Bf_pub
Bf_w3:
  v_mov_b64 v[72:73], 0
  v_mov_b64 v[74:75], 0
  v_mov_b64 v[76:77], 0
  v_mov_b64 v[78:79], 0
  s_and_b32 s55, s39, 3
  s_lshl_b32 s31, s55, 14
  s_add_u32 s31, s31, s13
  s_add_u32 s15, s31, 11264
  s_add_u32 s31, s31, 6144
  s_add_u32 s32, s15, 4096
  s_lshl_b32 s54, s55, 14
  s_add_u32 s54, s54, s13
  s_mov_b32 m0, 104448
  s_waitcnt lgkmcnt(0)
  buffer_load_dwordx4 v[16:19], v2, s[4:7], s15 offen offset:0 sc1
  buffer_load_dwordx4 v[20:23], v2, s[4:7], s32 offen offset:0 sc1
  s_sleep 2
P_72:
  buffer_load_dwordx4 v[16:19], v2, s[4:7], s15 offen offset:0 sc1
  buffer_load_dwordx4 v[20:23], v2, s[4:7], s32 offen offset:0 sc1
  s_add_u32 s101, s101, 1
  s_cmp_gt_u32 s101, 262144
  s_cbranch_scc1 L_abort
  s_waitcnt vmcnt(3)
  v_max3_u32 v13, v16, v17, v18
  v_max_u32 v13, v13, v19
  s_waitcnt vmcnt(2)
  v_max3_u32 v13, v13, v20, v21
  v_max3_u32 v13, v13, v22, v23
  v_cmp_eq_u32 vcc, -1, v13
  s_cbranch_vccnz P_72
  ds_write_b128 v8, v[16:19] offset:11264
  v_smfmac_f32_16x16x64_bf16 v[72:75], v[16:19], a[16:23], v3
  ds_write_b128 v8, v[20:23] offset:15360
  v_smfmac_f32_16x16x64_bf16 v[76:79], v[16:19], a[24:31], v3
  buffer_load_dwordx4 v2, s[4:7], s31 offen offset:0 sc1 lds
  v_smfmac_f32_16x16x64_bf16 v[72:75], v[20:23], a[80:87], v3
  buffer_load_dwordx4 v2, s[4:7], s31 offen offset:1024 sc1 lds
  s_waitcnt lgkmcnt(0)
  s_barrier
  ds_read_b128 v[32:35], v8 offset:8192
  ds_read_b128 v[36:39], v8 offset:9216
  v_smfmac_f32_16x16x64_bf16 v[76:79], v[20:23], a[88:95], v3
  ds_read_b128 v[40:43], v8 offset:10240
  s_waitcnt lgkmcnt(2)
  v_smfmac_f32_16x16x64_bf16 v[72:75], v[32:35], v[224:231], v3
  ds_read_b128 v[44:47], v8 offset:12288
  v_smfmac_f32_16x16x64_bf16 v[76:79], v[32:35], v[232:239], v3
  ds_read_b128 v[32:35], v8 offset:13312
  s_waitcnt lgkmcnt(3)
  v_smfmac_f32_16x16x64_bf16 v[72:75], v[36:39], v[240:247], v3
  v_smfmac_f32_16x16x64_bf16 v[76:79], v[36:39], v[248:255], v3
  ds_read_b128 v[36:39], v8 offset:14336
  s_waitcnt lgkmcnt(3)
  v_smfmac_f32_16x16x64_bf16 v[72:75], v[40:43], a[0:7], v3
  v_smfmac_f32_16x16x64_bf16 v[76:79], v[40:43], a[8:15], v3
  s_waitcnt lgkmcnt(2)
  v_smfmac_f32_16x16x64_bf16 v[72:75], v[44:47], a[32:39], v3
  v_smfmac_f32_16x16x64_bf16 v[76:79], v[44:47], a[40:47], v3
  s_waitcnt vmcnt(0)
  ds_read_b128 v[24:27], v8 offset:6144
  ds_read_b128 v[28:31], v8 offset:7168
  s_waitcnt lgkmcnt(3)
  v_smfmac_f32_16x16x64_bf16 v[72:75], v[32:35], a[48:55], v3
  v_smfmac_f32_16x16x64_bf16 v[76:79], v[32:35], a[56:63], v3
  s_waitcnt lgkmcnt(2)
  v_smfmac_f32_16x16x64_bf16 v[72:75], v[36:39], a[64:71], v3
  v_smfmac_f32_16x16x64_bf16 v[76:79], v[36:39], a[72:79], v3
  s_waitcnt lgkmcnt(0)
  v_max3_u32 v13, v24, v25, v26
  v_max3_u32 v14, v27, v28, v29
  v_max3_u32 v14, v14, v30, v31
  v_max_u32 v13, v13, v14
  v_cmp_eq_u32 vcc, -1, v13
  s_cbranch_vccz F2O_73
F2R_74:
  buffer_load_dwordx4 v2, s[4:7], s31 offen offset:0 sc1 lds
  buffer_load_dwordx4 v2, s[4:7], s31 offen offset:1024 sc1 lds
  s_add_u32 s101, s101, 1
  s_cmp_gt_u32 s101, 262144
  s_cbranch_scc1 L_abort
  s_waitcnt vmcnt(0)
  ds_read_b128 v[24:27], v8 offset:6144
  ds_read_b128 v[28:31], v8 offset:7168
  s_waitcnt lgkmcnt(0)
  v_max3_u32 v13, v24, v25, v26
  v_max3_u32 v14, v27, v28, v29
  v_max3_u32 v14, v14, v30, v31
  v_max_u32 v13, v13, v14
  v_cmp_eq_u32 vcc, -1, v13
  s_cbranch_vccnz F2R_74
F2O_73:
  s_barrier
  ds_read_b128 v[40:43], v8 offset:0
  ds_read_b128 v[44:47], v8 offset:1024
  v_smfmac_f32_16x16x64_bf16 v[72:75], v[24:27], v[192:199], v3
  ds_read_b128 v[16:19], v8 offset:2048
  v_smfmac_f32_16x16x64_bf16 v[76:79], v[24:27], v[200:207], v3
  ds_read_b128 v[20:23], v8 offset:3072
  v_smfmac_f32_16x16x64_bf16 v[72:75], v[28:31], v[208:215], v3
  ds_read_b128 v[32:35], v8 offset:4096
  v_smfmac_f32_16x16x64_bf16 v[76:79], v[28:31], v[216:223], v3
  ds_read_b128 v[36:39], v8 offset:5120
  s_waitcnt lgkmcnt(5)
  v_smfmac_f32_16x16x64_bf16 v[72:75], v[40:43], v[96:103], v3
  v_smfmac_f32_16x16x64_bf16 v[76:79], v[40:43], v[104:111], v3
  s_waitcnt lgkmcnt(4)
  v_smfmac_f32_16x16x64_bf16 v[72:75], v[44:47], v[112:119], v3
  v_smfmac_f32_16x16x64_bf16 v[76:79], v[44:47], v[120:127], v3
  s_waitcnt lgkmcnt(3)
  v_smfmac_f32_16x16x64_bf16 v[72:75], v[16:19], v[128:135], v3
  v_smfmac_f32_16x16x64_bf16 v[76:79], v[16:19], v[136:143], v3
  s_waitcnt lgkmcnt(2)
  v_smfmac_f32_16x16x64_bf16 v[72:75], v[20:23], v[144:151], v3
  v_smfmac_f32_16x16x64_bf16 v[76:79], v[20:23], v[152:159], v3
  s_waitcnt lgkmcnt(1)
  v_smfmac_f32_16x16x64_bf16 v[72:75], v[32:35], v[160:167], v3
  v_smfmac_f32_16x16x64_bf16 v[76:79], v[32:35], v[168:175], v3
  s_waitcnt lgkmcnt(0)
  v_smfmac_f32_16x16x64_bf16 v[72:75], v[36:39], v[176:183], v3
  v_smfmac_f32_16x16x64_bf16 v[76:79], v[36:39], v[184:191], v3
  s_nop 0
Bf_pub:
  s_and_b32 s50, s14, 1
  s_lshl_b32 s50, s50, 14
  v_add_u32 v15, s50, v8
  s_nop 2
  v_pk_add_f32 v[72:73], v[72:73], v[74:75]
  v_pk_add_f32 v[76:77], v[76:77], v[78:79]
  v_cvt_pk_bf16_f32 v72, v72, v73
  v_cvt_pk_bf16_f32 v73, v76, v77
  buffer_store_dwordx2 v[72:73], v11, s[4:7], s54 offen
  s_xor_b32 s54, s54, 32768
  v_mov_b64 v[94:95], -1
  buffer_store_dwordx2 v[94:95], v11, s[4:7], s54 offen
  s_cmp_ge_i32 s39, 0
  s_cbranch_scc1 B0_75
  buffer_store_dwordx2 v[72:73], v11, s[4:7], s13 offen
B0_75:
  s_mov_b32 s100, 4
SL_76:
  s_sleep 1
  s_sub_u32 s100, s100, 1
  s_cmp_lg_u32 s100, 0
  s_cbranch_scc1 SL_76
  s_cmp_ge_i32 s14, 62
  s_cbranch_scc1 Bf_done
Bf_zx:
  ds_read_b128 v[16:19], v15 offset:16384
  ds_read_b128 v[32:35], v15 offset:20480
  ds_read_b128 v[20:23], v15 offset:17408
  ds_read_b128 v[36:39], v15 offset:21504
  ds_read_b128 v[24:27], v15 offset:18432
  ds_read_b128 v[40:43], v15 offset:22528
  ds_read_b128 v[28:31], v15 offset:19456
  ds_read_b128 v[44:47], v15 offset:23552
  s_add_u32 s46, s14, 3
  s_and_b32 s46, s46, 3
  s_lshl_b32 s46, s46, 14
  s_add_u32 s46, s46, s13
  s_waitcnt lgkmcnt(6)
  v_mfma_f32_16x16x32_bf16 v[72:75], v[16:19], a[96:99], 0
  ds_read_b128 v[48:51], v6 offset:0
  ds_read_b128 v[52:55], v6 offset:1024
  v_mfma_f32_16x16x32_bf16 v[76:79], v[32:35], a[96:99], 0
  ds_read_b128 v[56:59], v6 offset:4096
  ds_read_b128 v[60:63], v6 offset:5120
  buffer_load_dword v9, v10, s[4:7], s46 offen sc1
  s_waitcnt lgkmcnt(8)
  v_mfma_f32_16x16x32_bf16 v[72:75], v[20:23], a[100:103], v[72:75]
  ds_read_b128 v[64:67], v6 offset:2048
  ds_read_b128 v[68:71], v6 offset:3072
  v_mfma_f32_16x16x32_bf16 v[76:79], v[36:39], a[100:103], v[76:79]
  s_add_u32 s43, s14, 3
  s_min_i32 s43, s43, 63
  s_lshr_b32 s44, s43, 2
  s_waitcnt lgkmcnt(8)
  v_mfma_f32_16x16x32_bf16 v[72:75], v[24:27], a[112:115], v[72:75]
  s_lshl_b32 s44, s44, 11
  s_add_u32 s44, s44, s41
  s_lshl_b32 s43, s43, 18
  v_mfma_f32_16x16x32_bf16 v[76:79], v[40:43], a[112:115], v[76:79]
  s_add_u32 s43, s43, s40
  s_add_u32 s45, s14, 4
  s_min_i32 s45, s45, 63
  s_waitcnt lgkmcnt(6)
  v_mfma_f32_16x16x32_bf16 v[72:75], v[28:31], a[116:119], v[72:75]
  s_lshr_b32 s45, s45, 2
  s_lshl_b32 s45, s45, 11
  s_add_u32 s45, s45, s41
  v_mfma_f32_16x16x32_bf16 v[76:79], v[44:47], a[116:119], v[76:79]
  s_and_b32 s47, s14, 1
  s_lshl_b32 s97, s47, 14
  s_xor_b32 s97, s97, 16384
  v_mfma_f32_16x16x32_bf16 v[80:83], v[16:19], a[104:107], 0
  s_add_u32 m0, s97, s42
  s_lshl_b32 s47, s47, 19
  s_add_u32 s47, s47, s13
  v_mfma_f32_16x16x32_bf16 v[84:87], v[32:35], a[104:107], 0
  v_mfma_f32_16x16x32_bf16 v[80:83], v[20:23], a[108:111], v[80:83]
  v_mfma_f32_16x16x32_bf16 v[84:87], v[36:39], a[108:111], v[84:87]
  v_mfma_f32_16x16x32_bf16 v[80:83], v[24:27], a[120:123], v[80:83]
  v_mfma_f32_16x16x32_bf16 v[84:87], v[40:43], a[120:123], v[84:87]
  v_mfma_f32_16x16x32_bf16 v[80:83], v[28:31], a[124:127], v[80:83]
  v_mfma_f32_16x16x32_bf16 v[84:87], v[44:47], a[124:127], v[84:87]
  v_cvt_pk_bf16_f32 v72, v72, v73
  v_cvt_pk_bf16_f32 v73, v74, v75
  s_waitcnt vmcnt(0)
  v_cmp_ne_u32 vcc, -1, v9
  v_cmp_eq_u32 s[48:49], 0, v4
  s_or_b64 vcc, vcc, s[48:49]
  s_cbranch_scc1 BS_77
BB_78:
  s_waitcnt lgkmcnt(4)
  v_mfma_f32_16x16x32_bf16 v[88:91], v[16:19], v[48:51], 0
  v_cvt_pk_bf16_f32 v74, v76, v77
  v_cvt_pk_bf16_f32 v75, v78, v79
  v_mfma_f32_16x16x32_bf16 v[92:95], v[32:35], v[48:51], 0
  s_add_u32 s31, s47, 0
  buffer_store_dwordx4 v[72:75], v12, s[4:7], s31 offen
  v_mfma_f32_16x16x32_bf16 v[88:91], v[20:23], v[52:55], v[88:91]
  v_mfma_f32_16x16x32_bf16 v[92:95], v[36:39], v[52:55], v[92:95]
  ds_read_b128 v[48:51], v6 offset:6144
  s_waitcnt lgkmcnt(3)
  v_mfma_f32_16x16x32_bf16 v[88:91], v[24:27], v[56:59], v[88:91]
  ds_read_b128 v[52:55], v6 offset:7168
  v_mfma_f32_16x16x32_bf16 v[92:95], v[40:43], v[56:59], v[92:95]
  buffer_load_dwordx4 v2, s[4:7], s43 offen offset:0 sc1 nt lds
  v_mfma_f32_16x16x32_bf16 v[88:91], v[28:31], v[60:63], v[88:91]
  buffer_load_dwordx4 v2, s[4:7], s43 offen offset:1024 sc1 nt lds
  v_mfma_f32_16x16x32_bf16 v[92:95], v[44:47], v[60:63], v[92:95]
  ds_read_b128 v[56:59], v6 offset:32768
  v_mfma_f32_16x16x32_bf16 v[72:75], v[16:19], a[128:131], 0
  ds_read_b128 v[60:63], v6 offset:33792
  v_mfma_f32_16x16x32_bf16 v[76:79], v[32:35], a[128:131], 0
  v_cvt_pk_bf16_f32 v80, v80, v81
  v_cvt_pk_bf16_f32 v81, v82, v83
  v_mfma_f32_16x16x32_bf16 v[72:75], v[20:23], a[132:135], v[72:75]
  v_cvt_pk_bf16_f32 v82, v84, v85
  v_cvt_pk_bf16_f32 v83, v86, v87
  v_mfma_f32_16x16x32_bf16 v[76:79], v[36:39], a[132:135], v[76:79]
  s_add_u32 s31, s47, 8192
  buffer_store_dwordx4 v[80:83], v12, s[4:7], s31 offen
  v_mfma_f32_16x16x32_bf16 v[72:75], v[24:27], a[144:147], v[72:75]
  buffer_load_dword v4, v5, s[4:7], s45 offen sc1
  v_mfma_f32_16x16x32_bf16 v[76:79], v[40:43], a[144:147], v[76:79]
  v_mfma_f32_16x16x32_bf16 v[72:75], v[28:31], a[148:151], v[72:75]
  v_mfma_f32_16x16x32_bf16 v[76:79], v[44:47], a[148:151], v[76:79]
  v_cvt_pk_bf16_f32 v88, v88, v89
  v_cvt_pk_bf16_f32 v89, v90, v91
  s_waitcnt lgkmcnt(4)
  v_mfma_f32_16x16x32_bf16 v[80:83], v[16:19], v[64:67], 0
  v_cvt_pk_bf16_f32 v90, v92, v93
  v_cvt_pk_bf16_f32 v91, v94, v95
  v_mfma_f32_16x16x32_bf16 v[84:87], v[32:35], v[64:67], 0
  s_add_u32 s31, s47, 327680
  buffer_store_dwordx4 v[88:91], v12, s[4:7], s31 offen
  v_mfma_f32_16x16x32_bf16 v[80:83], v[20:23], v[68:71], v[80:83]
  v_mfma_f32_16x16x32_bf16 v[84:87], v[36:39], v[68:71], v[84:87]
  ds_read_b128 v[64:67], v6 offset:36864
  s_waitcnt lgkmcnt(3)
  v_mfma_f32_16x16x32_bf16 v[80:83], v[24:27], v[48:51], v[80:83]
  ds_read_b128 v[68:71], v6 offset:37888
  v_mfma_f32_16x16x32_bf16 v[84:87], v[40:43], v[48:51], v[84:87]
  v_mfma_f32_16x16x32_bf16 v[80:83], v[28:31], v[52:55], v[80:83]
  v_mfma_f32_16x16x32_bf16 v[84:87], v[44:47], v[52:55], v[84:87]
  ds_read_b128 v[48:51], v6 offset:34816
  v_mfma_f32_16x16x32_bf16 v[88:91], v[16:19], a[136:139], 0
  ds_read_b128 v[52:55], v6 offset:35840
  v_mfma_f32_16x16x32_bf16 v[92:95], v[32:35], a[136:139], 0
  v_cvt_pk_bf16_f32 v72, v72, v73
  v_cvt_pk_bf16_f32 v73, v74, v75
  v_mfma_f32_16x16x32_bf16 v[88:91], v[20:23], a[140:143], v[88:91]
  v_cvt_pk_bf16_f32 v74, v76, v77
  v_cvt_pk_bf16_f32 v75, v78, v79
  v_mfma_f32_16x16x32_bf16 v[92:95], v[36:39], a[140:143], v[92:95]
  s_add_u32 s31, s47, 65536
  buffer_store_dwordx4 v[72:75], v12, s[4:7], s31 offen
  v_mfma_f32_16x16x32_bf16 v[88:91], v[24:27], a[152:155], v[88:91]
  v_mfma_f32_16x16x32_bf16 v[92:95], v[40:43], a[152:155], v[92:95]
  v_mfma_f32_16x16x32_bf16 v[88:91], v[28:31], a[156:159], v[88:91]
  v_mfma_f32_16x16x32_bf16 v[92:95], v[44:47], a[156:159], v[92:95]
  v_cvt_pk_bf16_f32 v80, v80, v81
  v_cvt_pk_bf16_f32 v81, v82, v83
  s_waitcnt lgkmcnt(4)
  v_mfma_f32_16x16x32_bf16 v[72:75], v[16:19], v[56:59], 0
  v_cvt_pk_bf16_f32 v82, v84, v85
  v_cvt_pk_bf16_f32 v83, v86, v87
  v_mfma_f32_16x16x32_bf16 v[76:79], v[32:35], v[56:59], 0
  s_add_u32 s31, s47, 335872
  buffer_store_dwordx4 v[80:83], v12, s[4:7], s31 offen
  v_mfma_f32_16x16x32_bf16 v[72:75], v[20:23], v[60:63], v[72:75]
  v_mfma_f32_16x16x32_bf16 v[76:79], v[36:39], v[60:63], v[76:79]
  ds_read_b128 v[56:59], v6 offset:38912
  s_waitcnt lgkmcnt(3)
  v_mfma_f32_16x16x32_bf16 v[72:75], v[24:27], v[64:67], v[72:75]
  ds_read_b128 v[60:63], v6 offset:39936
  v_mfma_f32_16x16x32_bf16 v[76:79], v[40:43], v[64:67], v[76:79]
  v_mfma_f32_16x16x32_bf16 v[72:75], v[28:31], v[68:71], v[72:75]
  v_mfma_f32_16x16x32_bf16 v[76:79], v[44:47], v[68:71], v[76:79]
  ds_read_b128 v[64:67], v7 offset:0
  v_mfma_f32_16x16x32_bf16 v[80:83], v[16:19], a[160:163], 0
  ds_read_b128 v[68:71], v7 offset:1024
  v_mfma_f32_16x16x32_bf16 v[84:87], v[32:35], a[160:163], 0
  v_cvt_pk_bf16_f32 v88, v88, v89
  v_cvt_pk_bf16_f32 v89, v90, v91
  v_mfma_f32_16x16x32_bf16 v[80:83], v[20:23], a[164:167], v[80:83]
  v_cvt_pk_bf16_f32 v90, v92, v93
  v_cvt_pk_bf16_f32 v91, v94, v95
  v_mfma_f32_16x16x32_bf16 v[84:87], v[36:39], a[164:167], v[84:87]
  s_add_u32 s31, s47, 73728
  buffer_store_dwordx4 v[88:91], v12, s[4:7], s31 offen
  v_mfma_f32_16x16x32_bf16 v[80:83], v[24:27], a[176:179], v[80:83]
  v_mfma_f32_16x16x32_bf16 v[84:87], v[40:43], a[176:179], v[84:87]
  v_mfma_f32_16x16x32_bf16 v[80:83], v[28:31], a[180:183], v[80:83]
  v_mfma_f32_16x16x32_bf16 v[84:87], v[44:47], a[180:183], v[84:87]
  v_cvt_pk_bf16_f32 v72, v72, v73
  v_cvt_pk_bf16_f32 v73, v74, v75
  s_waitcnt lgkmcnt(4)
  v_mfma_f32_16x16x32_bf16 v[88:91], v[16:19], v[48:51], 0
  v_cvt_pk_bf16_f32 v74, v76, v77
  v_cvt_pk_bf16_f32 v75, v78, v79
  v_mfma_f32_16x16x32_bf16 v[92:95], v[32:35], v[48:51], 0
  s_add_u32 s31, s47, 393216
  buffer_store_dwordx4 v[72:75], v12, s[4:7], s31 offen
  v_mfma_f32_16x16x32_bf16 v[88:91], v[20:23], v[52:55], v[88:91]
  v_mfma_f32_16x16x32_bf16 v[92:95], v[36:39], v[52:55], v[92:95]
  ds_read_b128 v[48:51], v7 offset:4096
  s_waitcnt lgkmcnt(3)
  v_mfma_f32_16x16x32_bf16 v[88:91], v[24:27], v[56:59], v[88:91]
  ds_read_b128 v[52:55], v7 offset:5120
  v_mfma_f32_16x16x32_bf16 v[92:95], v[40:43], v[56:59], v[92:95]
  v_mfma_f32_16x16x32_bf16 v[88:91], v[28:31], v[60:63], v[88:91]
  v_mfma_f32_16x16x32_bf16 v[92:95], v[44:47], v[60:63], v[92:95]
  ds_read_b128 v[56:59], v7 offset:2048
  v_mfma_f32_16x16x32_bf16 v[72:75], v[16:19], a[168:171], 0
  ds_read_b128 v[60:63], v7 offset:3072
  v_mfma_f32_16x16x32_bf16 v[76:79], v[32:35], a[168:171], 0
  v_cvt_pk_bf16_f32 v80, v80, v81
  v_cvt_pk_bf16_f32 v81, v82, v83
  v_mfma_f32_16x16x32_bf16 v[72:75], v[20:23], a[172:175], v[72:75]
  v_cvt_pk_bf16_f32 v82, v84, v85
  v_cvt_pk_bf16_f32 v83, v86, v87
  v_mfma_f32_16x16x32_bf16 v[76:79], v[36:39], a[172:175], v[76:79]
  s_add_u32 s31, s47, 131072
  buffer_store_dwordx4 v[80:83], v12, s[4:7], s31 offen
  v_mfma_f32_16x16x32_bf16 v[72:75], v[24:27], a[184:187], v[72:75]
  v_mfma_f32_16x16x32_bf16 v[76:79], v[40:43], a[184:187], v[76:79]
  v_mfma_f32_16x16x32_bf16 v[72:75], v[28:31], a[188:191], v[72:75]
  v_mfma_f32_16x16x32_bf16 v[76:79], v[44:47], a[188:191], v[76:79]
  v_cvt_pk_bf16_f32 v88, v88, v89
  v_cvt_pk_bf16_f32 v89, v90, v91
  s_waitcnt lgkmcnt(4)
  v_mfma_f32_16x16x32_bf16 v[80:83], v[16:19], v[64:67], 0
  v_cvt_pk_bf16_f32 v90, v92, v93
  v_cvt_pk_bf16_f32 v91, v94, v95
  v_mfma_f32_16x16x32_bf16 v[84:87], v[32:35], v[64:67], 0
  s_add_u32 s31, s47, 401408
  buffer_store_dwordx4 v[88:91], v12, s[4:7], s31 offen
  v_mfma_f32_16x16x32_bf16 v[80:83], v[20:23], v[68:71], v[80:83]
  v_mfma_f32_16x16x32_bf16 v[84:87], v[36:39], v[68:71], v[84:87]
  ds_read_b128 v[64:67], v7 offset:6144
  s_waitcnt lgkmcnt(3)
  v_mfma_f32_16x16x32_bf16 v[80:83], v[24:27], v[48:51], v[80:83]
  ds_read_b128 v[68:71], v7 offset:7168
  v_mfma_f32_16x16x32_bf16 v[84:87], v[40:43], v[48:51], v[84:87]
  v_mfma_f32_16x16x32_bf16 v[80:83], v[28:31], v[52:55], v[80:83]
  v_mfma_f32_16x16x32_bf16 v[84:87], v[44:47], v[52:55], v[84:87]
  v_cvt_pk_bf16_f32 v72, v72, v73
  v_cvt_pk_bf16_f32 v73, v74, v75
  v_mfma_f32_16x16x32_bf16 v[88:91], v[16:19], a[192:195], 0
  v_cvt_pk_bf16_f32 v74, v76, v77
  v_cvt_pk_bf16_f32 v75, v78, v79
  v_mfma_f32_16x16x32_bf16 v[92:95], v[32:35], a[192:195], 0
  s_add_u32 s31, s47, 139264
  buffer_store_dwordx4 v[72:75], v12, s[4:7], s31 offen
  v_mfma_f32_16x16x32_bf16 v[88:91], v[20:23], a[196:199], v[88:91]
  v_mfma_f32_16x16x32_bf16 v[92:95], v[36:39], a[196:199], v[92:95]
  v_mfma_f32_16x16x32_bf16 v[88:91], v[24:27], a[208:211], v[88:91]
  v_mfma_f32_16x16x32_bf16 v[92:95], v[40:43], a[208:211], v[92:95]
  v_mfma_f32_16x16x32_bf16 v[88:91], v[28:31], a[212:215], v[88:91]
  v_mfma_f32_16x16x32_bf16 v[92:95], v[44:47], a[212:215], v[92:95]
  v_cvt_pk_bf16_f32 v80, v80, v81
  v_cvt_pk_bf16_f32 v81, v82, v83
  s_waitcnt lgkmcnt(2)
  v_mfma_f32_16x16x32_bf16 v[72:75], v[16:19], v[56:59], 0
  v_cvt_pk_bf16_f32 v82, v84, v85
  v_cvt_pk_bf16_f32 v83, v86, v87
  v_mfma_f32_16x16x32_bf16 v[76:79], v[32:35], v[56:59], 0
  s_add_u32 s31, s47, 458752
  buffer_store_dwordx4 v[80:83], v12, s[4:7], s31 offen
  v_mfma_f32_16x16x32_bf16 v[72:75], v[20:23], v[60:63], v[72:75]
  v_mfma_f32_16x16x32_bf16 v[76:79], v[36:39], v[60:63], v[76:79]
  s_waitcnt lgkmcnt(0)
  v_mfma_f32_16x16x32_bf16 v[72:75], v[24:27], v[64:67], v[72:75]
  v_mfma_f32_16x16x32_bf16 v[76:79], v[40:43], v[64:67], v[76:79]
  v_mfma_f32_16x16x32_bf16 v[72:75], v[28:31], v[68:71], v[72:75]
  v_mfma_f32_16x16x32_bf16 v[76:79], v[44:47], v[68:71], v[76:79]
  v_cvt_pk_bf16_f32 v88, v88, v89
  v_cvt_pk_bf16_f32 v89, v90, v91
  v_mfma_f32_16x16x32_bf16 v[80:83], v[16:19], a[200:203], 0
  v_cvt_pk_bf16_f32 v90, v92, v93
  v_cvt_pk_bf16_f32 v91, v94, v95
  v_mfma_f32_16x16x32_bf16 v[84:87], v[32:35], a[200:203], 0
  s_add_u32 s31, s47, 196608
  buffer_store_dwordx4 v[88:91], v12, s[4:7], s31 offen
  v_mfma_f32_16x16x32_bf16 v[80:83], v[20:23], a[204:207], v[80:83]
  v_mfma_f32_16x16x32_bf16 v[84:87], v[36:39], a[204:207], v[84:87]
  v_mfma_f32_16x16x32_bf16 v[80:83], v[24:27], a[216:219], v[80:83]
  v_mfma_f32_16x16x32_bf16 v[84:87], v[40:43], a[216:219], v[84:87]
  v_mfma_f32_16x16x32_bf16 v[80:83], v[28:31], a[220:223], v[80:83]
  v_mfma_f32_16x16x32_bf16 v[84:87], v[44:47], a[220:223], v[84:87]
  v_cvt_pk_bf16_f32 v72, v72, v73
  v_cvt_pk_bf16_f32 v73, v74, v75
  v_mfma_f32_16x16x32_bf16 v[88:91], v[16:19], a[224:227], 0
  v_cvt_pk_bf16_f32 v74, v76, v77
  v_cvt_pk_bf16_f32 v75, v78, v79
  v_mfma_f32_16x16x32_bf16 v[92:95], v[32:35], a[224:227], 0
  s_add_u32 s31, s47, 466944
  buffer_store_dwordx4 v[72:75], v12, s[4:7], s31 offen
  v_mfma_f32_16x16x32_bf16 v[88:91], v[20:23], a[228:231], v[88:91]
  v_mfma_f32_16x16x32_bf16 v[92:95], v[36:39], a[228:231], v[92:95]
  v_mfma_f32_16x16x32_bf16 v[88:91], v[24:27], a[240:243], v[88:91]
  v_mfma_f32_16x16x32_bf16 v[92:95], v[40:43], a[240:243], v[92:95]
  v_mfma_f32_16x16x32_bf16 v[88:91], v[28:31], a[244:247], v[88:91]
  v_mfma_f32_16x16x32_bf16 v[92:95], v[44:47], a[244:247], v[92:95]
  v_cvt_pk_bf16_f32 v80, v80, v81
  v_cvt_pk_bf16_f32 v81, v82, v83
  v_mfma_f32_16x16x32_bf16 v[72:75], v[16:19], a[232:235], 0
  v_cvt_pk_bf16_f32 v82, v84, v85
  v_cvt_pk_bf16_f32 v83, v86, v87
  v_mfma_f32_16x16x32_bf16 v[76:79], v[32:35], a[232:235], 0
  s_add_u32 s31, s47, 204800
  buffer_store_dwordx4 v[80:83], v12, s[4:7], s31 offen
  v_mfma_f32_16x16x32_bf16 v[72:75], v[20:23], a[236:239], v[72:75]
  v_mfma_f32_16x16x32_bf16 v[76:79], v[36:39], a[236:239], v[76:79]
  v_mfma_f32_16x16x32_bf16 v[72:75], v[24:27], a[248:251], v[72:75]
  v_mfma_f32_16x16x32_bf16 v[76:79], v[40:43], a[248:251], v[76:79]
  v_mfma_f32_16x16x32_bf16 v[72:75], v[28:31], a[252:255], v[72:75]
  v_mfma_f32_16x16x32_bf16 v[76:79], v[44:47], a[252:255], v[76:79]
  v_cvt_pk_bf16_f32 v88, v88, v89
  v_cvt_pk_bf16_f32 v89, v90, v91
  s_nop 1
  v_cvt_pk_bf16_f32 v90, v92, v93
  v_cvt_pk_bf16_f32 v91, v94, v95
  s_add_u32 s31, s47, 262144
  buffer_store_dwordx4 v[88:91], v12, s[4:7], s31 offen
  v_cvt_pk_bf16_f32 v72, v72, v73
  v_cvt_pk_bf16_f32 v73, v74, v75
  v_cvt_pk_bf16_f32 v74, v76, v77
  v_cvt_pk_bf16_f32 v75, v78, v79
  s_add_u32 s31, s47, 270336
  buffer_store_dwordx4 v[72:75], v12, s[4:7], s31 offen
Bf_done:
  s_add_u32 s14, s14, 1
  s_cmp_ge_i32 s14, 64
  s_cbranch_scc1 L_end
  s_max_i32 s39, s14, 0
  s_cmp_ge_i32 s14, 1
  s_cbranch_scc1 Bf_top
  s_cmp_eq_i32 s14, -2
  s_cbranch_scc1 Bf_pro
  s_add_u32 s15, s14, 2
  v_mov_b32 v13, s15
  s_waitcnt vmcnt(0)
  s_mov_b64 exec, 1
  buffer_store_dword v13, v2, s[4:7], s38 offen
  s_mov_b64 exec, -1
Bf_pro:
  s_cmp_lg_i32 s14, -2
  s_cbranch_scc1 BW_79
  s_mov_b32 exec_lo, 0x1
  s_mov_b32 exec_hi, 0x0
F_80:
  buffer_load_dword v13, v2, s[4:7], s44 offen sc1
  s_waitcnt vmcnt(0)
  v_cmp_eq_u32 vcc, 0, v13
  s_cbranch_vccz FE_81
  s_add_u32 s101, s101, 1
  s_cmp_gt_u32 s101, 262144
  s_cbranch_scc1 L_abort
  s_sleep 2
  s_branch F_80
FE_81:
  s_mov_b64 exec, -1
  s_mov_b32 m0, s42
  s_nop 0
  buffer_load_dwordx4 v2, s[4:7], s43 offen offset:0 sc1 nt lds
  buffer_load_dwordx4 v2, s[4:7], s43 offen offset:1024 sc1 nt lds
  s_waitcnt vmcnt(0)
BW_79:
  s_and_b32 s50, s14, 1
  s_lshl_b32 s50, s50, 14
  v_add_u32 v15, s50, v8
  s_barrier
  s_branch Bf_zx
BS_77:
  s_cmp_lt_i32 s14, 0
  s_cbranch_scc1 BZ_82
BZ_83:
  buffer_load_dword v9, v10, s[4:7], s46 offen sc1
  s_add_u32 s101, s101, 1
  s_cmp_gt_u32 s101, 262144
  s_cbranch_scc1 L_abort
  s_waitcnt vmcnt(0)
  v_cmp_ne_u32 vcc, -1, v9
  s_cbranch_vccnz BZ_83
BZ_82:
  s_cmp_eq_i32 s14, -3
  s_cbranch_scc1 BB_78
  v_readfirstlane_b32 s97, v4
  s_cmp_lg_u32 s97, 0
  s_cbranch_scc1 BB_78
  s_mov_b32 exec_lo, 0x1
  s_mov_b32 exec_hi, 0x0
F_84:
  buffer_load_dword v13, v2, s[4:7], s44 offen sc1
  s_waitcnt vmcnt(0)
  v_cmp_eq_u32 vcc, 0, v13
  s_cbranch_vccz FE_85
  s_add_u32 s101, s101, 1
  s_cmp_gt_u32 s101, 262144
  s_cbranch_scc1 L_abort
  s_sleep 8
  s_branch F_84
FE_85:
  s_mov_b64 exec, -1
  s_branch BB_78
B_slow:
  s_mov_b32 s39, -1
Bs_top:
  s_cmp_eq_u32 s95, 1
  s_cbranch_scc1 Bs_w1
  s_cmp_eq_u32 s95, 2
  s_cbranch_scc1 Bs_w2
  s_cmp_eq_u32 s95, 3
  s_cbranch_scc1 Bs_w3
Bs_w0:
  v_mov_b64 v[72:73], 0
  v_mov_b64 v[74:75], 0
  v_mov_b64 v[76:77], 0
  v_mov_b64 v[78:79], 0
  s_and_b32 s55, s39, 3
  s_lshl_b32 s31, s55, 14
  s_add_u32 s31, s31, s13
  s_add_u32 s15, s31, 8192
  s_add_u32 s31, s31, 0
  s_add_u32 s32, s15, 4096
  s_lshl_b32 s54, s55, 14
  s_add_u32 s54, s54, s13
  s_mov_b32 m0, 98304
  s_waitcnt lgkmcnt(0)
  buffer_load_dwordx4 v[16:19], v2, s[4:7], s15 offen offset:0 sc1
  buffer_load_dwordx4 v[20:23], v2, s[4:7], s32 offen offset:0 sc1
  s_sleep 2
P_86:
  buffer_load_dwordx4 v[16:19], v2, s[4:7], s15 offen offset:0 sc1
  buffer_load_dwordx4 v[20:23], v2, s[4:7], s32 offen offset:0 sc1
  s_add_u32 s101, s101, 1
  s_cmp_gt_u32 s101, 262144
  s_cbranch_scc1 L_abort
  s_waitcnt vmcnt(3)
  v_max3_u32 v13, v16, v17, v18
  v_max_u32 v13, v13, v19
  s_waitcnt vmcnt(2)
  v_max3_u32 v13, v13, v20, v21
  v_max3_u32 v13, v13, v22, v23
  v_cmp_eq_u32 vcc, -1, v13
  s_cbranch_vccnz P_86
  ds_write_b128 v8, v[16:19] offset:8192
  v_smfmac_f32_16x16x64_bf16 v[72:75], v[16:19], v[224:231], v3
  ds_write_b128 v8, v[20:23] offset:12288
  v_smfmac_f32_16x16x64_bf16 v[76:79], v[16:19], v[232:239], v3
  buffer_load_dwordx4 v2, s[4:7], s31 offen offset:0 sc1 lds
  v_smfmac_f32_16x16x64_bf16 v[72:75], v[20:23], a[32:39], v3
  buffer_load_dwordx4 v2, s[4:7], s31 offen offset:1024 sc1 lds
  s_waitcnt lgkmcnt(0)
  s_barrier
  ds_read_b128 v[32:35], v8 offset:9216
  ds_read_b128 v[36:39], v8 offset:10240
  v_smfmac_f32_16x16x64_bf16 v[76:79], v[20:23], a[40:47], v3
  ds_read_b128 v[40:43], v8 offset:11264
  s_waitcnt lgkmcnt(2)
  v_smfmac_f32_16x16x64_bf16 v[72:75], v[32:35], v[240:247], v3
  ds_read_b128 v[44:47], v8 offset:13312
  v_smfmac_f32_16x16x64_bf16 v[76:79], v[32:35], v[248:255], v3
  ds_read_b128 v[32:35], v8 offset:14336
  s_waitcnt lgkmcnt(3)
  v_smfmac_f32_16x16x64_bf16 v[72:75], v[36:39], a[0:7], v3
  v_smfmac_f32_16x16x64_bf16 v[76:79], v[36:39], a[8:15], v3
  ds_read_b128 v[36:39], v8 offset:15360
  s_waitcnt lgkmcnt(3)
  v_smfmac_f32_16x16x64_bf16 v[72:75], v[40:43], a[16:23], v3
  v_smfmac_f32_16x16x64_bf16 v[76:79], v[40:43], a[24:31], v3
  s_waitcnt lgkmcnt(2)
  v_smfmac_f32_16x16x64_bf16 v[72:75], v[44:47], a[48:55], v3
  v_smfmac_f32_16x16x64_bf16 v[76:79], v[44:47], a[56:63], v3
  s_waitcnt vmcnt(0)
  ds_read_b128 v[24:27], v8 offset:0
  ds_read_b128 v[28:31], v8 offset:1024
  s_waitcnt lgkmcnt(3)
  v_smfmac_f32_16x16x64_bf16 v[72:75], v[32:35], a[64:71], v3
  v_smfmac_f32_16x16x64_bf16 v[76:79], v[32:35], a[72:79], v3
  s_waitcnt lgkmcnt(2)
  v_smfmac_f32_16x16x64_bf16 v[72:75], v[36:39], a[80:87], v3
  v_smfmac_f32_16x16x64_bf16 v[76:79], v[36:39], a[88:95], v3
  s_waitcnt lgkmcnt(0)
  v_max3_u32 v13, v24, v25, v26
  v_max3_u32 v14, v27, v28, v29
  v_max3_u32 v14, v14, v30, v31
  v_max_u32 v13, v13, v14
  v_cmp_eq_u32 vcc, -1, v13
  s_cbranch_vccz F2O_87
F2R_88:
  buffer_load_dwordx4 v2, s[4:7], s31 offen offset:0 sc1 lds
  buffer_load_dwordx4 v2, s[4:7], s31 offen offset:1024 sc1 lds
  s_add_u32 s101, s101, 1
  s_cmp_gt_u32 s101, 262144
  s_cbranch_scc1 L_abort
  s_waitcnt vmcnt(0)
  ds_read_b128 v[24:27], v8 offset:0
  ds_read_b128 v[28:31], v8 offset:1024
  s_waitcnt lgkmcnt(0)
  v_max3_u32 v13, v24, v25, v26
  v_max3_u32 v14, v27, v28, v29
  v_max3_u32 v14, v14, v30, v31
  v_max_u32 v13, v13, v14
  v_cmp_eq_u32 vcc, -1, v13
  s_cbranch_vccnz F2R_88
F2O_87:
  s_barrier
  ds_read_b128 v[40:43], v8 offset:2048
  ds_read_b128 v[44:47], v8 offset:3072
  v_smfmac_f32_16x16x64_bf16 v[72:75], v[24:27], v[96:103], v3
  ds_read_b128 v[16:19], v8 offset:4096
  v_smfmac_f32_16x16x64_bf16 v[76:79], v[24:27], v[104:111], v3
  ds_read_b128 v[20:23], v8 offset:5120
  v_smfmac_f32_16x16x64_bf16 v[72:75], v[28:31], v[112:119], v3
  ds_read_b128 v[32:35], v8 offset:6144
  v_smfmac_f32_16x16x64_bf16 v[76:79], v[28:31], v[120:127], v3
  ds_read_b128 v[36:39], v8 offset:7168
  s_waitcnt lgkmcnt(5)
  v_smfmac_f32_16x16x64_bf16 v[72:75], v[40:43], v[128:135], v3
  v_smfmac_f32_16x16x64_bf16 v[76:79], v[40:43], v[136:143], v3
  s_waitcnt lgkmcnt(4)
  v_smfmac_f32_16x16x64_bf16 v[72:75], v[44:47], v[144:151], v3
  v_smfmac_f32_16x16x64_bf16 v[76:79], v[44:47], v[152:159], v3
  s_waitcnt lgkmcnt(3)
  v_smfmac_f32_16x16x64_bf16 v[72:75], v[16:19], v[160:167], v3
  v_smfmac_f32_16x16x64_bf16 v[76:79], v[16:19], v[168:175], v3
  s_waitcnt lgkmcnt(2)
  v_smfmac_f32_16x16x64_bf16 v[72:75], v[20:23], v[176:183], v3
  v_smfmac_f32_16x16x64_bf16 v[76:79], v[20:23], v[184:191], v3
  s_waitcnt lgkmcnt(1)
  v_smfmac_f32_16x16x64_bf16 v[72:75], v[32:35], v[192:199], v3
  v_smfmac_f32_16x16x64_bf16 v[76:79], v[32:35], v[200:207], v3
  s_waitcnt lgkmcnt(0)
  v_smfmac_f32_16x16x64_bf16 v[72:75], v[36:39], v[208:215], v3
  v_smfmac_f32_16x16x64_bf16 v[76:79], v[36:39], v[216:223], v3
  s_branch Bs_pub
Bs_w1:
  v_mov_b64 v[72:73], 0
  v_mov_b64 v[74:75], 0
  v_mov_b64 v[76:77], 0
  v_mov_b64 v[78:79], 0
  s_and_b32 s55, s39, 3
  s_lshl_b32 s31, s55, 14
  s_add_u32 s31, s31, s13
  s_add_u32 s15, s31, 9216
  s_add_u32 s31, s31, 2048
  s_add_u32 s32, s15, 4096
  s_lshl_b32 s54, s55, 14
  s_add_u32 s54, s54, s13
  s_mov_b32 m0, 100352
  s_waitcnt lgkmcnt(0)
  buffer_load_dwordx4 v[16:19], v2, s[4:7], s15 offen offset:0 sc1
  buffer_load_dwordx4 v[20:23], v2, s[4:7], s32 offen offset:0 sc1
  s_sleep 2
P_89:
  buffer_load_dwordx4 v[16:19], v2, s[4:7], s15 offen offset:0 sc1
  buffer_load_dwordx4 v[20:23], v2, s[4:7], s32 offen offset:0 sc1
  s_add_u32 s101, s101, 1
  s_cmp_gt_u32 s101, 262144
  s_cbranch_scc1 L_abort
  s_waitcnt vmcnt(3)
  v_max3_u32 v13, v16, v17, v18
  v_max_u32 v13, v13, v19
  s_waitcnt vmcnt(2)
  v_max3_u32 v13, v13, v20, v21
  v_max3_u32 v13, v13, v22, v23
  v_cmp_eq_u32 vcc, -1, v13
  s_cbranch_vccnz P_89
  ds_write_b128 v8, v[16:19] offset:9216
  v_smfmac_f32_16x16x64_bf16 v[72:75], v[16:19], v[240:247], v3
  ds_write_b128 v8, v[20:23] offset:13312
  v_smfmac_f32_16x16x64_bf16 v[76:79], v[16:19], v[248:255], v3
  buffer_load_dwordx4 v2, s[4:7], s31 offen offset:0 sc1 lds
  v_smfmac_f32_16x16x64_bf16 v[72:75], v[20:23], a[48:55], v3
  buffer_load_dwordx4 v2, s[4:7], s31 offen offset:1024 sc1 lds
  s_waitcnt lgkmcnt(0)
  s_barrier
  ds_read_b128 v[32:35], v8 offset:8192
  ds_read_b128 v[36:39], v8 offset:10240
  v_smfmac_f32_16x16x64_bf16 v[76:79], v[20:23], a[56:63], v3
  ds_read_b128 v[40:43], v8 offset:11264
  s_waitcnt lgkmcnt(2)
  v_smfmac_f32_16x16x64_bf16 v[72:75], v[32:35], v[224:231], v3
  ds_read_b128 v[44:47], v8 offset:12288
  v_smfmac_f32_16x16x64_bf16 v[76:79], v[32:35], v[232:239], v3
  ds_read_b128 v[32:35], v8 offset:14336
  s_waitcnt lgkmcnt(3)
  v_smfmac_f32_16x16x64_bf16 v[72:75], v[36:39], a[0:7], v3
  v_smfmac_f32_16x16x64_bf16 v[76:79], v[36:39], a[8:15], v3
  ds_read_b128 v[36:39], v8 offset:15360
  s_waitcnt lgkmcnt(3)
  v_smfmac_f32_16x16x64_bf16 v[72:75], v[40:43], a[16:23], v3
  v_smfmac_f32_16x16x64_bf16 v[76:79], v[40:43], a[24:31], v3
  s_waitcnt lgkmcnt(2)
  v_smfmac_f32_16x16x64_bf16 v[72:75], v[44:47], a[32:39], v3
  v_smfmac_f32_16x16x64_bf16 v[76:79], v[44:47], a[40:47], v3
  s_waitcnt vmcnt(0)
  ds_read_b128 v[24:27], v8 offset:2048
  ds_read_b128 v[28:31], v8 offset:3072
  s_waitcnt lgkmcnt(3)
  v_smfmac_f32_16x16x64_bf16 v[72:75], v[32:35], a[64:71], v3
  v_smfmac_f32_16x16x64_bf16 v[76:79], v[32:35], a[72:79], v3
  s_waitcnt lgkmcnt(2)
  v_smfmac_f32_16x16x64_bf16 v[72:75], v[36:39], a[80:87], v3
  v_smfmac_f32_16x16x64_bf16 v[76:79], v[36:39], a[88:95], v3
  s_waitcnt lgkmcnt(0)
  v_max3_u32 v13, v24, v25, v26
  v_max3_u32 v14, v27, v28, v29
  v_max3_u32 v14, v14, v30, v31
  v_max_u32 v13, v13, v14
  v_cmp_eq_u32 vcc, -1, v13
  s_cbranch_vccz F2O_90
F2R_91:
  buffer_load_dwordx4 v2, s[4:7], s31 offen offset:0 sc1 lds
  buffer_load_dwordx4 v2, s[4:7], s31 offen offset:1024 sc1 lds
  s_add_u32 s101, s101, 1
  s_cmp_gt_u32 s101, 262144
  s_cbranch_scc1 L_abort
  s_waitcnt vmcnt(0)
  ds_read_b128 v[24:27], v8 offset:2048
  ds_read_b128 v[28:31], v8 offset:3072
  s_waitcnt lgkmcnt(0)
  v_max3_u32 v13, v24, v25, v26
  v_max3_u32 v14, v27, v28, v29
  v_max3_u32 v14, v14, v30, v31
  v_max_u32 v13, v13, v14
  v_cmp_eq_u32 vcc, -1, v13
  s_cbranch_vccnz F2R_91
F2O_90:
  s_barrier
  ds_read_b128 v[40:43], v8 offset:0
  ds_read_b128 v[44:47], v8 offset:1024
  v_smfmac_f32_16x16x64_bf16 v[72:75], v[24:27], v[128:135], v3
  ds_read_b128 v[16:19], v8 offset:4096
  v_smfmac_f32_16x16x64_bf16 v[76:79], v[24:27], v[136:143], v3
  ds_read_b128 v[20:23], v8 offset:5120
  v_smfmac_f32_16x16x64_bf16 v[72:75], v[28:31], v[144:151], v3
  ds_read_b128 v[32:35], v8 offset:6144
  v_smfmac_f32_16x16x64_bf16 v[76:79], v[28:31], v[152:159], v3
  ds_read_b128 v[36:39], v8 offset:7168
  s_waitcnt lgkmcnt(5)
  v_smfmac_f32_16x16x64_bf16 v[72:75], v[40:43], v[96:103], v3
  v_smfmac_f32_16x16x64_bf16 v[76:79], v[40:43], v[104:111], v3
  s_waitcnt lgkmcnt(4)
  v_smfmac_f32_16x16x64_bf16 v[72:75], v[44:47], v[112:119], v3
  v_smfmac_f32_16x16x64_bf16 v[76:79], v[44:47], v[120:127], v3
  s_waitcnt lgkmcnt(3)
  v_smfmac_f32_16x16x64_bf16 v[72:75], v[16:19], v[160:167], v3
  v_smfmac_f32_16x16x64_bf16 v[76:79], v[16:19], v[168:175], v3
  s_waitcnt lgkmcnt(2)
  v_smfmac_f32_16x16x64_bf16 v[72:75], v[20:23], v[176:183], v3
  v_smfmac_f32_16x16x64_bf16 v[76:79], v[20:23], v[184:191], v3
  s_waitcnt lgkmcnt(1)
  v_smfmac_f32_16x16x64_bf16 v[72:75], v[32:35], v[192:199], v3
  v_smfmac_f32_16x16x64_bf16 v[76:79], v[32:35], v[200:207], v3
  s_waitcnt lgkmcnt(0)
  v_smfmac_f32_16x16x64_bf16 v[72:75], v[36:39], v[208:215], v3
  v_smfmac_f32_16x16x64_bf16 v[76:79], v[36:39], v[216:223], v3
  s_branch Bs_pub
Bs_w2:
  v_mov_b64 v[72:73], 0
  v_mov_b64 v[74:75], 0
  v_mov_b64 v[76:77], 0
  v_mov_b64 v[78:79], 0
  s_and_b32 s55, s39, 3
  s_lshl_b32 s31, s55, 14
  s_add_u32 s31, s31, s13
  s_add_u32 s15, s31, 10240
  s_add_u32 s31, s31, 4096
  s_add_u32 s32, s15, 4096
  s_lshl_b32 s54, s55, 14
  s_add_u32 s54, s54, s13
  s_mov_b32 m0, 102400
  s_waitcnt lgkmcnt(0)
  buffer_load_dwordx4 v[16:19], v2, s[4:7], s15 offen offset:0 sc1
  buffer_load_dwordx4 v[20:23], v2, s[4:7], s32 offen offset:0 sc1
  s_sleep 2
P_92:
  buffer_load_dwordx4 v[16:19], v2, s[4:7], s15 offen offset:0 sc1
  buffer_load_dwordx4 v[20:23], v2, s[4:7], s32 offen offset:0 sc1
  s_add_u32 s101, s101, 1
  s_cmp_gt_u32 s101, 262144
  s_cbranch_scc1 L_abort
  s_waitcnt vmcnt(3)
  v_max3_u32 v13, v16, v17, v18
  v_max_u32 v13, v13, v19
  s_waitcnt vmcnt(2)
  v_max3_u32 v13, v13, v20, v21
  v_max3_u32 v13, v13, v22, v23
  v_cmp_eq_u32 vcc, -1, v13
  s_cbranch_vccnz P_92
  ds_write_b128 v8, v[16:19] offset:10240
  v_smfmac_f32_16x16x64_bf16 v[72:75], v[16:19], a[0:7], v3
  ds_write_b128 v8, v[20:23] offset:14336
  v_smfmac_f32_16x16x64_bf16 v[76:79], v[16:19], a[8:15], v3
  buffer_load_dwordx4 v2, s[4:7], s31 offen offset:0 sc1 lds
  v_smfmac_f32_16x16x64_bf16 v[72:75], v[20:23], a[64:71], v3
  buffer_load_dwordx4 v2, s[4:7], s31 offen offset:1024 sc1 lds
  s_waitcnt lgkmcnt(0)
  s_barrier
  ds_read_b128 v[32:35], v8 offset:8192
  ds_read_b128 v[36:39], v8 offset:9216
  v_smfmac_f32_16x16x64_bf16 v[76:79], v[20:23], a[72:79], v3
  ds_read_b128 v[40:43], v8 offset:11264
  s_waitcnt lgkmcnt(2)
  v_smfmac_f32_16x16x64_bf16 v[72:75], v[32:35], v[224:231], v3
  ds_read_b128 v[44:47], v8 offset:12288
  v_smfmac_f32_16x16x64_bf16 v[76:79], v[32:35], v[232:239], v3
  ds_read_b128 v[32:35], v8 offset:13312
  s_waitcnt lgkmcnt(3)
  v_smfmac_f32_16x16x64_bf16 v[72:75], v[36:39], v[240:247], v3
  v_smfmac_f32_16x16x64_bf16 v[76:79], v[36:39], v[248:255], v3
  ds_read_b128 v[36:39], v8 offset:15360
  s_waitcnt lgkmcnt(3)
  v_smfmac_f32_16x16x64_bf16 v[72:75], v[40:43], a[16:23], v3
  v_smfmac_f32_16x16x64_bf16 v[76:79], v[40:43], a[24:31], v3
  s_waitcnt lgkmcnt(2)
  v_smfmac_f32_16x16x64_bf16 v[72:75], v[44:47], a[32:39], v3
  v_smfmac_f32_16x16x64_bf16 v[76:79], v[44:47], a[40:47], v3
  s_waitcnt vmcnt(0)
  ds_read_b128 v[24:27], v8 offset:4096
  ds_read_b128 v[28:31], v8 offset:5120
  s_waitcnt lgkmcnt(3)
  v_smfmac_f32_16x16x64_bf16 v[72:75], v[32:35], a[48:55], v3
  v_smfmac_f32_16x16x64_bf16 v[76:79], v[32:35], a[56:63], v3
  s_waitcnt lgkmcnt(2)
  v_smfmac_f32_16x16x64_bf16 v[72:75], v[36:39], a[80:87], v3
  v_smfmac_f32_16x16x64_bf16 v[76:79], v[36:39], a[88:95], v3
  s_waitcnt lgkmcnt(0)
  v_max3_u32 v13, v24, v25, v26
  v_max3_u32 v14, v27, v28, v29
  v_max3_u32 v14, v14, v30, v31
  v_max_u32 v13, v13, v14
  v_cmp_eq_u32 vcc, -1, v13
  s_cbranch_vccz F2O_93
F2R_94:
  buffer_load_dwordx4 v2, s[4:7], s31 offen offset:0 sc1 lds
  buffer_load_dwordx4 v2, s[4:7], s31 offen offset:1024 sc1 lds
  s_add_u32 s101, s101, 1
  s_cmp_gt_u32 s101, 262144
  s_cbranch_scc1 L_abort
  s_waitcnt vmcnt(0)
  ds_read_b128 v[24:27], v8 offset:4096
  ds_read_b128 v[28:31], v8 offset:5120
  s_waitcnt lgkmcnt(0)
  v_max3_u32 v13, v24, v25, v26
  v_max3_u32 v14, v27, v28, v29
  v_max3_u32 v14, v14, v30, v31
  v_max_u32 v13, v13, v14
  v_cmp_eq_u32 vcc, -1, v13
  s_cbranch_vccnz F2R_94
F2O_93:
  s_barrier
  ds_read_b128 v[40:43], v8 offset:0
  ds_read_b128 v[44:47], v8 offset:1024
  v_smfmac_f32_16x16x64_bf16 v[72:75], v[24:27], v[160:167], v3
  ds_read_b128 v[16:19], v8 offset:2048
  v_smfmac_f32_16x16x64_bf16 v[76:79], v[24:27], v[168:175], v3
  ds_read_b128 v[20:23], v8 offset:3072
  v_smfmac_f32_16x16x64_bf16 v[72:75], v[28:31], v[176:183], v3
  ds_read_b128 v[32:35], v8 offset:6144
  v_smfmac_f32_16x16x64_bf16 v[76:79], v[28:31], v[184:191], v3
  ds_read_b128 v[36:39], v8 offset:7168
  s_waitcnt lgkmcnt(5)
  v_smfmac_f32_16x16x64_bf16 v[72:75], v[40:43], v[96:103], v3
  v_smfmac_f32_16x16x64_bf16 v[76:79], v[40:43], v[104:111], v3
  s_waitcnt lgkmcnt(4)
  v_smfmac_f32_16x16x64_bf16 v[72:75], v[44:47], v[112:119], v3
  v_smfmac_f32_16x16x64_bf16 v[76:79], v[44:47], v[120:127], v3
  s_waitcnt lgkmcnt(3)
  v_smfmac_f32_16x16x64_bf16 v[72:75], v[16:19], v[128:135], v3
  v_smfmac_f32_16x16x64_bf16 v[76:79], v[16:19], v[136:143], v3
  s_waitcnt lgkmcnt(2)
  v_smfmac_f32_16x16x64_bf16 v[72:75], v[20:23], v[144:151], v3
  v_smfmac_f32_16x16x64_bf16 v[76:79], v[20:23], v[152:159], v3
  s_waitcnt lgkmcnt(1)
  v_smfmac_f32_16x16x64_bf16 v[72:75], v[32:35], v[192:199], v3
  v_smfmac_f32_16x16x64_bf16 v[76:79], v[32:35], v[200:207], v3
  s_waitcnt lgkmcnt(0)
  v_smfmac_f32_16x16x64_bf16 v[72:75], v[36:39], v[208:215], v3
  v_smfmac_f32_16x16x64_bf16 v[76:79], v[36:39], v[216:223], v3
  s_branch Bs_pub
Bs_w3:
  v_mov_b64 v[72:73], 0
  v_mov_b64 v[74:75], 0
  v_mov_b64 v[76:77], 0
  v_mov_b64 v[78:79], 0
  s_and_b32 s55, s39, 3
  s_lshl_b32 s31, s55, 14
  s_add_u32 s31, s31, s13
  s_add_u32 s15, s31, 11264
  s_add_u32 s31, s31, 6144
  s_add_u32 s32, s15, 4096
  s_lshl_b32 s54, s55, 14
  s_add_u32 s54, s54, s13
  s_mov_b32 m0, 104448
  s_waitcnt lgkmcnt(0)
  buffer_load_dwordx4 v[16:19], v2, s[4:7], s15 offen offset:0 sc1
  buffer_load_dwordx4 v[20:23], v2, s[4:7], s32 offen offset:0 sc1
  s_sleep 2
P_95:
  buffer_load_dwordx4 v[16:19], v2, s[4:7], s15 offen offset:0 sc1
  buffer_load_dwordx4 v[20:23], v2, s[4:7], s32 offen offset:0 sc1
  s_add_u32 s101, s101, 1
  s_cmp_gt_u32 s101, 262144
  s_cbranch_scc1 L_abort
  s_waitcnt vmcnt(3)
  v_max3_u32 v13, v16, v17, v18
  v_max_u32 v13, v13, v19
  s_waitcnt vmcnt(2)
  v_max3_u32 v13, v13, v20, v21
  v_max3_u32 v13, v13, v22, v23
  v_cmp_eq_u32 vcc, -1, v13
  s_cbranch_vccnz P_95
  ds_write_b128 v8, v[16:19] offset:11264
  v_smfmac_f32_16x16x64_bf16 v[72:75], v[16:19], a[16:23], v3
  ds_write_b128 v8, v[20:23] offset:15360
  v_smfmac_f32_16x16x64_bf16 v[76:79], v[16:19], a[24:31], v3
  buffer_load_dwordx4 v2, s[4:7], s31 offen offset:0 sc1 lds
  v_smfmac_f32_16x16x64_bf16 v[72:75], v[20:23], a[80:87], v3
  buffer_load_dwordx4 v2, s[4:7], s31 offen offset:1024 sc1 lds
  s_waitcnt lgkmcnt(0)
  s_barrier
  ds_read_b128 v[32:35], v8 offset:8192
  ds_read_b128 v[36:39], v8 offset:9216
  v_smfmac_f32_16x16x64_bf16 v[76:79], v[20:23], a[88:95], v3
  ds_read_b128 v[40:43], v8 offset:10240
  s_waitcnt lgkmcnt(2)
  v_smfmac_f32_16x16x64_bf16 v[72:75], v[32:35], v[224:231], v3
  ds_read_b128 v[44:47], v8 offset:12288
  v_smfmac_f32_16x16x64_bf16 v[76:79], v[32:35], v[232:239], v3
  ds_read_b128 v[32:35], v8 offset:13312
  s_waitcnt lgkmcnt(3)
  v_smfmac_f32_16x16x64_bf16 v[72:75], v[36:39], v[240:247], v3
  v_smfmac_f32_16x16x64_bf16 v[76:79], v[36:39], v[248:255], v3
  ds_read_b128 v[36:39], v8 offset:14336
  s_waitcnt lgkmcnt(3)
  v_smfmac_f32_16x16x64_bf16 v[72:75], v[40:43], a[0:7], v3
  v_smfmac_f32_16x16x64_bf16 v[76:79], v[40:43], a[8:15], v3
  s_waitcnt lgkmcnt(2)
  v_smfmac_f32_16x16x64_bf16 v[72:75], v[44:47], a[32:39], v3
  v_smfmac_f32_16x16x64_bf16 v[76:79], v[44:47], a[40:47], v3
  s_waitcnt vmcnt(0)
  ds_read_b128 v[24:27], v8 offset:6144
  ds_read_b128 v[28:31], v8 offset:7168
  s_waitcnt lgkmcnt(3)
  v_smfmac_f32_16x16x64_bf16 v[72:75], v[32:35], a[48:55], v3
  v_smfmac_f32_16x16x64_bf16 v[76:79], v[32:35], a[56:63], v3
  s_waitcnt lgkmcnt(2)
  v_smfmac_f32_16x16x64_bf16 v[72:75], v[36:39], a[64:71], v3
  v_smfmac_f32_16x16x64_bf16 v[76:79], v[36:39], a[72:79], v3
  s_waitcnt lgkmcnt(0)
  v_max3_u32 v13, v24, v25, v26
  v_max3_u32 v14, v27, v28, v29
  v_max3_u32 v14, v14, v30, v31
  v_max_u32 v13, v13, v14
  v_cmp_eq_u32 vcc, -1, v13
  s_cbranch_vccz F2O_96
F2R_97:
  buffer_load_dwordx4 v2, s[4:7], s31 offen offset:0 sc1 lds
  buffer_load_dwordx4 v2, s[4:7], s31 offen offset:1024 sc1 lds
  s_add_u32 s101, s101, 1
  s_cmp_gt_u32 s101, 262144
  s_cbranch_scc1 L_abort
  s_waitcnt vmcnt(0)
  ds_read_b128 v[24:27], v8 offset:6144
  ds_read_b128 v[28:31], v8 offset:7168
  s_waitcnt lgkmcnt(0)
  v_max3_u32 v13, v24, v25, v26
  v_max3_u32 v14, v27, v28, v29
  v_max3_u32 v14, v14, v30, v31
  v_max_u32 v13, v13, v14
  v_cmp_eq_u32 vcc, -1, v13
  s_cbranch_vccnz F2R_97
F2O_96:
  s_barrier
  ds_read_b128 v[40:43], v8 offset:0
  ds_read_b128 v[44:47], v8 offset:1024
  v_smfmac_f32_16x16x64_bf16 v[72:75], v[24:27], v[192:199], v3
  ds_read_b128 v[16:19], v8 offset:2048
  v_smfmac_f32_16x16x64_bf16 v[76:79], v[24:27], v[200:207], v3
  ds_read_b128 v[20:23], v8 offset:3072
  v_smfmac_f32_16x16x64_bf16 v[72:75], v[28:31], v[208:215], v3
  ds_read_b128 v[32:35], v8 offset:4096
  v_smfmac_f32_16x16x64_bf16 v[76:79], v[28:31], v[216:223], v3
  ds_read_b128 v[36:39], v8 offset:5120
  s_waitcnt lgkmcnt(5)
  v_smfmac_f32_16x16x64_bf16 v[72:75], v[40:43], v[96:103], v3
  v_smfmac_f32_16x16x64_bf16 v[76:79], v[40:43], v[104:111], v3
  s_waitcnt lgkmcnt(4)
  v_smfmac_f32_16x16x64_bf16 v[72:75], v[44:47], v[112:119], v3
  v_smfmac_f32_16x16x64_bf16 v[76:79], v[44:47], v[120:127], v3
  s_waitcnt lgkmcnt(3)
  v_smfmac_f32_16x16x64_bf16 v[72:75], v[16:19], v[128:135], v3
  v_smfmac_f32_16x16x64_bf16 v[76:79], v[16:19], v[136:143], v3
  s_waitcnt lgkmcnt(2)
  v_smfmac_f32_16x16x64_bf16 v[72:75], v[20:23], v[144:151], v3
  v_smfmac_f32_16x16x64_bf16 v[76:79], v[20:23], v[152:159], v3
  s_waitcnt lgkmcnt(1)
  v_smfmac_f32_16x16x64_bf16 v[72:75], v[32:35], v[160:167], v3
  v_smfmac_f32_16x16x64_bf16 v[76:79], v[32:35], v[168:175], v3
  s_waitcnt lgkmcnt(0)
  v_smfmac_f32_16x16x64_bf16 v[72:75], v[36:39], v[176:183], v3
  v_smfmac_f32_16x16x64_bf16 v[76:79], v[36:39], v[184:191], v3
  s_nop 0
Bs_pub:
  s_and_b32 s50, s14, 1
  s_lshl_b32 s50, s50, 14
  v_add_u32 v15, s50, v8
  s_nop 2
  v_pk_add_f32 v[72:73], v[72:73], v[74:75]
  v_pk_add_f32 v[76:77], v[76:77], v[78:79]
  v_cvt_pk_bf16_f32 v72, v72, v73
  v_cvt_pk_bf16_f32 v73, v76, v77
  buffer_store_dwordx2 v[72:73], v11, s[4:7], s54 offen sc1
  s_xor_b32 s54, s54, 32768
  v_mov_b64 v[94:95], -1
  buffer_store_dwordx2 v[94:95], v11, s[4:7], s54 offen sc1
  s_cmp_ge_i32 s39, 0
  s_cbranch_scc1 B0_98
  buffer_store_dwordx2 v[72:73], v11, s[4:7], s13 offen sc1
B0_98:
  s_mov_b32 s100, 4
SL_99:
  s_sleep 1
  s_sub_u32 s100, s100, 1
  s_cmp_lg_u32 s100, 0
  s_cbranch_scc1 SL_99
  s_cmp_ge_i32 s14, 62
  s_cbranch_scc1 Bs_done
Bs_zx:
  ds_read_b128 v[16:19], v15 offset:16384
  ds_read_b128 v[32:35], v15 offset:20480
  ds_read_b128 v[20:23], v15 offset:17408
  ds_read_b128 v[36:39], v15 offset:21504
  ds_read_b128 v[24:27], v15 offset:18432
  ds_read_b128 v[40:43], v15 offset:22528
  ds_read_b128 v[28:31], v15 offset:19456
  ds_read_b128 v[44:47], v15 offset:23552
  s_add_u32 s46, s14, 3
  s_and_b32 s46, s46, 3
  s_lshl_b32 s46, s46, 14
  s_add_u32 s46, s46, s13
  s_waitcnt lgkmcnt(6)
  v_mfma_f32_16x16x32_bf16 v[72:75], v[16:19], a[96:99], 0
  ds_read_b128 v[48:51], v6 offset:0
  ds_read_b128 v[52:55], v6 offset:1024
  v_mfma_f32_16x16x32_bf16 v[76:79], v[32:35], a[96:99], 0
  ds_read_b128 v[56:59], v6 offset:4096
  ds_read_b128 v[60:63], v6 offset:5120
  buffer_load_dword v9, v10, s[4:7], s46 offen sc1
  s_waitcnt lgkmcnt(8)
  v_mfma_f32_16x16x32_bf16 v[72:75], v[20:23], a[100:103], v[72:75]
  ds_read_b128 v[64:67], v6 offset:2048
  ds_read_b128 v[68:71], v6 offset:3072
  v_mfma_f32_16x16x32_bf16 v[76:79], v[36:39], a[100:103], v[76:79]
  s_add_u32 s43, s14, 3
  s_min_i32 s43, s43, 63
  s_lshr_b32 s44, s43, 2
  s_waitcnt lgkmcnt(8)
  v_mfma_f32_16x16x32_bf16 v[72:75], v[24:27], a[112:115], v[72:75]
  s_lshl_b32 s44, s44, 11
  s_add_u32 s44, s44, s41
  s_lshl_b32 s43, s43, 18
  v_mfma_f32_16x16x32_bf16 v[76:79], v[40:43], a[112:115], v[76:79]
  s_add_u32 s43, s43, s40
  s_add_u32 s45, s14, 4
  s_min_i32 s45, s45, 63
  s_waitcnt lgkmcnt(6)
  v_mfma_f32_16x16x32_bf16 v[72:75], v[28:31], a[116:119], v[72:75]
  s_lshr_b32 s45, s45, 2
  s_lshl_b32 s45, s45, 11
  s_add_u32 s45, s45, s41
  v_mfma_f32_16x16x32_bf16 v[76:79], v[44:47], a[116:119], v[76:79]
  s_and_b32 s47, s14, 1
  s_lshl_b32 s97, s47, 14
  s_xor_b32 s97, s97, 16384
  v_mfma_f32_16x16x32_bf16 v[80:83], v[16:19], a[104:107], 0
  s_add_u32 m0, s97, s42
  s_lshl_b32 s47, s47, 19
  s_add_u32 s47, s47, s13
  v_mfma_f32_16x16x32_bf16 v[84:87], v[32:35], a[104:107], 0
  v_mfma_f32_16x16x32_bf16 v[80:83], v[20:23], a[108:111], v[80:83]
  v_mfma_f32_16x16x32_bf16 v[84:87], v[36:39], a[108:111], v[84:87]
  v_mfma_f32_16x16x32_bf16 v[80:83], v[24:27], a[120:123], v[80:83]
  v_mfma_f32_16x16x32_bf16 v[84:87], v[40:43], a[120:123], v[84:87]
  v_mfma_f32_16x16x32_bf16 v[80:83], v[28:31], a[124:127], v[80:83]
  v_mfma_f32_16x16x32_bf16 v[84:87], v[44:47], a[124:127], v[84:87]
  v_cvt_pk_bf16_f32 v72, v72, v73
  v_cvt_pk_bf16_f32 v73, v74, v75
  s_waitcnt vmcnt(0)
  v_cmp_ne_u32 vcc, -1, v9
  v_cmp_eq_u32 s[48:49], 0, v4
  s_or_b64 vcc, vcc, s[48:49]
  s_cbranch_scc1 BS_100
BB_101:
  s_waitcnt lgkmcnt(4)
  v_mfma_f32_16x16x32_bf16 v[88:91], v[16:19], v[48:51], 0
  v_cvt_pk_bf16_f32 v74, v76, v77
  v_cvt_pk_bf16_f32 v75, v78, v79
  v_mfma_f32_16x16x32_bf16 v[92:95], v[32:35], v[48:51], 0
  s_add_u32 s31, s47, 0
  buffer_store_dwordx4 v[72:75], v12, s[4:7], s31 offen sc1
  v_mfma_f32_16x16x32_bf16 v[88:91], v[20:23], v[52:55], v[88:91]
  v_mfma_f32_16x16x32_bf16 v[92:95], v[36:39], v[52:55], v[92:95]
  ds_read_b128 v[48:51], v6 offset:6144
  s_waitcnt lgkmcnt(3)
  v_mfma_f32_16x16x32_bf16 v[88:91], v[24:27], v[56:59], v[88:91]
  ds_read_b128 v[52:55], v6 offset:7168
  v_mfma_f32_16x16x32_bf16 v[92:95], v[40:43], v[56:59], v[92:95]
  buffer_load_dwordx4 v2, s[4:7], s43 offen offset:0 sc1 nt lds
  v_mfma_f32_16x16x32_bf16 v[88:91], v[28:31], v[60:63], v[88:91]
  buffer_load_dwordx4 v2, s[4:7], s43 offen offset:1024 sc1 nt lds
  v_mfma_f32_16x16x32_bf16 v[92:95], v[44:47], v[60:63], v[92:95]
  ds_read_b128 v[56:59], v6 offset:32768
  v_mfma_f32_16x16x32_bf16 v[72:75], v[16:19], a[128:131], 0
  ds_read_b128 v[60:63], v6 offset:33792
  v_mfma_f32_16x16x32_bf16 v[76:79], v[32:35], a[128:131], 0
  v_cvt_pk_bf16_f32 v80, v80, v81
  v_cvt_pk_bf16_f32 v81, v82, v83
  v_mfma_f32_16x16x32_bf16 v[72:75], v[20:23], a[132:135], v[72:75]
  v_cvt_pk_bf16_f32 v82, v84, v85
  v_cvt_pk_bf16_f32 v83, v86, v87
  v_mfma_f32_16x16x32_bf16 v[76:79], v[36:39], a[132:135], v[76:79]
  s_add_u32 s31, s47, 8192
  buffer_store_dwordx4 v[80:83], v12, s[4:7], s31 offen sc1
  v_mfma_f32_16x16x32_bf16 v[72:75], v[24:27], a[144:147], v[72:75]
  buffer_load_dword v4, v5, s[4:7], s45 offen sc1
  v_mfma_f32_16x16x32_bf16 v[76:79], v[40:43], a[144:147], v[76:79]
  v_mfma_f32_16x16x32_bf16 v[72:75], v[28:31], a[148:151], v[72:75]
  v_mfma_f32_16x16x32_bf16 v[76:79], v[44:47], a[148:151], v[76:79]
  v_cvt_pk_bf16_f32 v88, v88, v89
  v_cvt_pk_bf16_f32 v89, v90, v91
  s_waitcnt lgkmcnt(4)
  v_mfma_f32_16x16x32_bf16 v[80:83], v[16:19], v[64:67], 0
  v_cvt_pk_bf16_f32 v90, v92, v93
  v_cvt_pk_bf16_f32 v91, v94, v95
  v_mfma_f32_16x16x32_bf16 v[84:87], v[32:35], v[64:67], 0
  s_add_u32 s31, s47, 327680
  buffer_store_dwordx4 v[88:91], v12, s[4:7], s31 offen sc1
  v_mfma_f32_16x16x32_bf16 v[80:83], v[20:23], v[68:71], v[80:83]
  v_mfma_f32_16x16x32_bf16 v[84:87], v[36:39], v[68:71], v[84:87]
  ds_read_b128 v[64:67], v6 offset:36864
  s_waitcnt lgkmcnt(3)
  v_mfma_f32_16x16x32_bf16 v[80:83], v[24:27], v[48:51], v[80:83]
  ds_read_b128 v[68:71], v6 offset:37888
  v_mfma_f32_16x16x32_bf16 v[84:87], v[40:43], v[48:51], v[84:87]
  v_mfma_f32_16x16x32_bf16 v[80:83], v[28:31], v[52:55], v[80:83]
  v_mfma_f32_16x16x32_bf16 v[84:87], v[44:47], v[52:55], v[84:87]
  ds_read_b128 v[48:51], v6 offset:34816
  v_mfma_f32_16x16x32_bf16 v[88:91], v[16:19], a[136:139], 0
  ds_read_b128 v[52:55], v6 offset:35840
  v_mfma_f32_16x16x32_bf16 v[92:95], v[32:35], a[136:139], 0
  v_cvt_pk_bf16_f32 v72, v72, v73
  v_cvt_pk_bf16_f32 v73, v74, v75
  v_mfma_f32_16x16x32_bf16 v[88:91], v[20:23], a[140:143], v[88:91]
  v_cvt_pk_bf16_f32 v74, v76, v77
  v_cvt_pk_bf16_f32 v75, v78, v79
  v_mfma_f32_16x16x32_bf16 v[92:95], v[36:39], a[140:143], v[92:95]
  s_add_u32 s31, s47, 65536
  buffer_store_dwordx4 v[72:75], v12, s[4:7], s31 offen sc1
  v_mfma_f32_16x16x32_bf16 v[88:91], v[24:27], a[152:155], v[88:91]
  v_mfma_f32_16x16x32_bf16 v[92:95], v[40:43], a[152:155], v[92:95]
  v_mfma_f32_16x16x32_bf16 v[88:91], v[28:31], a[156:159], v[88:91]
  v_mfma_f32_16x16x32_bf16 v[92:95], v[44:47], a[156:159], v[92:95]
  v_cvt_pk_bf16_f32 v80, v80, v81
  v_cvt_pk_bf16_f32 v81, v82, v83
  s_waitcnt lgkmcnt(4)
  v_mfma_f32_16x16x32_bf16 v[72:75], v[16:19], v[56:59], 0
  v_cvt_pk_bf16_f32 v82, v84, v85
  v_cvt_pk_bf16_f32 v83, v86, v87
  v_mfma_f32_16x16x32_bf16 v[76:79], v[32:35], v[56:59], 0
  s_add_u32 s31, s47, 335872
  buffer_store_dwordx4 v[80:83], v12, s[4:7], s31 offen sc1
  v_mfma_f32_16x16x32_bf16 v[72:75], v[20:23], v[60:63], v[72:75]
  v_mfma_f32_16x16x32_bf16 v[76:79], v[36:39], v[60:63], v[76:79]
  ds_read_b128 v[56:59], v6 offset:38912
  s_waitcnt lgkmcnt(3)
  v_mfma_f32_16x16x32_bf16 v[72:75], v[24:27], v[64:67], v[72:75]
  ds_read_b128 v[60:63], v6 offset:39936
  v_mfma_f32_16x16x32_bf16 v[76:79], v[40:43], v[64:67], v[76:79]
  v_mfma_f32_16x16x32_bf16 v[72:75], v[28:31], v[68:71], v[72:75]
  v_mfma_f32_16x16x32_bf16 v[76:79], v[44:47], v[68:71], v[76:79]
  ds_read_b128 v[64:67], v7 offset:0
  v_mfma_f32_16x16x32_bf16 v[80:83], v[16:19], a[160:163], 0
  ds_read_b128 v[68:71], v7 offset:1024
  v_mfma_f32_16x16x32_bf16 v[84:87], v[32:35], a[160:163], 0
  v_cvt_pk_bf16_f32 v88, v88, v89
  v_cvt_pk_bf16_f32 v89, v90, v91
  v_mfma_f32_16x16x32_bf16 v[80:83], v[20:23], a[164:167], v[80:83]
  v_cvt_pk_bf16_f32 v90, v92, v93
  v_cvt_pk_bf16_f32 v91, v94, v95
  v_mfma_f32_16x16x32_bf16 v[84:87], v[36:39], a[164:167], v[84:87]
  s_add_u32 s31, s47, 73728
  buffer_store_dwordx4 v[88:91], v12, s[4:7], s31 offen sc1
  v_mfma_f32_16x16x32_bf16 v[80:83], v[24:27], a[176:179], v[80:83]
  v_mfma_f32_16x16x32_bf16 v[84:87], v[40:43], a[176:179], v[84:87]
  v_mfma_f32_16x16x32_bf16 v[80:83], v[28:31], a[180:183], v[80:83]
  v_mfma_f32_16x16x32_bf16 v[84:87], v[44:47], a[180:183], v[84:87]
  v_cvt_pk_bf16_f32 v72, v72, v73
  v_cvt_pk_bf16_f32 v73, v74, v75
  s_waitcnt lgkmcnt(4)
  v_mfma_f32_16x16x32_bf16 v[88:91], v[16:19], v[48:51], 0
  v_cvt_pk_bf16_f32 v74, v76, v77
  v_cvt_pk_bf16_f32 v75, v78, v79
  v_mfma_f32_16x16x32_bf16 v[92:95], v[32:35], v[48:51], 0
  s_add_u32 s31, s47, 393216
  buffer_store_dwordx4 v[72:75], v12, s[4:7], s31 offen sc1
  v_mfma_f32_16x16x32_bf16 v[88:91], v[20:23], v[52:55], v[88:91]
  v_mfma_f32_16x16x32_bf16 v[92:95], v[36:39], v[52:55], v[92:95]
  ds_read_b128 v[48:51], v7 offset:4096
  s_waitcnt lgkmcnt(3)
  v_mfma_f32_16x16x32_bf16 v[88:91], v[24:27], v[56:59], v[88:91]
  ds_read_b128 v[52:55], v7 offset:5120
  v_mfma_f32_16x16x32_bf16 v[92:95], v[40:43], v[56:59], v[92:95]
  v_mfma_f32_16x16x32_bf16 v[88:91], v[28:31], v[60:63], v[88:91]
  v_mfma_f32_16x16x32_bf16 v[92:95], v[44:47], v[60:63], v[92:95]
  ds_read_b128 v[56:59], v7 offset:2048
  v_mfma_f32_16x16x32_bf16 v[72:75], v[16:19], a[168:171], 0
  ds_read_b128 v[60:63], v7 offset:3072
  v_mfma_f32_16x16x32_bf16 v[76:79], v[32:35], a[168:171], 0
  v_cvt_pk_bf16_f32 v80, v80, v81
  v_cvt_pk_bf16_f32 v81, v82, v83
  v_mfma_f32_16x16x32_bf16 v[72:75], v[20:23], a[172:175], v[72:75]
  v_cvt_pk_bf16_f32 v82, v84, v85
  v_cvt_pk_bf16_f32 v83, v86, v87
  v_mfma_f32_16x16x32_bf16 v[76:79], v[36:39], a[172:175], v[76:79]
  s_add_u32 s31, s47, 131072
  buffer_store_dwordx4 v[80:83], v12, s[4:7], s31 offen sc1
  v_mfma_f32_16x16x32_bf16 v[72:75], v[24:27], a[184:187], v[72:75]
  v_mfma_f32_16x16x32_bf16 v[76:79], v[40:43], a[184:187], v[76:79]
  v_mfma_f32_16x16x32_bf16 v[72:75], v[28:31], a[188:191], v[72:75]
  v_mfma_f32_16x16x32_bf16 v[76:79], v[44:47], a[188:191], v[76:79]
  v_cvt_pk_bf16_f32 v88, v88, v89
  v_cvt_pk_bf16_f32 v89, v90, v91
  s_waitcnt lgkmcnt(4)
  v_mfma_f32_16x16x32_bf16 v[80:83], v[16:19], v[64:67], 0
  v_cvt_pk_bf16_f32 v90, v92, v93
  v_cvt_pk_bf16_f32 v91, v94, v95
  v_mfma_f32_16x16x32_bf16 v[84:87], v[32:35], v[64:67], 0
  s_add_u32 s31, s47, 401408
  buffer_store_dwordx4 v[88:91], v12, s[4:7], s31 offen sc1
  v_mfma_f32_16x16x32_bf16 v[80:83], v[20:23], v[68:71], v[80:83]
  v_mfma_f32_16x16x32_bf16 v[84:87], v[36:39], v[68:71], v[84:87]
  ds_read_b128 v[64:67], v7 offset:6144
  s_waitcnt lgkmcnt(3)
  v_mfma_f32_16x16x32_bf16 v[80:83], v[24:27], v[48:51], v[80:83]
  ds_read_b128 v[68:71], v7 offset:7168
  v_mfma_f32_16x16x32_bf16 v[84:87], v[40:43], v[48:51], v[84:87]
  v_mfma_f32_16x16x32_bf16 v[80:83], v[28:31], v[52:55], v[80:83]
  v_mfma_f32_16x16x32_bf16 v[84:87], v[44:47], v[52:55], v[84:87]
  v_cvt_pk_bf16_f32 v72, v72, v73
  v_cvt_pk_bf16_f32 v73, v74, v75
  v_mfma_f32_16x16x32_bf16 v[88:91], v[16:19], a[192:195], 0
  v_cvt_pk_bf16_f32 v74, v76, v77
  v_cvt_pk_bf16_f32 v75, v78, v79
  v_mfma_f32_16x16x32_bf16 v[92:95], v[32:35], a[192:195], 0
  s_add_u32 s31, s47, 139264
  buffer_store_dwordx4 v[72:75], v12, s[4:7], s31 offen sc1
  v_mfma_f32_16x16x32_bf16 v[88:91], v[20:23], a[196:199], v[88:91]
  v_mfma_f32_16x16x32_bf16 v[92:95], v[36:39], a[196:199], v[92:95]
  v_mfma_f32_16x16x32_bf16 v[88:91], v[24:27], a[208:211], v[88:91]
  v_mfma_f32_16x16x32_bf16 v[92:95], v[40:43], a[208:211], v[92:95]
  v_mfma_f32_16x16x32_bf16 v[88:91], v[28:31], a[212:215], v[88:91]
  v_mfma_f32_16x16x32_bf16 v[92:95], v[44:47], a[212:215], v[92:95]
  v_cvt_pk_bf16_f32 v80, v80, v81
  v_cvt_pk_bf16_f32 v81, v82, v83
  s_waitcnt lgkmcnt(2)
  v_mfma_f32_16x16x32_bf16 v[72:75], v[16:19], v[56:59], 0
  v_cvt_pk_bf16_f32 v82, v84, v85
  v_cvt_pk_bf16_f32 v83, v86, v87
  v_mfma_f32_16x16x32_bf16 v[76:79], v[32:35], v[56:59], 0
  s_add_u32 s31, s47, 458752
  buffer_store_dwordx4 v[80:83], v12, s[4:7], s31 offen sc1
  v_mfma_f32_16x16x32_bf16 v[72:75], v[20:23], v[60:63], v[72:75]
  v_mfma_f32_16x16x32_bf16 v[76:79], v[36:39], v[60:63], v[76:79]
  s_waitcnt lgkmcnt(0)
  v_mfma_f32_16x16x32_bf16 v[72:75], v[24:27], v[64:67], v[72:75]
  v_mfma_f32_16x16x32_bf16 v[76:79], v[40:43], v[64:67], v[76:79]
  v_mfma_f32_16x16x32_bf16 v[72:75], v[28:31], v[68:71], v[72:75]
  v_mfma_f32_16x16x32_bf16 v[76:79], v[44:47], v[68:71], v[76:79]
  v_cvt_pk_bf16_f32 v88, v88, v89
  v_cvt_pk_bf16_f32 v89, v90, v91
  v_mfma_f32_16x16x32_bf16 v[80:83], v[16:19], a[200:203], 0
  v_cvt_pk_bf16_f32 v90, v92, v93
  v_cvt_pk_bf16_f32 v91, v94, v95
  v_mfma_f32_16x16x32_bf16 v[84:87], v[32:35], a[200:203], 0
  s_add_u32 s31, s47, 196608
  buffer_store_dwordx4 v[88:91], v12, s[4:7], s31 offen sc1
  v_mfma_f32_16x16x32_bf16 v[80:83], v[20:23], a[204:207], v[80:83]
  v_mfma_f32_16x16x32_bf16 v[84:87], v[36:39], a[204:207], v[84:87]
  v_mfma_f32_16x16x32_bf16 v[80:83], v[24:27], a[216:219], v[80:83]
  v_mfma_f32_16x16x32_bf16 v[84:87], v[40:43], a[216:219], v[84:87]
  v_mfma_f32_16x16x32_bf16 v[80:83], v[28:31], a[220:223], v[80:83]
  v_mfma_f32_16x16x32_bf16 v[84:87], v[44:47], a[220:223], v[84:87]
  v_cvt_pk_bf16_f32 v72, v72, v73
  v_cvt_pk_bf16_f32 v73, v74, v75
  v_mfma_f32_16x16x32_bf16 v[88:91], v[16:19], a[224:227], 0
  v_cvt_pk_bf16_f32 v74, v76, v77
  v_cvt_pk_bf16_f32 v75, v78, v79
  v_mfma_f32_16x16x32_bf16 v[92:95], v[32:35], a[224:227], 0
  s_add_u32 s31, s47, 466944
  buffer_store_dwordx4 v[72:75], v12, s[4:7], s31 offen sc1
  v_mfma_f32_16x16x32_bf16 v[88:91], v[20:23], a[228:231], v[88:91]
  v_mfma_f32_16x16x32_bf16 v[92:95], v[36:39], a[228:231], v[92:95]
  v_mfma_f32_16x16x32_bf16 v[88:91], v[24:27], a[240:243], v[88:91]
  v_mfma_f32_16x16x32_bf16 v[92:95], v[40:43], a[240:243], v[92:95]
  v_mfma_f32_16x16x32_bf16 v[88:91], v[28:31], a[244:247], v[88:91]
  v_mfma_f32_16x16x32_bf16 v[92:95], v[44:47], a[244:247], v[92:95]
  v_cvt_pk_bf16_f32 v80, v80, v81
  v_cvt_pk_bf16_f32 v81, v82, v83
  v_mfma_f32_16x16x32_bf16 v[72:75], v[16:19], a[232:235], 0
  v_cvt_pk_bf16_f32 v82, v84, v85
  v_cvt_pk_bf16_f32 v83, v86, v87
  v_mfma_f32_16x16x32_bf16 v[76:79], v[32:35], a[232:235], 0
  s_add_u32 s31, s47, 204800
  buffer_store_dwordx4 v[80:83], v12, s[4:7], s31 offen sc1
  v_mfma_f32_16x16x32_bf16 v[72:75], v[20:23], a[236:239], v[72:75]
  v_mfma_f32_16x16x32_bf16 v[76:79], v[36:39], a[236:239], v[76:79]
  v_mfma_f32_16x16x32_bf16 v[72:75], v[24:27], a[248:251], v[72:75]
  v_mfma_f32_16x16x32_bf16 v[76:79], v[40:43], a[248:251], v[76:79]
  v_mfma_f32_16x16x32_bf16 v[72:75], v[28:31], a[252:255], v[72:75]
  v_mfma_f32_16x16x32_bf16 v[76:79], v[44:47], a[252:255], v[76:79]
  v_cvt_pk_bf16_f32 v88, v88, v89
  v_cvt_pk_bf16_f32 v89, v90, v91
  s_nop 1
  v_cvt_pk_bf16_f32 v90, v92, v93
  v_cvt_pk_bf16_f32 v91, v94, v95
  s_add_u32 s31, s47, 262144
  buffer_store_dwordx4 v[88:91], v12, s[4:7], s31 offen sc1
  v_cvt_pk_bf16_f32 v72, v72, v73
  v_cvt_pk_bf16_f32 v73, v74, v75
  v_cvt_pk_bf16_f32 v74, v76, v77
  v_cvt_pk_bf16_f32 v75, v78, v79
  s_add_u32 s31, s47, 270336
  buffer_store_dwordx4 v[72:75], v12, s[4:7], s31 offen sc1
Bs_done:
  s_add_u32 s14, s14, 1
  s_cmp_ge_i32 s14, 64
  s_cbranch_scc1 L_end
  s_max_i32 s39, s14, 0
  s_cmp_ge_i32 s14, 1
  s_cbranch_scc1 Bs_top
  s_cmp_eq_i32 s14, -2
  s_cbranch_scc1 Bs_pro
  s_add_u32 s15, s14, 2
  v_mov_b32 v13, s15
  s_waitcnt vmcnt(0)
  s_mov_b64 exec, 1
  buffer_store_dword v13, v2, s[4:7], s38 offen sc1
  s_mov_b64 exec, -1
Bs_pro:
  s_cmp_lg_i32 s14, -2
  s_cbranch_scc1 BW_102
  s_mov_b32 exec_lo, 0x1
  s_mov_b32 exec_hi, 0x0
F_103:
  buffer_load_dword v13, v2, s[4:7], s44 offen sc1
  s_waitcnt vmcnt(0)
  v_cmp_eq_u32 vcc, 0, v13
  s_cbranch_vccz FE_104
  s_add_u32 s101, s101, 1
  s_cmp_gt_u32 s101, 262144
  s_cbranch_scc1 L_abort
  s_sleep 2
  s_branch F_103
FE_104:
  s_mov_b64 exec, -1
  s_mov_b32 m0, s42
  s_nop 0
  buffer_load_dwordx4 v2, s[4:7], s43 offen offset:0 sc1 nt lds
  buffer_load_dwordx4 v2, s[4:7], s43 offen offset:1024 sc1 nt lds
  s_waitcnt vmcnt(0)
BW_102:
  s_and_b32 s50, s14, 1
  s_lshl_b32 s50, s50, 14
  v_add_u32 v15, s50, v8
  s_barrier
  s_branch Bs_zx
BS_100:
  s_cmp_lt_i32 s14, 0
  s_cbranch_scc1 BZ_105
BZ_106:
  buffer_load_dword v9, v10, s[4:7], s46 offen sc1
  s_add_u32 s101, s101, 1
  s_cmp_gt_u32 s101, 262144
  s_cbranch_scc1 L_abort
  s_waitcnt vmcnt(0)
  v_cmp_ne_u32 vcc, -1, v9
  s_cbranch_vccnz BZ_106
BZ_105:
  s_cmp_eq_i32 s14, -3
  s_cbranch_scc1 BB_101
  v_readfirstlane_b32 s97, v4
  s_cmp_lg_u32 s97, 0
  s_cbranch_scc1 BB_101
  s_mov_b32 exec_lo, 0x1
  s_mov_b32 exec_hi, 0x0
F_107:
  buffer_load_dword v13, v2, s[4:7], s44 offen sc1
  s_waitcnt vmcnt(0)
  v_cmp_eq_u32 vcc, 0, v13
  s_cbranch_vccz FE_108
  s_add_u32 s101, s101, 1
  s_cmp_gt_u32 s101, 262144
  s_cbranch_scc1 L_abort
  s_sleep 8
  s_branch F_107
FE_108:
  s_mov_b64 exec, -1
  s_branch BB_101
R_entry:
  s_and_b32 s39, s96, 15
  s_lshl_b32 s51, s39, 2
  s_add_u32 s51, s51, s95
  s_add_u32 s15, s92, 0x71fffff
  s_and_b32 s15, s15, 0xffe00000
  s_sub_u32 s52, s15, s92
  v_bfe_u32 v13, v1, 1, 2
  v_lshlrev_b32 v3, 6, v13
  v_bfe_u32 v13, v1, 3, 1
  v_lshl_add_u32 v3, v13, 5, v3
  v_and_b32 v13, 1, v1
  v_lshl_add_u32 v3, v13, 4, v3
  v_lshrrev_b32 v13, 4, v1
  v_lshl_add_u32 v3, v13, 2, v3
  s_lshl_b32 s15, s51, 8
  s_add_u32 s15, s15, 0
  v_add_u32 v3, s15, v3
  v_lshrrev_b32 v14, 4, v1
  v_lshlrev_b32 v13, 7, v14
  v_and_b32 v14, 7, v1
  v_lshl_add_u32 v13, v14, 4, v13
  v_bfe_u32 v14, v1, 3, 1
  v_lshl_add_u32 v13, v14, 3, v13
  v_lshlrev_b32 v13, 2, v1
  s_xor_b32 s15, s94, 0
  s_lshl_b32 s15, s15, 16
  s_lshr_b32 s31, s51, 5
  s_lshl_b32 s31, s31, 14
  s_add_u32 s15, s15, s31
  s_and_b32 s31, s51, 31
  s_lshl_b32 s31, s31, 8
  s_add_u32 s15, s15, s31
  v_add_u32 v4, s15, v13
  s_xor_b32 s15, s94, 1
  s_lshl_b32 s15, s15, 16
  s_lshr_b32 s31, s51, 5
  s_lshl_b32 s31, s31, 14
  s_add_u32 s15, s15, s31
  s_and_b32 s31, s51, 31
  s_lshl_b32 s31, s31, 8
  s_add_u32 s15, s15, s31
  v_add_u32 v5, s15, v13
  s_xor_b32 s15, s94, 2
  s_lshl_b32 s15, s15, 16
  s_lshr_b32 s31, s51, 5
  s_lshl_b32 s31, s31, 14
  s_add_u32 s15, s15, s31
  s_and_b32 s31, s51, 31
  s_lshl_b32 s31, s31, 8
  s_add_u32 s15, s15, s31
  v_add_u32 v6, s15, v13
  s_xor_b32 s15, s94, 3
  s_lshl_b32 s15, s15, 16
  s_lshr_b32 s31, s51, 5
  s_lshl_b32 s31, s31, 14
  s_add_u32 s15, s15, s31
  s_and_b32 s31, s51, 31
  s_lshl_b32 s31, s31, 8
  s_add_u32 s15, s15, s31
  v_add_u32 v7, s15, v13
  s_lshl_b32 s15, s51, 13
  s_add_u32 s15, s15, 2097152
  v_add_u32 v9, s15, v2
  s_lshl_b32 s15, s95, 12
  v_add_u32 v8, s15, v2
  v_lshlrev_b32 v30, 2, v1
  s_lshl_b32 s15, s95, 8
  v_add_u32 v31, s15, v30
  v_bfe_u32 v13, v1, 1, 1
  v_lshlrev_b32 v14, 7, v13
  v_and_b32 v13, 1, v1
  v_lshl_add_u32 v14, v13, 3, v14
  v_bfe_u32 v13, v1, 5, 1
  v_lshl_add_u32 v92, v13, 8, v14
  v_bfe_u32 v13, v1, 2, 3
  v_lshl_add_u32 v92, v13, 4, v92
  v_bfe_u32 v13, v1, 3, 1
  v_lshl_add_u32 v93, v13, 8, v14
  v_lshrrev_b32 v13, 4, v1
  v_lshl_add_u32 v93, v13, 5, v93
  v_bfe_u32 v13, v1, 2, 1
  v_lshl_add_u32 v93, v13, 4, v93
  s_lshl_b32 s34, s95, 8
  s_add_u32 s34, s34, 40960
  v_bfe_u32 v13, v1, 5, 1
  v_lshlrev_b32 v11, 9, v13
  v_and_b32 v13, 31, v1
  v_lshl_add_u32 v11, v13, 3, v11
  s_lshl_b32 s15, s95, 12
  v_add_u32 v11, s15, v11
  v_lshlrev_b32 v13, 3, v1
  s_lshl_b32 s15, s95, 9
  v_add_u32 v8, s15, v13
  s_lshl_b32 s15, s95, 11
  v_add_u32 v29, s15, v13
  v_and_b32 v13, 2, v1
  v_mov_b32 v12, 0x4444
  v_mov_b32 v14, 0xeeee
  v_cmp_ne_u32 vcc, 0, v13
  s_nop 1
  v_cndmask_b32 v12, v12, v14, vcc
  v_mov_b32 v88, -1
  v_mov_b32 v89, -1
  v_mov_b32 v90, -1
  v_mov_b32 v91, -1
  s_add_u32 s15, s13, 0
  buffer_store_dword v88, v3, s[4:7], s15 offen sc1
  s_add_u32 s15, s52, 0
  buffer_store_dword v88, v4, s[4:7], s15 offen sc1
  s_add_u32 s15, s52, 262144
  s_add_u32 s15, s52, 2097152
  s_add_u32 s15, s52, 2359296
  s_add_u32 s15, s52, 8192
  buffer_store_dword v88, v4, s[4:7], s15 offen sc1
  s_add_u32 s15, s52, 270336
  s_add_u32 s15, s52, 2105344
  s_add_u32 s15, s52, 2367488
  s_add_u32 s15, s13, 16384
  buffer_store_dword v88, v3, s[4:7], s15 offen sc1
  s_add_u32 s15, s52, 524288
  buffer_store_dword v88, v4, s[4:7], s15 offen sc1
  s_add_u32 s15, s52, 786432
  s_add_u32 s15, s52, 2621440
  s_add_u32 s15, s52, 2883584
  s_add_u32 s15, s52, 532480
  buffer_store_dword v88, v4, s[4:7], s15 offen sc1
  s_add_u32 s15, s52, 794624
  s_add_u32 s15, s52, 2629632
  s_add_u32 s15, s52, 2891776
  s_add_u32 s15, s13, 32768
  buffer_store_dword v88, v3, s[4:7], s15 offen sc1
  s_add_u32 s15, s52, 1048576
  buffer_store_dword v88, v4, s[4:7], s15 offen sc1
  s_add_u32 s15, s52, 1310720
  s_add_u32 s15, s52, 3145728
  s_add_u32 s15, s52, 3407872
  s_add_u32 s15, s52, 1056768
  buffer_store_dword v88, v4, s[4:7], s15 offen sc1
  s_add_u32 s15, s52, 1318912
  s_add_u32 s15, s52, 3153920
  s_add_u32 s15, s52, 3416064
  s_add_u32 s15, s13, 49152
  buffer_store_dword v88, v3, s[4:7], s15 offen sc1
  s_add_u32 s15, s52, 1572864
  buffer_store_dword v88, v4, s[4:7], s15 offen sc1
  s_add_u32 s15, s52, 1835008
  s_add_u32 s15, s52, 3670016
  s_add_u32 s15, s52, 3932160
  s_add_u32 s15, s52, 1581056
  buffer_store_dword v88, v4, s[4:7], s15 offen sc1
  s_add_u32 s15, s52, 1843200
  s_add_u32 s15, s52, 3678208
  s_add_u32 s15, s52, 3940352
  s_lshl_b32 s15, s94, 22
  s_lshl_b32 s31, s51, 10
  s_add_u32 s15, s15, s31
  s_add_u32 s15, s15, 0x4800000
  s_add_u32 s31, s15, 3670016
  buffer_store_dwordx4 v[88:91], v2, s[4:7], s31 offen sc1
  s_add_u32 s31, s15, 3735552
  buffer_store_dwordx4 v[88:91], v2, s[4:7], s31 offen sc1
  s_add_u32 s31, s15, 3801088
  buffer_store_dwordx4 v[88:91], v2, s[4:7], s31 offen sc1
  s_add_u32 s31, s15, 3866624
  buffer_store_dwordx4 v[88:91], v2, s[4:7], s31 offen sc1
  s_add_u32 s31, s15, 3932160
  buffer_store_dwordx4 v[88:91], v2, s[4:7], s31 offen sc1
  s_add_u32 s31, s15, 3997696
  buffer_store_dwordx4 v[88:91], v2, s[4:7], s31 offen sc1
  s_add_u32 s31, s15, 4063232
  buffer_store_dwordx4 v[88:91], v2, s[4:7], s31 offen sc1
  s_add_u32 s31, s15, 4128768
  buffer_store_dwordx4 v[88:91], v2, s[4:7], s31 offen sc1
  s_mov_b32 s16, s66
  s_mov_b32 s17, s67
  s_mov_b32 s18, 0x4000
  s_mov_b32 s19, 0x20000
  v_and_b32 v13, 7, v1
  v_lshlrev_b32 v15, 11, v13
  v_bfe_u32 v13, v1, 3, 1
  v_lshl_add_u32 v15, v13, 2, v15
  v_lshrrev_b32 v13, 4, v1
  v_lshl_add_u32 v15, v13, 3, v15
  s_lshl_b32 s15, s51, 5
  buffer_load_dword v10, v15, s[16:19], s15 offen
  s_lshr_b32 s15, s51, 1
  s_or_b32 s15, s94, s15
  s_cmp_lg_u32 s15, 0
  s_cbranch_scc1 R_noprobe
  s_waitcnt vmcnt(0)
  s_mov_b32 s53, -1
  s_mov_b32 s54, -1
  s_lshl_b32 s55, s51, 21
  s_mov_b32 s33, 6
  s_mov_b64 exec, 1
R_probe:
  s_add_u32 s15, s52, 0
  s_add_u32 s15, s15, s55
  s_memtime s[40:41]
  s_waitcnt lgkmcnt(0)
  buffer_store_dword v88, v4, s[4:7], s15 offen sc1
  s_waitcnt vmcnt(0)
  s_memtime s[42:43]
  s_waitcnt lgkmcnt(0)
  s_sub_u32 s40, s42, s40
  s_min_u32 s53, s53, s40
  s_add_u32 s15, s52, 8192
  s_add_u32 s15, s15, s55
  s_memtime s[40:41]
  s_waitcnt lgkmcnt(0)
  buffer_store_dword v88, v4, s[4:7], s15 offen sc1
  s_waitcnt vmcnt(0)
  s_memtime s[42:43]
  s_waitcnt lgkmcnt(0)
  s_sub_u32 s40, s42, s40
  s_min_u32 s54, s54, s40
  s_add_u32 s55, s55, 262144
  s_sub_u32 s33, s33, 1
  s_cmp_lg_u32 s33, 0
  s_cbranch_scc1 R_probe
  s_mov_b64 exec, -1
  s_cmp_lt_u32 s54, s53
  s_cselect_b32 s15, 1, 0
  s_lshl_b32 s15, s15, s51
  v_mov_b32 v13, s15
  v_mov_b32 v14, 164
  s_mov_b64 exec, 1
  buffer_atomic_add v13, v14, s[8:11], 0 offen
  s_mov_b64 exec, -1
R_noprobe:
  s_mov_b32 s16, s68
  s_mov_b32 s17, s69
  s_mov_b32 s18, 0x800000
  s_mov_b32 s19, 0x20000
  s_mov_b32 s20, s70
  s_mov_b32 s21, s71
  s_mov_b32 s22, 0x800000
  s_mov_b32 s23, 0x20000
  s_mov_b32 s24, s72
  s_mov_b32 s25, s73
  s_mov_b32 s26, 0x800000
  s_mov_b32 s27, 0x20000
  s_lshl_b32 s15, s51, 13
  s_lshl_b32 s31, s94, 11
  s_add_u32 s15, s15, s31
  s_mov_b32 s32, 4
R_pf:
  buffer_load_dwordx4 v[96:99], v2, s[16:19], s15 offen offset:0
  buffer_load_dwordx4 v[100:103], v2, s[16:19], s15 offen offset:1024
  buffer_load_dwordx4 v[104:107], v2, s[20:23], s15 offen offset:0
  buffer_load_dwordx4 v[108:111], v2, s[20:23], s15 offen offset:1024
  buffer_load_dwordx4 v[112:115], v2, s[24:27], s15 offen offset:0
  buffer_load_dwordx4 v[116:119], v2, s[24:27], s15 offen offset:1024
  s_add_u32 s15, s15, 524288
  s_waitcnt vmcnt(48)
  buffer_load_dwordx4 v[120:123], v2, s[16:19], s15 offen offset:0
  buffer_load_dwordx4 v[124:127], v2, s[16:19], s15 offen offset:1024
  buffer_load_dwordx4 v[128:131], v2, s[20:23], s15 offen offset:0
  buffer_load_dwordx4 v[132:135], v2, s[20:23], s15 offen offset:1024
  buffer_load_dwordx4 v[136:139], v2, s[24:27], s15 offen offset:0
  buffer_load_dwordx4 v[140:143], v2, s[24:27], s15 offen offset:1024
  s_add_u32 s15, s15, 524288
  s_waitcnt vmcnt(48)
  buffer_load_dwordx4 v[144:147], v2, s[16:19], s15 offen offset:0
  buffer_load_dwordx4 v[148:151], v2, s[16:19], s15 offen offset:1024
  buffer_load_dwordx4 v[152:155], v2, s[20:23], s15 offen offset:0
  buffer_load_dwordx4 v[156:159], v2, s[20:23], s15 offen offset:1024
  buffer_load_dwordx4 v[160:163], v2, s[24:27], s15 offen offset:0
  buffer_load_dwordx4 v[164:167], v2, s[24:27], s15 offen offset:1024
  s_add_u32 s15, s15, 524288
  s_waitcnt vmcnt(48)
  buffer_load_dwordx4 v[168:171], v2, s[16:19], s15 offen offset:0
  buffer_load_dwordx4 v[172:175], v2, s[16:19], s15 offen offset:1024
  buffer_load_dwordx4 v[176:179], v2, s[20:23], s15 offen offset:0
  buffer_load_dwordx4 v[180:183], v2, s[20:23], s15 offen offset:1024
  buffer_load_dwordx4 v[184:187], v2, s[24:27], s15 offen offset:0
  buffer_load_dwordx4 v[188:191], v2, s[24:27], s15 offen offset:1024
  s_add_u32 s15, s15, 524288
  s_waitcnt vmcnt(48)
  s_sub_u32 s32, s32, 1
  s_cmp_lg_u32 s32, 0
  s_cbranch_scc1 R_pf
  s_waitcnt vmcnt(24)
  s_barrier
  s_cmp_lg_u32 s95, 0
  s_cbranch_scc1 IS_109
  v_mov_b32 v13, 1
  v_mov_b32 v14, 160
  s_mov_b64 exec, 1
  buffer_atomic_add v13, v14, s[8:11], 0 offen
  s_mov_b64 exec, -1
IS_109:
  v_min_u32 v10, -2, v10
  s_mov_b32 s40, s74
  s_mov_b32 s41, s75
  s_mov_b32 s42, 0x800000
  s_mov_b32 s43, 0x20000
  v_lshrrev_b32 v13, 3, v1
  v_lshlrev_b32 v13, 11, v13
  v_and_b32 v14, 7, v1
  v_lshl_add_u32 v13, v14, 4, v13
  s_lshl_b32 s15, s94, 21
  s_lshl_b32 s31, s95, 19
  s_add_u32 s15, s15, s31
  s_lshl_b32 s31, s39, 7
  s_add_u32 s15, s15, s31
  s_lshl_b32 s31, s95, 15
  s_add_u32 m0, s31, 0
  s_nop 0
  buffer_load_dwordx4 v13, s[40:43], s15 offen lds
  s_add_u32 s15, s15, 16384
  s_add_u32 m0, s31, 1024
  s_nop 0
  buffer_load_dwordx4 v13, s[40:43], s15 offen lds
  s_add_u32 s15, s15, 16384
  s_add_u32 m0, s31, 2048
  s_nop 0
  buffer_load_dwordx4 v13, s[40:43], s15 offen lds
  s_add_u32 s15, s15, 16384
  s_add_u32 m0, s31, 3072
  s_nop 0
  buffer_load_dwordx4 v13, s[40:43], s15 offen lds
  s_add_u32 s15, s15, 16384
  s_add_u32 m0, s31, 4096
  s_nop 0
  buffer_load_dwordx4 v13, s[40:43], s15 offen lds
  s_add_u32 s15, s15, 16384
  s_add_u32 m0, s31, 5120
  s_nop 0
  buffer_load_dwordx4 v13, s[40:43], s15 offen lds
  s_add_u32 s15, s15, 16384
  s_add_u32 m0, s31, 6144
  s_nop 0
  buffer_load_dwordx4 v13, s[40:43], s15 offen lds
  s_add_u32 s15, s15, 16384
  s_add_u32 m0, s31, 7168
  s_nop 0
  buffer_load_dwordx4 v13, s[40:43], s15 offen lds
  s_add_u32 s15, s15, 16384
  s_add_u32 m0, s31, 8192
  s_nop 0
  buffer_load_dwordx4 v13, s[40:43], s15 offen lds
  s_add_u32 s15, s15, 16384
  s_add_u32 m0, s31, 9216
  s_nop 0
  buffer_load_dwordx4 v13, s[40:43], s15 offen lds
  s_add_u32 s15, s15, 16384
  s_add_u32 m0, s31, 10240
  s_nop 0
  buffer_load_dwordx4 v13, s[40:43], s15 offen lds
  s_add_u32 s15, s15, 16384
  s_add_u32 m0, s31, 11264
  s_nop 0
  buffer_load_dwordx4 v13, s[40:43], s15 offen lds
  s_add_u32 s15, s15, 16384
  s_add_u32 m0, s31, 12288
  s_nop 0
  buffer_load_dwordx4 v13, s[40:43], s15 offen lds
  s_add_u32 s15, s15, 16384
  s_add_u32 m0, s31, 13312
  s_nop 0
  buffer_load_dwordx4 v13, s[40:43], s15 offen lds
  s_add_u32 s15, s15, 16384
  s_add_u32 m0, s31, 14336
  s_nop 0
  buffer_load_dwordx4 v13, s[40:43], s15 offen lds
  s_add_u32 s15, s15, 16384
  s_add_u32 m0, s31, 15360
  s_nop 0
  buffer_load_dwordx4 v13, s[40:43], s15 offen lds
  s_add_u32 s15, s15, 16384
  s_add_u32 m0, s31, 16384
  s_nop 0
  buffer_load_dwordx4 v13, s[40:43], s15 offen lds
  s_add_u32 s15, s15, 16384
  s_add_u32 m0, s31, 17408
  s_nop 0
  buffer_load_dwordx4 v13, s[40:43], s15 offen lds
  s_add_u32 s15, s15, 16384
  s_add_u32 m0, s31, 18432
  s_nop 0
  buffer_load_dwordx4 v13, s[40:43], s15 offen lds
  s_add_u32 s15, s15, 16384
  s_add_u32 m0, s31, 19456
  s_nop 0
  buffer_load_dwordx4 v13, s[40:43], s15 offen lds
  s_add_u32 s15, s15, 16384
  s_add_u32 m0, s31, 20480
  s_nop 0
  buffer_load_dwordx4 v13, s[40:43], s15 offen lds
  s_add_u32 s15, s15, 16384
  s_add_u32 m0, s31, 21504
  s_nop 0
  buffer_load_dwordx4 v13, s[40:43], s15 offen lds
  s_add_u32 s15, s15, 16384
  s_add_u32 m0, s31, 22528
  s_nop 0
  buffer_load_dwordx4 v13, s[40:43], s15 offen lds
  s_add_u32 s15, s15, 16384
  s_add_u32 m0, s31, 23552
  s_nop 0
  buffer_load_dwordx4 v13, s[40:43], s15 offen lds
  s_add_u32 s15, s15, 16384
  s_add_u32 m0, s31, 24576
  s_nop 0
  buffer_load_dwordx4 v13, s[40:43], s15 offen lds
  s_add_u32 s15, s15, 16384
  s_add_u32 m0, s31, 25600
  s_nop 0
  buffer_load_dwordx4 v13, s[40:43], s15 offen lds
  s_add_u32 s15, s15, 16384
  s_add_u32 m0, s31, 26624
  s_nop 0
  buffer_load_dwordx4 v13, s[40:43], s15 offen lds
  s_add_u32 s15, s15, 16384
  s_add_u32 m0, s31, 27648
  s_nop 0
  buffer_load_dwordx4 v13, s[40:43], s15 offen lds
  s_add_u32 s15, s15, 16384
  s_add_u32 m0, s31, 28672
  s_nop 0
  buffer_load_dwordx4 v13, s[40:43], s15 offen lds
  s_add_u32 s15, s15, 16384
  s_add_u32 m0, s31, 29696
  s_nop 0
  buffer_load_dwordx4 v13, s[40:43], s15 offen lds
  s_add_u32 s15, s15, 16384
  s_add_u32 m0, s31, 30720
  s_nop 0
  buffer_load_dwordx4 v13, s[40:43], s15 offen lds
  s_add_u32 s15, s15, 16384
  s_add_u32 m0, s31, 31744
  s_nop 0
  buffer_load_dwordx4 v13, s[40:43], s15 offen lds
  s_add_u32 s15, s15, 16384
  s_waitcnt vmcnt(0)
  s_barrier
  v_bfe_u32 v14, v1, 3, 1
  v_lshlrev_b32 v13, 11, v14
  v_bfe_u32 v14, v1, 4, 1
  v_lshl_add_u32 v13, v14, 10, v13
  v_bfe_u32 v14, v1, 5, 1
  v_lshl_add_u32 v13, v14, 9, v13
  v_bfe_u32 v14, v1, 2, 1
  v_lshl_add_u32 v13, v14, 7, v13
  v_and_b32 v14, 3, v1
  v_lshl_add_u32 v13, v14, 3, v13
  s_lshl_b32 s15, s95, 15
  v_add_u32 v13, s15, v13
  ds_read_b64_tr_b16 a[0:1], v13 offset:0
  ds_read_b64_tr_b16 a[2:3], v13 offset:256
  ds_read_b64_tr_b16 a[4:5], v13 offset:4096
  ds_read_b64_tr_b16 a[6:7], v13 offset:4352
  ds_read_b64_tr_b16 a[8:9], v13 offset:8192
  ds_read_b64_tr_b16 a[10:11], v13 offset:8448
  ds_read_b64_tr_b16 a[12:13], v13 offset:12288
  ds_read_b64_tr_b16 a[14:15], v13 offset:12544
  ds_read_b64_tr_b16 a[16:17], v13 offset:16384
  ds_read_b64_tr_b16 a[18:19], v13 offset:16640
  ds_read_b64_tr_b16 a[20:21], v13 offset:20480
  ds_read_b64_tr_b16 a[22:23], v13 offset:20736
  ds_read_b64_tr_b16 a[24:25], v13 offset:24576
  ds_read_b64_tr_b16 a[26:27], v13 offset:24832
  ds_read_b64_tr_b16 a[28:29], v13 offset:28672
  ds_read_b64_tr_b16 a[30:31], v13 offset:28928
  ds_read_b64_tr_b16 a[32:33], v13 offset:32
  ds_read_b64_tr_b16 a[34:35], v13 offset:288
  ds_read_b64_tr_b16 a[36:37], v13 offset:4128
  ds_read_b64_tr_b16 a[38:39], v13 offset:4384
  ds_read_b64_tr_b16 a[40:41], v13 offset:8224
  ds_read_b64_tr_b16 a[42:43], v13 offset:8480
  ds_read_b64_tr_b16 a[44:45], v13 offset:12320
  ds_read_b64_tr_b16 a[46:47], v13 offset:12576
  ds_read_b64_tr_b16 a[48:49], v13 offset:16416
  ds_read_b64_tr_b16 a[50:51], v13 offset:16672
  ds_read_b64_tr_b16 a[52:53], v13 offset:20512
  ds_read_b64_tr_b16 a[54:55], v13 offset:20768
  ds_read_b64_tr_b16 a[56:57], v13 offset:24608
  ds_read_b64_tr_b16 a[58:59], v13 offset:24864
  ds_read_b64_tr_b16 a[60:61], v13 offset:28704
  ds_read_b64_tr_b16 a[62:63], v13 offset:28960
  ds_read_b64_tr_b16 a[64:65], v13 offset:64
  ds_read_b64_tr_b16 a[66:67], v13 offset:320
  ds_read_b64_tr_b16 a[68:69], v13 offset:4160
  ds_read_b64_tr_b16 a[70:71], v13 offset:4416
  ds_read_b64_tr_b16 a[72:73], v13 offset:8256
  ds_read_b64_tr_b16 a[74:75], v13 offset:8512
  ds_read_b64_tr_b16 a[76:77], v13 offset:12352
  ds_read_b64_tr_b16 a[78:79], v13 offset:12608
  ds_read_b64_tr_b16 a[80:81], v13 offset:16448
  ds_read_b64_tr_b16 a[82:83], v13 offset:16704
  ds_read_b64_tr_b16 a[84:85], v13 offset:20544
  ds_read_b64_tr_b16 a[86:87], v13 offset:20800
  ds_read_b64_tr_b16 a[88:89], v13 offset:24640
  ds_read_b64_tr_b16 a[90:91], v13 offset:24896
  ds_read_b64_tr_b16 a[92:93], v13 offset:28736
  ds_read_b64_tr_b16 a[94:95], v13 offset:28992
  ds_read_b64_tr_b16 a[96:97], v13 offset:96
  ds_read_b64_tr_b16 a[98:99], v13 offset:352
  ds_read_b64_tr_b16 a[100:101], v13 offset:4192
  ds_read_b64_tr_b16 a[102:103], v13 offset:4448
  ds_read_b64_tr_b16 a[104:105], v13 offset:8288
  ds_read_b64_tr_b16 a[106:107], v13 offset:8544
  ds_read_b64_tr_b16 a[108:109], v13 offset:12384
  ds_read_b64_tr_b16 a[110:111], v13 offset:12640
  ds_read_b64_tr_b16 a[112:113], v13 offset:16480
  ds_read_b64_tr_b16 a[114:115], v13 offset:16736
  ds_read_b64_tr_b16 a[116:117], v13 offset:20576
  ds_read_b64_tr_b16 a[118:119], v13 offset:20832
  ds_read_b64_tr_b16 a[120:121], v13 offset:24672
  ds_read_b64_tr_b16 a[122:123], v13 offset:24928
  ds_read_b64_tr_b16 a[124:125], v13 offset:28768
  ds_read_b64_tr_b16 a[126:127], v13 offset:29024
  s_waitcnt lgkmcnt(0)
  s_barrier
  s_mov_b32 s14, -1
  v_mov_b32 v15, 65536
  s_cmp_lg_u32 s95, 3
  s_cbranch_scc1 IW_110
  v_mov_b32 v14, 160
W_111:
  buffer_load_dword v13, v14, s[8:11], 0 offen sc1
  s_waitcnt vmcnt(0)
  v_readfirstlane_b32 s97, v13
  s_and_b32 s97, s97, 0xffff
  s_cmp_eq_u32 s97, 0x80
  s_cbranch_scc1 WE_112
  s_add_u32 s101, s101, 1
  s_cmp_gt_u32 s101, 262144
  s_cbranch_scc1 L_abort
  s_sleep 16
  s_branch W_111
WE_112:
  v_mov_b32 v14, 148
W_113:
  buffer_load_dword v13, v14, s[8:11], 0 offen sc1
  s_waitcnt vmcnt(0)
  v_readfirstlane_b32 s97, v13
  s_and_b32 s97, s97, 0x1
  s_cmp_eq_u32 s97, 0x1
  s_cbranch_scc1 WE_114
  s_add_u32 s101, s101, 1
  s_cmp_gt_u32 s101, 262144
  s_cbranch_scc1 L_abort
  s_sleep 16
  s_branch W_113
WE_114:
  v_mov_b32 v14, 164
  buffer_load_dwordx2 v[88:89], v14, s[8:11], 0 offen sc1
  s_waitcnt vmcnt(0)
  ds_write_b64 v15, v[88:89]
  s_waitcnt lgkmcnt(0)
IW_110:
  s_barrier
  ds_read_b64 v[88:89], v15
  s_waitcnt lgkmcnt(0)
  v_readfirstlane_b32 s98, v88
  v_readfirstlane_b32 s97, v89
  s_cmp_lg_u32 s97, 0
  s_cbranch_scc1 R_slow
  v_mov_b32 v88, -1
  v_mov_b32 v89, -1
  s_and_b32 s15, s98, 2
  s_lshl_b32 s15, s15, 12
  s_add_u32 s30, s52, s15
  s_add_u32 s30, s30, 2097152
  s_and_b32 s15, s98, 1
  s_lshl_b32 s15, s15, 13
  s_add_u32 s52, s52, s15
  s_add_u32 s15, s13, 49152
  buffer_store_dword v10, v3, s[4:7], s15 offen
  s_lshl_b32 s15, s51, 13
  s_add_u32 s15, s15, s13
  s_and_b32 s31, s51, 7
  s_lshl_b32 s31, s31, 13
  s_add_u32 s31, s31, s13
  s_add_u32 s31, s31, 524288
  v_lshlrev_b32 v84, 7, v1
  buffer_load_dword v96, v84, s[4:7], s15 offen sc1
  buffer_load_dword v97, v84, s[4:7], s31 offen sc1
Rf_loop:
  s_and_b32 s55, s14, 3
  s_lshl_b32 s33, s55, 14
  s_add_u32 s33, s33, s13
  s_lshl_b32 s15, s95, 12
  s_add_u32 m0, s15, 24576
  s_add_u32 s33, s33, s15
  s_add_u32 s33, s33, 524288
  s_lshl_b32 s40, s55, 15
  s_add_u32 s40, s40, s13
  s_add_u32 s40, s40, 131072
  s_mul_i32 s32, s95, 5120
  s_add_u32 s40, s40, s32
  s_add_u32 s41, s40, 4096
  v_add_u32 v15, s32, v2
  s_add_u32 s48, s32, 4096
  s_lshl_b32 s15, s55, 19
  s_add_u32 s16, s15, s52
  s_add_u32 s17, s16, 262144
  s_add_u32 s18, s15, s30
  s_add_u32 s19, s18, 262144
  s_add_u32 s53, s14, 1
  s_and_b32 s15, s53, 3
  s_lshl_b32 s43, s15, 14
  s_add_u32 s43, s43, s13
  s_and_b32 s46, s53, 1
  s_lshl_b32 s46, s46, 19
  s_add_u32 s46, s46, s13
  s_add_u32 s47, s46, 4096
  s_lshl_b32 s15, s55, 13
  s_add_u32 s15, s15, s13
  s_add_u32 s45, s15, 69632
  s_lshl_b32 s32, s95, 8
  s_add_u32 s45, s45, s32
  s_lshl_b32 s32, s95, 10
  s_add_u32 s15, s15, s32
  s_add_u32 s44, s15, 65536
  v_add_u32 v87, s32, v2
  v_mov_b64 v[224:225], 0
  v_mov_b64 v[226:227], 0
  v_mov_b64 v[228:229], 0
  v_mov_b64 v[230:231], 0
  v_mov_b64 v[232:233], 0
  v_mov_b64 v[234:235], 0
  v_mov_b64 v[236:237], 0
  v_mov_b64 v[238:239], 0
  v_mov_b64 v[240:241], 0
  v_mov_b64 v[242:243], 0
  v_mov_b64 v[244:245], 0
  v_mov_b64 v[246:247], 0
  v_mov_b64 v[248:249], 0
  v_mov_b64 v[250:251], 0
  v_mov_b64 v[252:253], 0
  v_mov_b64 v[254:255], 0
Rf_loop_top:
  s_mov_b32 s100, 5
SL_116:
  s_sleep 1
  s_sub_u32 s100, s100, 1
  s_cmp_lg_u32 s100, 0
  s_cbranch_scc1 SL_116
P_117:
  buffer_load_dwordx4 v2, s[4:7], s33 offen offset:0 sc1 lds
  buffer_load_dwordx4 v2, s[4:7], s33 offen offset:1024 sc1 lds
  buffer_load_dwordx4 v2, s[4:7], s33 offen offset:2048 sc1 lds
  buffer_load_dwordx4 v2, s[4:7], s33 offen offset:3072 sc1 lds
  s_add_u32 s101, s101, 1
  s_cmp_gt_u32 s101, 262144
  s_cbranch_scc1 L_abort
  s_waitcnt vmcnt(3)
  ds_read_b64_tr_b16 v[96:97], v11 offset:24576
  ds_read_b64_tr_b16 v[98:99], v11 offset:24832
  s_waitcnt vmcnt(2)
  ds_read_b64_tr_b16 v[100:101], v11 offset:25600
  ds_read_b64_tr_b16 v[102:103], v11 offset:25856
  s_waitcnt vmcnt(1)
  ds_read_b64_tr_b16 v[104:105], v11 offset:26624
  ds_read_b64_tr_b16 v[106:107], v11 offset:26880
  s_waitcnt vmcnt(0)
  ds_read_b64_tr_b16 v[108:109], v11 offset:27648
  ds_read_b64_tr_b16 v[110:111], v11 offset:27904
  s_waitcnt lgkmcnt(4)
  v_pk_max_u16 v84, v96, v97
  v_pk_max_u16 v85, v98, v99
  v_pk_max_u16 v84, v84, v100
  v_pk_max_u16 v85, v85, v101
  v_pk_max_u16 v84, v84, v102
  v_pk_max_u16 v85, v85, v103
  s_waitcnt lgkmcnt(0)
  v_pk_max_u16 v84, v84, v104
  v_pk_max_u16 v85, v85, v105
  v_pk_max_u16 v84, v84, v106
  v_pk_max_u16 v85, v85, v107
  v_pk_max_u16 v84, v84, v108
  v_pk_max_u16 v85, v85, v109
  v_pk_max_u16 v84, v84, v110
  v_pk_max_u16 v85, v85, v111
  v_pk_max_u16 v84, v84, v85
  v_pk_max_u16 v84, v84, v84 op_sel:[0,1] op_sel_hi:[1,0]
  s_nop 0
  v_cmp_eq_u32 vcc, -1, v84
  s_cbranch_vccnz P_117
  v_smfmac_f32_16x16x64_bf16 v[224:227], v[96:99], a[0:7], v12
  v_smfmac_f32_16x16x64_bf16 v[228:231], v[104:107], a[16:23], v12
  v_smfmac_f32_16x16x64_bf16 v[232:235], v[96:99], a[32:39], v12
  v_smfmac_f32_16x16x64_bf16 v[236:239], v[104:107], a[48:55], v12
  v_smfmac_f32_16x16x64_bf16 v[240:243], v[96:99], a[64:71], v12
  v_smfmac_f32_16x16x64_bf16 v[244:247], v[104:107], a[80:87], v12
  v_smfmac_f32_16x16x64_bf16 v[248:251], v[96:99], a[96:103], v12
  v_smfmac_f32_16x16x64_bf16 v[252:255], v[104:107], a[112:119], v12
  v_smfmac_f32_16x16x64_bf16 v[224:227], v[100:103], a[8:15], v12
  v_smfmac_f32_16x16x64_bf16 v[228:231], v[108:111], a[24:31], v12
  buffer_load_dwordx4 v[24:27], v2, s[4:7], s44 offen sc1
  buffer_load_dword v28, v30, s[4:7], s45 offen sc1
  v_smfmac_f32_16x16x64_bf16 v[232:235], v[100:103], a[40:47], v12
  v_smfmac_f32_16x16x64_bf16 v[236:239], v[108:111], a[56:63], v12
  v_smfmac_f32_16x16x64_bf16 v[240:243], v[100:103], a[72:79], v12
  v_smfmac_f32_16x16x64_bf16 v[244:247], v[108:111], a[88:95], v12
  v_smfmac_f32_16x16x64_bf16 v[248:251], v[100:103], a[104:111], v12
  v_smfmac_f32_16x16x64_bf16 v[252:255], v[108:111], a[120:127], v12
  s_nop 0
  v_pk_add_f32 v[224:225], v[224:225], v[226:227]
  v_pk_add_f32 v[228:229], v[228:229], v[230:231]
  v_pk_add_f32 v[232:233], v[232:233], v[234:235]
  v_pk_add_f32 v[236:237], v[236:237], v[238:239]
  v_pk_add_f32 v[240:241], v[240:241], v[242:243]
  v_pk_add_f32 v[244:245], v[244:245], v[246:247]
  v_pk_add_f32 v[248:249], v[248:249], v[250:251]
  v_pk_add_f32 v[252:253], v[252:253], v[254:255]
  v_cvt_pk_bf16_f32 v112, v224, v225
  v_cvt_pk_bf16_f32 v113, v228, v229
  ds_write_b64 v8, v[112:113] offset:49152
  v_cvt_pk_bf16_f32 v114, v232, v233
  v_cvt_pk_bf16_f32 v115, v236, v237
  ds_write_b64 v8, v[114:115] offset:51200
  v_cvt_pk_bf16_f32 v116, v240, v241
  v_cvt_pk_bf16_f32 v117, v244, v245
  ds_write_b64 v8, v[116:117] offset:53248
  v_cvt_pk_bf16_f32 v118, v248, v249
  v_cvt_pk_bf16_f32 v119, v252, v253
  ds_write_b64 v8, v[118:119] offset:55296
  s_cmp_lg_u32 s14, 0
  s_cbranch_scc1 RZ_118
  s_bfe_u32 s15, s51, 0x20001
  s_lshl_b32 s15, s15, 5
  s_add_u32 s15, s15, s13
  s_add_u32 s15, s15, 98304
  s_mov_b64 exec, 0xff
MK_119:
  buffer_load_dword v84, v30, s[4:7], s15 offen sc1
  s_add_u32 s101, s101, 1
  s_cmp_gt_u32 s101, 262144
  s_cbranch_scc1 L_abort
  s_waitcnt vmcnt(0)
  v_cmp_gt_u32 vcc, 1, v84
  s_cbranch_vccnz MK_119
  s_mov_b64 exec, -1
  s_add_u32 s15, s13, 4096
  buffer_load_dwordx4 v[192:195], v9, s[4:7], s13 offen offset:0 sc1
  buffer_load_dwordx4 v[196:199], v9, s[4:7], s13 offen offset:1024 sc1
  buffer_load_dwordx4 v[200:203], v9, s[4:7], s13 offen offset:2048 sc1
  buffer_load_dwordx4 v[204:207], v9, s[4:7], s13 offen offset:3072 sc1
  buffer_load_dwordx4 v[208:211], v9, s[4:7], s15 offen offset:0 sc1
  buffer_load_dwordx4 v[212:215], v9, s[4:7], s15 offen offset:1024 sc1
  buffer_load_dwordx4 v[216:219], v9, s[4:7], s15 offen offset:2048 sc1
  buffer_load_dwordx4 v[220:223], v9, s[4:7], s15 offen offset:3072 sc1
  s_add_u32 s15, s13, 49152
  s_waitcnt vmcnt(0)
  buffer_store_dword v88, v3, s[4:7], s15 offen
RZ_118:
P_120:
  buffer_load_dwordx4 v[24:27], v2, s[4:7], s44 offen sc1
  buffer_load_dword v28, v30, s[4:7], s45 offen sc1
  s_add_u32 s101, s101, 1
  s_cmp_gt_u32 s101, 262144
  s_cbranch_scc1 L_abort
  s_waitcnt vmcnt(2)
  v_max3_u32 v84, v24, v25, v26
  v_max3_u32 v84, v84, v27, v28
  v_cmp_eq_u32 vcc, -1, v84
  s_cbranch_vccnz P_120
  ds_write_b128 v87, v[24:27] offset:0
  ds_write_b32 v31, v28 offset:40960
  s_waitcnt lgkmcnt(0)
  s_barrier
  ds_read_b64_tr_b16 v[32:33], v92 offset:0
  ds_read_b64_tr_b16 v[34:35], v92 offset:512
  ds_read_b64_tr_b16 v[36:37], v92 offset:1024
  ds_read_b64_tr_b16 v[38:39], v92 offset:1536
  ds_read_b64_tr_b16 v[40:41], v92 offset:2048
  ds_read_b64_tr_b16 v[42:43], v92 offset:2560
  ds_read_b64_tr_b16 v[44:45], v92 offset:3072
  ds_read_b64_tr_b16 v[46:47], v92 offset:3584
  s_waitcnt lgkmcnt(6)
  v_mfma_f32_16x16x32_bf16 v[52:55], v[192:195], v[32:35], 0
  ds_read_b64_tr_b16 v[48:49], v93 offset:40960
  v_mfma_f32_16x16x32_bf16 v[56:59], v[208:211], v[32:35], 0
  ds_read2st64_b64 v[16:19], v29 offset0:96 offset1:97
  s_waitcnt lgkmcnt(6)
  v_mfma_f32_16x16x32_bf16 v[52:55], v[196:199], v[36:39], v[52:55]
  ds_read_b64_tr_b16 v[50:51], v93 offset:41472
  v_mfma_f32_16x16x32_bf16 v[56:59], v[212:215], v[36:39], v[56:59]
  ds_read2st64_b64 v[20:23], v29 offset0:98 offset1:99
  s_waitcnt lgkmcnt(6)
  v_mfma_f32_16x16x32_bf16 v[52:55], v[200:203], v[40:43], v[52:55]
  v_mfma_f32_16x16x32_bf16 v[56:59], v[216:219], v[40:43], v[56:59]
  s_waitcnt lgkmcnt(4)
  v_mfma_f32_16x16x32_bf16 v[52:55], v[204:207], v[44:47], v[52:55]
  v_mfma_f32_16x16x32_bf16 v[56:59], v[220:223], v[44:47], v[56:59]
  s_cmp_eq_u32 s14, 63
  s_cbranch_scc1 RPX_115
  s_waitcnt lgkmcnt(0)
  v_mfma_f32_16x16x32_bf16 v[52:55], v[16:19], v[48:51], v[52:55]
  v_mfma_f32_16x16x32_bf16 v[56:59], v[20:23], v[48:51], v[56:59]
  s_nop 7
  v_add_f32_dpp v68, v56, v52 row_ror:8 row_mask:0xf bank_mask:0x3
  v_add_f32_dpp v69, v57, v53 row_ror:8 row_mask:0xf bank_mask:0x3
  v_add_f32_dpp v68, v54, v58 row_ror:8 row_mask:0xf bank_mask:0xc
  v_add_f32_dpp v69, v55, v59 row_ror:8 row_mask:0xf bank_mask:0xc
  v_cvt_pk_bf16_f32 v80, v68, v69
  buffer_store_dword v80, v4, s[4:7], s16 offen sc1
  v_lshlrev_b32 v68, 16, v80
  v_and_b32 v69, 0xffff0000, v80
  s_mov_b32 m0, s48
  s_nop 0
  buffer_load_dwordx4 v2, s[4:7], s40 offen offset:0 sc1 lds
  buffer_load_dwordx4 v2, s[4:7], s40 offen offset:1024 sc1 lds
  buffer_load_dwordx4 v2, s[4:7], s40 offen offset:2048 sc1 lds
  buffer_load_dwordx4 v2, s[4:7], s40 offen offset:3072 sc1 lds
  s_add_u32 m0, s48, 4096
  s_nop 0
  buffer_load_dwordx4 v2, s[4:7], s41 offen offset:0 sc1 lds
  s_mov_b32 s100, 4
SL_121:
  s_sleep 1
  s_sub_u32 s100, s100, 1
  s_cmp_lg_u32 s100, 0
  s_cbranch_scc1 SL_121
  buffer_load_dword v70, v5, s[4:7], s16 offen sc1
  buffer_load_dword v71, v6, s[4:7], s16 offen sc1
  buffer_load_dword v72, v7, s[4:7], s16 offen sc1
  v_mov_b64 v[224:225], 0
  v_mov_b64 v[226:227], 0
  v_mov_b64 v[228:229], 0
  v_mov_b64 v[230:231], 0
  v_mov_b64 v[232:233], 0
  v_mov_b64 v[234:235], 0
  v_mov_b64 v[236:237], 0
  v_mov_b64 v[238:239], 0
  v_mov_b64 v[240:241], 0
  v_mov_b64 v[242:243], 0
  v_mov_b64 v[244:245], 0
  v_mov_b64 v[246:247], 0
  v_mov_b64 v[248:249], 0
  v_mov_b64 v[250:251], 0
  v_mov_b64 v[252:253], 0
  v_mov_b64 v[254:255], 0
  s_branch P_124
P_123:
  buffer_load_dword v70, v5, s[4:7], s16 offen sc1
  buffer_load_dword v71, v6, s[4:7], s16 offen sc1
  buffer_load_dword v72, v7, s[4:7], s16 offen sc1
  s_add_u32 s101, s101, 1
  s_cmp_gt_u32 s101, 262144
  s_cbranch_scc1 L_abort
P_124:
  s_waitcnt vmcnt(0)
  v_max3_u32 v84, v70, v71, v72
  v_lshlrev_b32 v76, 16, v70
  v_and_b32 v77, 0xffff0000, v70
  v_lshlrev_b32 v78, 16, v71
  v_and_b32 v79, 0xffff0000, v71
  v_lshlrev_b32 v80, 16, v72
  v_and_b32 v81, 0xffff0000, v72
  v_cmp_eq_u32 vcc, -1, v84
  v_pk_add_f32 v[76:77], v[68:69], v[76:77]
  v_pk_add_f32 v[78:79], v[78:79], v[80:81]
  v_pk_add_f32 v[76:77], v[76:77], v[78:79]
  s_cbranch_vccnz P_123
EO_122:
  s_cmp_lt_i32 s14, 0
  s_cbranch_scc1 RW_125
  v_cvt_pk_bf16_f32 v86, v76, v77
RB_126:
  buffer_store_dword v86, v3, s[4:7], s43 offen
  s_branch P_130
P_129:
  s_mov_b32 m0, s48
  s_nop 0
  buffer_load_dwordx4 v2, s[4:7], s40 offen offset:0 sc1 lds
  buffer_load_dwordx4 v2, s[4:7], s40 offen offset:1024 sc1 lds
  buffer_load_dwordx4 v2, s[4:7], s40 offen offset:2048 sc1 lds
  buffer_load_dwordx4 v2, s[4:7], s40 offen offset:3072 sc1 lds
  s_add_u32 m0, s48, 4096
  s_nop 0
  buffer_load_dwordx4 v2, s[4:7], s41 offen offset:0 sc1 lds
  s_add_u32 s101, s101, 1
  s_cmp_gt_u32 s101, 262144
  s_cbranch_scc1 L_abort
  s_waitcnt vmcnt(0)
P_130:
  ds_read_b128 v[96:99], v15 offset:4096
  ds_read_b128 v[100:103], v15 offset:5120
  ds_read_b128 v[104:107], v15 offset:6144
  ds_read_b128 v[108:111], v15 offset:7168
  ds_read_b128 v[112:115], v15 offset:8192
  s_waitcnt lgkmcnt(0)
  v_max3_u32 v84, v96, v97, v98
  v_max3_u32 v85, v99, v100, v101
  v_max3_u32 v85, v85, v102, v103
  v_max3_u32 v84, v84, v104, v105
  v_max3_u32 v85, v85, v106, v107
  v_max3_u32 v84, v84, v108, v109
  v_max3_u32 v85, v85, v110, v111
  v_max3_u32 v84, v84, v112, v113
  v_max3_u32 v85, v85, v114, v115
  v_max_u32 v84, v84, v85
  v_cmp_eq_u32 vcc, -1, v84
  s_cbranch_vccnz P_129
  s_barrier
RP_128:
  s_cmp_lg_u32 s14, 0
  s_cbranch_scc1 RM_131
  s_bfe_u32 s15, s51, 0x20001
  s_lshl_b32 s15, s15, 5
  s_add_u32 s15, s15, s13
  s_add_u32 s15, s15, 98304
  s_mov_b64 exec, 0xff
MK_132:
  buffer_load_dword v84, v30, s[4:7], s15 offen sc1
  s_add_u32 s101, s101, 1
  s_cmp_gt_u32 s101, 262144
  s_cbranch_scc1 L_abort
  s_waitcnt vmcnt(0)
  v_cmp_gt_u32 vcc, 2, v84
  s_cbranch_vccnz MK_132
  s_mov_b64 exec, -1
RM_131:
  ds_read_b128 v[96:99], v2 offset:4096
  ds_read_b128 v[128:131], v2 offset:12288
  ds_read_b128 v[100:103], v2 offset:5120
  ds_read_b128 v[132:135], v2 offset:13312
  ds_read_b128 v[104:107], v2 offset:6144
  ds_read_b128 v[136:139], v2 offset:14336
  ds_read_b128 v[108:111], v2 offset:7168
  ds_read_b128 v[140:143], v2 offset:15360
  ds_read_b128 v[112:115], v2 offset:8192
  s_waitcnt lgkmcnt(8)
  v_mfma_f32_16x16x32_bf16 v[176:179], v[192:195], v[96:99], 0
  ds_read_b128 v[144:147], v2 offset:16384
  s_waitcnt lgkmcnt(8)
  v_mfma_f32_16x16x32_bf16 v[180:183], v[192:195], v[128:131], 0
  buffer_load_dwordx4 v[192:195], v9, s[4:7], s46 offen offset:0 sc1
  ds_read_b128 v[116:119], v2 offset:9216
  s_waitcnt lgkmcnt(8)
  v_mfma_f32_16x16x32_bf16 v[176:179], v[196:199], v[100:103], v[176:179]
  ds_read_b128 v[148:151], v2 offset:17408
  s_waitcnt lgkmcnt(8)
  v_mfma_f32_16x16x32_bf16 v[180:183], v[196:199], v[132:135], v[180:183]
  buffer_load_dwordx4 v[196:199], v9, s[4:7], s46 offen offset:1024 sc1
  ds_read_b128 v[120:123], v2 offset:10240
  s_waitcnt lgkmcnt(8)
  v_mfma_f32_16x16x32_bf16 v[176:179], v[200:203], v[104:107], v[176:179]
  ds_read_b128 v[152:155], v2 offset:18432
  s_waitcnt lgkmcnt(8)
  v_mfma_f32_16x16x32_bf16 v[180:183], v[200:203], v[136:139], v[180:183]
  buffer_load_dwordx4 v[200:203], v9, s[4:7], s46 offen offset:2048 sc1
  ds_read_b128 v[124:127], v2 offset:11264
  s_waitcnt lgkmcnt(8)
  v_mfma_f32_16x16x32_bf16 v[176:179], v[204:207], v[108:111], v[176:179]
  ds_read_b128 v[156:159], v2 offset:19456
  s_waitcnt lgkmcnt(8)
  v_mfma_f32_16x16x32_bf16 v[180:183], v[204:207], v[140:143], v[180:183]
  buffer_load_dwordx4 v[204:207], v9, s[4:7], s46 offen offset:3072 sc1
  ds_read_b128 v[160:163], v2 offset:20480
  s_waitcnt lgkmcnt(8)
  v_mfma_f32_16x16x32_bf16 v[176:179], v[208:211], v[112:115], v[176:179]
  ds_read_b128 v[168:171], v2 offset:22528
  s_waitcnt lgkmcnt(8)
  v_mfma_f32_16x16x32_bf16 v[180:183], v[208:211], v[144:147], v[180:183]
  buffer_load_dwordx4 v[208:211], v9, s[4:7], s47 offen offset:0 sc1
  ds_read_b128 v[164:167], v2 offset:21504
  s_waitcnt lgkmcnt(8)
  v_mfma_f32_16x16x32_bf16 v[176:179], v[212:215], v[116:119], v[176:179]
  ds_read_b128 v[172:175], v2 offset:23552
  s_waitcnt lgkmcnt(8)
  v_mfma_f32_16x16x32_bf16 v[180:183], v[212:215], v[148:151], v[180:183]
  buffer_load_dwordx4 v[212:215], v9, s[4:7], s47 offen offset:1024 sc1
  s_waitcnt lgkmcnt(7)
  v_mfma_f32_16x16x32_bf16 v[176:179], v[216:219], v[120:123], v[176:179]
  s_waitcnt lgkmcnt(6)
  v_mfma_f32_16x16x32_bf16 v[180:183], v[216:219], v[152:155], v[180:183]
  buffer_load_dwordx4 v[216:219], v9, s[4:7], s47 offen offset:2048 sc1
  s_waitcnt lgkmcnt(5)
  v_mfma_f32_16x16x32_bf16 v[176:179], v[220:223], v[124:127], v[176:179]
  s_waitcnt lgkmcnt(4)
  v_mfma_f32_16x16x32_bf16 v[180:183], v[220:223], v[156:159], v[180:183]
  buffer_load_dwordx4 v[220:223], v9, s[4:7], s47 offen offset:3072 sc1
  s_waitcnt lgkmcnt(3)
  v_mfma_f32_16x16x32_bf16 v[176:179], v[16:19], v[160:163], v[176:179]
  s_waitcnt lgkmcnt(2)
  v_mfma_f32_16x16x32_bf16 v[180:183], v[16:19], v[168:171], v[180:183]
  s_waitcnt lgkmcnt(1)
  v_mfma_f32_16x16x32_bf16 v[176:179], v[20:23], v[164:167], v[176:179]
  s_waitcnt lgkmcnt(0)
  v_mfma_f32_16x16x32_bf16 v[180:183], v[20:23], v[172:175], v[180:183]
  s_lshl_b32 s15, s55, 16
  s_lshl_b32 s31, s51, 10
  s_add_u32 s15, s15, s31
  s_add_u32 s15, s15, s13
  s_add_u32 s15, s15, 262144
  s_nop 2
  v_cvt_pk_bf16_f32 v184, v176, v177
  v_cvt_pk_bf16_f32 v185, v178, v179
  v_cvt_pk_bf16_f32 v186, v180, v181
  v_cvt_pk_bf16_f32 v187, v182, v183
  s_cmp_eq_u32 s14, 62
  s_cbranch_scc1 RA_133
  buffer_store_dwordx4 v[184:187], v2, s[4:7], s15 offen
  s_branch RA_134
RA_133:
  s_lshl_b32 s15, s94, 22
  s_sub_u32 s31, s14, 0
  s_lshl_b32 s31, s31, 16
  s_add_u32 s15, s15, s31
  s_lshl_b32 s31, s51, 10
  s_add_u32 s15, s15, s31
  s_add_u32 s15, s15, 0x4800000
  buffer_store_dwordx4 v[184:187], v2, s[4:7], s15 offen sc1
RA_134:
  s_lshl_b32 s49, s55, 14
  s_add_u32 s49, s49, s13
  s_cmp_ge_i32 s14, 0
  s_cbranch_scc1 RW_135
  s_lshl_b32 s31, s51, 13
  s_add_u32 s31, s31, s13
  v_lshlrev_b32 v84, 7, v1
  s_add_u32 s15, s31, 2621440
  buffer_load_dword v25, v84, s[4:7], s15 offen sc1
RW_135:
  s_add_u32 s14, s14, 1
  s_and_b32 s55, s14, 3
  s_lshl_b32 s33, s55, 14
  s_add_u32 s33, s33, s13
  s_lshl_b32 s15, s95, 12
  s_add_u32 m0, s15, 24576
  s_add_u32 s33, s33, s15
  s_add_u32 s33, s33, 524288
  s_lshl_b32 s40, s55, 15
  s_add_u32 s40, s40, s13
  s_add_u32 s40, s40, 131072
  s_mul_i32 s32, s95, 5120
  s_add_u32 s40, s40, s32
  s_add_u32 s41, s40, 4096
  v_add_u32 v15, s32, v2
  s_add_u32 s48, s32, 4096
  s_lshl_b32 s15, s55, 19
  s_add_u32 s16, s15, s52
  s_add_u32 s17, s16, 262144
  s_add_u32 s18, s15, s30
  s_add_u32 s19, s18, 262144
  s_add_u32 s53, s14, 1
  s_and_b32 s15, s53, 3
  s_lshl_b32 s43, s15, 14
  s_add_u32 s43, s43, s13
  s_and_b32 s46, s53, 1
  s_lshl_b32 s46, s46, 19
  s_add_u32 s46, s46, s13
  s_add_u32 s47, s46, 4096
  s_lshl_b32 s15, s55, 13
  s_add_u32 s15, s15, s13
  s_add_u32 s45, s15, 69632
  s_lshl_b32 s32, s95, 8
  s_add_u32 s45, s45, s32
  s_lshl_b32 s32, s95, 10
  s_add_u32 s15, s15, s32
  s_add_u32 s44, s15, 65536
  v_add_u32 v87, s32, v2
  s_cmp_eq_u32 s14, 0
  s_cbranch_scc1 Rf_loop_top
  s_waitcnt vmcnt(1)
  buffer_store_dword v88, v3, s[4:7], s49 offen
  s_branch Rf_loop_top
RP_127:
P_136:
  s_mov_b32 m0, s48
  s_nop 0
  buffer_load_dwordx4 v2, s[4:7], s40 offen offset:0 sc1 lds
  buffer_load_dwordx4 v2, s[4:7], s40 offen offset:1024 sc1 lds
  buffer_load_dwordx4 v2, s[4:7], s40 offen offset:2048 sc1 lds
  buffer_load_dwordx4 v2, s[4:7], s40 offen offset:3072 sc1 lds
  s_add_u32 m0, s48, 4096
  s_nop 0
  buffer_load_dwordx4 v2, s[4:7], s41 offen offset:0 sc1 lds
  s_add_u32 s101, s101, 1
  s_cmp_gt_u32 s101, 262144
  s_cbranch_scc1 L_abort
  s_waitcnt vmcnt(0)
P_137:
  ds_read_b128 v[96:99], v15 offset:4096
  ds_read_b128 v[100:103], v15 offset:5120
  ds_read_b128 v[104:107], v15 offset:6144
  ds_read_b128 v[108:111], v15 offset:7168
  ds_read_b128 v[112:115], v15 offset:8192
  s_waitcnt lgkmcnt(0)
  v_max3_u32 v84, v96, v97, v98
  v_max3_u32 v85, v99, v100, v101
  v_max3_u32 v85, v85, v102, v103
  v_max3_u32 v84, v84, v104, v105
  v_max3_u32 v85, v85, v106, v107
  v_max3_u32 v84, v84, v108, v109
  v_max3_u32 v85, v85, v110, v111
  v_max3_u32 v84, v84, v112, v113
  v_max3_u32 v85, v85, v114, v115
  v_max_u32 v84, v84, v85
  v_cmp_eq_u32 vcc, -1, v84
  s_cbranch_vccnz P_136
  s_barrier
  s_branch RP_128
RW_125:
  v_mov_b32 v86, v10
  s_branch RB_126
RPX_115:
P_138:
  s_mov_b32 m0, s48
  s_nop 0
  buffer_load_dwordx4 v2, s[4:7], s40 offen offset:0 sc1 lds
  buffer_load_dwordx4 v2, s[4:7], s40 offen offset:1024 sc1 lds
  buffer_load_dwordx4 v2, s[4:7], s40 offen offset:2048 sc1 lds
  buffer_load_dwordx4 v2, s[4:7], s40 offen offset:3072 sc1 lds
  s_add_u32 m0, s48, 4096
  s_nop 0
  buffer_load_dwordx4 v2, s[4:7], s41 offen offset:0 sc1 lds
  s_add_u32 s101, s101, 1
  s_cmp_gt_u32 s101, 262144
  s_cbranch_scc1 L_abort
  s_waitcnt vmcnt(0)
P_139:
  ds_read_b128 v[96:99], v15 offset:4096
  ds_read_b128 v[100:103], v15 offset:5120
  ds_read_b128 v[104:107], v15 offset:6144
  ds_read_b128 v[108:111], v15 offset:7168
  ds_read_b128 v[112:115], v15 offset:8192
  s_waitcnt lgkmcnt(0)
  v_max3_u32 v84, v96, v97, v98
  v_max3_u32 v85, v99, v100, v101
  v_max3_u32 v85, v85, v102, v103
  v_max3_u32 v84, v84, v104, v105
  v_max3_u32 v85, v85, v106, v107
  v_max3_u32 v84, v84, v108, v109
  v_max3_u32 v85, v85, v110, v111
  v_max3_u32 v84, v84, v112, v113
  v_max3_u32 v85, v85, v114, v115
  v_max_u32 v84, v84, v85
  v_cmp_eq_u32 vcc, -1, v84
  s_cbranch_vccnz P_138
  s_barrier
  ds_read_b128 v[96:99], v2 offset:4096
  ds_read_b128 v[128:131], v2 offset:12288
  ds_read_b128 v[100:103], v2 offset:5120
  ds_read_b128 v[132:135], v2 offset:13312
  ds_read_b128 v[104:107], v2 offset:6144
  ds_read_b128 v[136:139], v2 offset:14336
  ds_read_b128 v[108:111], v2 offset:7168
  ds_read_b128 v[140:143], v2 offset:15360
  ds_read_b128 v[112:115], v2 offset:8192
  s_waitcnt lgkmcnt(8)
  v_mfma_f32_16x16x32_bf16 v[176:179], v[192:195], v[96:99], 0
  ds_read_b128 v[144:147], v2 offset:16384
  s_waitcnt lgkmcnt(8)
  v_mfma_f32_16x16x32_bf16 v[180:183], v[192:195], v[128:131], 0
  ds_read_b128 v[116:119], v2 offset:9216
  s_waitcnt lgkmcnt(8)
  v_mfma_f32_16x16x32_bf16 v[176:179], v[196:199], v[100:103], v[176:179]
  ds_read_b128 v[148:151], v2 offset:17408
  s_waitcnt lgkmcnt(8)
  v_mfma_f32_16x16x32_bf16 v[180:183], v[196:199], v[132:135], v[180:183]
  ds_read_b128 v[120:123], v2 offset:10240
  s_waitcnt lgkmcnt(8)
  v_mfma_f32_16x16x32_bf16 v[176:179], v[200:203], v[104:107], v[176:179]
  ds_read_b128 v[152:155], v2 offset:18432
  s_waitcnt lgkmcnt(8)
  v_mfma_f32_16x16x32_bf16 v[180:183], v[200:203], v[136:139], v[180:183]
  ds_read_b128 v[124:127], v2 offset:11264
  s_waitcnt lgkmcnt(8)
  v_mfma_f32_16x16x32_bf16 v[176:179], v[204:207], v[108:111], v[176:179]
  ds_read_b128 v[156:159], v2 offset:19456
  s_waitcnt lgkmcnt(8)
  v_mfma_f32_16x16x32_bf16 v[180:183], v[204:207], v[140:143], v[180:183]
  ds_read_b128 v[160:163], v2 offset:20480
  s_waitcnt lgkmcnt(8)
  v_mfma_f32_16x16x32_bf16 v[176:179], v[208:211], v[112:115], v[176:179]
  ds_read_b128 v[168:171], v2 offset:22528
  s_waitcnt lgkmcnt(8)
  v_mfma_f32_16x16x32_bf16 v[180:183], v[208:211], v[144:147], v[180:183]
  ds_read_b128 v[164:167], v2 offset:21504
  s_waitcnt lgkmcnt(8)
  v_mfma_f32_16x16x32_bf16 v[176:179], v[212:215], v[116:119], v[176:179]
  ds_read_b128 v[172:175], v2 offset:23552
  s_waitcnt lgkmcnt(8)
  v_mfma_f32_16x16x32_bf16 v[180:183], v[212:215], v[148:151], v[180:183]
  s_waitcnt lgkmcnt(7)
  v_mfma_f32_16x16x32_bf16 v[176:179], v[216:219], v[120:123], v[176:179]
  s_waitcnt lgkmcnt(6)
  v_mfma_f32_16x16x32_bf16 v[180:183], v[216:219], v[152:155], v[180:183]
  s_waitcnt lgkmcnt(5)
  v_mfma_f32_16x16x32_bf16 v[176:179], v[220:223], v[124:127], v[176:179]
  s_waitcnt lgkmcnt(4)
  v_mfma_f32_16x16x32_bf16 v[180:183], v[220:223], v[156:159], v[180:183]
  s_waitcnt lgkmcnt(3)
  v_mfma_f32_16x16x32_bf16 v[176:179], v[16:19], v[160:163], v[176:179]
  s_waitcnt lgkmcnt(2)
  v_mfma_f32_16x16x32_bf16 v[180:183], v[16:19], v[168:171], v[180:183]
  s_waitcnt lgkmcnt(1)
  v_mfma_f32_16x16x32_bf16 v[176:179], v[20:23], v[164:167], v[176:179]
  s_waitcnt lgkmcnt(0)
  v_mfma_f32_16x16x32_bf16 v[180:183], v[20:23], v[172:175], v[180:183]
  s_nop 7
  v_cvt_pk_bf16_f32 v184, v176, v177
  v_cvt_pk_bf16_f32 v185, v178, v179
  v_cvt_pk_bf16_f32 v186, v180, v181
  v_cvt_pk_bf16_f32 v187, v182, v183
  s_lshl_b32 s15, s94, 22
  s_sub_u32 s31, s14, 0
  s_lshl_b32 s31, s31, 16
  s_add_u32 s15, s15, s31
  s_lshl_b32 s31, s51, 10
  s_add_u32 s15, s15, s31
  s_add_u32 s15, s15, 0x4800000
  buffer_store_dwordx4 v[184:187], v2, s[4:7], s15 offen sc1
  s_branch L_end
R_slow:
  v_mov_b32 v88, -1
  v_mov_b32 v89, -1
  s_and_b32 s15, s98, 2
  s_lshl_b32 s15, s15, 12
  s_add_u32 s30, s52, s15
  s_add_u32 s30, s30, 2097152
  s_and_b32 s15, s98, 1
  s_lshl_b32 s15, s15, 13
  s_add_u32 s52, s52, s15
  s_add_u32 s15, s13, 49152
  buffer_store_dword v10, v3, s[4:7], s15 offen sc1
  s_lshl_b32 s15, s51, 13
  s_add_u32 s15, s15, s13
  s_and_b32 s31, s51, 7
  s_lshl_b32 s31, s31, 13
  s_add_u32 s31, s31, s13
  s_add_u32 s31, s31, 524288
  v_lshlrev_b32 v84, 7, v1
  buffer_load_dword v96, v84, s[4:7], s15 offen sc1
  buffer_load_dword v97, v84, s[4:7], s31 offen sc1
Rs_loop:
  s_and_b32 s55, s14, 3
  s_lshl_b32 s33, s55, 14
  s_add_u32 s33, s33, s13
  s_lshl_b32 s15, s95, 12
  s_add_u32 m0, s15, 24576
  s_add_u32 s33, s33, s15
  s_add_u32 s33, s33, 524288
  s_lshl_b32 s40, s55, 15
  s_add_u32 s40, s40, s13
  s_add_u32 s40, s40, 131072
  s_mul_i32 s32, s95, 5120
  s_add_u32 s40, s40, s32
  s_add_u32 s41, s40, 4096
  v_add_u32 v15, s32, v2
  s_add_u32 s48, s32, 4096
  s_lshl_b32 s15, s55, 19
  s_add_u32 s16, s15, s52
  s_add_u32 s17, s16, 262144
  s_add_u32 s18, s15, s30
  s_add_u32 s19, s18, 262144
  s_add_u32 s53, s14, 1
  s_and_b32 s15, s53, 3
  s_lshl_b32 s43, s15, 14
  s_add_u32 s43, s43, s13
  s_and_b32 s46, s53, 1
  s_lshl_b32 s46, s46, 19
  s_add_u32 s46, s46, s13
  s_add_u32 s47, s46, 4096
  s_lshl_b32 s15, s55, 13
  s_add_u32 s15, s15, s13
  s_add_u32 s45, s15, 69632
  s_lshl_b32 s32, s95, 8
  s_add_u32 s45, s45, s32
  s_lshl_b32 s32, s95, 10
  s_add_u32 s15, s15, s32
  s_add_u32 s44, s15, 65536
  v_add_u32 v87, s32, v2
  v_mov_b64 v[224:225], 0
  v_mov_b64 v[226:227], 0
  v_mov_b64 v[228:229], 0
  v_mov_b64 v[230:231], 0
  v_mov_b64 v[232:233], 0
  v_mov_b64 v[234:235], 0
  v_mov_b64 v[236:237], 0
  v_mov_b64 v[238:239], 0
  v_mov_b64 v[240:241], 0
  v_mov_b64 v[242:243], 0
  v_mov_b64 v[244:245], 0
  v_mov_b64 v[246:247], 0
  v_mov_b64 v[248:249], 0
  v_mov_b64 v[250:251], 0
  v_mov_b64 v[252:253], 0
  v_mov_b64 v[254:255], 0
Rs_loop_top:
  s_mov_b32 s100, 5
SL_141:
  s_sleep 1
  s_sub_u32 s100, s100, 1
  s_cmp_lg_u32 s100, 0
  s_cbranch_scc1 SL_141
P_142:
  buffer_load_dwordx4 v2, s[4:7], s33 offen offset:0 sc1 lds
  buffer_load_dwordx4 v2, s[4:7], s33 offen offset:1024 sc1 lds
  buffer_load_dwordx4 v2, s[4:7], s33 offen offset:2048 sc1 lds
  buffer_load_dwordx4 v2, s[4:7], s33 offen offset:3072 sc1 lds
  s_add_u32 s101, s101, 1
  s_cmp_gt_u32 s101, 262144
  s_cbranch_scc1 L_abort
  s_waitcnt vmcnt(3)
  ds_read_b64_tr_b16 v[96:97], v11 offset:24576
  ds_read_b64_tr_b16 v[98:99], v11 offset:24832
  s_waitcnt vmcnt(2)
  ds_read_b64_tr_b16 v[100:101], v11 offset:25600
  ds_read_b64_tr_b16 v[102:103], v11 offset:25856
  s_waitcnt vmcnt(1)
  ds_read_b64_tr_b16 v[104:105], v11 offset:26624
  ds_read_b64_tr_b16 v[106:107], v11 offset:26880
  s_waitcnt vmcnt(0)
  ds_read_b64_tr_b16 v[108:109], v11 offset:27648
  ds_read_b64_tr_b16 v[110:111], v11 offset:27904
  s_waitcnt lgkmcnt(4)
  v_pk_max_u16 v84, v96, v97
  v_pk_max_u16 v85, v98, v99
  v_pk_max_u16 v84, v84, v100
  v_pk_max_u16 v85, v85, v101
  v_pk_max_u16 v84, v84, v102
  v_pk_max_u16 v85, v85, v103
  s_waitcnt lgkmcnt(0)
  v_pk_max_u16 v84, v84, v104
  v_pk_max_u16 v85, v85, v105
  v_pk_max_u16 v84, v84, v106
  v_pk_max_u16 v85, v85, v107
  v_pk_max_u16 v84, v84, v108
  v_pk_max_u16 v85, v85, v109
  v_pk_max_u16 v84, v84, v110
  v_pk_max_u16 v85, v85, v111
  v_pk_max_u16 v84, v84, v85
  v_pk_max_u16 v84, v84, v84 op_sel:[0,1] op_sel_hi:[1,0]
  s_nop 0
  v_cmp_eq_u32 vcc, -1, v84
  s_cbranch_vccnz P_142
  v_smfmac_f32_16x16x64_bf16 v[224:227], v[96:99], a[0:7], v12
  v_smfmac_f32_16x16x64_bf16 v[228:231], v[104:107], a[16:23], v12
  v_smfmac_f32_16x16x64_bf16 v[232:235], v[96:99], a[32:39], v12
  v_smfmac_f32_16x16x64_bf16 v[236:239], v[104:107], a[48:55], v12
  v_smfmac_f32_16x16x64_bf16 v[240:243], v[96:99], a[64:71], v12
  v_smfmac_f32_16x16x64_bf16 v[244:247], v[104:107], a[80:87], v12
  v_smfmac_f32_16x16x64_bf16 v[248:251], v[96:99], a[96:103], v12
  v_smfmac_f32_16x16x64_bf16 v[252:255], v[104:107], a[112:119], v12
  v_smfmac_f32_16x16x64_bf16 v[224:227], v[100:103], a[8:15], v12
  v_smfmac_f32_16x16x64_bf16 v[228:231], v[108:111], a[24:31], v12
  buffer_load_dwordx4 v[24:27], v2, s[4:7], s44 offen sc1
  buffer_load_dword v28, v30, s[4:7], s45 offen sc1
  v_smfmac_f32_16x16x64_bf16 v[232:235], v[100:103], a[40:47], v12
  v_smfmac_f32_16x16x64_bf16 v[236:239], v[108:111], a[56:63], v12
  v_smfmac_f32_16x16x64_bf16 v[240:243], v[100:103], a[72:79], v12
  v_smfmac_f32_16x16x64_bf16 v[244:247], v[108:111], a[88:95], v12
  v_smfmac_f32_16x16x64_bf16 v[248:251], v[100:103], a[104:111], v12
  v_smfmac_f32_16x16x64_bf16 v[252:255], v[108:111], a[120:127], v12
  s_nop 0
  v_pk_add_f32 v[224:225], v[224:225], v[226:227]
  v_pk_add_f32 v[228:229], v[228:229], v[230:231]
  v_pk_add_f32 v[232:233], v[232:233], v[234:235]
  v_pk_add_f32 v[236:237], v[236:237], v[238:239]
  v_pk_add_f32 v[240:241], v[240:241], v[242:243]
  v_pk_add_f32 v[244:245], v[244:245], v[246:247]
  v_pk_add_f32 v[248:249], v[248:249], v[250:251]
  v_pk_add_f32 v[252:253], v[252:253], v[254:255]
  v_cvt_pk_bf16_f32 v112, v224, v225
  v_cvt_pk_bf16_f32 v113, v228, v229
  ds_write_b64 v8, v[112:113] offset:49152
  v_cvt_pk_bf16_f32 v114, v232, v233
  v_cvt_pk_bf16_f32 v115, v236, v237
  ds_write_b64 v8, v[114:115] offset:51200
  v_cvt_pk_bf16_f32 v116, v240, v241
  v_cvt_pk_bf16_f32 v117, v244, v245
  ds_write_b64 v8, v[116:117] offset:53248
  v_cvt_pk_bf16_f32 v118, v248, v249
  v_cvt_pk_bf16_f32 v119, v252, v253
  ds_write_b64 v8, v[118:119] offset:55296
  s_cmp_lg_u32 s14, 0
  s_cbranch_scc1 RZ_143
  s_bfe_u32 s15, s51, 0x20001
  s_lshl_b32 s15, s15, 5
  s_add_u32 s15, s15, s13
  s_add_u32 s15, s15, 98304
  s_mov_b64 exec, 0xff
MK_144:
  buffer_load_dword v84, v30, s[4:7], s15 offen sc1
  s_add_u32 s101, s101, 1
  s_cmp_gt_u32 s101, 262144
  s_cbranch_scc1 L_abort
  s_waitcnt vmcnt(0)
  v_cmp_gt_u32 vcc, 1, v84
  s_cbranch_vccnz MK_144
  s_mov_b64 exec, -1
  s_add_u32 s15, s13, 4096
  buffer_load_dwordx4 v[192:195], v9, s[4:7], s13 offen offset:0 sc1
  buffer_load_dwordx4 v[196:199], v9, s[4:7], s13 offen offset:1024 sc1
  buffer_load_dwordx4 v[200:203], v9, s[4:7], s13 offen offset:2048 sc1
  buffer_load_dwordx4 v[204:207], v9, s[4:7], s13 offen offset:3072 sc1
  buffer_load_dwordx4 v[208:211], v9, s[4:7], s15 offen offset:0 sc1
  buffer_load_dwordx4 v[212:215], v9, s[4:7], s15 offen offset:1024 sc1
  buffer_load_dwordx4 v[216:219], v9, s[4:7], s15 offen offset:2048 sc1
  buffer_load_dwordx4 v[220:223], v9, s[4:7], s15 offen offset:3072 sc1
  s_add_u32 s15, s13, 49152
  s_waitcnt vmcnt(0)
  buffer_store_dword v88, v3, s[4:7], s15 offen sc1
RZ_143:
P_145:
  buffer_load_dwordx4 v[24:27], v2, s[4:7], s44 offen sc1
  buffer_load_dword v28, v30, s[4:7], s45 offen sc1
  s_add_u32 s101, s101, 1
  s_cmp_gt_u32 s101, 262144
  s_cbranch_scc1 L_abort
  s_waitcnt vmcnt(2)
  v_max3_u32 v84, v24, v25, v26
  v_max3_u32 v84, v84, v27, v28
  v_cmp_eq_u32 vcc, -1, v84
  s_cbranch_vccnz P_145
  ds_write_b128 v87, v[24:27] offset:0
  ds_write_b32 v31, v28 offset:40960
  s_waitcnt lgkmcnt(0)
  s_barrier
  ds_read_b64_tr_b16 v[32:33], v92 offset:0
  ds_read_b64_tr_b16 v[34:35], v92 offset:512
  ds_read_b64_tr_b16 v[36:37], v92 offset:1024
  ds_read_b64_tr_b16 v[38:39], v92 offset:1536
  ds_read_b64_tr_b16 v[40:41], v92 offset:2048
  ds_read_b64_tr_b16 v[42:43], v92 offset:2560
  ds_read_b64_tr_b16 v[44:45], v92 offset:3072
  ds_read_b64_tr_b16 v[46:47], v92 offset:3584
  s_waitcnt lgkmcnt(6)
  v_mfma_f32_16x16x32_bf16 v[52:55], v[192:195], v[32:35], 0
  ds_read_b64_tr_b16 v[48:49], v93 offset:40960
  v_mfma_f32_16x16x32_bf16 v[56:59], v[208:211], v[32:35], 0
  ds_read2st64_b64 v[16:19], v29 offset0:96 offset1:97
  s_waitcnt lgkmcnt(6)
  v_mfma_f32_16x16x32_bf16 v[52:55], v[196:199], v[36:39], v[52:55]
  ds_read_b64_tr_b16 v[50:51], v93 offset:41472
  v_mfma_f32_16x16x32_bf16 v[56:59], v[212:215], v[36:39], v[56:59]
  ds_read2st64_b64 v[20:23], v29 offset0:98 offset1:99
  s_waitcnt lgkmcnt(6)
  v_mfma_f32_16x16x32_bf16 v[52:55], v[200:203], v[40:43], v[52:55]
  v_mfma_f32_16x16x32_bf16 v[56:59], v[216:219], v[40:43], v[56:59]
  s_waitcnt lgkmcnt(4)
  v_mfma_f32_16x16x32_bf16 v[52:55], v[204:207], v[44:47], v[52:55]
  v_mfma_f32_16x16x32_bf16 v[56:59], v[220:223], v[44:47], v[56:59]
  s_cmp_eq_u32 s14, 63
  s_cbranch_scc1 RPX_140
  s_waitcnt lgkmcnt(0)
  v_mfma_f32_16x16x32_bf16 v[52:55], v[16:19], v[48:51], v[52:55]
  v_mfma_f32_16x16x32_bf16 v[56:59], v[20:23], v[48:51], v[56:59]
  s_nop 7
  v_add_f32_dpp v68, v56, v52 row_ror:8 row_mask:0xf bank_mask:0x3
  v_add_f32_dpp v69, v57, v53 row_ror:8 row_mask:0xf bank_mask:0x3
  v_add_f32_dpp v68, v54, v58 row_ror:8 row_mask:0xf bank_mask:0xc
  v_add_f32_dpp v69, v55, v59 row_ror:8 row_mask:0xf bank_mask:0xc
  v_cvt_pk_bf16_f32 v80, v68, v69
  buffer_store_dword v80, v4, s[4:7], s16 offen sc1
  v_lshlrev_b32 v68, 16, v80
  v_and_b32 v69, 0xffff0000, v80
  s_mov_b32 m0, s48
  s_nop 0
  buffer_load_dwordx4 v2, s[4:7], s40 offen offset:0 sc1 lds
  buffer_load_dwordx4 v2, s[4:7], s40 offen offset:1024 sc1 lds
  buffer_load_dwordx4 v2, s[4:7], s40 offen offset:2048 sc1 lds
  buffer_load_dwordx4 v2, s[4:7], s40 offen offset:3072 sc1 lds
  s_add_u32 m0, s48, 4096
  s_nop 0
  buffer_load_dwordx4 v2, s[4:7], s41 offen offset:0 sc1 lds
  s_mov_b32 s100, 4
SL_146:
  s_sleep 1
  s_sub_u32 s100, s100, 1
  s_cmp_lg_u32 s100, 0
  s_cbranch_scc1 SL_146
  buffer_load_dword v70, v5, s[4:7], s16 offen sc1
  buffer_load_dword v71, v6, s[4:7], s16 offen sc1
  buffer_load_dword v72, v7, s[4:7], s16 offen sc1
  v_mov_b64 v[224:225], 0
  v_mov_b64 v[226:227], 0
  v_mov_b64 v[228:229], 0
  v_mov_b64 v[230:231], 0
  v_mov_b64 v[232:233], 0
  v_mov_b64 v[234:235], 0
  v_mov_b64 v[236:237], 0
  v_mov_b64 v[238:239], 0
  v_mov_b64 v[240:241], 0
  v_mov_b64 v[242:243], 0
  v_mov_b64 v[244:245], 0
  v_mov_b64 v[246:247], 0
  v_mov_b64 v[248:249], 0
  v_mov_b64 v[250:251], 0
  v_mov_b64 v[252:253], 0
  v_mov_b64 v[254:255], 0
  s_branch P_149
P_148:
  buffer_load_dword v70, v5, s[4:7], s16 offen sc1
  buffer_load_dword v71, v6, s[4:7], s16 offen sc1
  buffer_load_dword v72, v7, s[4:7], s16 offen sc1
  s_add_u32 s101, s101, 1
  s_cmp_gt_u32 s101, 262144
  s_cbranch_scc1 L_abort
P_149:
  s_waitcnt vmcnt(0)
  v_max3_u32 v84, v70, v71, v72
  v_lshlrev_b32 v76, 16, v70
  v_and_b32 v77, 0xffff0000, v70
  v_lshlrev_b32 v78, 16, v71
  v_and_b32 v79, 0xffff0000, v71
  v_lshlrev_b32 v80, 16, v72
  v_and_b32 v81, 0xffff0000, v72
  v_cmp_eq_u32 vcc, -1, v84
  v_pk_add_f32 v[76:77], v[68:69], v[76:77]
  v_pk_add_f32 v[78:79], v[78:79], v[80:81]
  v_pk_add_f32 v[76:77], v[76:77], v[78:79]
  s_cbranch_vccnz P_148
EO_147:
  s_cmp_lt_i32 s14, 0
  s_cbranch_scc1 RW_150
  v_cvt_pk_bf16_f32 v86, v76, v77
RB_151:
  buffer_store_dword v86, v3, s[4:7], s43 offen sc1
  s_branch P_155
P_154:
  s_mov_b32 m0, s48
  s_nop 0
  buffer_load_dwordx4 v2, s[4:7], s40 offen offset:0 sc1 lds
  buffer_load_dwordx4 v2, s[4:7], s40 offen offset:1024 sc1 lds
  buffer_load_dwordx4 v2, s[4:7], s40 offen offset:2048 sc1 lds
  buffer_load_dwordx4 v2, s[4:7], s40 offen offset:3072 sc1 lds
  s_add_u32 m0, s48, 4096
  s_nop 0
  buffer_load_dwordx4 v2, s[4:7], s41 offen offset:0 sc1 lds
  s_add_u32 s101, s101, 1
  s_cmp_gt_u32 s101, 262144
  s_cbranch_scc1 L_abort
  s_waitcnt vmcnt(0)
P_155:
  ds_read_b128 v[96:99], v15 offset:4096
  ds_read_b128 v[100:103], v15 offset:5120
  ds_read_b128 v[104:107], v15 offset:6144
  ds_read_b128 v[108:111], v15 offset:7168
  ds_read_b128 v[112:115], v15 offset:8192
  s_waitcnt lgkmcnt(0)
  v_max3_u32 v84, v96, v97, v98
  v_max3_u32 v85, v99, v100, v101
  v_max3_u32 v85, v85, v102, v103
  v_max3_u32 v84, v84, v104, v105
  v_max3_u32 v85, v85, v106, v107
  v_max3_u32 v84, v84, v108, v109
  v_max3_u32 v85, v85, v110, v111
  v_max3_u32 v84, v84, v112, v113
  v_max3_u32 v85, v85, v114, v115
  v_max_u32 v84, v84, v85
  v_cmp_eq_u32 vcc, -1, v84
  s_cbranch_vccnz P_154
  s_barrier
RP_153:
  s_cmp_lg_u32 s14, 0
  s_cbranch_scc1 RM_156
  s_bfe_u32 s15, s51, 0x20001
  s_lshl_b32 s15, s15, 5
  s_add_u32 s15, s15, s13
  s_add_u32 s15, s15, 98304
  s_mov_b64 exec, 0xff
MK_157:
  buffer_load_dword v84, v30, s[4:7], s15 offen sc1
  s_add_u32 s101, s101, 1
  s_cmp_gt_u32 s101, 262144
  s_cbranch_scc1 L_abort
  s_waitcnt vmcnt(0)
  v_cmp_gt_u32 vcc, 2, v84
  s_cbranch_vccnz MK_157
  s_mov_b64 exec, -1
RM_156:
  ds_read_b128 v[96:99], v2 offset:4096
  ds_read_b128 v[128:131], v2 offset:12288
  ds_read_b128 v[100:103], v2 offset:5120
  ds_read_b128 v[132:135], v2 offset:13312
  ds_read_b128 v[104:107], v2 offset:6144
  ds_read_b128 v[136:139], v2 offset:14336
  ds_read_b128 v[108:111], v2 offset:7168
  ds_read_b128 v[140:143], v2 offset:15360
  ds_read_b128 v[112:115], v2 offset:8192
  s_waitcnt lgkmcnt(8)
  v_mfma_f32_16x16x32_bf16 v[176:179], v[192:195], v[96:99], 0
  ds_read_b128 v[144:147], v2 offset:16384
  s_waitcnt lgkmcnt(8)
  v_mfma_f32_16x16x32_bf16 v[180:183], v[192:195], v[128:131], 0
  buffer_load_dwordx4 v[192:195], v9, s[4:7], s46 offen offset:0 sc1
  ds_read_b128 v[116:119], v2 offset:9216
  s_waitcnt lgkmcnt(8)
  v_mfma_f32_16x16x32_bf16 v[176:179], v[196:199], v[100:103], v[176:179]
  ds_read_b128 v[148:151], v2 offset:17408
  s_waitcnt lgkmcnt(8)
  v_mfma_f32_16x16x32_bf16 v[180:183], v[196:199], v[132:135], v[180:183]
  buffer_load_dwordx4 v[196:199], v9, s[4:7], s46 offen offset:1024 sc1
  ds_read_b128 v[120:123], v2 offset:10240
  s_waitcnt lgkmcnt(8)
  v_mfma_f32_16x16x32_bf16 v[176:179], v[200:203], v[104:107], v[176:179]
  ds_read_b128 v[152:155], v2 offset:18432
  s_waitcnt lgkmcnt(8)
  v_mfma_f32_16x16x32_bf16 v[180:183], v[200:203], v[136:139], v[180:183]
  buffer_load_dwordx4 v[200:203], v9, s[4:7], s46 offen offset:2048 sc1
  ds_read_b128 v[124:127], v2 offset:11264
  s_waitcnt lgkmcnt(8)
  v_mfma_f32_16x16x32_bf16 v[176:179], v[204:207], v[108:111], v[176:179]
  ds_read_b128 v[156:159], v2 offset:19456
  s_waitcnt lgkmcnt(8)
  v_mfma_f32_16x16x32_bf16 v[180:183], v[204:207], v[140:143], v[180:183]
  buffer_load_dwordx4 v[204:207], v9, s[4:7], s46 offen offset:3072 sc1
  ds_read_b128 v[160:163], v2 offset:20480
  s_waitcnt lgkmcnt(8)
  v_mfma_f32_16x16x32_bf16 v[176:179], v[208:211], v[112:115], v[176:179]
  ds_read_b128 v[168:171], v2 offset:22528
  s_waitcnt lgkmcnt(8)
  v_mfma_f32_16x16x32_bf16 v[180:183], v[208:211], v[144:147], v[180:183]
  buffer_load_dwordx4 v[208:211], v9, s[4:7], s47 offen offset:0 sc1
  ds_read_b128 v[164:167], v2 offset:21504
  s_waitcnt lgkmcnt(8)
  v_mfma_f32_16x16x32_bf16 v[176:179], v[212:215], v[116:119], v[176:179]
  ds_read_b128 v[172:175], v2 offset:23552
  s_waitcnt lgkmcnt(8)
  v_mfma_f32_16x16x32_bf16 v[180:183], v[212:215], v[148:151], v[180:183]
  buffer_load_dwordx4 v[212:215], v9, s[4:7], s47 offen offset:1024 sc1
  s_waitcnt lgkmcnt(7)
  v_mfma_f32_16x16x32_bf16 v[176:179], v[216:219], v[120:123], v[176:179]
  s_waitcnt lgkmcnt(6)
  v_mfma_f32_16x16x32_bf16 v[180:183], v[216:219], v[152:155], v[180:183]
  buffer_load_dwordx4 v[216:219], v9, s[4:7], s47 offen offset:2048 sc1
  s_waitcnt lgkmcnt(5)
  v_mfma_f32_16x16x32_bf16 v[176:179], v[220:223], v[124:127], v[176:179]
  s_waitcnt lgkmcnt(4)
  v_mfma_f32_16x16x32_bf16 v[180:183], v[220:223], v[156:159], v[180:183]
  buffer_load_dwordx4 v[220:223], v9, s[4:7], s47 offen offset:3072 sc1
  s_waitcnt lgkmcnt(3)
  v_mfma_f32_16x16x32_bf16 v[176:179], v[16:19], v[160:163], v[176:179]
  s_waitcnt lgkmcnt(2)
  v_mfma_f32_16x16x32_bf16 v[180:183], v[16:19], v[168:171], v[180:183]
  s_waitcnt lgkmcnt(1)
  v_mfma_f32_16x16x32_bf16 v[176:179], v[20:23], v[164:167], v[176:179]
  s_waitcnt lgkmcnt(0)
  v_mfma_f32_16x16x32_bf16 v[180:183], v[20:23], v[172:175], v[180:183]
  s_lshl_b32 s15, s55, 16
  s_lshl_b32 s31, s51, 10
  s_add_u32 s15, s15, s31
  s_add_u32 s15, s15, s13
  s_add_u32 s15, s15, 262144
  s_nop 2
  v_cvt_pk_bf16_f32 v184, v176, v177
  v_cvt_pk_bf16_f32 v185, v178, v179
  v_cvt_pk_bf16_f32 v186, v180, v181
  v_cvt_pk_bf16_f32 v187, v182, v183
  s_cmp_eq_u32 s14, 62
  s_cbranch_scc1 RA_158
  buffer_store_dwordx4 v[184:187], v2, s[4:7], s15 offen sc1
  s_branch RA_159
RA_158:
  s_lshl_b32 s15, s94, 22
  s_sub_u32 s31, s14, 0
  s_lshl_b32 s31, s31, 16
  s_add_u32 s15, s15, s31
  s_lshl_b32 s31, s51, 10
  s_add_u32 s15, s15, s31
  s_add_u32 s15, s15, 0x4800000
  buffer_store_dwordx4 v[184:187], v2, s[4:7], s15 offen sc1
RA_159:
  s_lshl_b32 s49, s55, 14
  s_add_u32 s49, s49, s13
  s_cmp_ge_i32 s14, 0
  s_cbranch_scc1 RW_160
  s_lshl_b32 s31, s51, 13
  s_add_u32 s31, s31, s13
  v_lshlrev_b32 v84, 7, v1
  s_add_u32 s15, s31, 2621440
  buffer_load_dword v25, v84, s[4:7], s15 offen sc1
RW_160:
  s_add_u32 s14, s14, 1
  s_and_b32 s55, s14, 3
  s_lshl_b32 s33, s55, 14
  s_add_u32 s33, s33, s13
  s_lshl_b32 s15, s95, 12
  s_add_u32 m0, s15, 24576
  s_add_u32 s33, s33, s15
  s_add_u32 s33, s33, 524288
  s_lshl_b32 s40, s55, 15
  s_add_u32 s40, s40, s13
  s_add_u32 s40, s40, 131072
  s_mul_i32 s32, s95, 5120
  s_add_u32 s40, s40, s32
  s_add_u32 s41, s40, 4096
  v_add_u32 v15, s32, v2
  s_add_u32 s48, s32, 4096
  s_lshl_b32 s15, s55, 19
  s_add_u32 s16, s15, s52
  s_add_u32 s17, s16, 262144
  s_add_u32 s18, s15, s30
  s_add_u32 s19, s18, 262144
  s_add_u32 s53, s14, 1
  s_and_b32 s15, s53, 3
  s_lshl_b32 s43, s15, 14
  s_add_u32 s43, s43, s13
  s_and_b32 s46, s53, 1
  s_lshl_b32 s46, s46, 19
  s_add_u32 s46, s46, s13
  s_add_u32 s47, s46, 4096
  s_lshl_b32 s15, s55, 13
  s_add_u32 s15, s15, s13
  s_add_u32 s45, s15, 69632
  s_lshl_b32 s32, s95, 8
  s_add_u32 s45, s45, s32
  s_lshl_b32 s32, s95, 10
  s_add_u32 s15, s15, s32
  s_add_u32 s44, s15, 65536
  v_add_u32 v87, s32, v2
  s_cmp_eq_u32 s14, 0
  s_cbranch_scc1 Rs_loop_top
  s_waitcnt vmcnt(1)
  buffer_store_dword v88, v3, s[4:7], s49 offen sc1
  s_branch Rs_loop_top
RP_152:
P_161:
  s_mov_b32 m0, s48
  s_nop 0
  buffer_load_dwordx4 v2, s[4:7], s40 offen offset:0 sc1 lds
  buffer_load_dwordx4 v2, s[4:7], s40 offen offset:1024 sc1 lds
  buffer_load_dwordx4 v2, s[4:7], s40 offen offset:2048 sc1 lds
  buffer_load_dwordx4 v2, s[4:7], s40 offen offset:3072 sc1 lds
  s_add_u32 m0, s48, 4096
  s_nop 0
  buffer_load_dwordx4 v2, s[4:7], s41 offen offset:0 sc1 lds
  s_add_u32 s101, s101, 1
  s_cmp_gt_u32 s101, 262144
  s_cbranch_scc1 L_abort
  s_waitcnt vmcnt(0)
P_162:
  ds_read_b128 v[96:99], v15 offset:4096
  ds_read_b128 v[100:103], v15 offset:5120
  ds_read_b128 v[104:107], v15 offset:6144
  ds_read_b128 v[108:111], v15 offset:7168
  ds_read_b128 v[112:115], v15 offset:8192
  s_waitcnt lgkmcnt(0)
  v_max3_u32 v84, v96, v97, v98
  v_max3_u32 v85, v99, v100, v101
  v_max3_u32 v85, v85, v102, v103
  v_max3_u32 v84, v84, v104, v105
  v_max3_u32 v85, v85, v106, v107
  v_max3_u32 v84, v84, v108, v109
  v_max3_u32 v85, v85, v110, v111
  v_max3_u32 v84, v84, v112, v113
  v_max3_u32 v85, v85, v114, v115
  v_max_u32 v84, v84, v85
  v_cmp_eq_u32 vcc, -1, v84
  s_cbranch_vccnz P_161
  s_barrier
  s_branch RP_153
RW_150:
  v_mov_b32 v86, v10
  s_branch RB_151
RPX_140:
P_163:
  s_mov_b32 m0, s48
  s_nop 0
  buffer_load_dwordx4 v2, s[4:7], s40 offen offset:0 sc1 lds
  buffer_load_dwordx4 v2, s[4:7], s40 offen offset:1024 sc1 lds
  buffer_load_dwordx4 v2, s[4:7], s40 offen offset:2048 sc1 lds
  buffer_load_dwordx4 v2, s[4:7], s40 offen offset:3072 sc1 lds
  s_add_u32 m0, s48, 4096
  s_nop 0
  buffer_load_dwordx4 v2, s[4:7], s41 offen offset:0 sc1 lds
  s_add_u32 s101, s101, 1
  s_cmp_gt_u32 s101, 262144
  s_cbranch_scc1 L_abort
  s_waitcnt vmcnt(0)
P_164:
  ds_read_b128 v[96:99], v15 offset:4096
  ds_read_b128 v[100:103], v15 offset:5120
  ds_read_b128 v[104:107], v15 offset:6144
  ds_read_b128 v[108:111], v15 offset:7168
  ds_read_b128 v[112:115], v15 offset:8192
  s_waitcnt lgkmcnt(0)
  v_max3_u32 v84, v96, v97, v98
  v_max3_u32 v85, v99, v100, v101
  v_max3_u32 v85, v85, v102, v103
  v_max3_u32 v84, v84, v104, v105
  v_max3_u32 v85, v85, v106, v107
  v_max3_u32 v84, v84, v108, v109
  v_max3_u32 v85, v85, v110, v111
  v_max3_u32 v84, v84, v112, v113
  v_max3_u32 v85, v85, v114, v115
  v_max_u32 v84, v84, v85
  v_cmp_eq_u32 vcc, -1, v84
  s_cbranch_vccnz P_163
  s_barrier
  ds_read_b128 v[96:99], v2 offset:4096
  ds_read_b128 v[128:131], v2 offset:12288
  ds_read_b128 v[100:103], v2 offset:5120
  ds_read_b128 v[132:135], v2 offset:13312
  ds_read_b128 v[104:107], v2 offset:6144
  ds_read_b128 v[136:139], v2 offset:14336
  ds_read_b128 v[108:111], v2 offset:7168
  ds_read_b128 v[140:143], v2 offset:15360
  ds_read_b128 v[112:115], v2 offset:8192
  s_waitcnt lgkmcnt(8)
  v_mfma_f32_16x16x32_bf16 v[176:179], v[192:195], v[96:99], 0
  ds_read_b128 v[144:147], v2 offset:16384
  s_waitcnt lgkmcnt(8)
  v_mfma_f32_16x16x32_bf16 v[180:183], v[192:195], v[128:131], 0
  ds_read_b128 v[116:119], v2 offset:9216
  s_waitcnt lgkmcnt(8)
  v_mfma_f32_16x16x32_bf16 v[176:179], v[196:199], v[100:103], v[176:179]
  ds_read_b128 v[148:151], v2 offset:17408
  s_waitcnt lgkmcnt(8)
  v_mfma_f32_16x16x32_bf16 v[180:183], v[196:199], v[132:135], v[180:183]
  ds_read_b128 v[120:123], v2 offset:10240
  s_waitcnt lgkmcnt(8)
  v_mfma_f32_16x16x32_bf16 v[176:179], v[200:203], v[104:107], v[176:179]
  ds_read_b128 v[152:155], v2 offset:18432
  s_waitcnt lgkmcnt(8)
  v_mfma_f32_16x16x32_bf16 v[180:183], v[200:203], v[136:139], v[180:183]
  ds_read_b128 v[124:127], v2 offset:11264
  s_waitcnt lgkmcnt(8)
  v_mfma_f32_16x16x32_bf16 v[176:179], v[204:207], v[108:111], v[176:179]
  ds_read_b128 v[156:159], v2 offset:19456
  s_waitcnt lgkmcnt(8)
  v_mfma_f32_16x16x32_bf16 v[180:183], v[204:207], v[140:143], v[180:183]
  ds_read_b128 v[160:163], v2 offset:20480
  s_waitcnt lgkmcnt(8)
  v_mfma_f32_16x16x32_bf16 v[176:179], v[208:211], v[112:115], v[176:179]
  ds_read_b128 v[168:171], v2 offset:22528
  s_waitcnt lgkmcnt(8)
  v_mfma_f32_16x16x32_bf16 v[180:183], v[208:211], v[144:147], v[180:183]
  ds_read_b128 v[164:167], v2 offset:21504
  s_waitcnt lgkmcnt(8)
  v_mfma_f32_16x16x32_bf16 v[176:179], v[212:215], v[116:119], v[176:179]
  ds_read_b128 v[172:175], v2 offset:23552
  s_waitcnt lgkmcnt(8)
  v_mfma_f32_16x16x32_bf16 v[180:183], v[212:215], v[148:151], v[180:183]
  s_waitcnt lgkmcnt(7)
  v_mfma_f32_16x16x32_bf16 v[176:179], v[216:219], v[120:123], v[176:179]
  s_waitcnt lgkmcnt(6)
  v_mfma_f32_16x16x32_bf16 v[180:183], v[216:219], v[152:155], v[180:183]
  s_waitcnt lgkmcnt(5)
  v_mfma_f32_16x16x32_bf16 v[176:179], v[220:223], v[124:127], v[176:179]
  s_waitcnt lgkmcnt(4)
  v_mfma_f32_16x16x32_bf16 v[180:183], v[220:223], v[156:159], v[180:183]
  s_waitcnt lgkmcnt(3)
  v_mfma_f32_16x16x32_bf16 v[176:179], v[16:19], v[160:163], v[176:179]
  s_waitcnt lgkmcnt(2)
  v_mfma_f32_16x16x32_bf16 v[180:183], v[16:19], v[168:171], v[180:183]
  s_waitcnt lgkmcnt(1)
  v_mfma_f32_16x16x32_bf16 v[176:179], v[20:23], v[164:167], v[176:179]
  s_waitcnt lgkmcnt(0)
  v_mfma_f32_16x16x32_bf16 v[180:183], v[20:23], v[172:175], v[180:183]
  s_nop 7
  v_cvt_pk_bf16_f32 v184, v176, v177
  v_cvt_pk_bf16_f32 v185, v178, v179
  v_cvt_pk_bf16_f32 v186, v180, v181
  v_cvt_pk_bf16_f32 v187, v182, v183
  s_lshl_b32 s15, s94, 22
  s_sub_u32 s31, s14, 0
  s_lshl_b32 s31, s31, 16
  s_add_u32 s15, s15, s31
  s_lshl_b32 s31, s51, 10
  s_add_u32 s15, s15, s31
  s_add_u32 s15, s15, 0x4800000
  buffer_store_dwordx4 v[184:187], v2, s[4:7], s15 offen sc1
  s_branch L_end
G_entry:
  s_mov_b32 s3, 0
  s_and_b32 s60, s95, 1
  s_lshr_b32 s61, s95, 1
  v_lshlrev_b32 v8, 4, v1
  v_lshrrev_b32 v20, 4, v1
  s_lshl_b32 s56, s60, 2
  v_add_u32 v11, s56, v20
  s_lshl_b32 s56, s60, 3
  v_add_u32 v10, s56, v20
  v_bfe_u32 v21, v1, 1, 3
  v_xor_b32 v21, v21, v11
  v_lshlrev_b32 v21, 5, v21
  v_and_b32 v22, 1, v1
  v_lshlrev_b32 v22, 4, v22
  v_add_u32 v12, v21, v22
  v_lshrrev_b32 v20, 3, v1
  s_lshl_b32 s56, s60, 3
  v_add_u32 v20, s56, v20
  v_lshrrev_b32 v21, 1, v20
  v_and_b32 v22, 7, v1
  v_xor_b32 v21, v21, v22
  v_lshlrev_b32 v21, 4, v21
  v_lshlrev_b32 v20, 11, v20
  v_add_u32 v13, v20, v21
  v_bfe_u32 v20, v1, 2, 3
  v_lshrrev_b32 v21, 5, v1
  v_lshlrev_b32 v21, 4, v21
  v_add_u32 v21, v21, v20
  v_lshlrev_b32 v21, 8, v21
  v_and_b32 v22, 3, v1
  v_lshlrev_b32 v22, 3, v22
  v_add_u32 v21, v21, v22
  s_lshl_b32 s56, s95, 1
  v_xor_b32 v22, s56, v20
  v_lshlrev_b32 v22, 5, v22
  v_add_u32 v14, v21, v22
  s_add_u32 s56, s56, 1
  v_xor_b32 v22, s56, v20
  v_lshlrev_b32 v22, 5, v22
  v_add_u32 v15, v21, v22
  v_and_b32 v20, 15, v1
  v_lshrrev_b32 v21, 1, v20
  v_lshrrev_b32 v22, 4, v1
  v_xor_b32 v21, v21, v22
  v_lshlrev_b32 v20, 7, v20
  v_lshlrev_b32 v22, 4, v21
  v_add_u32 v16, v20, v22
  v_xor_b32 v21, 4, v21
  v_lshlrev_b32 v22, 4, v21
  v_add_u32 v17, v20, v22
  v_mov_b32 v18, v8
  v_add_u32 v19, 1024, v8
  s_lshl_b32 s40, s61, 14
  s_lshl_b32 s56, s60, 10
  s_add_u32 s40, s40, s56
  s_lshl_b32 s41, s61, 13
  s_add_u32 s41, s41, s56
  s_add_u32 s41, s41, 32768
  s_mov_b32 s42, 49152
  s_getpc_b64 s[54:55]
  s_add_u32 s54, s54, gm_tbl@rel32@lo+4
  s_addc_u32 s55, s55, gm_tbl@rel32@hi+12
  s_mov_b32 s48, 0
  s_mov_b32 s47, 0
  s_mov_b32 s49, 0
  s_and_b32 s50, s94, 7
  s_mov_b32 s51, 0
  s_mov_b32 s62, 0
  s_mov_b32 s52, 0
  s_mov_b32 s53, 0
  s_mov_b32 s78, 0
G_slow:
  s_cmp_eq_u32 s48, 0
  s_cbranch_scc1 FS_165
  s_waitcnt vmcnt(0)
  s_barrier
  s_cmp_lg_u32 s95, 0
  s_cbranch_scc1 FS_165
  s_cmp_lg_u32 s47, 0
  s_cbranch_scc1 ED_166
  v_mov_b32 v26, 1
  v_mov_b32 v27, 144
  s_mov_b64 exec, 1
  buffer_atomic_add v26, v27, s[8:11], 0 offen sc0
  s_waitcnt vmcnt(0)
  s_mov_b64 exec, -1
  v_readfirstlane_b32 s97, v26
  s_cmp_lg_u32 s97, 0
  s_cbranch_scc1 EC_167
  v_mov_b32 v28, 0
  v_mov_b32 v29, 0
  v_mov_b32 v30, 0
  v_mov_b32 v31, 0
  v_lshlrev_b32 v27, 4, v1
  s_mov_b32 s97, 0x7600000
  buffer_store_dwordx4 v[28:31], v27, s[4:7], s97 offen offset:0 sc1
  buffer_store_dwordx4 v[28:31], v27, s[4:7], s97 offen offset:1024 sc1
  buffer_store_dwordx4 v[28:31], v27, s[4:7], s97 offen offset:2048 sc1
  buffer_store_dwordx4 v[28:31], v27, s[4:7], s97 offen offset:3072 sc1
  s_mov_b32 s97, 0x7601000
  buffer_store_dwordx4 v[28:31], v27, s[4:7], s97 offen offset:0 sc1
  buffer_store_dwordx4 v[28:31], v27, s[4:7], s97 offen offset:1024 sc1
  buffer_store_dwordx4 v[28:31], v27, s[4:7], s97 offen offset:2048 sc1
  buffer_store_dwordx4 v[28:31], v27, s[4:7], s97 offen offset:3072 sc1
  s_mov_b32 s97, 0x7602000
  buffer_store_dwordx4 v[28:31], v27, s[4:7], s97 offen offset:0 sc1
  buffer_store_dwordx4 v[28:31], v27, s[4:7], s97 offen offset:1024 sc1
  buffer_store_dwordx4 v[28:31], v27, s[4:7], s97 offen offset:2048 sc1
  buffer_store_dwordx4 v[28:31], v27, s[4:7], s97 offen offset:3072 sc1
  s_mov_b32 s97, 0x7603000
  buffer_store_dwordx4 v[28:31], v27, s[4:7], s97 offen offset:0 sc1
  buffer_store_dwordx4 v[28:31], v27, s[4:7], s97 offen offset:1024 sc1
  buffer_store_dwordx4 v[28:31], v27, s[4:7], s97 offen offset:2048 sc1
  buffer_store_dwordx4 v[28:31], v27, s[4:7], s97 offen offset:3072 sc1
  s_mov_b32 s97, 0x7604000
  buffer_store_dwordx4 v[28:31], v27, s[4:7], s97 offen offset:0 sc1
  buffer_store_dwordx4 v[28:31], v27, s[4:7], s97 offen offset:1024 sc1
  buffer_store_dwordx4 v[28:31], v27, s[4:7], s97 offen offset:2048 sc1
  buffer_store_dwordx4 v[28:31], v27, s[4:7], s97 offen offset:3072 sc1
  s_mov_b32 s97, 0x7605000
  buffer_store_dwordx4 v[28:31], v27, s[4:7], s97 offen offset:0 sc1
  buffer_store_dwordx4 v[28:31], v27, s[4:7], s97 offen offset:1024 sc1
  buffer_store_dwordx4 v[28:31], v27, s[4:7], s97 offen offset:2048 sc1
  buffer_store_dwordx4 v[28:31], v27, s[4:7], s97 offen offset:3072 sc1
  s_mov_b32 s97, 0x7606000
  buffer_store_dwordx4 v[28:31], v27, s[4:7], s97 offen offset:0 sc1
  buffer_store_dwordx4 v[28:31], v27, s[4:7], s97 offen offset:1024 sc1
  buffer_store_dwordx4 v[28:31], v27, s[4:7], s97 offen offset:2048 sc1
  buffer_store_dwordx4 v[28:31], v27, s[4:7], s97 offen offset:3072 sc1
  s_mov_b32 s97, 0x7607000
  buffer_store_dwordx4 v[28:31], v27, s[4:7], s97 offen offset:0 sc1
  buffer_store_dwordx4 v[28:31], v27, s[4:7], s97 offen offset:1024 sc1
  buffer_store_dwordx4 v[28:31], v27, s[4:7], s97 offen offset:2048 sc1
  buffer_store_dwordx4 v[28:31], v27, s[4:7], s97 offen offset:3072 sc1
  s_waitcnt vmcnt(0)
  v_mov_b32 v26, 1
  v_mov_b32 v27, 148
  s_mov_b64 exec, 1
  buffer_store_dword v26, v27, s[8:11], 0 offen sc1
  s_mov_b64 exec, -1
EC_167:
  v_mov_b32 v21, 148
W_168:
  buffer_load_dword v20, v21, s[8:11], 0 offen sc1
  s_waitcnt vmcnt(0)
  v_readfirstlane_b32 s97, v20
  s_and_b32 s97, s97, 0x1
  s_cmp_eq_u32 s97, 0x1
  s_cbranch_scc1 WE_169
  s_add_u32 s101, s101, 1
  s_cmp_gt_u32 s101, 262144
  s_cbranch_scc1 L_abort
  s_sleep 8
  s_branch W_168
WE_169:
  s_mov_b32 s47, 1
ED_166:
  v_mov_b32 v20, 1
  v_mov_b32 v21, s48
  s_mov_b64 exec, 1
  buffer_store_dword v20, v21, s[4:7], 0 offen sc1
  s_mov_b64 exec, -1
FS_165:
  s_mov_b32 s48, 0
  s_cmp_lg_u32 s95, 0
  s_cbranch_scc1 G_slow_wait
  s_cmp_eq_u32 s62, 0
  s_cbranch_scc1 G_try
  s_cmp_lg_u32 s51, 0
  s_cbranch_scc1 G_scan
G_rolechk:
  s_add_u32 s101, s101, 1
  s_cmp_gt_u32 s101, 262144
  s_cbranch_scc1 L_abort
  v_and_b32 v25, 7, v1
  v_lshlrev_b32 v25, 2, v25
  buffer_load_dword v24, v25, s[8:11], 0 offen offset:128 sc1
  s_waitcnt vmcnt(0)
  v_cmp_gt_u32 vcc, 32, v24
  s_and_b32 s56, vcc_lo, 15
  s_cmp_eq_u32 s56, 0
  s_cbranch_scc1 G_verified
  s_ff1_i32_b32 s57, s56
  v_mov_b32 v20, 1
  v_mov_b32 v21, 168
  s_mov_b64 exec, 1
  buffer_atomic_or v20, v21, s[8:11], 0 offen sc0
  s_waitcnt vmcnt(0)
  s_add_u32 s56, s57, 32
  s_lshl_b32 s56, s56, 2
  v_mov_b32 v20, 1
  v_mov_b32 v21, s56
  buffer_atomic_add v20, v21, s[8:11], 0 offen sc0
  s_waitcnt vmcnt(0)
  s_mov_b64 exec, -1
  v_readfirstlane_b32 s58, v20
  s_cmp_ge_u32 s58, 32
  s_cbranch_scc1 G_rolechk
  s_lshl_b32 s57, s57, 4
  s_lshl_b32 s58, s58, 8
  s_or_b32 s43, s57, s58
  s_or_b32 s43, s43, 4
  s_branch G_got
G_verified:
  s_mov_b32 s51, 1
  s_branch G_scan
G_try:
  s_lshl_b32 s56, s49, 3
  s_add_u32 s56, s56, s50
  s_lshl_b32 s56, s56, 3
  s_load_dwordx2 s[52:53], s[54:55], s56
  s_lshl_b32 s56, s49, 3
  s_add_u32 s56, s56, s50
  s_add_u32 s56, s56, 0
  s_lshl_b32 s56, s56, 2
  v_mov_b32 v22, 1
  v_mov_b32 v23, s56
  s_mov_b64 exec, 1
  buffer_atomic_add v22, v23, s[8:11], 0 offen sc0
  s_mov_b64 exec, -1
  s_waitcnt vmcnt(0) lgkmcnt(0)
  v_readfirstlane_b32 s57, v22
  s_cmp_lt_u32 s57, s53
  s_cbranch_scc1 G_fetch
G_scan:
  s_add_u32 s101, s101, 1
  s_cmp_gt_u32 s101, 262144
  s_cbranch_scc1 L_abort
  v_and_b32 v20, 31, v1
  v_min_u32 v20, 23, v20
  v_lshlrev_b32 v21, 2, v20
  v_lshlrev_b32 v23, 3, v20
  buffer_load_dword v22, v21, s[8:11], 0 offen offset:0 sc1
  global_load_dword v24, v23, s[54:55] offset:4
  s_waitcnt vmcnt(0)
  v_cmp_lt_u32 vcc, v22, v24
  s_mov_b32 s43, 0xfffffffe
  s_and_b32 s56, vcc_lo, 0xffffff
  s_cmp_eq_u32 s56, 0
  s_cbranch_scc1 G_got
  s_ff1_i32_b32 s57, s56
  s_lshr_b32 s49, s57, 3
  s_and_b32 s57, s57, 0x18
  s_lshr_b32 s56, s56, s57
  s_and_b32 s56, s56, 0xff
  s_lshl_b32 s57, s56, 8
  s_or_b32 s56, s56, s57
  s_and_b32 s57, s94, 7
  s_lshr_b32 s56, s56, s57
  s_ff1_i32_b32 s56, s56
  s_add_u32 s56, s56, s57
  s_and_b32 s50, s56, 7
  s_cmp_eq_u32 s49, 0
  s_cbranch_scc1 G_try
  s_cmp_eq_u32 s51, 0
  s_cbranch_scc1 G_rolechk
  s_branch G_try
G_fetch:
  s_add_u32 s57, s57, s52
  s_lshl_b32 s57, s57, 2
  s_load_dword s43, s[54:55], s57
  s_waitcnt lgkmcnt(0)
G_got:
  v_mov_b32 v20, s43
  v_mov_b32 v21, 147460
  ds_write_b32 v21, v20
  s_waitcnt lgkmcnt(0)
G_slow_wait:
  s_barrier
  v_mov_b32 v21, 147460
  ds_read_b32 v20, v21
  s_waitcnt lgkmcnt(0)
  v_readfirstlane_b32 s43, v20
  s_barrier
  s_cmp_eq_u32 s43, 0xfffffffe
  s_cbranch_scc1 L_end
G_run:
  s_add_u32 s101, s101, 64
  s_cmp_gt_u32 s101, 262144
  s_cbranch_scc1 L_abort
  s_and_b32 s44, s43, 15
  s_bfe_u32 s45, s43, 0x40004
  s_lshr_b32 s46, s43, 8
  s_cmp_eq_u32 s44, 4
  s_cbranch_scc1 G_torole
  s_cmp_eq_u32 s44, 3
  s_cbranch_scc1 G_comb
  s_cmp_eq_u32 s44, 5
  s_cbranch_scc1 G_pfi
  s_cmp_eq_u32 s44, 2
  s_cbranch_scc1 G_set_down
  s_mov_b32 s16, s64
  s_mov_b32 s17, s65
  s_mov_b32 s18, 0x400000
  s_mov_b32 s19, 0x20000
  s_mov_b32 s28, 0
  s_mov_b32 s29, 32768
  s_mov_b32 s30, 65536
  s_mov_b32 s31, 98304
  s_mov_b32 s33, 128
  s_bfe_u32 s56, s43, 0x40004
  s_lshl_b32 s56, s56, 18
  s_lshl_b32 s57, s61, 17
  s_add_u32 s56, s56, s57
  v_add_u32 v3, s56, v13
  s_bitcmp1_b32 s43, 0
  s_cbranch_scc1 SU_170
  s_lshr_b32 s56, s43, 12
  s_cmp_eq_u32 s56, 0
  s_cselect_b64 s[12:13], s[68:69], s[70:71]
  s_cmp_eq_u32 s56, 2
  s_cselect_b64 s[12:13], s[72:73], s[12:13]
  s_mov_b32 s14, 0x800000
  s_mov_b32 s15, 0x20000
  s_mov_b32 s20, 0
  s_mov_b32 s21, 32768
  s_mov_b32 s22, 131072
  s_mov_b32 s23, 163840
  s_mov_b32 s24, 262144
  s_mov_b32 s25, 294912
  s_mov_b32 s26, 393216
  s_mov_b32 s27, 425984
  s_mov_b32 s32, 524288
  v_lshlrev_b32 v2, 13, v10
  v_add_u32 v2, v2, v12
  s_bfe_u32 s56, s43, 0x40008
  s_lshl_b32 s56, s56, 9
  s_lshl_b32 s57, s61, 8
  s_add_u32 s56, s56, s57
  v_add_u32 v2, s56, v2
  s_branch SE_171
SU_170:
  s_cmp_eq_u32 s61, 0
  s_cselect_b64 s[12:13], s[80:81], s[82:83]
  s_mov_b32 s14, 0x700000
  s_mov_b32 s15, 0x20000
  s_mov_b32 s20, 0
  s_mov_b32 s21, 28672
  s_mov_b32 s22, 114688
  s_mov_b32 s23, 143360
  s_mov_b32 s24, 229376
  s_mov_b32 s25, 258048
  s_mov_b32 s26, 344064
  s_mov_b32 s27, 372736
  s_mov_b32 s32, 458752
  v_mul_u32_u24 v2, 7168, v10
  v_add_u32 v2, v2, v12
  s_andn2_b32 s56, s43, 0xff
  v_add_u32 v2, s56, v2
SE_171:
  s_mov_b32 s36, 16
  v_mov_b32 v6, v16
  v_mov_b32 v7, v17
  s_branch G_go
G_set_down:
  s_cmp_eq_u32 s48, 0
  s_cbranch_scc1 FS_172
  s_waitcnt vmcnt(0)
  s_barrier
  s_cmp_lg_u32 s95, 0
  s_cbranch_scc1 FS_172
  s_cmp_lg_u32 s47, 0
  s_cbranch_scc1 ED_173
  v_mov_b32 v26, 1
  v_mov_b32 v27, 144
  s_mov_b64 exec, 1
  buffer_atomic_add v26, v27, s[8:11], 0 offen sc0
  s_waitcnt vmcnt(0)
  s_mov_b64 exec, -1
  v_readfirstlane_b32 s97, v26
  s_cmp_lg_u32 s97, 0
  s_cbranch_scc1 EC_174
  v_mov_b32 v28, 0
  v_mov_b32 v29, 0
  v_mov_b32 v30, 0
  v_mov_b32 v31, 0
  v_lshlrev_b32 v27, 4, v1
  s_mov_b32 s97, 0x7600000
  buffer_store_dwordx4 v[28:31], v27, s[4:7], s97 offen offset:0 sc1
  buffer_store_dwordx4 v[28:31], v27, s[4:7], s97 offen offset:1024 sc1
  buffer_store_dwordx4 v[28:31], v27, s[4:7], s97 offen offset:2048 sc1
  buffer_store_dwordx4 v[28:31], v27, s[4:7], s97 offen offset:3072 sc1
  s_mov_b32 s97, 0x7601000
  buffer_store_dwordx4 v[28:31], v27, s[4:7], s97 offen offset:0 sc1
  buffer_store_dwordx4 v[28:31], v27, s[4:7], s97 offen offset:1024 sc1
  buffer_store_dwordx4 v[28:31], v27, s[4:7], s97 offen offset:2048 sc1
  buffer_store_dwordx4 v[28:31], v27, s[4:7], s97 offen offset:3072 sc1
  s_mov_b32 s97, 0x7602000
  buffer_store_dwordx4 v[28:31], v27, s[4:7], s97 offen offset:0 sc1
  buffer_store_dwordx4 v[28:31], v27, s[4:7], s97 offen offset:1024 sc1
  buffer_store_dwordx4 v[28:31], v27, s[4:7], s97 offen offset:2048 sc1
  buffer_store_dwordx4 v[28:31], v27, s[4:7], s97 offen offset:3072 sc1
  s_mov_b32 s97, 0x7603000
  buffer_store_dwordx4 v[28:31], v27, s[4:7], s97 offen offset:0 sc1
  buffer_store_dwordx4 v[28:31], v27, s[4:7], s97 offen offset:1024 sc1
  buffer_store_dwordx4 v[28:31], v27, s[4:7], s97 offen offset:2048 sc1
  buffer_store_dwordx4 v[28:31], v27, s[4:7], s97 offen offset:3072 sc1
  s_mov_b32 s97, 0x7604000
  buffer_store_dwordx4 v[28:31], v27, s[4:7], s97 offen offset:0 sc1
  buffer_store_dwordx4 v[28:31], v27, s[4:7], s97 offen offset:1024 sc1
  buffer_store_dwordx4 v[28:31], v27, s[4:7], s97 offen offset:2048 sc1
  buffer_store_dwordx4 v[28:31], v27, s[4:7], s97 offen offset:3072 sc1
  s_mov_b32 s97, 0x7605000
  buffer_store_dwordx4 v[28:31], v27, s[4:7], s97 offen offset:0 sc1
  buffer_store_dwordx4 v[28:31], v27, s[4:7], s97 offen offset:1024 sc1
  buffer_store_dwordx4 v[28:31], v27, s[4:7], s97 offen offset:2048 sc1
  buffer_store_dwordx4 v[28:31], v27, s[4:7], s97 offen offset:3072 sc1
  s_mov_b32 s97, 0x7606000
  buffer_store_dwordx4 v[28:31], v27, s[4:7], s97 offen offset:0 sc1
  buffer_store_dwordx4 v[28:31], v27, s[4:7], s97 offen offset:1024 sc1
  buffer_store_dwordx4 v[28:31], v27, s[4:7], s97 offen offset:2048 sc1
  buffer_store_dwordx4 v[28:31], v27, s[4:7], s97 offen offset:3072 sc1
  s_mov_b32 s97, 0x7607000
  buffer_store_dwordx4 v[28:31], v27, s[4:7], s97 offen offset:0 sc1
  buffer_store_dwordx4 v[28:31], v27, s[4:7], s97 offen offset:1024 sc1
  buffer_store_dwordx4 v[28:31], v27, s[4:7], s97 offen offset:2048 sc1
  buffer_store_dwordx4 v[28:31], v27, s[4:7], s97 offen offset:3072 sc1
  s_waitcnt vmcnt(0)
  v_mov_b32 v26, 1
  v_mov_b32 v27, 148
  s_mov_b64 exec, 1
  buffer_store_dword v26, v27, s[8:11], 0 offen sc1
  s_mov_b64 exec, -1
EC_174:
  v_mov_b32 v21, 148
W_175:
  buffer_load_dword v20, v21, s[8:11], 0 offen sc1
  s_waitcnt vmcnt(0)
  v_readfirstlane_b32 s97, v20
  s_and_b32 s97, s97, 0x1
  s_cmp_eq_u32 s97, 0x1
  s_cbranch_scc1 WE_176
  s_add_u32 s101, s101, 1
  s_cmp_gt_u32 s101, 262144
  s_cbranch_scc1 L_abort
  s_sleep 8
  s_branch W_175
WE_176:
  s_mov_b32 s47, 1
ED_173:
  v_mov_b32 v20, 1
  v_mov_b32 v21, s48
  s_mov_b64 exec, 1
  buffer_store_dword v20, v21, s[4:7], 0 offen sc1
  s_mov_b64 exec, -1
FS_172:
  s_mov_b32 s48, 0
  s_cmp_lg_u32 s95, 0
  s_cbranch_scc1 WE_177
  s_cmp_lg_u32 s47, 0
  s_cbranch_scc1 ED_178
  v_mov_b32 v26, 1
  v_mov_b32 v27, 144
  s_mov_b64 exec, 1
  buffer_atomic_add v26, v27, s[8:11], 0 offen sc0
  s_waitcnt vmcnt(0)
  s_mov_b64 exec, -1
  v_readfirstlane_b32 s97, v26
  s_cmp_lg_u32 s97, 0
  s_cbranch_scc1 EC_179
  v_mov_b32 v28, 0
  v_mov_b32 v29, 0
  v_mov_b32 v30, 0
  v_mov_b32 v31, 0
  v_lshlrev_b32 v27, 4, v1
  s_mov_b32 s97, 0x7600000
  buffer_store_dwordx4 v[28:31], v27, s[4:7], s97 offen offset:0 sc1
  buffer_store_dwordx4 v[28:31], v27, s[4:7], s97 offen offset:1024 sc1
  buffer_store_dwordx4 v[28:31], v27, s[4:7], s97 offen offset:2048 sc1
  buffer_store_dwordx4 v[28:31], v27, s[4:7], s97 offen offset:3072 sc1
  s_mov_b32 s97, 0x7601000
  buffer_store_dwordx4 v[28:31], v27, s[4:7], s97 offen offset:0 sc1
  buffer_store_dwordx4 v[28:31], v27, s[4:7], s97 offen offset:1024 sc1
  buffer_store_dwordx4 v[28:31], v27, s[4:7], s97 offen offset:2048 sc1
  buffer_store_dwordx4 v[28:31], v27, s[4:7], s97 offen offset:3072 sc1
  s_mov_b32 s97, 0x7602000
  buffer_store_dwordx4 v[28:31], v27, s[4:7], s97 offen offset:0 sc1
  buffer_store_dwordx4 v[28:31], v27, s[4:7], s97 offen offset:1024 sc1
  buffer_store_dwordx4 v[28:31], v27, s[4:7], s97 offen offset:2048 sc1
  buffer_store_dwordx4 v[28:31], v27, s[4:7], s97 offen offset:3072 sc1
  s_mov_b32 s97, 0x7603000
  buffer_store_dwordx4 v[28:31], v27, s[4:7], s97 offen offset:0 sc1
  buffer_store_dwordx4 v[28:31], v27, s[4:7], s97 offen offset:1024 sc1
  buffer_store_dwordx4 v[28:31], v27, s[4:7], s97 offen offset:2048 sc1
  buffer_store_dwordx4 v[28:31], v27, s[4:7], s97 offen offset:3072 sc1
  s_mov_b32 s97, 0x7604000
  buffer_store_dwordx4 v[28:31], v27, s[4:7], s97 offen offset:0 sc1
  buffer_store_dwordx4 v[28:31], v27, s[4:7], s97 offen offset:1024 sc1
  buffer_store_dwordx4 v[28:31], v27, s[4:7], s97 offen offset:2048 sc1
  buffer_store_dwordx4 v[28:31], v27, s[4:7], s97 offen offset:3072 sc1
  s_mov_b32 s97, 0x7605000
  buffer_store_dwordx4 v[28:31], v27, s[4:7], s97 offen offset:0 sc1
  buffer_store_dwordx4 v[28:31], v27, s[4:7], s97 offen offset:1024 sc1
  buffer_store_dwordx4 v[28:31], v27, s[4:7], s97 offen offset:2048 sc1
  buffer_store_dwordx4 v[28:31], v27, s[4:7], s97 offen offset:3072 sc1
  s_mov_b32 s97, 0x7606000
  buffer_store_dwordx4 v[28:31], v27, s[4:7], s97 offen offset:0 sc1
  buffer_store_dwordx4 v[28:31], v27, s[4:7], s97 offen offset:1024 sc1
  buffer_store_dwordx4 v[28:31], v27, s[4:7], s97 offen offset:2048 sc1
  buffer_store_dwordx4 v[28:31], v27, s[4:7], s97 offen offset:3072 sc1
  s_mov_b32 s97, 0x7607000
  buffer_store_dwordx4 v[28:31], v27, s[4:7], s97 offen offset:0 sc1
  buffer_store_dwordx4 v[28:31], v27, s[4:7], s97 offen offset:1024 sc1
  buffer_store_dwordx4 v[28:31], v27, s[4:7], s97 offen offset:2048 sc1
  buffer_store_dwordx4 v[28:31], v27, s[4:7], s97 offen offset:3072 sc1
  s_waitcnt vmcnt(0)
  v_mov_b32 v26, 1
  v_mov_b32 v27, 148
  s_mov_b64 exec, 1
  buffer_store_dword v26, v27, s[8:11], 0 offen sc1
  s_mov_b64 exec, -1
EC_179:
  v_mov_b32 v21, 148
W_180:
  buffer_load_dword v20, v21, s[8:11], 0 offen sc1
  s_waitcnt vmcnt(0)
  v_readfirstlane_b32 s97, v20
  s_and_b32 s97, s97, 0x1
  s_cmp_eq_u32 s97, 0x1
  s_cbranch_scc1 WE_181
  s_add_u32 s101, s101, 1
  s_cmp_gt_u32 s101, 262144
  s_cbranch_scc1 L_abort
  s_sleep 8
  s_branch W_180
WE_181:
  s_mov_b32 s47, 1
ED_178:
  s_lshl_b32 s56, s45, 11
  s_add_u32 s56, s56, 0x7600100
  s_lshr_b32 s57, s46, 2
  s_mul_i32 s57, s57, 56
  s_add_u32 s56, s56, s57
  v_lshlrev_b32 v24, 2, v1
  s_mov_b32 exec_lo, 0x3fff
  s_mov_b32 exec_hi, 0x0
F_182:
  buffer_load_dword v20, v24, s[4:7], s56 offen sc1
  s_waitcnt vmcnt(0)
  v_cmp_eq_u32 vcc, 0, v20
  s_cbranch_vccz FE_183
  s_add_u32 s101, s101, 1
  s_cmp_gt_u32 s101, 262144
  s_cbranch_scc1 L_abort
  s_sleep 8
  s_branch F_182
FE_183:
  s_mov_b64 exec, -1
WE_177:
  s_barrier
  s_mov_b32 s16, s92
  s_mov_b32 s17, s93
  s_mov_b32 s18, 0x10000000
  s_mov_b32 s19, 0x20000
  s_mov_b32 s28, 0
  s_mov_b32 s29, 114688
  s_mov_b32 s30, 229376
  s_mov_b32 s31, 344064
  s_mov_b32 s33, 2048
  s_mov_b32 s36, 28
  s_lshr_b32 s58, s46, 2
  s_lshl_b32 s56, s45, 3
  s_lshl_b32 s57, s61, 2
  s_add_u32 s56, s56, s57
  s_mul_i32 s56, s56, 112
  s_add_u32 s56, s56, s60
  s_mul_i32 s57, s58, 56
  s_add_u32 s56, s56, s57
  s_lshl_b32 s56, s56, 10
  s_add_u32 s56, s56, 0x3000000
  v_add_u32 v3, s56, v8
  v_mov_b32 v6, v18
  v_mov_b32 v7, v19
  s_mov_b32 s12, s84
  s_mov_b32 s13, s85
  s_mov_b32 s14, 0x700000
  s_mov_b32 s15, 0x20000
  s_mov_b32 s20, 0
  s_mov_b32 s21, 32768
  s_mov_b32 s22, 16384
  s_mov_b32 s23, 49152
  s_mov_b32 s24, 65536
  s_mov_b32 s25, 98304
  s_mov_b32 s26, 81920
  s_mov_b32 s27, 114688
  s_mov_b32 s32, 131072
  v_lshlrev_b32 v2, 11, v11
  v_add_u32 v2, v2, v12
  s_and_b32 s56, s46, 3
  s_lshl_b32 s56, s56, 9
  s_lshl_b32 s57, s61, 8
  s_add_u32 s56, s56, s57
  s_mul_i32 s57, s58, 3670016
  s_add_u32 s56, s56, s57
  v_add_u32 v2, s56, v2
  s_waitcnt vmcnt(0)
G_go:
  v_mov_b32 v4, v14
  v_mov_b32 v5, v15
  s_mov_b32 s39, 0
  s_mov_b32 s38, 0
  s_mov_b32 s34, s40
  s_mov_b32 s35, s41
  s_add_u32 m0, s34, 0
  s_nop 0
  buffer_load_dwordx4 v2, s[12:15], s20 offen lds
  s_add_u32 m0, s34, 2048
  s_nop 0
  buffer_load_dwordx4 v2, s[12:15], s21 offen lds
  s_add_u32 m0, s35, 0
  s_nop 0
  buffer_load_dwordx4 v3, s[16:19], s28 offen sc1 lds
  s_add_u32 m0, s34, 4096
  s_nop 0
  buffer_load_dwordx4 v2, s[12:15], s22 offen lds
  s_add_u32 m0, s34, 6144
  s_nop 0
  buffer_load_dwordx4 v2, s[12:15], s23 offen lds
  s_add_u32 m0, s35, 2048
  s_nop 0
  buffer_load_dwordx4 v3, s[16:19], s29 offen sc1 lds
  s_add_u32 m0, s34, 8192
  s_nop 0
  buffer_load_dwordx4 v2, s[12:15], s24 offen lds
  s_add_u32 m0, s34, 10240
  s_nop 0
  buffer_load_dwordx4 v2, s[12:15], s25 offen lds
  s_add_u32 m0, s35, 4096
  s_nop 0
  buffer_load_dwordx4 v3, s[16:19], s30 offen sc1 lds
  s_add_u32 m0, s34, 12288
  s_nop 0
  buffer_load_dwordx4 v2, s[12:15], s26 offen lds
  s_add_u32 m0, s34, 14336
  s_nop 0
  buffer_load_dwordx4 v2, s[12:15], s27 offen lds
  s_add_u32 m0, s35, 6144
  s_nop 0
  buffer_load_dwordx4 v3, s[16:19], s31 offen sc1 lds
  v_add_u32 v2, s32, v2
  v_add_u32 v3, s33, v3
  s_add_u32 s39, s39, 49152
  s_cmp_eq_u32 s39, 147456
  s_cselect_b32 s39, 0, s39
  s_add_u32 s34, s40, s39
  s_add_u32 s35, s41, s39
  s_add_u32 m0, s34, 0
  s_nop 0
  buffer_load_dwordx4 v2, s[12:15], s20 offen lds
  s_add_u32 m0, s34, 2048
  s_nop 0
  buffer_load_dwordx4 v2, s[12:15], s21 offen lds
  s_add_u32 m0, s35, 0
  s_nop 0
  buffer_load_dwordx4 v3, s[16:19], s28 offen sc1 lds
  s_add_u32 m0, s34, 4096
  s_nop 0
  buffer_load_dwordx4 v2, s[12:15], s22 offen lds
  s_add_u32 m0, s34, 6144
  s_nop 0
  buffer_load_dwordx4 v2, s[12:15], s23 offen lds
  s_add_u32 m0, s35, 2048
  s_nop 0
  buffer_load_dwordx4 v3, s[16:19], s29 offen sc1 lds
  s_add_u32 m0, s34, 8192
  s_nop 0
  buffer_load_dwordx4 v2, s[12:15], s24 offen lds
  s_add_u32 m0, s34, 10240
  s_nop 0
  buffer_load_dwordx4 v2, s[12:15], s25 offen lds
  s_add_u32 m0, s35, 4096
  s_nop 0
  buffer_load_dwordx4 v3, s[16:19], s30 offen sc1 lds
  s_add_u32 m0, s34, 12288
  s_nop 0
  buffer_load_dwordx4 v2, s[12:15], s26 offen lds
  s_add_u32 m0, s34, 14336
  s_nop 0
  buffer_load_dwordx4 v2, s[12:15], s27 offen lds
  s_add_u32 m0, s35, 6144
  s_nop 0
  buffer_load_dwordx4 v3, s[16:19], s31 offen sc1 lds
  v_add_u32 v2, s32, v2
  v_add_u32 v3, s33, v3
  s_add_u32 s39, s39, 49152
  s_cmp_eq_u32 s39, 147456
  s_cselect_b32 s39, 0, s39
  s_add_u32 s34, s40, s39
  s_add_u32 s35, s41, s39
  s_add_u32 m0, s34, 0
  s_nop 0
  buffer_load_dwordx4 v2, s[12:15], s20 offen lds
  s_add_u32 m0, s34, 2048
  s_nop 0
  buffer_load_dwordx4 v2, s[12:15], s21 offen lds
  s_add_u32 m0, s35, 0
  s_nop 0
  buffer_load_dwordx4 v3, s[16:19], s28 offen sc1 lds
  s_add_u32 m0, s34, 4096
  s_nop 0
  buffer_load_dwordx4 v2, s[12:15], s22 offen lds
  s_add_u32 m0, s34, 6144
  s_nop 0
  buffer_load_dwordx4 v2, s[12:15], s23 offen lds
  s_add_u32 m0, s35, 2048
  s_nop 0
  buffer_load_dwordx4 v3, s[16:19], s29 offen sc1 lds
  s_waitcnt vmcnt(18)
  s_barrier
  ds_read_b64_tr_b16 a[32:33], v4 offset:0
  ds_read_b64_tr_b16 a[34:35], v4 offset:2048
  ds_read_b128 a[0:3], v6 offset:32768
  ds_read_b64_tr_b16 a[36:37], v5 offset:0
  ds_read_b64_tr_b16 a[38:39], v5 offset:2048
  ds_read_b64_tr_b16 a[40:41], v4 offset:16384
  ds_read_b64_tr_b16 a[42:43], v4 offset:18432
  ds_read_b64_tr_b16 a[44:45], v5 offset:16384
  ds_read_b64_tr_b16 a[46:47], v5 offset:18432
  ds_read_b128 a[4:7], v6 offset:34816
  ds_read_b128 a[8:11], v6 offset:36864
  ds_read_b128 a[12:15], v6 offset:38912
  ds_read_b128 a[16:19], v6 offset:40960
  ds_read_b128 a[20:23], v6 offset:43008
  ds_read_b128 a[24:27], v6 offset:45056
  ds_read_b128 a[28:31], v6 offset:47104
G_tile:
  s_mov_b32 s76, s36
  s_mov_b32 s77, 0
  s_waitcnt lgkmcnt(0)
  v_mfma_f32_16x16x32_bf16 v[128:131], a[32:35], a[0:3], 0
  ds_read_b64_tr_b16 a[80:81], v4 offset:8192
  v_mfma_f32_16x16x32_bf16 v[132:135], a[36:39], a[0:3], 0
  ds_read_b64_tr_b16 a[82:83], v4 offset:10240
  v_mfma_f32_16x16x32_bf16 v[136:139], a[40:43], a[0:3], 0
  ds_read_b128 a[48:51], v7 offset:32768
  s_add_u32 m0, s34, 8192
  v_mfma_f32_16x16x32_bf16 v[140:143], a[44:47], a[0:3], 0
  buffer_load_dwordx4 v2, s[12:15], s24 offen lds
  v_mfma_f32_16x16x32_bf16 v[144:147], a[32:35], a[4:7], 0
  ds_read_b64_tr_b16 a[84:85], v5 offset:8192
  v_mfma_f32_16x16x32_bf16 v[148:151], a[36:39], a[4:7], 0
  ds_read_b64_tr_b16 a[86:87], v5 offset:10240
  v_mfma_f32_16x16x32_bf16 v[152:155], a[40:43], a[4:7], 0
  ds_read_b64_tr_b16 a[88:89], v4 offset:24576
  s_add_u32 m0, s34, 10240
  v_mfma_f32_16x16x32_bf16 v[156:159], a[44:47], a[4:7], 0
  buffer_load_dwordx4 v2, s[12:15], s25 offen lds
  v_mfma_f32_16x16x32_bf16 v[160:163], a[32:35], a[8:11], 0
  ds_read_b64_tr_b16 a[90:91], v4 offset:26624
  v_mfma_f32_16x16x32_bf16 v[164:167], a[36:39], a[8:11], 0
  ds_read_b64_tr_b16 a[92:93], v5 offset:24576
  v_mfma_f32_16x16x32_bf16 v[168:171], a[40:43], a[8:11], 0
  ds_read_b64_tr_b16 a[94:95], v5 offset:26624
  s_add_u32 m0, s35, 4096
  v_mfma_f32_16x16x32_bf16 v[172:175], a[44:47], a[8:11], 0
  buffer_load_dwordx4 v3, s[16:19], s30 offen sc1 lds
  v_mfma_f32_16x16x32_bf16 v[176:179], a[32:35], a[12:15], 0
  ds_read_b128 a[52:55], v7 offset:34816
  v_mfma_f32_16x16x32_bf16 v[180:183], a[36:39], a[12:15], 0
  ds_read_b128 a[56:59], v7 offset:36864
  v_mfma_f32_16x16x32_bf16 v[184:187], a[40:43], a[12:15], 0
  ds_read_b128 a[60:63], v7 offset:38912
  s_add_u32 m0, s34, 12288
  v_mfma_f32_16x16x32_bf16 v[188:191], a[44:47], a[12:15], 0
  buffer_load_dwordx4 v2, s[12:15], s26 offen lds
  v_mfma_f32_16x16x32_bf16 v[192:195], a[32:35], a[16:19], 0
  ds_read_b128 a[64:67], v7 offset:40960
  v_mfma_f32_16x16x32_bf16 v[196:199], a[36:39], a[16:19], 0
  ds_read_b128 a[68:71], v7 offset:43008
  v_mfma_f32_16x16x32_bf16 v[200:203], a[40:43], a[16:19], 0
  ds_read_b128 a[72:75], v7 offset:45056
  s_add_u32 m0, s34, 14336
  v_mfma_f32_16x16x32_bf16 v[204:207], a[44:47], a[16:19], 0
  buffer_load_dwordx4 v2, s[12:15], s27 offen lds
  v_mfma_f32_16x16x32_bf16 v[208:211], a[32:35], a[20:23], 0
  ds_read_b128 a[76:79], v7 offset:47104
  v_mfma_f32_16x16x32_bf16 v[212:215], a[36:39], a[20:23], 0
  v_mfma_f32_16x16x32_bf16 v[216:219], a[40:43], a[20:23], 0
  s_add_u32 m0, s35, 6144
  v_mfma_f32_16x16x32_bf16 v[220:223], a[44:47], a[20:23], 0
  buffer_load_dwordx4 v3, s[16:19], s31 offen sc1 lds
  v_mfma_f32_16x16x32_bf16 v[224:227], a[32:35], a[24:27], 0
  v_add_u32 v2, s32, v2
  v_add_u32 v3, s33, v3
  v_mfma_f32_16x16x32_bf16 v[228:231], a[36:39], a[24:27], 0
  s_add_u32 s39, s39, 49152
  s_cmp_eq_u32 s39, 147456
  v_mfma_f32_16x16x32_bf16 v[232:235], a[40:43], a[24:27], 0
  s_cselect_b32 s39, 0, s39
  s_add_u32 s34, s40, s39
  v_mfma_f32_16x16x32_bf16 v[236:239], a[44:47], a[24:27], 0
  s_add_u32 s35, s41, s39
  s_add_u32 s38, s38, 1
  v_mfma_f32_16x16x32_bf16 v[240:243], a[32:35], a[28:31], 0
  s_cmp_eq_u32 s38, 3
  s_cselect_b32 s38, 0, s38
  v_mfma_f32_16x16x32_bf16 v[244:247], a[36:39], a[28:31], 0
  s_cselect_b32 s37, 0xfffe8000, s42
  v_add_u32 v4, s37, v4
  v_mfma_f32_16x16x32_bf16 v[248:251], a[40:43], a[28:31], 0
  v_add_u32 v5, s37, v5
  v_add_u32 v6, s37, v6
  v_mfma_f32_16x16x32_bf16 v[252:255], a[44:47], a[28:31], 0
  v_add_u32 v7, s37, v7
  s_cmp_eq_u32 s36, s76
  s_branch G_mid
G_kl:
  v_mfma_f32_16x16x32_bf16 v[128:131], a[32:35], a[0:3], v[128:131]
  ds_read_b64_tr_b16 a[80:81], v4 offset:8192
  v_mfma_f32_16x16x32_bf16 v[132:135], a[36:39], a[0:3], v[132:135]
  ds_read_b64_tr_b16 a[82:83], v4 offset:10240
  v_mfma_f32_16x16x32_bf16 v[136:139], a[40:43], a[0:3], v[136:139]
  ds_read_b128 a[48:51], v7 offset:32768
  s_add_u32 m0, s34, 8192
  v_mfma_f32_16x16x32_bf16 v[140:143], a[44:47], a[0:3], v[140:143]
  buffer_load_dwordx4 v2, s[12:15], s24 offen lds
  v_mfma_f32_16x16x32_bf16 v[144:147], a[32:35], a[4:7], v[144:147]
  ds_read_b64_tr_b16 a[84:85], v5 offset:8192
  v_mfma_f32_16x16x32_bf16 v[148:151], a[36:39], a[4:7], v[148:151]
  ds_read_b64_tr_b16 a[86:87], v5 offset:10240
  v_mfma_f32_16x16x32_bf16 v[152:155], a[40:43], a[4:7], v[152:155]
  ds_read_b64_tr_b16 a[88:89], v4 offset:24576
  s_add_u32 m0, s34, 10240
  v_mfma_f32_16x16x32_bf16 v[156:159], a[44:47], a[4:7], v[156:159]
  buffer_load_dwordx4 v2, s[12:15], s25 offen lds
  v_mfma_f32_16x16x32_bf16 v[160:163], a[32:35], a[8:11], v[160:163]
  ds_read_b64_tr_b16 a[90:91], v4 offset:26624
  v_mfma_f32_16x16x32_bf16 v[164:167], a[36:39], a[8:11], v[164:167]
  ds_read_b64_tr_b16 a[92:93], v5 offset:24576
  v_mfma_f32_16x16x32_bf16 v[168:171], a[40:43], a[8:11], v[168:171]
  ds_read_b64_tr_b16 a[94:95], v5 offset:26624
  s_add_u32 m0, s35, 4096
  v_mfma_f32_16x16x32_bf16 v[172:175], a[44:47], a[8:11], v[172:175]
  buffer_load_dwordx4 v3, s[16:19], s30 offen sc1 lds
  v_mfma_f32_16x16x32_bf16 v[176:179], a[32:35], a[12:15], v[176:179]
  ds_read_b128 a[52:55], v7 offset:34816
  v_mfma_f32_16x16x32_bf16 v[180:183], a[36:39], a[12:15], v[180:183]
  ds_read_b128 a[56:59], v7 offset:36864
  v_mfma_f32_16x16x32_bf16 v[184:187], a[40:43], a[12:15], v[184:187]
  ds_read_b128 a[60:63], v7 offset:38912
  s_add_u32 m0, s34, 12288
  v_mfma_f32_16x16x32_bf16 v[188:191], a[44:47], a[12:15], v[188:191]
  buffer_load_dwordx4 v2, s[12:15], s26 offen lds
  v_mfma_f32_16x16x32_bf16 v[192:195], a[32:35], a[16:19], v[192:195]
  ds_read_b128 a[64:67], v7 offset:40960
  v_mfma_f32_16x16x32_bf16 v[196:199], a[36:39], a[16:19], v[196:199]
  ds_read_b128 a[68:71], v7 offset:43008
  v_mfma_f32_16x16x32_bf16 v[200:203], a[40:43], a[16:19], v[200:203]
  ds_read_b128 a[72:75], v7 offset:45056
  s_add_u32 m0, s34, 14336
  v_mfma_f32_16x16x32_bf16 v[204:207], a[44:47], a[16:19], v[204:207]
  buffer_load_dwordx4 v2, s[12:15], s27 offen lds
  v_mfma_f32_16x16x32_bf16 v[208:211], a[32:35], a[20:23], v[208:211]
  ds_read_b128 a[76:79], v7 offset:47104
  v_mfma_f32_16x16x32_bf16 v[212:215], a[36:39], a[20:23], v[212:215]
  v_mfma_f32_16x16x32_bf16 v[216:219], a[40:43], a[20:23], v[216:219]
  s_add_u32 m0, s35, 6144
  v_mfma_f32_16x16x32_bf16 v[220:223], a[44:47], a[20:23], v[220:223]
  buffer_load_dwordx4 v3, s[16:19], s31 offen sc1 lds
  v_mfma_f32_16x16x32_bf16 v[224:227], a[32:35], a[24:27], v[224:227]
  v_add_u32 v2, s32, v2
  v_add_u32 v3, s33, v3
  v_mfma_f32_16x16x32_bf16 v[228:231], a[36:39], a[24:27], v[228:231]
  s_add_u32 s39, s39, 49152
  s_cmp_eq_u32 s39, 147456
  v_mfma_f32_16x16x32_bf16 v[232:235], a[40:43], a[24:27], v[232:235]
  s_cselect_b32 s39, 0, s39
  s_add_u32 s34, s40, s39
  v_mfma_f32_16x16x32_bf16 v[236:239], a[44:47], a[24:27], v[236:239]
  s_add_u32 s35, s41, s39
  s_add_u32 s38, s38, 1
  v_mfma_f32_16x16x32_bf16 v[240:243], a[32:35], a[28:31], v[240:243]
  s_cmp_eq_u32 s38, 3
  s_cselect_b32 s38, 0, s38
  v_mfma_f32_16x16x32_bf16 v[244:247], a[36:39], a[28:31], v[244:247]
  s_cselect_b32 s37, 0xfffe8000, s42
  v_add_u32 v4, s37, v4
  v_mfma_f32_16x16x32_bf16 v[248:251], a[40:43], a[28:31], v[248:251]
  v_add_u32 v5, s37, v5
  v_add_u32 v6, s37, v6
  v_mfma_f32_16x16x32_bf16 v[252:255], a[44:47], a[28:31], v[252:255]
  v_add_u32 v7, s37, v7
  s_cmp_eq_u32 s36, s76
G_mid:
  s_waitcnt vmcnt(12) lgkmcnt(0)
  s_barrier
  s_cbranch_scc1 G_event
G_b:
  v_mfma_f32_16x16x32_bf16 v[128:131], a[80:83], a[48:51], v[128:131]
  ds_read_b64_tr_b16 a[32:33], v4 offset:0
  v_mfma_f32_16x16x32_bf16 v[132:135], a[84:87], a[48:51], v[132:135]
  ds_read_b64_tr_b16 a[34:35], v4 offset:2048
  v_mfma_f32_16x16x32_bf16 v[136:139], a[88:91], a[48:51], v[136:139]
  ds_read_b128 a[0:3], v6 offset:32768
  s_add_u32 m0, s34, 0
  v_mfma_f32_16x16x32_bf16 v[140:143], a[92:95], a[48:51], v[140:143]
  buffer_load_dwordx4 v2, s[12:15], s20 offen lds
  v_mfma_f32_16x16x32_bf16 v[144:147], a[80:83], a[52:55], v[144:147]
  ds_read_b64_tr_b16 a[36:37], v5 offset:0
  v_mfma_f32_16x16x32_bf16 v[148:151], a[84:87], a[52:55], v[148:151]
  ds_read_b64_tr_b16 a[38:39], v5 offset:2048
  v_mfma_f32_16x16x32_bf16 v[152:155], a[88:91], a[52:55], v[152:155]
  ds_read_b64_tr_b16 a[40:41], v4 offset:16384
  s_add_u32 m0, s34, 2048
  v_mfma_f32_16x16x32_bf16 v[156:159], a[92:95], a[52:55], v[156:159]
  buffer_load_dwordx4 v2, s[12:15], s21 offen lds
  v_mfma_f32_16x16x32_bf16 v[160:163], a[80:83], a[56:59], v[160:163]
  ds_read_b64_tr_b16 a[42:43], v4 offset:18432
  v_mfma_f32_16x16x32_bf16 v[164:167], a[84:87], a[56:59], v[164:167]
  ds_read_b64_tr_b16 a[44:45], v5 offset:16384
  v_mfma_f32_16x16x32_bf16 v[168:171], a[88:91], a[56:59], v[168:171]
  ds_read_b64_tr_b16 a[46:47], v5 offset:18432
  s_add_u32 m0, s35, 0
  v_mfma_f32_16x16x32_bf16 v[172:175], a[92:95], a[56:59], v[172:175]
  buffer_load_dwordx4 v3, s[16:19], s28 offen sc1 lds
  v_mfma_f32_16x16x32_bf16 v[176:179], a[80:83], a[60:63], v[176:179]
  ds_read_b128 a[4:7], v6 offset:34816
  v_mfma_f32_16x16x32_bf16 v[180:183], a[84:87], a[60:63], v[180:183]
  ds_read_b128 a[8:11], v6 offset:36864
  v_mfma_f32_16x16x32_bf16 v[184:187], a[88:91], a[60:63], v[184:187]
  ds_read_b128 a[12:15], v6 offset:38912
  s_add_u32 m0, s34, 4096
  v_mfma_f32_16x16x32_bf16 v[188:191], a[92:95], a[60:63], v[188:191]
  buffer_load_dwordx4 v2, s[12:15], s22 offen lds
  v_mfma_f32_16x16x32_bf16 v[192:195], a[80:83], a[64:67], v[192:195]
  ds_read_b128 a[16:19], v6 offset:40960
  v_mfma_f32_16x16x32_bf16 v[196:199], a[84:87], a[64:67], v[196:199]
  ds_read_b128 a[20:23], v6 offset:43008
  v_mfma_f32_16x16x32_bf16 v[200:203], a[88:91], a[64:67], v[200:203]
  ds_read_b128 a[24:27], v6 offset:45056
  s_add_u32 m0, s34, 6144
  v_mfma_f32_16x16x32_bf16 v[204:207], a[92:95], a[64:67], v[204:207]
  buffer_load_dwordx4 v2, s[12:15], s23 offen lds
  v_mfma_f32_16x16x32_bf16 v[208:211], a[80:83], a[68:71], v[208:211]
  ds_read_b128 a[28:31], v6 offset:47104
  v_mfma_f32_16x16x32_bf16 v[212:215], a[84:87], a[68:71], v[212:215]
  v_mfma_f32_16x16x32_bf16 v[216:219], a[88:91], a[68:71], v[216:219]
  s_add_u32 m0, s35, 2048
  v_mfma_f32_16x16x32_bf16 v[220:223], a[92:95], a[68:71], v[220:223]
  buffer_load_dwordx4 v3, s[16:19], s29 offen sc1 lds
  v_mfma_f32_16x16x32_bf16 v[224:227], a[80:83], a[72:75], v[224:227]
  s_sub_u32 s36, s36, 1
  s_cmp_lg_u32 s36, 0
  v_mfma_f32_16x16x32_bf16 v[228:231], a[84:87], a[72:75], v[228:231]
  v_mfma_f32_16x16x32_bf16 v[232:235], a[88:91], a[72:75], v[232:235]
  v_mfma_f32_16x16x32_bf16 v[236:239], a[92:95], a[72:75], v[236:239]
  v_mfma_f32_16x16x32_bf16 v[240:243], a[80:83], a[76:79], v[240:243]
  v_mfma_f32_16x16x32_bf16 v[244:247], a[84:87], a[76:79], v[244:247]
  v_mfma_f32_16x16x32_bf16 v[248:251], a[88:91], a[76:79], v[248:251]
  v_mfma_f32_16x16x32_bf16 v[252:255], a[92:95], a[76:79], v[252:255]
  s_waitcnt lgkmcnt(0)
  s_cbranch_scc1 G_kl
  s_lshl_b32 s48, s45, 11
  s_lshl_b32 s56, s46, 2
  s_add_u32 s48, s48, s56
  s_cmp_eq_u32 s44, 1
  s_cbranch_scc1 G_ep_up
  s_cmp_eq_u32 s44, 2
  s_cbranch_scc1 G_ep_dn
  s_lshr_b32 s56, s46, 4
  s_lshl_b32 s56, s56, 24
  s_lshl_b32 s57, s45, 20
  s_add_u32 s56, s56, s57
  s_and_b32 s57, s46, 15
  s_lshl_b32 s57, s57, 13
  s_add_u32 s56, s56, s57
  s_mov_b32 s57, 126976
  s_add_u32 s48, s48, 0x7600000
  s_branch G_ep_st
G_ep_dn:
  s_lshl_b32 s56, s45, 18
  s_and_b32 s57, s46, 3
  s_lshl_b32 s57, s57, 13
  s_add_u32 s56, s56, s57
  s_lshr_b32 s57, s46, 2
  s_lshl_b32 s57, s57, 22
  s_add_u32 s56, s56, s57
  s_add_u32 s56, s56, 0x4000000
  s_mov_b32 s57, 28672
  s_add_u32 s48, s48, 0x7600200
G_ep_st:
  s_lshl_b32 s58, s95, 10
  s_add_u32 s66, s56, s58
  s_mov_b32 s67, 4096
  s_mov_b32 s74, s57
  s_mov_b32 s78, 4
  v_cvt_pk_bf16_f32 v64, v128, v129
  v_cvt_pk_bf16_f32 v65, v130, v131
  v_cvt_pk_bf16_f32 v66, v132, v133
  v_cvt_pk_bf16_f32 v67, v134, v135
  v_cvt_pk_bf16_f32 v68, v136, v137
  v_cvt_pk_bf16_f32 v69, v138, v139
  v_cvt_pk_bf16_f32 v70, v140, v141
  v_cvt_pk_bf16_f32 v71, v142, v143
  v_cvt_pk_bf16_f32 v72, v144, v145
  v_cvt_pk_bf16_f32 v73, v146, v147
  v_cvt_pk_bf16_f32 v74, v148, v149
  v_cvt_pk_bf16_f32 v75, v150, v151
  v_cvt_pk_bf16_f32 v76, v152, v153
  v_cvt_pk_bf16_f32 v77, v154, v155
  v_cvt_pk_bf16_f32 v78, v156, v157
  v_cvt_pk_bf16_f32 v79, v158, v159
  v_cvt_pk_bf16_f32 v80, v160, v161
  v_cvt_pk_bf16_f32 v81, v162, v163
  v_cvt_pk_bf16_f32 v82, v164, v165
  v_cvt_pk_bf16_f32 v83, v166, v167
  v_cvt_pk_bf16_f32 v84, v168, v169
  v_cvt_pk_bf16_f32 v85, v170, v171
  v_cvt_pk_bf16_f32 v86, v172, v173
  v_cvt_pk_bf16_f32 v87, v174, v175
  v_cvt_pk_bf16_f32 v88, v176, v177
  v_cvt_pk_bf16_f32 v89, v178, v179
  v_cvt_pk_bf16_f32 v90, v180, v181
  v_cvt_pk_bf16_f32 v91, v182, v183
  v_cvt_pk_bf16_f32 v92, v184, v185
  v_cvt_pk_bf16_f32 v93, v186, v187
  v_cvt_pk_bf16_f32 v94, v188, v189
  v_cvt_pk_bf16_f32 v95, v190, v191
  v_cvt_pk_bf16_f32 v96, v192, v193
  v_cvt_pk_bf16_f32 v97, v194, v195
  v_cvt_pk_bf16_f32 v98, v196, v197
  v_cvt_pk_bf16_f32 v99, v198, v199
  v_cvt_pk_bf16_f32 v100, v200, v201
  v_cvt_pk_bf16_f32 v101, v202, v203
  v_cvt_pk_bf16_f32 v102, v204, v205
  v_cvt_pk_bf16_f32 v103, v206, v207
  v_cvt_pk_bf16_f32 v104, v208, v209
  v_cvt_pk_bf16_f32 v105, v210, v211
  v_cvt_pk_bf16_f32 v106, v212, v213
  v_cvt_pk_bf16_f32 v107, v214, v215
  v_cvt_pk_bf16_f32 v108, v216, v217
  v_cvt_pk_bf16_f32 v109, v218, v219
  v_cvt_pk_bf16_f32 v110, v220, v221
  v_cvt_pk_bf16_f32 v111, v222, v223
  v_cvt_pk_bf16_f32 v112, v224, v225
  v_cvt_pk_bf16_f32 v113, v226, v227
  v_cvt_pk_bf16_f32 v114, v228, v229
  v_cvt_pk_bf16_f32 v115, v230, v231
  v_cvt_pk_bf16_f32 v116, v232, v233
  v_cvt_pk_bf16_f32 v117, v234, v235
  v_cvt_pk_bf16_f32 v118, v236, v237
  v_cvt_pk_bf16_f32 v119, v238, v239
  v_cvt_pk_bf16_f32 v120, v240, v241
  v_cvt_pk_bf16_f32 v121, v242, v243
  v_cvt_pk_bf16_f32 v122, v244, v245
  v_cvt_pk_bf16_f32 v123, v246, v247
  v_cvt_pk_bf16_f32 v124, v248, v249
  v_cvt_pk_bf16_f32 v125, v250, v251
  v_cvt_pk_bf16_f32 v126, v252, v253
  v_cvt_pk_bf16_f32 v127, v254, v255
  s_branch G_next
G_ep_up:
  s_mul_i32 s56, s45, 896
  s_lshl_b32 s57, s46, 2
  s_add_u32 s56, s56, s57
  s_add_u32 s56, s56, s95
  s_lshl_b32 s56, s56, 10
  s_add_u32 s66, s56, 0x3000000
  s_add_u32 s48, s48, 0x7600100
  s_mov_b32 s57, 0xbfb8aa3b
  s_mov_b32 s67, 114688
  s_mov_b32 s74, 114688
  s_mov_b32 s78, 2
  v_mul_f32 v32, s57, v128
  v_mul_f32 v33, s57, v129
  v_mul_f32 v34, s57, v130
  v_mul_f32 v35, s57, v131
  v_mul_f32 v36, s57, v132
  v_mul_f32 v37, s57, v133
  v_mul_f32 v38, s57, v134
  v_mul_f32 v39, s57, v135
  v_exp_f32 v32, v32
  v_exp_f32 v33, v33
  v_exp_f32 v34, v34
  v_exp_f32 v35, v35
  v_exp_f32 v36, v36
  v_exp_f32 v37, v37
  v_exp_f32 v38, v38
  v_exp_f32 v39, v39
  v_pk_mul_f32 v[128:129], v[128:129], v[136:137]
  v_pk_mul_f32 v[130:131], v[130:131], v[138:139]
  v_pk_mul_f32 v[132:133], v[132:133], v[140:141]
  v_pk_mul_f32 v[134:135], v[134:135], v[142:143]
  v_add_f32 v32, 1.0, v32
  v_add_f32 v33, 1.0, v33
  v_add_f32 v34, 1.0, v34
  v_add_f32 v35, 1.0, v35
  v_add_f32 v36, 1.0, v36
  v_add_f32 v37, 1.0, v37
  v_add_f32 v38, 1.0, v38
  v_add_f32 v39, 1.0, v39
  v_rcp_f32 v32, v32
  v_rcp_f32 v33, v33
  v_rcp_f32 v34, v34
  v_rcp_f32 v35, v35
  v_rcp_f32 v36, v36
  v_rcp_f32 v37, v37
  v_rcp_f32 v38, v38
  v_rcp_f32 v39, v39
  s_nop 0
  v_pk_mul_f32 v[128:129], v[128:129], v[32:33]
  v_pk_mul_f32 v[130:131], v[130:131], v[34:35]
  v_pk_mul_f32 v[132:133], v[132:133], v[36:37]
  v_pk_mul_f32 v[134:135], v[134:135], v[38:39]
  v_cvt_pk_bf16_f32 v64, v128, v129
  v_cvt_pk_bf16_f32 v65, v130, v131
  v_cvt_pk_bf16_f32 v66, v132, v133
  v_cvt_pk_bf16_f32 v67, v134, v135
  v_mul_f32 v40, s57, v144
  v_mul_f32 v41, s57, v145
  v_mul_f32 v42, s57, v146
  v_mul_f32 v43, s57, v147
  v_mul_f32 v44, s57, v148
  v_mul_f32 v45, s57, v149
  v_mul_f32 v46, s57, v150
  v_mul_f32 v47, s57, v151
  v_exp_f32 v40, v40
  v_exp_f32 v41, v41
  v_exp_f32 v42, v42
  v_exp_f32 v43, v43
  v_exp_f32 v44, v44
  v_exp_f32 v45, v45
  v_exp_f32 v46, v46
  v_exp_f32 v47, v47
  v_pk_mul_f32 v[144:145], v[144:145], v[152:153]
  v_pk_mul_f32 v[146:147], v[146:147], v[154:155]
  v_pk_mul_f32 v[148:149], v[148:149], v[156:157]
  v_pk_mul_f32 v[150:151], v[150:151], v[158:159]
  v_add_f32 v40, 1.0, v40
  v_add_f32 v41, 1.0, v41
  v_add_f32 v42, 1.0, v42
  v_add_f32 v43, 1.0, v43
  v_add_f32 v44, 1.0, v44
  v_add_f32 v45, 1.0, v45
  v_add_f32 v46, 1.0, v46
  v_add_f32 v47, 1.0, v47
  v_rcp_f32 v40, v40
  v_rcp_f32 v41, v41
  v_rcp_f32 v42, v42
  v_rcp_f32 v43, v43
  v_rcp_f32 v44, v44
  v_rcp_f32 v45, v45
  v_rcp_f32 v46, v46
  v_rcp_f32 v47, v47
  s_nop 0
  v_pk_mul_f32 v[144:145], v[144:145], v[40:41]
  v_pk_mul_f32 v[146:147], v[146:147], v[42:43]
  v_pk_mul_f32 v[148:149], v[148:149], v[44:45]
  v_pk_mul_f32 v[150:151], v[150:151], v[46:47]
  v_cvt_pk_bf16_f32 v68, v144, v145
  v_cvt_pk_bf16_f32 v69, v146, v147
  v_cvt_pk_bf16_f32 v70, v148, v149
  v_cvt_pk_bf16_f32 v71, v150, v151
  v_mul_f32 v48, s57, v160
  v_mul_f32 v49, s57, v161
  v_mul_f32 v50, s57, v162
  v_mul_f32 v51, s57, v163
  v_mul_f32 v52, s57, v164
  v_mul_f32 v53, s57, v165
  v_mul_f32 v54, s57, v166
  v_mul_f32 v55, s57, v167
  v_exp_f32 v48, v48
  v_exp_f32 v49, v49
  v_exp_f32 v50, v50
  v_exp_f32 v51, v51
  v_exp_f32 v52, v52
  v_exp_f32 v53, v53
  v_exp_f32 v54, v54
  v_exp_f32 v55, v55
  v_pk_mul_f32 v[160:161], v[160:161], v[168:169]
  v_pk_mul_f32 v[162:163], v[162:163], v[170:171]
  v_pk_mul_f32 v[164:165], v[164:165], v[172:173]
  v_pk_mul_f32 v[166:167], v[166:167], v[174:175]
  v_add_f32 v48, 1.0, v48
  v_add_f32 v49, 1.0, v49
  v_add_f32 v50, 1.0, v50
  v_add_f32 v51, 1.0, v51
  v_add_f32 v52, 1.0, v52
  v_add_f32 v53, 1.0, v53
  v_add_f32 v54, 1.0, v54
  v_add_f32 v55, 1.0, v55
  v_rcp_f32 v48, v48
  v_rcp_f32 v49, v49
  v_rcp_f32 v50, v50
  v_rcp_f32 v51, v51
  v_rcp_f32 v52, v52
  v_rcp_f32 v53, v53
  v_rcp_f32 v54, v54
  v_rcp_f32 v55, v55
  s_nop 0
  v_pk_mul_f32 v[160:161], v[160:161], v[48:49]
  v_pk_mul_f32 v[162:163], v[162:163], v[50:51]
  v_pk_mul_f32 v[164:165], v[164:165], v[52:53]
  v_pk_mul_f32 v[166:167], v[166:167], v[54:55]
  v_cvt_pk_bf16_f32 v72, v160, v161
  v_cvt_pk_bf16_f32 v73, v162, v163
  v_cvt_pk_bf16_f32 v74, v164, v165
  v_cvt_pk_bf16_f32 v75, v166, v167
  v_mul_f32 v56, s57, v176
  v_mul_f32 v57, s57, v177
  v_mul_f32 v58, s57, v178
  v_mul_f32 v59, s57, v179
  v_mul_f32 v60, s57, v180
  v_mul_f32 v61, s57, v181
  v_mul_f32 v62, s57, v182
  v_mul_f32 v63, s57, v183
  v_exp_f32 v56, v56
  v_exp_f32 v57, v57
  v_exp_f32 v58, v58
  v_exp_f32 v59, v59
  v_exp_f32 v60, v60
  v_exp_f32 v61, v61
  v_exp_f32 v62, v62
  v_exp_f32 v63, v63
  v_pk_mul_f32 v[176:177], v[176:177], v[184:185]
  v_pk_mul_f32 v[178:179], v[178:179], v[186:187]
  v_pk_mul_f32 v[180:181], v[180:181], v[188:189]
  v_pk_mul_f32 v[182:183], v[182:183], v[190:191]
  v_add_f32 v56, 1.0, v56
  v_add_f32 v57, 1.0, v57
  v_add_f32 v58, 1.0, v58
  v_add_f32 v59, 1.0, v59
  v_add_f32 v60, 1.0, v60
  v_add_f32 v61, 1.0, v61
  v_add_f32 v62, 1.0, v62
  v_add_f32 v63, 1.0, v63
  v_rcp_f32 v56, v56
  v_rcp_f32 v57, v57
  v_rcp_f32 v58, v58
  v_rcp_f32 v59, v59
  v_rcp_f32 v60, v60
  v_rcp_f32 v61, v61
  v_rcp_f32 v62, v62
  v_rcp_f32 v63, v63
  s_nop 0
  v_pk_mul_f32 v[176:177], v[176:177], v[56:57]
  v_pk_mul_f32 v[178:179], v[178:179], v[58:59]
  v_pk_mul_f32 v[180:181], v[180:181], v[60:61]
  v_pk_mul_f32 v[182:183], v[182:183], v[62:63]
  v_cvt_pk_bf16_f32 v76, v176, v177
  v_cvt_pk_bf16_f32 v77, v178, v179
  v_cvt_pk_bf16_f32 v78, v180, v181
  v_cvt_pk_bf16_f32 v79, v182, v183
  v_mul_f32 v32, s57, v192
  v_mul_f32 v33, s57, v193
  v_mul_f32 v34, s57, v194
  v_mul_f32 v35, s57, v195
  v_mul_f32 v36, s57, v196
  v_mul_f32 v37, s57, v197
  v_mul_f32 v38, s57, v198
  v_mul_f32 v39, s57, v199
  v_exp_f32 v32, v32
  v_exp_f32 v33, v33
  v_exp_f32 v34, v34
  v_exp_f32 v35, v35
  v_exp_f32 v36, v36
  v_exp_f32 v37, v37
  v_exp_f32 v38, v38
  v_exp_f32 v39, v39
  v_pk_mul_f32 v[192:193], v[192:193], v[200:201]
  v_pk_mul_f32 v[194:195], v[194:195], v[202:203]
  v_pk_mul_f32 v[196:197], v[196:197], v[204:205]
  v_pk_mul_f32 v[198:199], v[198:199], v[206:207]
  v_add_f32 v32, 1.0, v32
  v_add_f32 v33, 1.0, v33
  v_add_f32 v34, 1.0, v34
  v_add_f32 v35, 1.0, v35
  v_add_f32 v36, 1.0, v36
  v_add_f32 v37, 1.0, v37
  v_add_f32 v38, 1.0, v38
  v_add_f32 v39, 1.0, v39
  v_rcp_f32 v32, v32
  v_rcp_f32 v33, v33
  v_rcp_f32 v34, v34
  v_rcp_f32 v35, v35
  v_rcp_f32 v36, v36
  v_rcp_f32 v37, v37
  v_rcp_f32 v38, v38
  v_rcp_f32 v39, v39
  s_nop 0
  v_pk_mul_f32 v[192:193], v[192:193], v[32:33]
  v_pk_mul_f32 v[194:195], v[194:195], v[34:35]
  v_pk_mul_f32 v[196:197], v[196:197], v[36:37]
  v_pk_mul_f32 v[198:199], v[198:199], v[38:39]
  v_cvt_pk_bf16_f32 v80, v192, v193
  v_cvt_pk_bf16_f32 v81, v194, v195
  v_cvt_pk_bf16_f32 v82, v196, v197
  v_cvt_pk_bf16_f32 v83, v198, v199
  v_mul_f32 v40, s57, v208
  v_mul_f32 v41, s57, v209
  v_mul_f32 v42, s57, v210
  v_mul_f32 v43, s57, v211
  v_mul_f32 v44, s57, v212
  v_mul_f32 v45, s57, v213
  v_mul_f32 v46, s57, v214
  v_mul_f32 v47, s57, v215
  v_exp_f32 v40, v40
  v_exp_f32 v41, v41
  v_exp_f32 v42, v42
  v_exp_f32 v43, v43
  v_exp_f32 v44, v44
  v_exp_f32 v45, v45
  v_exp_f32 v46, v46
  v_exp_f32 v47, v47
  v_pk_mul_f32 v[208:209], v[208:209], v[216:217]
  v_pk_mul_f32 v[210:211], v[210:211], v[218:219]
  v_pk_mul_f32 v[212:213], v[212:213], v[220:221]
  v_pk_mul_f32 v[214:215], v[214:215], v[222:223]
  v_add_f32 v40, 1.0, v40
  v_add_f32 v41, 1.0, v41
  v_add_f32 v42, 1.0, v42
  v_add_f32 v43, 1.0, v43
  v_add_f32 v44, 1.0, v44
  v_add_f32 v45, 1.0, v45
  v_add_f32 v46, 1.0, v46
  v_add_f32 v47, 1.0, v47
  v_rcp_f32 v40, v40
  v_rcp_f32 v41, v41
  v_rcp_f32 v42, v42
  v_rcp_f32 v43, v43
  v_rcp_f32 v44, v44
  v_rcp_f32 v45, v45
  v_rcp_f32 v46, v46
  v_rcp_f32 v47, v47
  s_nop 0
  v_pk_mul_f32 v[208:209], v[208:209], v[40:41]
  v_pk_mul_f32 v[210:211], v[210:211], v[42:43]
  v_pk_mul_f32 v[212:213], v[212:213], v[44:45]
  v_pk_mul_f32 v[214:215], v[214:215], v[46:47]
  v_cvt_pk_bf16_f32 v84, v208, v209
  v_cvt_pk_bf16_f32 v85, v210, v211
  v_cvt_pk_bf16_f32 v86, v212, v213
  v_cvt_pk_bf16_f32 v87, v214, v215
  v_mul_f32 v48, s57, v224
  v_mul_f32 v49, s57, v225
  v_mul_f32 v50, s57, v226
  v_mul_f32 v51, s57, v227
  v_mul_f32 v52, s57, v228
  v_mul_f32 v53, s57, v229
  v_mul_f32 v54, s57, v230
  v_mul_f32 v55, s57, v231
  v_exp_f32 v48, v48
  v_exp_f32 v49, v49
  v_exp_f32 v50, v50
  v_exp_f32 v51, v51
  v_exp_f32 v52, v52
  v_exp_f32 v53, v53
  v_exp_f32 v54, v54
  v_exp_f32 v55, v55
  v_pk_mul_f32 v[224:225], v[224:225], v[232:233]
  v_pk_mul_f32 v[226:227], v[226:227], v[234:235]
  v_pk_mul_f32 v[228:229], v[228:229], v[236:237]
  v_pk_mul_f32 v[230:231], v[230:231], v[238:239]
  v_add_f32 v48, 1.0, v48
  v_add_f32 v49, 1.0, v49
  v_add_f32 v50, 1.0, v50
  v_add_f32 v51, 1.0, v51
  v_add_f32 v52, 1.0, v52
  v_add_f32 v53, 1.0, v53
  v_add_f32 v54, 1.0, v54
  v_add_f32 v55, 1.0, v55
  v_rcp_f32 v48, v48
  v_rcp_f32 v49, v49
  v_rcp_f32 v50, v50
  v_rcp_f32 v51, v51
  v_rcp_f32 v52, v52
  v_rcp_f32 v53, v53
  v_rcp_f32 v54, v54
  v_rcp_f32 v55, v55
  s_nop 0
  v_pk_mul_f32 v[224:225], v[224:225], v[48:49]
  v_pk_mul_f32 v[226:227], v[226:227], v[50:51]
  v_pk_mul_f32 v[228:229], v[228:229], v[52:53]
  v_pk_mul_f32 v[230:231], v[230:231], v[54:55]
  v_cvt_pk_bf16_f32 v88, v224, v225
  v_cvt_pk_bf16_f32 v89, v226, v227
  v_cvt_pk_bf16_f32 v90, v228, v229
  v_cvt_pk_bf16_f32 v91, v230, v231
  v_mul_f32 v56, s57, v240
  v_mul_f32 v57, s57, v241
  v_mul_f32 v58, s57, v242
  v_mul_f32 v59, s57, v243
  v_mul_f32 v60, s57, v244
  v_mul_f32 v61, s57, v245
  v_mul_f32 v62, s57, v246
  v_mul_f32 v63, s57, v247
  v_exp_f32 v56, v56
  v_exp_f32 v57, v57
  v_exp_f32 v58, v58
  v_exp_f32 v59, v59
  v_exp_f32 v60, v60
  v_exp_f32 v61, v61
  v_exp_f32 v62, v62
  v_exp_f32 v63, v63
  v_pk_mul_f32 v[240:241], v[240:241], v[248:249]
  v_pk_mul_f32 v[242:243], v[242:243], v[250:251]
  v_pk_mul_f32 v[244:245], v[244:245], v[252:253]
  v_pk_mul_f32 v[246:247], v[246:247], v[254:255]
  v_add_f32 v56, 1.0, v56
  v_add_f32 v57, 1.0, v57
  v_add_f32 v58, 1.0, v58
  v_add_f32 v59, 1.0, v59
  v_add_f32 v60, 1.0, v60
  v_add_f32 v61, 1.0, v61
  v_add_f32 v62, 1.0, v62
  v_add_f32 v63, 1.0, v63
  v_rcp_f32 v56, v56
  v_rcp_f32 v57, v57
  v_rcp_f32 v58, v58
  v_rcp_f32 v59, v59
  v_rcp_f32 v60, v60
  v_rcp_f32 v61, v61
  v_rcp_f32 v62, v62
  v_rcp_f32 v63, v63
  s_nop 0
  v_pk_mul_f32 v[240:241], v[240:241], v[56:57]
  v_pk_mul_f32 v[242:243], v[242:243], v[58:59]
  v_pk_mul_f32 v[244:245], v[244:245], v[60:61]
  v_pk_mul_f32 v[246:247], v[246:247], v[62:63]
  v_cvt_pk_bf16_f32 v92, v240, v241
  v_cvt_pk_bf16_f32 v93, v242, v243
  v_cvt_pk_bf16_f32 v94, v244, v245
  v_cvt_pk_bf16_f32 v95, v246, v247
G_next:
  s_bitcmp1_b32 s79, 2
  s_cbranch_scc1 G_now
  s_and_b32 s56, s43, 0xff
  s_cmp_lg_u32 s56, 0
  s_cbranch_scc1 G_cont
G_now:
  buffer_store_dwordx4 v[64:67], v8, s[4:7], s66 offen sc1
  s_add_u32 s66, s66, s67
  buffer_store_dwordx4 v[68:71], v8, s[4:7], s66 offen sc1
  s_add_u32 s66, s66, s74
  buffer_store_dwordx4 v[72:75], v8, s[4:7], s66 offen sc1
  s_add_u32 s66, s66, s67
  buffer_store_dwordx4 v[76:79], v8, s[4:7], s66 offen sc1
  s_add_u32 s66, s66, s74
  buffer_store_dwordx4 v[80:83], v8, s[4:7], s66 offen sc1
  s_add_u32 s66, s66, s67
  buffer_store_dwordx4 v[84:87], v8, s[4:7], s66 offen sc1
  s_add_u32 s66, s66, s74
  buffer_store_dwordx4 v[88:91], v8, s[4:7], s66 offen sc1
  s_add_u32 s66, s66, s67
  buffer_store_dwordx4 v[92:95], v8, s[4:7], s66 offen sc1
  s_add_u32 s66, s66, s74
  s_cmp_eq_u32 s78, 2
  s_cbranch_scc1 G_now2
  buffer_store_dwordx4 v[96:99], v8, s[4:7], s66 offen sc1
  s_add_u32 s66, s66, s67
  buffer_store_dwordx4 v[100:103], v8, s[4:7], s66 offen sc1
  s_add_u32 s66, s66, s74
  buffer_store_dwordx4 v[104:107], v8, s[4:7], s66 offen sc1
  s_add_u32 s66, s66, s67
  buffer_store_dwordx4 v[108:111], v8, s[4:7], s66 offen sc1
  s_add_u32 s66, s66, s74
  buffer_store_dwordx4 v[112:115], v8, s[4:7], s66 offen sc1
  s_add_u32 s66, s66, s67
  buffer_store_dwordx4 v[116:119], v8, s[4:7], s66 offen sc1
  s_add_u32 s66, s66, s74
  buffer_store_dwordx4 v[120:123], v8, s[4:7], s66 offen sc1
  s_add_u32 s66, s66, s67
  buffer_store_dwordx4 v[124:127], v8, s[4:7], s66 offen sc1
  s_add_u32 s66, s66, s74
G_now2:
  s_mov_b32 s78, 0
  s_cmp_eq_u32 s79, 0xffffffff
  s_cbranch_scc1 G_slow
  s_cmp_eq_u32 s48, 0
  s_cbranch_scc1 FS_184
  s_waitcnt vmcnt(0)
  s_barrier
  s_cmp_lg_u32 s95, 0
  s_cbranch_scc1 FS_184
  s_cmp_lg_u32 s47, 0
  s_cbranch_scc1 ED_185
  v_mov_b32 v26, 1
  v_mov_b32 v27, 144
  s_mov_b64 exec, 1
  buffer_atomic_add v26, v27, s[8:11], 0 offen sc0
  s_waitcnt vmcnt(0)
  s_mov_b64 exec, -1
  v_readfirstlane_b32 s97, v26
  s_cmp_lg_u32 s97, 0
  s_cbranch_scc1 EC_186
  v_mov_b32 v28, 0
  v_mov_b32 v29, 0
  v_mov_b32 v30, 0
  v_mov_b32 v31, 0
  v_lshlrev_b32 v27, 4, v1
  s_mov_b32 s97, 0x7600000
  buffer_store_dwordx4 v[28:31], v27, s[4:7], s97 offen offset:0 sc1
  buffer_store_dwordx4 v[28:31], v27, s[4:7], s97 offen offset:1024 sc1
  buffer_store_dwordx4 v[28:31], v27, s[4:7], s97 offen offset:2048 sc1
  buffer_store_dwordx4 v[28:31], v27, s[4:7], s97 offen offset:3072 sc1
  s_mov_b32 s97, 0x7601000
  buffer_store_dwordx4 v[28:31], v27, s[4:7], s97 offen offset:0 sc1
  buffer_store_dwordx4 v[28:31], v27, s[4:7], s97 offen offset:1024 sc1
  buffer_store_dwordx4 v[28:31], v27, s[4:7], s97 offen offset:2048 sc1
  buffer_store_dwordx4 v[28:31], v27, s[4:7], s97 offen offset:3072 sc1
  s_mov_b32 s97, 0x7602000
  buffer_store_dwordx4 v[28:31], v27, s[4:7], s97 offen offset:0 sc1
  buffer_store_dwordx4 v[28:31], v27, s[4:7], s97 offen offset:1024 sc1
  buffer_store_dwordx4 v[28:31], v27, s[4:7], s97 offen offset:2048 sc1
  buffer_store_dwordx4 v[28:31], v27, s[4:7], s97 offen offset:3072 sc1
  s_mov_b32 s97, 0x7603000
  buffer_store_dwordx4 v[28:31], v27, s[4:7], s97 offen offset:0 sc1
  buffer_store_dwordx4 v[28:31], v27, s[4:7], s97 offen offset:1024 sc1
  buffer_store_dwordx4 v[28:31], v27, s[4:7], s97 offen offset:2048 sc1
  buffer_store_dwordx4 v[28:31], v27, s[4:7], s97 offen offset:3072 sc1
  s_mov_b32 s97, 0x7604000
  buffer_store_dwordx4 v[28:31], v27, s[4:7], s97 offen offset:0 sc1
  buffer_store_dwordx4 v[28:31], v27, s[4:7], s97 offen offset:1024 sc1
  buffer_store_dwordx4 v[28:31], v27, s[4:7], s97 offen offset:2048 sc1
  buffer_store_dwordx4 v[28:31], v27, s[4:7], s97 offen offset:3072 sc1
  s_mov_b32 s97, 0x7605000
  buffer_store_dwordx4 v[28:31], v27, s[4:7], s97 offen offset:0 sc1
  buffer_store_dwordx4 v[28:31], v27, s[4:7], s97 offen offset:1024 sc1
  buffer_store_dwordx4 v[28:31], v27, s[4:7], s97 offen offset:2048 sc1
  buffer_store_dwordx4 v[28:31], v27, s[4:7], s97 offen offset:3072 sc1
  s_mov_b32 s97, 0x7606000
  buffer_store_dwordx4 v[28:31], v27, s[4:7], s97 offen offset:0 sc1
  buffer_store_dwordx4 v[28:31], v27, s[4:7], s97 offen offset:1024 sc1
  buffer_store_dwordx4 v[28:31], v27, s[4:7], s97 offen offset:2048 sc1
  buffer_store_dwordx4 v[28:31], v27, s[4:7], s97 offen offset:3072 sc1
  s_mov_b32 s97, 0x7607000
  buffer_store_dwordx4 v[28:31], v27, s[4:7], s97 offen offset:0 sc1
  buffer_store_dwordx4 v[28:31], v27, s[4:7], s97 offen offset:1024 sc1
  buffer_store_dwordx4 v[28:31], v27, s[4:7], s97 offen offset:2048 sc1
  buffer_store_dwordx4 v[28:31], v27, s[4:7], s97 offen offset:3072 sc1
  s_waitcnt vmcnt(0)
  v_mov_b32 v26, 1
  v_mov_b32 v27, 148
  s_mov_b64 exec, 1
  buffer_store_dword v26, v27, s[8:11], 0 offen sc1
  s_mov_b64 exec, -1
EC_186:
  v_mov_b32 v21, 148
W_187:
  buffer_load_dword v20, v21, s[8:11], 0 offen sc1
  s_waitcnt vmcnt(0)
  v_readfirstlane_b32 s97, v20
  s_and_b32 s97, s97, 0x1
  s_cmp_eq_u32 s97, 0x1
  s_cbranch_scc1 WE_188
  s_add_u32 s101, s101, 1
  s_cmp_gt_u32 s101, 262144
  s_cbranch_scc1 L_abort
  s_sleep 8
  s_branch W_187
WE_188:
  s_mov_b32 s47, 1
ED_185:
  v_mov_b32 v20, 1
  v_mov_b32 v21, s48
  s_mov_b64 exec, 1
  buffer_store_dword v20, v21, s[4:7], 0 offen sc1
  s_mov_b64 exec, -1
FS_184:
  s_mov_b32 s48, 0
  s_mov_b32 s43, s79
  s_branch G_run
G_cont:
  s_add_u32 s101, s101, 64
  s_cmp_gt_u32 s101, 262144
  s_cbranch_scc1 L_abort
  s_mov_b32 s43, s79
  s_and_b32 s44, s43, 15
  s_bfe_u32 s45, s43, 0x40004
  s_lshr_b32 s46, s43, 8
  s_mov_b32 s36, 16
  s_branch G_tile
G_event:
  s_sub_u32 s76, s76, 1
  s_add_u32 s77, s77, 1
  s_cmp_ge_u32 s77, 3
  s_cbranch_scc1 G_ev3
  s_cmp_eq_u32 s77, 2
  s_cbranch_scc1 G_ev2
  s_cmp_eq_u32 s78, 0
  s_cbranch_scc1 G_b
  buffer_store_dwordx4 v[64:67], v8, s[4:7], s66 offen sc1
  s_add_u32 s66, s66, s67
  buffer_store_dwordx4 v[68:71], v8, s[4:7], s66 offen sc1
  s_add_u32 s66, s66, s74
  buffer_store_dwordx4 v[72:75], v8, s[4:7], s66 offen sc1
  s_add_u32 s66, s66, s67
  buffer_store_dwordx4 v[76:79], v8, s[4:7], s66 offen sc1
  s_add_u32 s66, s66, s74
  buffer_store_dwordx4 v[80:83], v8, s[4:7], s66 offen sc1
  s_add_u32 s66, s66, s67
  buffer_store_dwordx4 v[84:87], v8, s[4:7], s66 offen sc1
  s_add_u32 s66, s66, s74
  buffer_store_dwordx4 v[88:91], v8, s[4:7], s66 offen sc1
  s_add_u32 s66, s66, s67
  buffer_store_dwordx4 v[92:95], v8, s[4:7], s66 offen sc1
  s_add_u32 s66, s66, s74
  s_branch G_b
G_ev2:
  s_cmp_lg_u32 s78, 4
  s_cbranch_scc1 G_ev2a
  buffer_store_dwordx4 v[96:99], v8, s[4:7], s66 offen sc1
  s_add_u32 s66, s66, s67
  buffer_store_dwordx4 v[100:103], v8, s[4:7], s66 offen sc1
  s_add_u32 s66, s66, s74
  buffer_store_dwordx4 v[104:107], v8, s[4:7], s66 offen sc1
  s_add_u32 s66, s66, s67
  buffer_store_dwordx4 v[108:111], v8, s[4:7], s66 offen sc1
  s_add_u32 s66, s66, s74
  buffer_store_dwordx4 v[112:115], v8, s[4:7], s66 offen sc1
  s_add_u32 s66, s66, s67
  buffer_store_dwordx4 v[116:119], v8, s[4:7], s66 offen sc1
  s_add_u32 s66, s66, s74
  buffer_store_dwordx4 v[120:123], v8, s[4:7], s66 offen sc1
  s_add_u32 s66, s66, s67
  buffer_store_dwordx4 v[124:127], v8, s[4:7], s66 offen sc1
  s_add_u32 s66, s66, s74
G_ev2a:
  s_mov_b32 s78, 0
  s_cmp_eq_u32 s95, 0
  s_cbranch_scc1 G_b
  s_mov_b32 s48, 0
  s_mov_b32 s62, 1
  s_mov_b32 s76, 3
  s_mov_b32 s77, 5
  s_branch G_b
G_ev3:
  s_cmp_eq_u32 s77, 6
  s_cbranch_scc1 G_e3
  s_cmp_eq_u32 s77, 5
  s_cbranch_scc1 G_e2
  s_cmp_eq_u32 s77, 4
  s_cbranch_scc1 G_e1
  s_mov_b32 s76, 8
  s_cmp_eq_u32 s48, 0
  s_cbranch_scc1 G_b
  s_cmp_lg_u32 s47, 0
  s_cbranch_scc1 ED_189
  v_mov_b32 v26, 1
  v_mov_b32 v27, 144
  s_mov_b64 exec, 1
  buffer_atomic_add v26, v27, s[8:11], 0 offen sc0
  s_waitcnt vmcnt(0)
  s_mov_b64 exec, -1
  v_readfirstlane_b32 s97, v26
  s_cmp_lg_u32 s97, 0
  s_cbranch_scc1 EC_190
  v_mov_b32 v28, 0
  v_mov_b32 v29, 0
  v_mov_b32 v30, 0
  v_mov_b32 v31, 0
  v_lshlrev_b32 v27, 4, v1
  s_mov_b32 s97, 0x7600000
  buffer_store_dwordx4 v[28:31], v27, s[4:7], s97 offen offset:0 sc1
  buffer_store_dwordx4 v[28:31], v27, s[4:7], s97 offen offset:1024 sc1
  buffer_store_dwordx4 v[28:31], v27, s[4:7], s97 offen offset:2048 sc1
  buffer_store_dwordx4 v[28:31], v27, s[4:7], s97 offen offset:3072 sc1
  s_mov_b32 s97, 0x7601000
  buffer_store_dwordx4 v[28:31], v27, s[4:7], s97 offen offset:0 sc1
  buffer_store_dwordx4 v[28:31], v27, s[4:7], s97 offen offset:1024 sc1
  buffer_store_dwordx4 v[28:31], v27, s[4:7], s97 offen offset:2048 sc1
  buffer_store_dwordx4 v[28:31], v27, s[4:7], s97 offen offset:3072 sc1
  s_mov_b32 s97, 0x7602000
  buffer_store_dwordx4 v[28:31], v27, s[4:7], s97 offen offset:0 sc1
  buffer_store_dwordx4 v[28:31], v27, s[4:7], s97 offen offset:1024 sc1
  buffer_store_dwordx4 v[28:31], v27, s[4:7], s97 offen offset:2048 sc1
  buffer_store_dwordx4 v[28:31], v27, s[4:7], s97 offen offset:3072 sc1
  s_mov_b32 s97, 0x7603000
  buffer_store_dwordx4 v[28:31], v27, s[4:7], s97 offen offset:0 sc1
  buffer_store_dwordx4 v[28:31], v27, s[4:7], s97 offen offset:1024 sc1
  buffer_store_dwordx4 v[28:31], v27, s[4:7], s97 offen offset:2048 sc1
  buffer_store_dwordx4 v[28:31], v27, s[4:7], s97 offen offset:3072 sc1
  s_mov_b32 s97, 0x7604000
  buffer_store_dwordx4 v[28:31], v27, s[4:7], s97 offen offset:0 sc1
  buffer_store_dwordx4 v[28:31], v27, s[4:7], s97 offen offset:1024 sc1
  buffer_store_dwordx4 v[28:31], v27, s[4:7], s97 offen offset:2048 sc1
  buffer_store_dwordx4 v[28:31], v27, s[4:7], s97 offen offset:3072 sc1
  s_mov_b32 s97, 0x7605000
  buffer_store_dwordx4 v[28:31], v27, s[4:7], s97 offen offset:0 sc1
  buffer_store_dwordx4 v[28:31], v27, s[4:7], s97 offen offset:1024 sc1
  buffer_store_dwordx4 v[28:31], v27, s[4:7], s97 offen offset:2048 sc1
  buffer_store_dwordx4 v[28:31], v27, s[4:7], s97 offen offset:3072 sc1
  s_mov_b32 s97, 0x7606000
  buffer_store_dwordx4 v[28:31], v27, s[4:7], s97 offen offset:0 sc1
  buffer_store_dwordx4 v[28:31], v27, s[4:7], s97 offen offset:1024 sc1
  buffer_store_dwordx4 v[28:31], v27, s[4:7], s97 offen offset:2048 sc1
  buffer_store_dwordx4 v[28:31], v27, s[4:7], s97 offen offset:3072 sc1
  s_mov_b32 s97, 0x7607000
  buffer_store_dwordx4 v[28:31], v27, s[4:7], s97 offen offset:0 sc1
  buffer_store_dwordx4 v[28:31], v27, s[4:7], s97 offen offset:1024 sc1
  buffer_store_dwordx4 v[28:31], v27, s[4:7], s97 offen offset:2048 sc1
  buffer_store_dwordx4 v[28:31], v27, s[4:7], s97 offen offset:3072 sc1
  s_waitcnt vmcnt(0)
  v_mov_b32 v26, 1
  v_mov_b32 v27, 148
  s_mov_b64 exec, 1
  buffer_store_dword v26, v27, s[8:11], 0 offen sc1
  s_mov_b64 exec, -1
EC_190:
  v_mov_b32 v21, 148
W_191:
  buffer_load_dword v20, v21, s[8:11], 0 offen sc1
  s_waitcnt vmcnt(0)
  v_readfirstlane_b32 s97, v20
  s_and_b32 s97, s97, 0x1
  s_cmp_eq_u32 s97, 0x1
  s_cbranch_scc1 WE_192
  s_add_u32 s101, s101, 1
  s_cmp_gt_u32 s101, 262144
  s_cbranch_scc1 L_abort
  s_sleep 8
  s_branch W_191
WE_192:
  s_mov_b32 s47, 1
ED_189:
  v_mov_b32 v20, 1
  v_mov_b32 v21, s48
  s_mov_b64 exec, 1
  buffer_store_dword v20, v21, s[4:7], 0 offen sc1
  s_mov_b64 exec, -1
  s_mov_b32 s48, 0
  s_branch G_b
G_e1:
  s_mov_b32 s76, 5
  s_mov_b32 s59, 0
  s_and_b32 s56, s51, s47
  s_cmp_lg_u32 s56, 0
  s_cbranch_scc1 G_pf1
  v_and_b32 v25, 7, v1
  v_lshlrev_b32 v25, 2, v25
  buffer_load_dword v24, v25, s[8:11], 0 offen offset:128 sc1
  s_cmp_lg_u32 s51, 0
  s_cbranch_scc1 G_pf1
  s_cmp_lg_u32 s62, 0
  s_cbranch_scc1 G_e1x
G_pf1:
  s_cmp_eq_u32 s44, 2
  s_cbranch_scc1 G_e1x
  s_lshl_b32 s56, s49, 3
  s_add_u32 s56, s56, s50
  s_add_u32 s56, s56, 0
  s_lshl_b32 s56, s56, 2
  v_mov_b32 v22, 1
  v_mov_b32 v23, s56
  s_mov_b64 exec, 1
  buffer_atomic_add v22, v23, s[8:11], 0 offen sc0
  s_mov_b64 exec, -1
  s_mov_b32 s59, 1
G_e1x:
  s_mov_b32 s62, 1
  s_branch G_b
G_e2:
  s_mov_b32 s76, 3
  s_and_b32 s56, s51, s47
  s_cmp_lg_u32 s56, 0
  s_cbranch_scc1 G_ver0
  v_cmp_gt_u32 vcc, 32, v24
  s_and_b32 s56, vcc_lo, 15
  s_cmp_eq_u32 s56, 0
  s_cselect_b32 s51, 1, 0
  v_readlane_b32 s47, v24, 5
G_ver0:
  s_mov_b32 s58, 0xffffffff
  s_cmp_eq_u32 s59, 0
  s_cbranch_scc1 G_wnext
  v_readfirstlane_b32 s57, v22
  s_cmp_ge_u32 s57, s53
  s_cbranch_scc1 G_wnext
  s_add_u32 s57, s57, s52
  s_lshl_b32 s57, s57, 2
  s_load_dword s58, s[54:55], s57
  s_waitcnt lgkmcnt(0)
G_wnext:
  v_mov_b32 v26, s58
  v_mov_b32 v27, 147456
  ds_write_b32 v27, v26
  s_branch G_b
G_e3:
  s_mov_b32 s76, -1
  v_mov_b32 v27, 147456
  ds_read_b32 v26, v27
  s_waitcnt lgkmcnt(0)
  v_readfirstlane_b32 s79, v26
  s_cmp_eq_u32 s79, 0xffffffff
  s_cbranch_scc1 G_e3n
  s_and_b32 s56, s43, 0xff
  s_cmp_eq_u32 s56, 0
  s_cbranch_scc1 G_e3n
  s_bitcmp1_b32 s79, 2
  s_cbranch_scc1 G_e3n
  s_mov_b32 s16, s64
  s_mov_b32 s17, s65
  s_mov_b32 s18, 0x400000
  s_mov_b32 s19, 0x20000
  s_mov_b32 s28, 0
  s_mov_b32 s29, 32768
  s_mov_b32 s30, 65536
  s_mov_b32 s31, 98304
  s_mov_b32 s33, 128
  s_bfe_u32 s56, s79, 0x40004
  s_lshl_b32 s56, s56, 18
  s_lshl_b32 s57, s61, 17
  s_add_u32 s56, s56, s57
  v_add_u32 v3, s56, v13
  s_bitcmp1_b32 s79, 0
  s_cbranch_scc1 SU_193
  s_lshr_b32 s56, s79, 12
  s_cmp_eq_u32 s56, 0
  s_cselect_b64 s[12:13], s[68:69], s[70:71]
  s_cmp_eq_u32 s56, 2
  s_cselect_b64 s[12:13], s[72:73], s[12:13]
  s_mov_b32 s14, 0x800000
  s_mov_b32 s15, 0x20000
  s_mov_b32 s20, 0
  s_mov_b32 s21, 32768
  s_mov_b32 s22, 131072
  s_mov_b32 s23, 163840
  s_mov_b32 s24, 262144
  s_mov_b32 s25, 294912
  s_mov_b32 s26, 393216
  s_mov_b32 s27, 425984
  s_mov_b32 s32, 524288
  v_lshlrev_b32 v2, 13, v10
  v_add_u32 v2, v2, v12
  s_bfe_u32 s56, s79, 0x40008
  s_lshl_b32 s56, s56, 9
  s_lshl_b32 s57, s61, 8
  s_add_u32 s56, s56, s57
  v_add_u32 v2, s56, v2
  s_branch SE_194
SU_193:
  s_cmp_eq_u32 s61, 0
  s_cselect_b64 s[12:13], s[80:81], s[82:83]
  s_mov_b32 s14, 0x700000
  s_mov_b32 s15, 0x20000
  s_mov_b32 s20, 0
  s_mov_b32 s21, 28672
  s_mov_b32 s22, 114688
  s_mov_b32 s23, 143360
  s_mov_b32 s24, 229376
  s_mov_b32 s25, 258048
  s_mov_b32 s26, 344064
  s_mov_b32 s27, 372736
  s_mov_b32 s32, 458752
  v_mul_u32_u24 v2, 7168, v10
  v_add_u32 v2, v2, v12
  s_andn2_b32 s56, s79, 0xff
  v_add_u32 v2, s56, v2
SE_194:
  s_branch G_b
G_e3n:
  s_mov_b32 s14, 0
  s_mov_b32 s18, 0
  s_branch G_b
G_comb:
  s_cmp_eq_u32 s48, 0
  s_cbranch_scc1 FS_195
  s_waitcnt vmcnt(0)
  s_barrier
  s_cmp_lg_u32 s95, 0
  s_cbranch_scc1 FS_195
  s_cmp_lg_u32 s47, 0
  s_cbranch_scc1 ED_196
  v_mov_b32 v26, 1
  v_mov_b32 v27, 144
  s_mov_b64 exec, 1
  buffer_atomic_add v26, v27, s[8:11], 0 offen sc0
  s_waitcnt vmcnt(0)
  s_mov_b64 exec, -1
  v_readfirstlane_b32 s97, v26
  s_cmp_lg_u32 s97, 0
  s_cbranch_scc1 EC_197
  v_mov_b32 v28, 0
  v_mov_b32 v29, 0
  v_mov_b32 v30, 0
  v_mov_b32 v31, 0
  v_lshlrev_b32 v27, 4, v1
  s_mov_b32 s97, 0x7600000
  buffer_store_dwordx4 v[28:31], v27, s[4:7], s97 offen offset:0 sc1
  buffer_store_dwordx4 v[28:31], v27, s[4:7], s97 offen offset:1024 sc1
  buffer_store_dwordx4 v[28:31], v27, s[4:7], s97 offen offset:2048 sc1
  buffer_store_dwordx4 v[28:31], v27, s[4:7], s97 offen offset:3072 sc1
  s_mov_b32 s97, 0x7601000
  buffer_store_dwordx4 v[28:31], v27, s[4:7], s97 offen offset:0 sc1
  buffer_store_dwordx4 v[28:31], v27, s[4:7], s97 offen offset:1024 sc1
  buffer_store_dwordx4 v[28:31], v27, s[4:7], s97 offen offset:2048 sc1
  buffer_store_dwordx4 v[28:31], v27, s[4:7], s97 offen offset:3072 sc1
  s_mov_b32 s97, 0x7602000
  buffer_store_dwordx4 v[28:31], v27, s[4:7], s97 offen offset:0 sc1
  buffer_store_dwordx4 v[28:31], v27, s[4:7], s97 offen offset:1024 sc1
  buffer_store_dwordx4 v[28:31], v27, s[4:7], s97 offen offset:2048 sc1
  buffer_store_dwordx4 v[28:31], v27, s[4:7], s97 offen offset:3072 sc1
  s_mov_b32 s97, 0x7603000
  buffer_store_dwordx4 v[28:31], v27, s[4:7], s97 offen offset:0 sc1
  buffer_store_dwordx4 v[28:31], v27, s[4:7], s97 offen offset:1024 sc1
  buffer_store_dwordx4 v[28:31], v27, s[4:7], s97 offen offset:2048 sc1
  buffer_store_dwordx4 v[28:31], v27, s[4:7], s97 offen offset:3072 sc1
  s_mov_b32 s97, 0x7604000
  buffer_store_dwordx4 v[28:31], v27, s[4:7], s97 offen offset:0 sc1
  buffer_store_dwordx4 v[28:31], v27, s[4:7], s97 offen offset:1024 sc1
  buffer_store_dwordx4 v[28:31], v27, s[4:7], s97 offen offset:2048 sc1
  buffer_store_dwordx4 v[28:31], v27, s[4:7], s97 offen offset:3072 sc1
  s_mov_b32 s97, 0x7605000
  buffer_store_dwordx4 v[28:31], v27, s[4:7], s97 offen offset:0 sc1
  buffer_store_dwordx4 v[28:31], v27, s[4:7], s97 offen offset:1024 sc1
  buffer_store_dwordx4 v[28:31], v27, s[4:7], s97 offen offset:2048 sc1
  buffer_store_dwordx4 v[28:31], v27, s[4:7], s97 offen offset:3072 sc1
  s_mov_b32 s97, 0x7606000
  buffer_store_dwordx4 v[28:31], v27, s[4:7], s97 offen offset:0 sc1
  buffer_store_dwordx4 v[28:31], v27, s[4:7], s97 offen offset:1024 sc1
  buffer_store_dwordx4 v[28:31], v27, s[4:7], s97 offen offset:2048 sc1
  buffer_store_dwordx4 v[28:31], v27, s[4:7], s97 offen offset:3072 sc1
  s_mov_b32 s97, 0x7607000
  buffer_store_dwordx4 v[28:31], v27, s[4:7], s97 offen offset:0 sc1
  buffer_store_dwordx4 v[28:31], v27, s[4:7], s97 offen offset:1024 sc1
  buffer_store_dwordx4 v[28:31], v27, s[4:7], s97 offen offset:2048 sc1
  buffer_store_dwordx4 v[28:31], v27, s[4:7], s97 offen offset:3072 sc1
  s_waitcnt vmcnt(0)
  v_mov_b32 v26, 1
  v_mov_b32 v27, 148
  s_mov_b64 exec, 1
  buffer_store_dword v26, v27, s[8:11], 0 offen sc1
  s_mov_b64 exec, -1
EC_197:
  v_mov_b32 v21, 148
W_198:
  buffer_load_dword v20, v21, s[8:11], 0 offen sc1
  s_waitcnt vmcnt(0)
  v_readfirstlane_b32 s97, v20
  s_and_b32 s97, s97, 0x1
  s_cmp_eq_u32 s97, 0x1
  s_cbranch_scc1 WE_199
  s_add_u32 s101, s101, 1
  s_cmp_gt_u32 s101, 262144
  s_cbranch_scc1 L_abort
  s_sleep 8
  s_branch W_198
WE_199:
  s_mov_b32 s47, 1
ED_196:
  v_mov_b32 v20, 1
  v_mov_b32 v21, s48
  s_mov_b64 exec, 1
  buffer_store_dword v20, v21, s[4:7], 0 offen sc1
  s_mov_b64 exec, -1
FS_195:
  s_mov_b32 s48, 0
  s_mov_b32 s16, s64
  s_mov_b32 s17, s65
  s_mov_b32 s18, 0x400000
  s_mov_b32 s19, 0x20000
  s_mov_b32 s12, s86
  s_mov_b32 s13, s87
  s_mov_b32 s14, 0x800
  s_mov_b32 s15, 0x20000
  v_and_b32 v20, 15, v1
  v_lshlrev_b32 v20, 11, v20
  v_lshrrev_b32 v21, 4, v1
  v_lshlrev_b32 v22, 4, v21
  v_add_u32 v3, v20, v22
  s_lshr_b32 s58, s46, 2
  s_lshl_b32 s58, s58, 16
  s_lshl_b32 s57, s95, 9
  s_add_u32 s56, s58, s57
  s_add_u32 s59, s56, 32768
  buffer_load_dwordx4 a[0:3], v3, s[16:19], s56 offen offset:0
  buffer_load_dwordx4 a[32:35], v3, s[16:19], s59 offen offset:0
  buffer_load_dwordx4 a[64:67], v22, s[12:15], s57 offen offset:0
  buffer_load_dwordx4 a[4:7], v3, s[16:19], s56 offen offset:64
  buffer_load_dwordx4 a[36:39], v3, s[16:19], s59 offen offset:64
  buffer_load_dwordx4 a[68:71], v22, s[12:15], s57 offen offset:64
  buffer_load_dwordx4 a[8:11], v3, s[16:19], s56 offen offset:128
  buffer_load_dwordx4 a[40:43], v3, s[16:19], s59 offen offset:128
  buffer_load_dwordx4 a[72:75], v22, s[12:15], s57 offen offset:128
  buffer_load_dwordx4 a[12:15], v3, s[16:19], s56 offen offset:192
  buffer_load_dwordx4 a[44:47], v3, s[16:19], s59 offen offset:192
  buffer_load_dwordx4 a[76:79], v22, s[12:15], s57 offen offset:192
  buffer_load_dwordx4 a[16:19], v3, s[16:19], s56 offen offset:256
  buffer_load_dwordx4 a[48:51], v3, s[16:19], s59 offen offset:256
  buffer_load_dwordx4 a[80:83], v22, s[12:15], s57 offen offset:256
  buffer_load_dwordx4 a[20:23], v3, s[16:19], s56 offen offset:320
  buffer_load_dwordx4 a[52:55], v3, s[16:19], s59 offen offset:320
  buffer_load_dwordx4 a[84:87], v22, s[12:15], s57 offen offset:320
  buffer_load_dwordx4 a[24:27], v3, s[16:19], s56 offen offset:384
  buffer_load_dwordx4 a[56:59], v3, s[16:19], s59 offen offset:384
  buffer_load_dwordx4 a[88:91], v22, s[12:15], s57 offen offset:384
  buffer_load_dwordx4 a[28:31], v3, s[16:19], s56 offen offset:448
  buffer_load_dwordx4 a[60:63], v3, s[16:19], s59 offen offset:448
  buffer_load_dwordx4 a[92:95], v22, s[12:15], s57 offen offset:448
  v_and_b32 v23, 1, v21
  v_lshlrev_b32 v23, 5, v23
  v_lshrrev_b32 v24, 1, v21
  v_lshlrev_b32 v24, 4, v24
  v_add3_u32 v2, v20, v23, v24
  s_mov_b32 s12, s88
  s_mov_b32 s13, s89
  s_mov_b32 s14, 0x400000
  s_mov_b32 s15, 0x20000
  s_cmp_lg_u32 s95, 0
  s_cbranch_scc1 WE_200
  s_cmp_lg_u32 s47, 0
  s_cbranch_scc1 ED_201
  v_mov_b32 v26, 1
  v_mov_b32 v27, 144
  s_mov_b64 exec, 1
  buffer_atomic_add v26, v27, s[8:11], 0 offen sc0
  s_waitcnt vmcnt(0)
  s_mov_b64 exec, -1
  v_readfirstlane_b32 s97, v26
  s_cmp_lg_u32 s97, 0
  s_cbranch_scc1 EC_202
  v_mov_b32 v28, 0
  v_mov_b32 v29, 0
  v_mov_b32 v30, 0
  v_mov_b32 v31, 0
  v_lshlrev_b32 v27, 4, v1
  s_mov_b32 s97, 0x7600000
  buffer_store_dwordx4 v[28:31], v27, s[4:7], s97 offen offset:0 sc1
  buffer_store_dwordx4 v[28:31], v27, s[4:7], s97 offen offset:1024 sc1
  buffer_store_dwordx4 v[28:31], v27, s[4:7], s97 offen offset:2048 sc1
  buffer_store_dwordx4 v[28:31], v27, s[4:7], s97 offen offset:3072 sc1
  s_mov_b32 s97, 0x7601000
  buffer_store_dwordx4 v[28:31], v27, s[4:7], s97 offen offset:0 sc1
  buffer_store_dwordx4 v[28:31], v27, s[4:7], s97 offen offset:1024 sc1
  buffer_store_dwordx4 v[28:31], v27, s[4:7], s97 offen offset:2048 sc1
  buffer_store_dwordx4 v[28:31], v27, s[4:7], s97 offen offset:3072 sc1
  s_mov_b32 s97, 0x7602000
  buffer_store_dwordx4 v[28:31], v27, s[4:7], s97 offen offset:0 sc1
  buffer_store_dwordx4 v[28:31], v27, s[4:7], s97 offen offset:1024 sc1
  buffer_store_dwordx4 v[28:31], v27, s[4:7], s97 offen offset:2048 sc1
  buffer_store_dwordx4 v[28:31], v27, s[4:7], s97 offen offset:3072 sc1
  s_mov_b32 s97, 0x7603000
  buffer_store_dwordx4 v[28:31], v27, s[4:7], s97 offen offset:0 sc1
  buffer_store_dwordx4 v[28:31], v27, s[4:7], s97 offen offset:1024 sc1
  buffer_store_dwordx4 v[28:31], v27, s[4:7], s97 offen offset:2048 sc1
  buffer_store_dwordx4 v[28:31], v27, s[4:7], s97 offen offset:3072 sc1
  s_mov_b32 s97, 0x7604000
  buffer_store_dwordx4 v[28:31], v27, s[4:7], s97 offen offset:0 sc1
  buffer_store_dwordx4 v[28:31], v27, s[4:7], s97 offen offset:1024 sc1
  buffer_store_dwordx4 v[28:31], v27, s[4:7], s97 offen offset:2048 sc1
  buffer_store_dwordx4 v[28:31], v27, s[4:7], s97 offen offset:3072 sc1
  s_mov_b32 s97, 0x7605000
  buffer_store_dwordx4 v[28:31], v27, s[4:7], s97 offen offset:0 sc1
  buffer_store_dwordx4 v[28:31], v27, s[4:7], s97 offen offset:1024 sc1
  buffer_store_dwordx4 v[28:31], v27, s[4:7], s97 offen offset:2048 sc1
  buffer_store_dwordx4 v[28:31], v27, s[4:7], s97 offen offset:3072 sc1
  s_mov_b32 s97, 0x7606000
  buffer_store_dwordx4 v[28:31], v27, s[4:7], s97 offen offset:0 sc1
  buffer_store_dwordx4 v[28:31], v27, s[4:7], s97 offen offset:1024 sc1
  buffer_store_dwordx4 v[28:31], v27, s[4:7], s97 offen offset:2048 sc1
  buffer_store_dwordx4 v[28:31], v27, s[4:7], s97 offen offset:3072 sc1
  s_mov_b32 s97, 0x7607000
  buffer_store_dwordx4 v[28:31], v27, s[4:7], s97 offen offset:0 sc1
  buffer_store_dwordx4 v[28:31], v27, s[4:7], s97 offen offset:1024 sc1
  buffer_store_dwordx4 v[28:31], v27, s[4:7], s97 offen offset:2048 sc1
  buffer_store_dwordx4 v[28:31], v27, s[4:7], s97 offen offset:3072 sc1
  s_waitcnt vmcnt(0)
  v_mov_b32 v26, 1
  v_mov_b32 v27, 148
  s_mov_b64 exec, 1
  buffer_store_dword v26, v27, s[8:11], 0 offen sc1
  s_mov_b64 exec, -1
EC_202:
  v_mov_b32 v21, 148
W_203:
  buffer_load_dword v20, v21, s[8:11], 0 offen sc1
  s_waitcnt vmcnt(0)
  v_readfirstlane_b32 s97, v20
  s_and_b32 s97, s97, 0x1
  s_cmp_eq_u32 s97, 0x1
  s_cbranch_scc1 WE_204
  s_add_u32 s101, s101, 1
  s_cmp_gt_u32 s101, 262144
  s_cbranch_scc1 L_abort
  s_sleep 8
  s_branch W_203
WE_204:
  s_mov_b32 s47, 1
ED_201:
  s_lshl_b32 s56, s45, 11
  s_add_u32 s56, s56, 0x7600200
  v_lshlrev_b32 v24, 2, v1
  s_mov_b32 exec_lo, 0xff
  s_mov_b32 exec_hi, 0x0
F_205:
  buffer_load_dword v20, v24, s[4:7], s56 offen sc1
  s_waitcnt vmcnt(0)
  v_cmp_eq_u32 vcc, 0, v20
  s_cbranch_vccz FE_206
  s_add_u32 s101, s101, 1
  s_cmp_gt_u32 s101, 262144
  s_cbranch_scc1 L_abort
  s_sleep 16
  s_branch F_205
FE_206:
  s_mov_b64 exec, -1
WE_200:
  s_barrier
  s_cmp_ge_u32 s45, 14
  s_cbranch_scc1 G_c15
G_cbig:
  s_and_b32 s56, s46, 3
  s_lshl_b32 s56, s56, 3
  s_mul_i32 s59, s95, 4
  s_add_u32 s59, s59, s56
  s_lshl_b32 s56, s59, 10
  s_add_u32 s36, s58, s56
  s_add_u32 s56, s36, 0x4000000
  buffer_load_dwordx4 v[32:35], v8, s[4:7], s56 offen offset:0 sc1
  buffer_load_dwordx4 v[36:39], v8, s[4:7], s56 offen offset:1024 sc1
  buffer_load_dwordx4 v[40:43], v8, s[4:7], s56 offen offset:2048 sc1
  buffer_load_dwordx4 v[44:47], v8, s[4:7], s56 offen offset:3072 sc1
  s_add_u32 s56, s36, 0x4008000
  buffer_load_dwordx4 v[48:51], v8, s[4:7], s56 offen offset:0 sc1
  buffer_load_dwordx4 v[52:55], v8, s[4:7], s56 offen offset:1024 sc1
  buffer_load_dwordx4 v[56:59], v8, s[4:7], s56 offen offset:2048 sc1
  buffer_load_dwordx4 v[60:63], v8, s[4:7], s56 offen offset:3072 sc1
  s_add_u32 s56, s36, 0x4400000
  buffer_load_dwordx4 v[64:67], v8, s[4:7], s56 offen offset:0 sc1
  buffer_load_dwordx4 v[68:71], v8, s[4:7], s56 offen offset:1024 sc1
  buffer_load_dwordx4 v[72:75], v8, s[4:7], s56 offen offset:2048 sc1
  buffer_load_dwordx4 v[76:79], v8, s[4:7], s56 offen offset:3072 sc1
  s_add_u32 s56, s36, 0x4408000
  buffer_load_dwordx4 v[80:83], v8, s[4:7], s56 offen offset:0 sc1
  buffer_load_dwordx4 v[84:87], v8, s[4:7], s56 offen offset:1024 sc1
  buffer_load_dwordx4 v[88:91], v8, s[4:7], s56 offen offset:2048 sc1
  buffer_load_dwordx4 v[92:95], v8, s[4:7], s56 offen offset:3072 sc1
  s_waitcnt vmcnt(16)
  v_mfma_f32_16x16x32_bf16 v[224:227], a[64:67], a[0:3], 0
  v_mfma_f32_16x16x32_bf16 v[228:231], a[64:67], a[32:35], 0
  v_mfma_f32_16x16x32_bf16 v[224:227], a[68:71], a[4:7], v[224:227]
  v_mfma_f32_16x16x32_bf16 v[228:231], a[68:71], a[36:39], v[228:231]
  v_mfma_f32_16x16x32_bf16 v[224:227], a[72:75], a[8:11], v[224:227]
  v_mfma_f32_16x16x32_bf16 v[228:231], a[72:75], a[40:43], v[228:231]
  v_mfma_f32_16x16x32_bf16 v[224:227], a[76:79], a[12:15], v[224:227]
  v_mfma_f32_16x16x32_bf16 v[228:231], a[76:79], a[44:47], v[228:231]
  v_mfma_f32_16x16x32_bf16 v[224:227], a[80:83], a[16:19], v[224:227]
  v_mfma_f32_16x16x32_bf16 v[228:231], a[80:83], a[48:51], v[228:231]
  v_mfma_f32_16x16x32_bf16 v[224:227], a[84:87], a[20:23], v[224:227]
  v_mfma_f32_16x16x32_bf16 v[228:231], a[84:87], a[52:55], v[228:231]
  v_mfma_f32_16x16x32_bf16 v[224:227], a[88:91], a[24:27], v[224:227]
  v_mfma_f32_16x16x32_bf16 v[228:231], a[88:91], a[56:59], v[228:231]
  v_mfma_f32_16x16x32_bf16 v[224:227], a[92:95], a[28:31], v[224:227]
  v_mfma_f32_16x16x32_bf16 v[228:231], a[92:95], a[60:63], v[228:231]
  v_lshlrev_b32 v25, 3, v0
  v_add_u32 v25, 147520, v25
  v_lshlrev_b32 v6, 3, v1
  v_add_u32 v3, 147520, v6
  s_nop 7
  ds_write2_b32 v25, v224, v228 offset0:0 offset1:1
  s_waitcnt lgkmcnt(0)
  s_cmp_lg_u32 s95, 0
  s_cbranch_scc1 WE_207
  s_cmp_lg_u32 s47, 0
  s_cbranch_scc1 ED_208
  v_mov_b32 v26, 1
  v_mov_b32 v27, 144
  s_mov_b64 exec, 1
  buffer_atomic_add v26, v27, s[8:11], 0 offen sc0
  s_waitcnt vmcnt(0)
  s_mov_b64 exec, -1
  v_readfirstlane_b32 s97, v26
  s_cmp_lg_u32 s97, 0
  s_cbranch_scc1 EC_209
  v_mov_b32 v28, 0
  v_mov_b32 v29, 0
  v_mov_b32 v30, 0
  v_mov_b32 v31, 0
  v_lshlrev_b32 v27, 4, v1
  s_mov_b32 s97, 0x7600000
  buffer_store_dwordx4 v[28:31], v27, s[4:7], s97 offen offset:0 sc1
  buffer_store_dwordx4 v[28:31], v27, s[4:7], s97 offen offset:1024 sc1
  buffer_store_dwordx4 v[28:31], v27, s[4:7], s97 offen offset:2048 sc1
  buffer_store_dwordx4 v[28:31], v27, s[4:7], s97 offen offset:3072 sc1
  s_mov_b32 s97, 0x7601000
  buffer_store_dwordx4 v[28:31], v27, s[4:7], s97 offen offset:0 sc1
  buffer_store_dwordx4 v[28:31], v27, s[4:7], s97 offen offset:1024 sc1
  buffer_store_dwordx4 v[28:31], v27, s[4:7], s97 offen offset:2048 sc1
  buffer_store_dwordx4 v[28:31], v27, s[4:7], s97 offen offset:3072 sc1
  s_mov_b32 s97, 0x7602000
  buffer_store_dwordx4 v[28:31], v27, s[4:7], s97 offen offset:0 sc1
  buffer_store_dwordx4 v[28:31], v27, s[4:7], s97 offen offset:1024 sc1
  buffer_store_dwordx4 v[28:31], v27, s[4:7], s97 offen offset:2048 sc1
  buffer_store_dwordx4 v[28:31], v27, s[4:7], s97 offen offset:3072 sc1
  s_mov_b32 s97, 0x7603000
  buffer_store_dwordx4 v[28:31], v27, s[4:7], s97 offen offset:0 sc1
  buffer_store_dwordx4 v[28:31], v27, s[4:7], s97 offen offset:1024 sc1
  buffer_store_dwordx4 v[28:31], v27, s[4:7], s97 offen offset:2048 sc1
  buffer_store_dwordx4 v[28:31], v27, s[4:7], s97 offen offset:3072 sc1
  s_mov_b32 s97, 0x7604000
  buffer_store_dwordx4 v[28:31], v27, s[4:7], s97 offen offset:0 sc1
  buffer_store_dwordx4 v[28:31], v27, s[4:7], s97 offen offset:1024 sc1
  buffer_store_dwordx4 v[28:31], v27, s[4:7], s97 offen offset:2048 sc1
  buffer_store_dwordx4 v[28:31], v27, s[4:7], s97 offen offset:3072 sc1
  s_mov_b32 s97, 0x7605000
  buffer_store_dwordx4 v[28:31], v27, s[4:7], s97 offen offset:0 sc1
  buffer_store_dwordx4 v[28:31], v27, s[4:7], s97 offen offset:1024 sc1
  buffer_store_dwordx4 v[28:31], v27, s[4:7], s97 offen offset:2048 sc1
  buffer_store_dwordx4 v[28:31], v27, s[4:7], s97 offen offset:3072 sc1
  s_mov_b32 s97, 0x7606000
  buffer_store_dwordx4 v[28:31], v27, s[4:7], s97 offen offset:0 sc1
  buffer_store_dwordx4 v[28:31], v27, s[4:7], s97 offen offset:1024 sc1
  buffer_store_dwordx4 v[28:31], v27, s[4:7], s97 offen offset:2048 sc1
  buffer_store_dwordx4 v[28:31], v27, s[4:7], s97 offen offset:3072 sc1
  s_mov_b32 s97, 0x7607000
  buffer_store_dwordx4 v[28:31], v27, s[4:7], s97 offen offset:0 sc1
  buffer_store_dwordx4 v[28:31], v27, s[4:7], s97 offen offset:1024 sc1
  buffer_store_dwordx4 v[28:31], v27, s[4:7], s97 offen offset:2048 sc1
  buffer_store_dwordx4 v[28:31], v27, s[4:7], s97 offen offset:3072 sc1
  s_waitcnt vmcnt(0)
  v_mov_b32 v26, 1
  v_mov_b32 v27, 148
  s_mov_b64 exec, 1
  buffer_store_dword v26, v27, s[8:11], 0 offen sc1
  s_mov_b64 exec, -1
EC_209:
  v_mov_b32 v21, 148
W_210:
  buffer_load_dword v20, v21, s[8:11], 0 offen sc1
  s_waitcnt vmcnt(0)
  v_readfirstlane_b32 s97, v20
  s_and_b32 s97, s97, 0x1
  s_cmp_eq_u32 s97, 0x1
  s_cbranch_scc1 WE_211
  s_add_u32 s101, s101, 1
  s_cmp_gt_u32 s101, 262144
  s_cbranch_scc1 L_abort
  s_sleep 8
  s_branch W_210
WE_211:
  s_mov_b32 s47, 1
ED_208:
  s_lshl_b32 s56, s45, 11
  s_add_u32 s56, s56, 0x7600300
  v_lshlrev_b32 v24, 2, v1
  s_mov_b32 exec_lo, 0xffffffff
  s_mov_b32 exec_hi, 0x0
F_212:
  buffer_load_dword v20, v24, s[4:7], s56 offen sc1
  s_waitcnt vmcnt(0)
  v_cmp_eq_u32 vcc, 0, v20
  s_cbranch_vccz FE_213
  s_add_u32 s101, s101, 1
  s_cmp_gt_u32 s101, 262144
  s_cbranch_scc1 L_abort
  s_sleep 8
  s_branch F_212
FE_213:
  s_mov_b64 exec, -1
WE_207:
  s_barrier
  s_lshl_b32 s56, s59, 11
  s_add_u32 s36, s58, s56
  s_add_u32 s56, s36, 0x4800000
  buffer_load_dwordx4 v[96:99], v8, s[4:7], s56 offen offset:0 sc1
  buffer_load_dwordx4 v[100:103], v8, s[4:7], s56 offen offset:1024 sc1
  buffer_load_dwordx4 v[104:107], v8, s[4:7], s56 offen offset:2048 sc1
  buffer_load_dwordx4 v[108:111], v8, s[4:7], s56 offen offset:3072 sc1
  s_add_u32 s56, s36, 0x4801000
  buffer_load_dwordx4 v[112:115], v8, s[4:7], s56 offen offset:0 sc1
  buffer_load_dwordx4 v[116:119], v8, s[4:7], s56 offen offset:1024 sc1
  buffer_load_dwordx4 v[120:123], v8, s[4:7], s56 offen offset:2048 sc1
  buffer_load_dwordx4 v[124:127], v8, s[4:7], s56 offen offset:3072 sc1
  s_add_u32 s56, s36, 0x4c00000
  buffer_load_dwordx4 v[128:131], v8, s[4:7], s56 offen offset:0 sc1
  buffer_load_dwordx4 v[132:135], v8, s[4:7], s56 offen offset:1024 sc1
  buffer_load_dwordx4 v[136:139], v8, s[4:7], s56 offen offset:2048 sc1
  buffer_load_dwordx4 v[140:143], v8, s[4:7], s56 offen offset:3072 sc1
  s_add_u32 s56, s36, 0x4c01000
  buffer_load_dwordx4 v[144:147], v8, s[4:7], s56 offen offset:0 sc1
  buffer_load_dwordx4 v[148:151], v8, s[4:7], s56 offen offset:1024 sc1
  buffer_load_dwordx4 v[152:155], v8, s[4:7], s56 offen offset:2048 sc1
  buffer_load_dwordx4 v[156:159], v8, s[4:7], s56 offen offset:3072 sc1
  s_add_u32 s56, s36, 0x5000000
  buffer_load_dwordx4 v[160:163], v8, s[4:7], s56 offen offset:0 sc1
  buffer_load_dwordx4 v[164:167], v8, s[4:7], s56 offen offset:1024 sc1
  buffer_load_dwordx4 v[168:171], v8, s[4:7], s56 offen offset:2048 sc1
  buffer_load_dwordx4 v[172:175], v8, s[4:7], s56 offen offset:3072 sc1
  s_add_u32 s56, s36, 0x5001000
  buffer_load_dwordx4 v[176:179], v8, s[4:7], s56 offen offset:0 sc1
  buffer_load_dwordx4 v[180:183], v8, s[4:7], s56 offen offset:1024 sc1
  buffer_load_dwordx4 v[184:187], v8, s[4:7], s56 offen offset:2048 sc1
  buffer_load_dwordx4 v[188:191], v8, s[4:7], s56 offen offset:3072 sc1
  s_add_u32 s56, s36, 0x5400000
  buffer_load_dwordx4 v[192:195], v8, s[4:7], s56 offen offset:0 sc1
  buffer_load_dwordx4 v[196:199], v8, s[4:7], s56 offen offset:1024 sc1
  buffer_load_dwordx4 v[200:203], v8, s[4:7], s56 offen offset:2048 sc1
  buffer_load_dwordx4 v[204:207], v8, s[4:7], s56 offen offset:3072 sc1
  s_add_u32 s56, s36, 0x5401000
  buffer_load_dwordx4 v[208:211], v8, s[4:7], s56 offen offset:0 sc1
  buffer_load_dwordx4 v[212:215], v8, s[4:7], s56 offen offset:1024 sc1
  buffer_load_dwordx4 v[216:219], v8, s[4:7], s56 offen offset:2048 sc1
  buffer_load_dwordx4 v[220:223], v8, s[4:7], s56 offen offset:3072 sc1
  ds_read_b64 v[232:233], v3 offset:0
  ds_read_b64 v[234:235], v3 offset:512
  ds_read_b64 v[236:237], v3 offset:1024
  ds_read_b64 v[238:239], v3 offset:1536
  s_waitcnt lgkmcnt(0)
  v_pk_add_f32 v[232:233], v[232:233], v[234:235]
  v_pk_add_f32 v[236:237], v[236:237], v[238:239]
  v_pk_add_f32 v[4:5], v[232:233], v[236:237]
  v_mul_f32 v4, 0xbfb8aa3b, v4
  v_exp_f32 v4, v4
  s_nop 0
  v_add_f32 v4, 1.0, v4
  v_rcp_f32 v4, v4
  s_nop 0
  v_sub_f32 v6, 1.0, v4
  v_mul_f32 v5, 0xbfb8aa3b, v5
  v_exp_f32 v5, v5
  s_nop 0
  v_add_f32 v5, 1.0, v5
  v_rcp_f32 v5, v5
  s_nop 0
  v_sub_f32 v7, 1.0, v5
  s_waitcnt vmcnt(32)
  v_lshlrev_b32 v224, 16, v32
  v_and_b32 v225, 0xffff0000, v32
  v_lshlrev_b32 v226, 16, v64
  v_and_b32 v227, 0xffff0000, v64
  v_pk_add_f32 v[224:225], v[224:225], v[226:227]
  v_mul_f32 v32, v6, v224
  v_mul_f32 v64, v6, v225
  v_lshlrev_b32 v224, 16, v33
  v_and_b32 v225, 0xffff0000, v33
  v_lshlrev_b32 v226, 16, v65
  v_and_b32 v227, 0xffff0000, v65
  v_pk_add_f32 v[224:225], v[224:225], v[226:227]
  v_mul_f32 v33, v6, v224
  v_mul_f32 v65, v6, v225
  v_lshlrev_b32 v224, 16, v34
  v_and_b32 v225, 0xffff0000, v34
  v_lshlrev_b32 v226, 16, v66
  v_and_b32 v227, 0xffff0000, v66
  v_pk_add_f32 v[224:225], v[224:225], v[226:227]
  v_mul_f32 v34, v6, v224
  v_mul_f32 v66, v6, v225
  v_lshlrev_b32 v224, 16, v35
  v_and_b32 v225, 0xffff0000, v35
  v_lshlrev_b32 v226, 16, v67
  v_and_b32 v227, 0xffff0000, v67
  v_pk_add_f32 v[224:225], v[224:225], v[226:227]
  v_mul_f32 v35, v6, v224
  v_mul_f32 v67, v6, v225
  v_lshlrev_b32 v224, 16, v36
  v_and_b32 v225, 0xffff0000, v36
  v_lshlrev_b32 v226, 16, v68
  v_and_b32 v227, 0xffff0000, v68
  v_pk_add_f32 v[224:225], v[224:225], v[226:227]
  v_mul_f32 v36, v6, v224
  v_mul_f32 v68, v6, v225
  v_lshlrev_b32 v224, 16, v37
  v_and_b32 v225, 0xffff0000, v37
  v_lshlrev_b32 v226, 16, v69
  v_and_b32 v227, 0xffff0000, v69
  v_pk_add_f32 v[224:225], v[224:225], v[226:227]
  v_mul_f32 v37, v6, v224
  v_mul_f32 v69, v6, v225
  v_lshlrev_b32 v224, 16, v38
  v_and_b32 v225, 0xffff0000, v38
  v_lshlrev_b32 v226, 16, v70
  v_and_b32 v227, 0xffff0000, v70
  v_pk_add_f32 v[224:225], v[224:225], v[226:227]
  v_mul_f32 v38, v6, v224
  v_mul_f32 v70, v6, v225
  v_lshlrev_b32 v224, 16, v39
  v_and_b32 v225, 0xffff0000, v39
  v_lshlrev_b32 v226, 16, v71
  v_and_b32 v227, 0xffff0000, v71
  v_pk_add_f32 v[224:225], v[224:225], v[226:227]
  v_mul_f32 v39, v6, v224
  v_mul_f32 v71, v6, v225
  v_lshlrev_b32 v224, 16, v40
  v_and_b32 v225, 0xffff0000, v40
  v_lshlrev_b32 v226, 16, v72
  v_and_b32 v227, 0xffff0000, v72
  v_pk_add_f32 v[224:225], v[224:225], v[226:227]
  v_mul_f32 v40, v6, v224
  v_mul_f32 v72, v6, v225
  v_lshlrev_b32 v224, 16, v41
  v_and_b32 v225, 0xffff0000, v41
  v_lshlrev_b32 v226, 16, v73
  v_and_b32 v227, 0xffff0000, v73
  v_pk_add_f32 v[224:225], v[224:225], v[226:227]
  v_mul_f32 v41, v6, v224
  v_mul_f32 v73, v6, v225
  v_lshlrev_b32 v224, 16, v42
  v_and_b32 v225, 0xffff0000, v42
  v_lshlrev_b32 v226, 16, v74
  v_and_b32 v227, 0xffff0000, v74
  v_pk_add_f32 v[224:225], v[224:225], v[226:227]
  v_mul_f32 v42, v6, v224
  v_mul_f32 v74, v6, v225
  v_lshlrev_b32 v224, 16, v43
  v_and_b32 v225, 0xffff0000, v43
  v_lshlrev_b32 v226, 16, v75
  v_and_b32 v227, 0xffff0000, v75
  v_pk_add_f32 v[224:225], v[224:225], v[226:227]
  v_mul_f32 v43, v6, v224
  v_mul_f32 v75, v6, v225
  v_lshlrev_b32 v224, 16, v44
  v_and_b32 v225, 0xffff0000, v44
  v_lshlrev_b32 v226, 16, v76
  v_and_b32 v227, 0xffff0000, v76
  v_pk_add_f32 v[224:225], v[224:225], v[226:227]
  v_mul_f32 v44, v6, v224
  v_mul_f32 v76, v6, v225
  v_lshlrev_b32 v224, 16, v45
  v_and_b32 v225, 0xffff0000, v45
  v_lshlrev_b32 v226, 16, v77
  v_and_b32 v227, 0xffff0000, v77
  v_pk_add_f32 v[224:225], v[224:225], v[226:227]
  v_mul_f32 v45, v6, v224
  v_mul_f32 v77, v6, v225
  v_lshlrev_b32 v224, 16, v46
  v_and_b32 v225, 0xffff0000, v46
  v_lshlrev_b32 v226, 16, v78
  v_and_b32 v227, 0xffff0000, v78
  v_pk_add_f32 v[224:225], v[224:225], v[226:227]
  v_mul_f32 v46, v6, v224
  v_mul_f32 v78, v6, v225
  v_lshlrev_b32 v224, 16, v47
  v_and_b32 v225, 0xffff0000, v47
  v_lshlrev_b32 v226, 16, v79
  v_and_b32 v227, 0xffff0000, v79
  v_pk_add_f32 v[224:225], v[224:225], v[226:227]
  v_mul_f32 v47, v6, v224
  v_mul_f32 v79, v6, v225
  v_lshlrev_b32 v224, 16, v48
  v_and_b32 v225, 0xffff0000, v48
  v_lshlrev_b32 v226, 16, v80
  v_and_b32 v227, 0xffff0000, v80
  v_pk_add_f32 v[224:225], v[224:225], v[226:227]
  v_mul_f32 v48, v7, v224
  v_mul_f32 v80, v7, v225
  v_lshlrev_b32 v224, 16, v49
  v_and_b32 v225, 0xffff0000, v49
  v_lshlrev_b32 v226, 16, v81
  v_and_b32 v227, 0xffff0000, v81
  v_pk_add_f32 v[224:225], v[224:225], v[226:227]
  v_mul_f32 v49, v7, v224
  v_mul_f32 v81, v7, v225
  v_lshlrev_b32 v224, 16, v50
  v_and_b32 v225, 0xffff0000, v50
  v_lshlrev_b32 v226, 16, v82
  v_and_b32 v227, 0xffff0000, v82
  v_pk_add_f32 v[224:225], v[224:225], v[226:227]
  v_mul_f32 v50, v7, v224
  v_mul_f32 v82, v7, v225
  v_lshlrev_b32 v224, 16, v51
  v_and_b32 v225, 0xffff0000, v51
  v_lshlrev_b32 v226, 16, v83
  v_and_b32 v227, 0xffff0000, v83
  v_pk_add_f32 v[224:225], v[224:225], v[226:227]
  v_mul_f32 v51, v7, v224
  v_mul_f32 v83, v7, v225
  v_lshlrev_b32 v224, 16, v52
  v_and_b32 v225, 0xffff0000, v52
  v_lshlrev_b32 v226, 16, v84
  v_and_b32 v227, 0xffff0000, v84
  v_pk_add_f32 v[224:225], v[224:225], v[226:227]
  v_mul_f32 v52, v7, v224
  v_mul_f32 v84, v7, v225
  v_lshlrev_b32 v224, 16, v53
  v_and_b32 v225, 0xffff0000, v53
  v_lshlrev_b32 v226, 16, v85
  v_and_b32 v227, 0xffff0000, v85
  v_pk_add_f32 v[224:225], v[224:225], v[226:227]
  v_mul_f32 v53, v7, v224
  v_mul_f32 v85, v7, v225
  v_lshlrev_b32 v224, 16, v54
  v_and_b32 v225, 0xffff0000, v54
  v_lshlrev_b32 v226, 16, v86
  v_and_b32 v227, 0xffff0000, v86
  v_pk_add_f32 v[224:225], v[224:225], v[226:227]
  v_mul_f32 v54, v7, v224
  v_mul_f32 v86, v7, v225
  v_lshlrev_b32 v224, 16, v55
  v_and_b32 v225, 0xffff0000, v55
  v_lshlrev_b32 v226, 16, v87
  v_and_b32 v227, 0xffff0000, v87
  v_pk_add_f32 v[224:225], v[224:225], v[226:227]
  v_mul_f32 v55, v7, v224
  v_mul_f32 v87, v7, v225
  v_lshlrev_b32 v224, 16, v56
  v_and_b32 v225, 0xffff0000, v56
  v_lshlrev_b32 v226, 16, v88
  v_and_b32 v227, 0xffff0000, v88
  v_pk_add_f32 v[224:225], v[224:225], v[226:227]
  v_mul_f32 v56, v7, v224
  v_mul_f32 v88, v7, v225
  v_lshlrev_b32 v224, 16, v57
  v_and_b32 v225, 0xffff0000, v57
  v_lshlrev_b32 v226, 16, v89
  v_and_b32 v227, 0xffff0000, v89
  v_pk_add_f32 v[224:225], v[224:225], v[226:227]
  v_mul_f32 v57, v7, v224
  v_mul_f32 v89, v7, v225
  v_lshlrev_b32 v224, 16, v58
  v_and_b32 v225, 0xffff0000, v58
  v_lshlrev_b32 v226, 16, v90
  v_and_b32 v227, 0xffff0000, v90
  v_pk_add_f32 v[224:225], v[224:225], v[226:227]
  v_mul_f32 v58, v7, v224
  v_mul_f32 v90, v7, v225
  v_lshlrev_b32 v224, 16, v59
  v_and_b32 v225, 0xffff0000, v59
  v_lshlrev_b32 v226, 16, v91
  v_and_b32 v227, 0xffff0000, v91
  v_pk_add_f32 v[224:225], v[224:225], v[226:227]
  v_mul_f32 v59, v7, v224
  v_mul_f32 v91, v7, v225
  v_lshlrev_b32 v224, 16, v60
  v_and_b32 v225, 0xffff0000, v60
  v_lshlrev_b32 v226, 16, v92
  v_and_b32 v227, 0xffff0000, v92
  v_pk_add_f32 v[224:225], v[224:225], v[226:227]
  v_mul_f32 v60, v7, v224
  v_mul_f32 v92, v7, v225
  v_lshlrev_b32 v224, 16, v61
  v_and_b32 v225, 0xffff0000, v61
  v_lshlrev_b32 v226, 16, v93
  v_and_b32 v227, 0xffff0000, v93
  v_pk_add_f32 v[224:225], v[224:225], v[226:227]
  v_mul_f32 v61, v7, v224
  v_mul_f32 v93, v7, v225
  v_lshlrev_b32 v224, 16, v62
  v_and_b32 v225, 0xffff0000, v62
  v_lshlrev_b32 v226, 16, v94
  v_and_b32 v227, 0xffff0000, v94
  v_pk_add_f32 v[224:225], v[224:225], v[226:227]
  v_mul_f32 v62, v7, v224
  v_mul_f32 v94, v7, v225
  v_lshlrev_b32 v224, 16, v63
  v_and_b32 v225, 0xffff0000, v63
  v_lshlrev_b32 v226, 16, v95
  v_and_b32 v227, 0xffff0000, v95
  v_pk_add_f32 v[224:225], v[224:225], v[226:227]
  v_mul_f32 v63, v7, v224
  v_mul_f32 v95, v7, v225
  s_lshl_b32 s56, s59, 6
  s_add_u32 s56, s58, s56
  s_add_u32 s57, s56, 32768
  s_waitcnt vmcnt(0)
  v_lshlrev_b32 v224, 16, v96
  v_and_b32 v225, 0xffff0000, v96
  v_lshlrev_b32 v226, 16, v128
  v_and_b32 v227, 0xffff0000, v128
  v_lshlrev_b32 v228, 16, v160
  v_and_b32 v229, 0xffff0000, v160
  v_lshlrev_b32 v230, 16, v192
  v_and_b32 v231, 0xffff0000, v192
  v_pk_add_f32 v[224:225], v[224:225], v[226:227]
  v_pk_add_f32 v[228:229], v[228:229], v[230:231]
  v_pk_add_f32 v[224:225], v[224:225], v[228:229]
  v_fma_f32 v224, v4, v224, v32
  v_fma_f32 v225, v4, v225, v64
  v_cvt_pk_bf16_f32 v232, v224, v225
  v_lshlrev_b32 v224, 16, v97
  v_and_b32 v225, 0xffff0000, v97
  v_lshlrev_b32 v226, 16, v129
  v_and_b32 v227, 0xffff0000, v129
  v_lshlrev_b32 v228, 16, v161
  v_and_b32 v229, 0xffff0000, v161
  v_lshlrev_b32 v230, 16, v193
  v_and_b32 v231, 0xffff0000, v193
  v_pk_add_f32 v[224:225], v[224:225], v[226:227]
  v_pk_add_f32 v[228:229], v[228:229], v[230:231]
  v_pk_add_f32 v[224:225], v[224:225], v[228:229]
  v_fma_f32 v224, v4, v224, v33
  v_fma_f32 v225, v4, v225, v65
  v_cvt_pk_bf16_f32 v233, v224, v225
  v_lshlrev_b32 v224, 16, v100
  v_and_b32 v225, 0xffff0000, v100
  v_lshlrev_b32 v226, 16, v132
  v_and_b32 v227, 0xffff0000, v132
  v_lshlrev_b32 v228, 16, v164
  v_and_b32 v229, 0xffff0000, v164
  v_lshlrev_b32 v230, 16, v196
  v_and_b32 v231, 0xffff0000, v196
  v_pk_add_f32 v[224:225], v[224:225], v[226:227]
  v_pk_add_f32 v[228:229], v[228:229], v[230:231]
  v_pk_add_f32 v[224:225], v[224:225], v[228:229]
  v_fma_f32 v224, v4, v224, v34
  v_fma_f32 v225, v4, v225, v66
  v_cvt_pk_bf16_f32 v234, v224, v225
  v_lshlrev_b32 v224, 16, v101
  v_and_b32 v225, 0xffff0000, v101
  v_lshlrev_b32 v226, 16, v133
  v_and_b32 v227, 0xffff0000, v133
  v_lshlrev_b32 v228, 16, v165
  v_and_b32 v229, 0xffff0000, v165
  v_lshlrev_b32 v230, 16, v197
  v_and_b32 v231, 0xffff0000, v197
  v_pk_add_f32 v[224:225], v[224:225], v[226:227]
  v_pk_add_f32 v[228:229], v[228:229], v[230:231]
  v_pk_add_f32 v[224:225], v[224:225], v[228:229]
  v_fma_f32 v224, v4, v224, v35
  v_fma_f32 v225, v4, v225, v67
  v_cvt_pk_bf16_f32 v235, v224, v225
  s_nop 1
  v_permlane16_swap_b32 v232, v234
  v_permlane16_swap_b32 v233, v235
  buffer_store_dwordx4 v[232:235], v2, s[12:15], s56 offen offset:0
  v_lshlrev_b32 v224, 16, v104
  v_and_b32 v225, 0xffff0000, v104
  v_lshlrev_b32 v226, 16, v136
  v_and_b32 v227, 0xffff0000, v136
  v_lshlrev_b32 v228, 16, v168
  v_and_b32 v229, 0xffff0000, v168
  v_lshlrev_b32 v230, 16, v200
  v_and_b32 v231, 0xffff0000, v200
  v_pk_add_f32 v[224:225], v[224:225], v[226:227]
  v_pk_add_f32 v[228:229], v[228:229], v[230:231]
  v_pk_add_f32 v[224:225], v[224:225], v[228:229]
  v_fma_f32 v224, v4, v224, v36
  v_fma_f32 v225, v4, v225, v68
  v_cvt_pk_bf16_f32 v236, v224, v225
  v_lshlrev_b32 v224, 16, v105
  v_and_b32 v225, 0xffff0000, v105
  v_lshlrev_b32 v226, 16, v137
  v_and_b32 v227, 0xffff0000, v137
  v_lshlrev_b32 v228, 16, v169
  v_and_b32 v229, 0xffff0000, v169
  v_lshlrev_b32 v230, 16, v201
  v_and_b32 v231, 0xffff0000, v201
  v_pk_add_f32 v[224:225], v[224:225], v[226:227]
  v_pk_add_f32 v[228:229], v[228:229], v[230:231]
  v_pk_add_f32 v[224:225], v[224:225], v[228:229]
  v_fma_f32 v224, v4, v224, v37
  v_fma_f32 v225, v4, v225, v69
  v_cvt_pk_bf16_f32 v237, v224, v225
  v_lshlrev_b32 v224, 16, v108
  v_and_b32 v225, 0xffff0000, v108
  v_lshlrev_b32 v226, 16, v140
  v_and_b32 v227, 0xffff0000, v140
  v_lshlrev_b32 v228, 16, v172
  v_and_b32 v229, 0xffff0000, v172
  v_lshlrev_b32 v230, 16, v204
  v_and_b32 v231, 0xffff0000, v204
  v_pk_add_f32 v[224:225], v[224:225], v[226:227]
  v_pk_add_f32 v[228:229], v[228:229], v[230:231]
  v_pk_add_f32 v[224:225], v[224:225], v[228:229]
  v_fma_f32 v224, v4, v224, v38
  v_fma_f32 v225, v4, v225, v70
  v_cvt_pk_bf16_f32 v238, v224, v225
  v_lshlrev_b32 v224, 16, v109
  v_and_b32 v225, 0xffff0000, v109
  v_lshlrev_b32 v226, 16, v141
  v_and_b32 v227, 0xffff0000, v141
  v_lshlrev_b32 v228, 16, v173
  v_and_b32 v229, 0xffff0000, v173
  v_lshlrev_b32 v230, 16, v205
  v_and_b32 v231, 0xffff0000, v205
  v_pk_add_f32 v[224:225], v[224:225], v[226:227]
  v_pk_add_f32 v[228:229], v[228:229], v[230:231]
  v_pk_add_f32 v[224:225], v[224:225], v[228:229]
  v_fma_f32 v224, v4, v224, v39
  v_fma_f32 v225, v4, v225, v71
  v_cvt_pk_bf16_f32 v239, v224, v225
  s_nop 1
  v_permlane16_swap_b32 v236, v238
  v_permlane16_swap_b32 v237, v239
  buffer_store_dwordx4 v[236:239], v2, s[12:15], s56 offen offset:64
  v_lshlrev_b32 v224, 16, v112
  v_and_b32 v225, 0xffff0000, v112
  v_lshlrev_b32 v226, 16, v144
  v_and_b32 v227, 0xffff0000, v144
  v_lshlrev_b32 v228, 16, v176
  v_and_b32 v229, 0xffff0000, v176
  v_lshlrev_b32 v230, 16, v208
  v_and_b32 v231, 0xffff0000, v208
  v_pk_add_f32 v[224:225], v[224:225], v[226:227]
  v_pk_add_f32 v[228:229], v[228:229], v[230:231]
  v_pk_add_f32 v[224:225], v[224:225], v[228:229]
  v_fma_f32 v224, v4, v224, v40
  v_fma_f32 v225, v4, v225, v72
  v_cvt_pk_bf16_f32 v240, v224, v225
  v_lshlrev_b32 v224, 16, v113
  v_and_b32 v225, 0xffff0000, v113
  v_lshlrev_b32 v226, 16, v145
  v_and_b32 v227, 0xffff0000, v145
  v_lshlrev_b32 v228, 16, v177
  v_and_b32 v229, 0xffff0000, v177
  v_lshlrev_b32 v230, 16, v209
  v_and_b32 v231, 0xffff0000, v209
  v_pk_add_f32 v[224:225], v[224:225], v[226:227]
  v_pk_add_f32 v[228:229], v[228:229], v[230:231]
  v_pk_add_f32 v[224:225], v[224:225], v[228:229]
  v_fma_f32 v224, v4, v224, v41
  v_fma_f32 v225, v4, v225, v73
  v_cvt_pk_bf16_f32 v241, v224, v225
  v_lshlrev_b32 v224, 16, v116
  v_and_b32 v225, 0xffff0000, v116
  v_lshlrev_b32 v226, 16, v148
  v_and_b32 v227, 0xffff0000, v148
  v_lshlrev_b32 v228, 16, v180
  v_and_b32 v229, 0xffff0000, v180
  v_lshlrev_b32 v230, 16, v212
  v_and_b32 v231, 0xffff0000, v212
  v_pk_add_f32 v[224:225], v[224:225], v[226:227]
  v_pk_add_f32 v[228:229], v[228:229], v[230:231]
  v_pk_add_f32 v[224:225], v[224:225], v[228:229]
  v_fma_f32 v224, v4, v224, v42
  v_fma_f32 v225, v4, v225, v74
  v_cvt_pk_bf16_f32 v242, v224, v225
  v_lshlrev_b32 v224, 16, v117
  v_and_b32 v225, 0xffff0000, v117
  v_lshlrev_b32 v226, 16, v149
  v_and_b32 v227, 0xffff0000, v149
  v_lshlrev_b32 v228, 16, v181
  v_and_b32 v229, 0xffff0000, v181
  v_lshlrev_b32 v230, 16, v213
  v_and_b32 v231, 0xffff0000, v213
  v_pk_add_f32 v[224:225], v[224:225], v[226:227]
  v_pk_add_f32 v[228:229], v[228:229], v[230:231]
  v_pk_add_f32 v[224:225], v[224:225], v[228:229]
  v_fma_f32 v224, v4, v224, v43
  v_fma_f32 v225, v4, v225, v75
  v_cvt_pk_bf16_f32 v243, v224, v225
  s_nop 1
  v_permlane16_swap_b32 v240, v242
  v_permlane16_swap_b32 v241, v243
  buffer_store_dwordx4 v[240:243], v2, s[12:15], s56 offen offset:128
  v_lshlrev_b32 v224, 16, v120
  v_and_b32 v225, 0xffff0000, v120
  v_lshlrev_b32 v226, 16, v152
  v_and_b32 v227, 0xffff0000, v152
  v_lshlrev_b32 v228, 16, v184
  v_and_b32 v229, 0xffff0000, v184
  v_lshlrev_b32 v230, 16, v216
  v_and_b32 v231, 0xffff0000, v216
  v_pk_add_f32 v[224:225], v[224:225], v[226:227]
  v_pk_add_f32 v[228:229], v[228:229], v[230:231]
  v_pk_add_f32 v[224:225], v[224:225], v[228:229]
  v_fma_f32 v224, v4, v224, v44
  v_fma_f32 v225, v4, v225, v76
  v_cvt_pk_bf16_f32 v244, v224, v225
  v_lshlrev_b32 v224, 16, v121
  v_and_b32 v225, 0xffff0000, v121
  v_lshlrev_b32 v226, 16, v153
  v_and_b32 v227, 0xffff0000, v153
  v_lshlrev_b32 v228, 16, v185
  v_and_b32 v229, 0xffff0000, v185
  v_lshlrev_b32 v230, 16, v217
  v_and_b32 v231, 0xffff0000, v217
  v_pk_add_f32 v[224:225], v[224:225], v[226:227]
  v_pk_add_f32 v[228:229], v[228:229], v[230:231]
  v_pk_add_f32 v[224:225], v[224:225], v[228:229]
  v_fma_f32 v224, v4, v224, v45
  v_fma_f32 v225, v4, v225, v77
  v_cvt_pk_bf16_f32 v245, v224, v225
  v_lshlrev_b32 v224, 16, v124
  v_and_b32 v225, 0xffff0000, v124
  v_lshlrev_b32 v226, 16, v156
  v_and_b32 v227, 0xffff0000, v156
  v_lshlrev_b32 v228, 16, v188
  v_and_b32 v229, 0xffff0000, v188
  v_lshlrev_b32 v230, 16, v220
  v_and_b32 v231, 0xffff0000, v220
  v_pk_add_f32 v[224:225], v[224:225], v[226:227]
  v_pk_add_f32 v[228:229], v[228:229], v[230:231]
  v_pk_add_f32 v[224:225], v[224:225], v[228:229]
  v_fma_f32 v224, v4, v224, v46
  v_fma_f32 v225, v4, v225, v78
  v_cvt_pk_bf16_f32 v246, v224, v225
  v_lshlrev_b32 v224, 16, v125
  v_and_b32 v225, 0xffff0000, v125
  v_lshlrev_b32 v226, 16, v157
  v_and_b32 v227, 0xffff0000, v157
  v_lshlrev_b32 v228, 16, v189
  v_and_b32 v229, 0xffff0000, v189
  v_lshlrev_b32 v230, 16, v221
  v_and_b32 v231, 0xffff0000, v221
  v_pk_add_f32 v[224:225], v[224:225], v[226:227]
  v_pk_add_f32 v[228:229], v[228:229], v[230:231]
  v_pk_add_f32 v[224:225], v[224:225], v[228:229]
  v_fma_f32 v224, v4, v224, v47
  v_fma_f32 v225, v4, v225, v79
  v_cvt_pk_bf16_f32 v247, v224, v225
  s_nop 1
  v_permlane16_swap_b32 v244, v246
  v_permlane16_swap_b32 v245, v247
  buffer_store_dwordx4 v[244:247], v2, s[12:15], s56 offen offset:192
  v_lshlrev_b32 v224, 16, v98
  v_and_b32 v225, 0xffff0000, v98
  v_lshlrev_b32 v226, 16, v130
  v_and_b32 v227, 0xffff0000, v130
  v_lshlrev_b32 v228, 16, v162
  v_and_b32 v229, 0xffff0000, v162
  v_lshlrev_b32 v230, 16, v194
  v_and_b32 v231, 0xffff0000, v194
  v_pk_add_f32 v[224:225], v[224:225], v[226:227]
  v_pk_add_f32 v[228:229], v[228:229], v[230:231]
  v_pk_add_f32 v[224:225], v[224:225], v[228:229]
  v_fma_f32 v224, v5, v224, v48
  v_fma_f32 v225, v5, v225, v80
  v_cvt_pk_bf16_f32 v232, v224, v225
  v_lshlrev_b32 v224, 16, v99
  v_and_b32 v225, 0xffff0000, v99
  v_lshlrev_b32 v226, 16, v131
  v_and_b32 v227, 0xffff0000, v131
  v_lshlrev_b32 v228, 16, v163
  v_and_b32 v229, 0xffff0000, v163
  v_lshlrev_b32 v230, 16, v195
  v_and_b32 v231, 0xffff0000, v195
  v_pk_add_f32 v[224:225], v[224:225], v[226:227]
  v_pk_add_f32 v[228:229], v[228:229], v[230:231]
  v_pk_add_f32 v[224:225], v[224:225], v[228:229]
  v_fma_f32 v224, v5, v224, v49
  v_fma_f32 v225, v5, v225, v81
  v_cvt_pk_bf16_f32 v233, v224, v225
  v_lshlrev_b32 v224, 16, v102
  v_and_b32 v225, 0xffff0000, v102
  v_lshlrev_b32 v226, 16, v134
  v_and_b32 v227, 0xffff0000, v134
  v_lshlrev_b32 v228, 16, v166
  v_and_b32 v229, 0xffff0000, v166
  v_lshlrev_b32 v230, 16, v198
  v_and_b32 v231, 0xffff0000, v198
  v_pk_add_f32 v[224:225], v[224:225], v[226:227]
  v_pk_add_f32 v[228:229], v[228:229], v[230:231]
  v_pk_add_f32 v[224:225], v[224:225], v[228:229]
  v_fma_f32 v224, v5, v224, v50
  v_fma_f32 v225, v5, v225, v82
  v_cvt_pk_bf16_f32 v234, v224, v225
  v_lshlrev_b32 v224, 16, v103
  v_and_b32 v225, 0xffff0000, v103
  v_lshlrev_b32 v226, 16, v135
  v_and_b32 v227, 0xffff0000, v135
  v_lshlrev_b32 v228, 16, v167
  v_and_b32 v229, 0xffff0000, v167
  v_lshlrev_b32 v230, 16, v199
  v_and_b32 v231, 0xffff0000, v199
  v_pk_add_f32 v[224:225], v[224:225], v[226:227]
  v_pk_add_f32 v[228:229], v[228:229], v[230:231]
  v_pk_add_f32 v[224:225], v[224:225], v[228:229]
  v_fma_f32 v224, v5, v224, v51
  v_fma_f32 v225, v5, v225, v83
  v_cvt_pk_bf16_f32 v235, v224, v225
  s_nop 1
  v_permlane16_swap_b32 v232, v234
  v_permlane16_swap_b32 v233, v235
  buffer_store_dwordx4 v[232:235], v2, s[12:15], s57 offen offset:0
  v_lshlrev_b32 v224, 16, v106
  v_and_b32 v225, 0xffff0000, v106
  v_lshlrev_b32 v226, 16, v138
  v_and_b32 v227, 0xffff0000, v138
  v_lshlrev_b32 v228, 16, v170
  v_and_b32 v229, 0xffff0000, v170
  v_lshlrev_b32 v230, 16, v202
  v_and_b32 v231, 0xffff0000, v202
  v_pk_add_f32 v[224:225], v[224:225], v[226:227]
  v_pk_add_f32 v[228:229], v[228:229], v[230:231]
  v_pk_add_f32 v[224:225], v[224:225], v[228:229]
  v_fma_f32 v224, v5, v224, v52
  v_fma_f32 v225, v5, v225, v84
  v_cvt_pk_bf16_f32 v236, v224, v225
  v_lshlrev_b32 v224, 16, v107
  v_and_b32 v225, 0xffff0000, v107
  v_lshlrev_b32 v226, 16, v139
  v_and_b32 v227, 0xffff0000, v139
  v_lshlrev_b32 v228, 16, v171
  v_and_b32 v229, 0xffff0000, v171
  v_lshlrev_b32 v230, 16, v203
  v_and_b32 v231, 0xffff0000, v203
  v_pk_add_f32 v[224:225], v[224:225], v[226:227]
  v_pk_add_f32 v[228:229], v[228:229], v[230:231]
  v_pk_add_f32 v[224:225], v[224:225], v[228:229]
  v_fma_f32 v224, v5, v224, v53
  v_fma_f32 v225, v5, v225, v85
  v_cvt_pk_bf16_f32 v237, v224, v225
  v_lshlrev_b32 v224, 16, v110
  v_and_b32 v225, 0xffff0000, v110
  v_lshlrev_b32 v226, 16, v142
  v_and_b32 v227, 0xffff0000, v142
  v_lshlrev_b32 v228, 16, v174
  v_and_b32 v229, 0xffff0000, v174
  v_lshlrev_b32 v230, 16, v206
  v_and_b32 v231, 0xffff0000, v206
  v_pk_add_f32 v[224:225], v[224:225], v[226:227]
  v_pk_add_f32 v[228:229], v[228:229], v[230:231]
  v_pk_add_f32 v[224:225], v[224:225], v[228:229]
  v_fma_f32 v224, v5, v224, v54
  v_fma_f32 v225, v5, v225, v86
  v_cvt_pk_bf16_f32 v238, v224, v225
  v_lshlrev_b32 v224, 16, v111
  v_and_b32 v225, 0xffff0000, v111
  v_lshlrev_b32 v226, 16, v143
  v_and_b32 v227, 0xffff0000, v143
  v_lshlrev_b32 v228, 16, v175
  v_and_b32 v229, 0xffff0000, v175
  v_lshlrev_b32 v230, 16, v207
  v_and_b32 v231, 0xffff0000, v207
  v_pk_add_f32 v[224:225], v[224:225], v[226:227]
  v_pk_add_f32 v[228:229], v[228:229], v[230:231]
  v_pk_add_f32 v[224:225], v[224:225], v[228:229]
  v_fma_f32 v224, v5, v224, v55
  v_fma_f32 v225, v5, v225, v87
  v_cvt_pk_bf16_f32 v239, v224, v225
  s_nop 1
  v_permlane16_swap_b32 v236, v238
  v_permlane16_swap_b32 v237, v239
  buffer_store_dwordx4 v[236:239], v2, s[12:15], s57 offen offset:64
  v_lshlrev_b32 v224, 16, v114
  v_and_b32 v225, 0xffff0000, v114
  v_lshlrev_b32 v226, 16, v146
  v_and_b32 v227, 0xffff0000, v146
  v_lshlrev_b32 v228, 16, v178
  v_and_b32 v229, 0xffff0000, v178
  v_lshlrev_b32 v230, 16, v210
  v_and_b32 v231, 0xffff0000, v210
  v_pk_add_f32 v[224:225], v[224:225], v[226:227]
  v_pk_add_f32 v[228:229], v[228:229], v[230:231]
  v_pk_add_f32 v[224:225], v[224:225], v[228:229]
  v_fma_f32 v224, v5, v224, v56
  v_fma_f32 v225, v5, v225, v88
  v_cvt_pk_bf16_f32 v240, v224, v225
  v_lshlrev_b32 v224, 16, v115
  v_and_b32 v225, 0xffff0000, v115
  v_lshlrev_b32 v226, 16, v147
  v_and_b32 v227, 0xffff0000, v147
  v_lshlrev_b32 v228, 16, v179
  v_and_b32 v229, 0xffff0000, v179
  v_lshlrev_b32 v230, 16, v211
  v_and_b32 v231, 0xffff0000, v211
  v_pk_add_f32 v[224:225], v[224:225], v[226:227]
  v_pk_add_f32 v[228:229], v[228:229], v[230:231]
  v_pk_add_f32 v[224:225], v[224:225], v[228:229]
  v_fma_f32 v224, v5, v224, v57
  v_fma_f32 v225, v5, v225, v89
  v_cvt_pk_bf16_f32 v241, v224, v225
  v_lshlrev_b32 v224, 16, v118
  v_and_b32 v225, 0xffff0000, v118
  v_lshlrev_b32 v226, 16, v150
  v_and_b32 v227, 0xffff0000, v150
  v_lshlrev_b32 v228, 16, v182
  v_and_b32 v229, 0xffff0000, v182
  v_lshlrev_b32 v230, 16, v214
  v_and_b32 v231, 0xffff0000, v214
  v_pk_add_f32 v[224:225], v[224:225], v[226:227]
  v_pk_add_f32 v[228:229], v[228:229], v[230:231]
  v_pk_add_f32 v[224:225], v[224:225], v[228:229]
  v_fma_f32 v224, v5, v224, v58
  v_fma_f32 v225, v5, v225, v90
  v_cvt_pk_bf16_f32 v242, v224, v225
  v_lshlrev_b32 v224, 16, v119
  v_and_b32 v225, 0xffff0000, v119
  v_lshlrev_b32 v226, 16, v151
  v_and_b32 v227, 0xffff0000, v151
  v_lshlrev_b32 v228, 16, v183
  v_and_b32 v229, 0xffff0000, v183
  v_lshlrev_b32 v230, 16, v215
  v_and_b32 v231, 0xffff0000, v215
  v_pk_add_f32 v[224:225], v[224:225], v[226:227]
  v_pk_add_f32 v[228:229], v[228:229], v[230:231]
  v_pk_add_f32 v[224:225], v[224:225], v[228:229]
  v_fma_f32 v224, v5, v224, v59
  v_fma_f32 v225, v5, v225, v91
  v_cvt_pk_bf16_f32 v243, v224, v225
  s_nop 1
  v_permlane16_swap_b32 v240, v242
  v_permlane16_swap_b32 v241, v243
  buffer_store_dwordx4 v[240:243], v2, s[12:15], s57 offen offset:128
  v_lshlrev_b32 v224, 16, v122
  v_and_b32 v225, 0xffff0000, v122
  v_lshlrev_b32 v226, 16, v154
  v_and_b32 v227, 0xffff0000, v154
  v_lshlrev_b32 v228, 16, v186
  v_and_b32 v229, 0xffff0000, v186
  v_lshlrev_b32 v230, 16, v218
  v_and_b32 v231, 0xffff0000, v218
  v_pk_add_f32 v[224:225], v[224:225], v[226:227]
  v_pk_add_f32 v[228:229], v[228:229], v[230:231]
  v_pk_add_f32 v[224:225], v[224:225], v[228:229]
  v_fma_f32 v224, v5, v224, v60
  v_fma_f32 v225, v5, v225, v92
  v_cvt_pk_bf16_f32 v244, v224, v225
  v_lshlrev_b32 v224, 16, v123
  v_and_b32 v225, 0xffff0000, v123
  v_lshlrev_b32 v226, 16, v155
  v_and_b32 v227, 0xffff0000, v155
  v_lshlrev_b32 v228, 16, v187
  v_and_b32 v229, 0xffff0000, v187
  v_lshlrev_b32 v230, 16, v219
  v_and_b32 v231, 0xffff0000, v219
  v_pk_add_f32 v[224:225], v[224:225], v[226:227]
  v_pk_add_f32 v[228:229], v[228:229], v[230:231]
  v_pk_add_f32 v[224:225], v[224:225], v[228:229]
  v_fma_f32 v224, v5, v224, v61
  v_fma_f32 v225, v5, v225, v93
  v_cvt_pk_bf16_f32 v245, v224, v225
  v_lshlrev_b32 v224, 16, v126
  v_and_b32 v225, 0xffff0000, v126
  v_lshlrev_b32 v226, 16, v158
  v_and_b32 v227, 0xffff0000, v158
  v_lshlrev_b32 v228, 16, v190
  v_and_b32 v229, 0xffff0000, v190
  v_lshlrev_b32 v230, 16, v222
  v_and_b32 v231, 0xffff0000, v222
  v_pk_add_f32 v[224:225], v[224:225], v[226:227]
  v_pk_add_f32 v[228:229], v[228:229], v[230:231]
  v_pk_add_f32 v[224:225], v[224:225], v[228:229]
  v_fma_f32 v224, v5, v224, v62
  v_fma_f32 v225, v5, v225, v94
  v_cvt_pk_bf16_f32 v246, v224, v225
  v_lshlrev_b32 v224, 16, v127
  v_and_b32 v225, 0xffff0000, v127
  v_lshlrev_b32 v226, 16, v159
  v_and_b32 v227, 0xffff0000, v159
  v_lshlrev_b32 v228, 16, v191
  v_and_b32 v229, 0xffff0000, v191
  v_lshlrev_b32 v230, 16, v223
  v_and_b32 v231, 0xffff0000, v223
  v_pk_add_f32 v[224:225], v[224:225], v[226:227]
  v_pk_add_f32 v[228:229], v[228:229], v[230:231]
  v_pk_add_f32 v[224:225], v[224:225], v[228:229]
  v_fma_f32 v224, v5, v224, v63
  v_fma_f32 v225, v5, v225, v95
  v_cvt_pk_bf16_f32 v247, v224, v225
  s_nop 1
  v_permlane16_swap_b32 v244, v246
  v_permlane16_swap_b32 v245, v247
  buffer_store_dwordx4 v[244:247], v2, s[12:15], s57 offen offset:192
  s_branch G_cend
G_c15:
  s_and_b32 s56, s46, 3
  s_lshl_b32 s56, s56, 3
  s_mul_i32 s59, s95, 2
  s_add_u32 s59, s59, s56
  s_lshl_b32 s56, s59, 10
  s_add_u32 s36, s58, s56
  s_add_u32 s56, s36, 0x4000000
  buffer_load_dwordx4 v[32:35], v8, s[4:7], s56 offen offset:0 sc1
  buffer_load_dwordx4 v[36:39], v8, s[4:7], s56 offen offset:1024 sc1
  s_add_u32 s56, s36, 0x4008000
  buffer_load_dwordx4 v[40:43], v8, s[4:7], s56 offen offset:0 sc1
  buffer_load_dwordx4 v[44:47], v8, s[4:7], s56 offen offset:1024 sc1
  s_add_u32 s56, s36, 0x4400000
  buffer_load_dwordx4 v[48:51], v8, s[4:7], s56 offen offset:0 sc1
  buffer_load_dwordx4 v[52:55], v8, s[4:7], s56 offen offset:1024 sc1
  s_add_u32 s56, s36, 0x4408000
  buffer_load_dwordx4 v[56:59], v8, s[4:7], s56 offen offset:0 sc1
  buffer_load_dwordx4 v[60:63], v8, s[4:7], s56 offen offset:1024 sc1
  s_waitcnt vmcnt(8)
  v_mfma_f32_16x16x32_bf16 v[224:227], a[64:67], a[0:3], 0
  v_mfma_f32_16x16x32_bf16 v[228:231], a[64:67], a[32:35], 0
  v_mfma_f32_16x16x32_bf16 v[224:227], a[68:71], a[4:7], v[224:227]
  v_mfma_f32_16x16x32_bf16 v[228:231], a[68:71], a[36:39], v[228:231]
  v_mfma_f32_16x16x32_bf16 v[224:227], a[72:75], a[8:11], v[224:227]
  v_mfma_f32_16x16x32_bf16 v[228:231], a[72:75], a[40:43], v[228:231]
  v_mfma_f32_16x16x32_bf16 v[224:227], a[76:79], a[12:15], v[224:227]
  v_mfma_f32_16x16x32_bf16 v[228:231], a[76:79], a[44:47], v[228:231]
  v_mfma_f32_16x16x32_bf16 v[224:227], a[80:83], a[16:19], v[224:227]
  v_mfma_f32_16x16x32_bf16 v[228:231], a[80:83], a[48:51], v[228:231]
  v_mfma_f32_16x16x32_bf16 v[224:227], a[84:87], a[20:23], v[224:227]
  v_mfma_f32_16x16x32_bf16 v[228:231], a[84:87], a[52:55], v[228:231]
  v_mfma_f32_16x16x32_bf16 v[224:227], a[88:91], a[24:27], v[224:227]
  v_mfma_f32_16x16x32_bf16 v[228:231], a[88:91], a[56:59], v[228:231]
  v_mfma_f32_16x16x32_bf16 v[224:227], a[92:95], a[28:31], v[224:227]
  v_mfma_f32_16x16x32_bf16 v[228:231], a[92:95], a[60:63], v[228:231]
  v_lshlrev_b32 v25, 3, v0
  v_add_u32 v25, 147520, v25
  v_lshlrev_b32 v6, 3, v1
  v_add_u32 v3, 147520, v6
  s_nop 7
  ds_write2_b32 v25, v224, v228 offset0:0 offset1:1
  s_waitcnt lgkmcnt(0)
  s_barrier
  ds_read_b64 v[232:233], v3 offset:0
  ds_read_b64 v[234:235], v3 offset:512
  ds_read_b64 v[236:237], v3 offset:1024
  ds_read_b64 v[238:239], v3 offset:1536
  s_waitcnt lgkmcnt(0)
  v_pk_add_f32 v[232:233], v[232:233], v[234:235]
  v_pk_add_f32 v[236:237], v[236:237], v[238:239]
  v_pk_add_f32 v[4:5], v[232:233], v[236:237]
  v_mul_f32 v4, 0xbfb8aa3b, v4
  v_exp_f32 v4, v4
  s_nop 0
  v_add_f32 v4, 1.0, v4
  v_rcp_f32 v4, v4
  s_nop 0
  v_sub_f32 v6, 1.0, v4
  v_mul_f32 v5, 0xbfb8aa3b, v5
  v_exp_f32 v5, v5
  s_nop 0
  v_add_f32 v5, 1.0, v5
  v_rcp_f32 v5, v5
  s_nop 0
  v_sub_f32 v7, 1.0, v5
  s_waitcnt vmcnt(0)
  v_lshlrev_b32 v224, 16, v32
  v_and_b32 v225, 0xffff0000, v32
  v_lshlrev_b32 v226, 16, v48
  v_and_b32 v227, 0xffff0000, v48
  v_pk_add_f32 v[224:225], v[224:225], v[226:227]
  v_mul_f32 v32, v6, v224
  v_mul_f32 v48, v6, v225
  v_lshlrev_b32 v224, 16, v33
  v_and_b32 v225, 0xffff0000, v33
  v_lshlrev_b32 v226, 16, v49
  v_and_b32 v227, 0xffff0000, v49
  v_pk_add_f32 v[224:225], v[224:225], v[226:227]
  v_mul_f32 v33, v6, v224
  v_mul_f32 v49, v6, v225
  v_lshlrev_b32 v224, 16, v34
  v_and_b32 v225, 0xffff0000, v34
  v_lshlrev_b32 v226, 16, v50
  v_and_b32 v227, 0xffff0000, v50
  v_pk_add_f32 v[224:225], v[224:225], v[226:227]
  v_mul_f32 v34, v6, v224
  v_mul_f32 v50, v6, v225
  v_lshlrev_b32 v224, 16, v35
  v_and_b32 v225, 0xffff0000, v35
  v_lshlrev_b32 v226, 16, v51
  v_and_b32 v227, 0xffff0000, v51
  v_pk_add_f32 v[224:225], v[224:225], v[226:227]
  v_mul_f32 v35, v6, v224
  v_mul_f32 v51, v6, v225
  v_lshlrev_b32 v224, 16, v36
  v_and_b32 v225, 0xffff0000, v36
  v_lshlrev_b32 v226, 16, v52
  v_and_b32 v227, 0xffff0000, v52
  v_pk_add_f32 v[224:225], v[224:225], v[226:227]
  v_mul_f32 v36, v6, v224
  v_mul_f32 v52, v6, v225
  v_lshlrev_b32 v224, 16, v37
  v_and_b32 v225, 0xffff0000, v37
  v_lshlrev_b32 v226, 16, v53
  v_and_b32 v227, 0xffff0000, v53
  v_pk_add_f32 v[224:225], v[224:225], v[226:227]
  v_mul_f32 v37, v6, v224
  v_mul_f32 v53, v6, v225
  v_lshlrev_b32 v224, 16, v38
  v_and_b32 v225, 0xffff0000, v38
  v_lshlrev_b32 v226, 16, v54
  v_and_b32 v227, 0xffff0000, v54
  v_pk_add_f32 v[224:225], v[224:225], v[226:227]
  v_mul_f32 v38, v6, v224
  v_mul_f32 v54, v6, v225
  v_lshlrev_b32 v224, 16, v39
  v_and_b32 v225, 0xffff0000, v39
  v_lshlrev_b32 v226, 16, v55
  v_and_b32 v227, 0xffff0000, v55
  v_pk_add_f32 v[224:225], v[224:225], v[226:227]
  v_mul_f32 v39, v6, v224
  v_mul_f32 v55, v6, v225
  v_lshlrev_b32 v224, 16, v40
  v_and_b32 v225, 0xffff0000, v40
  v_lshlrev_b32 v226, 16, v56
  v_and_b32 v227, 0xffff0000, v56
  v_pk_add_f32 v[224:225], v[224:225], v[226:227]
  v_mul_f32 v40, v7, v224
  v_mul_f32 v56, v7, v225
  v_lshlrev_b32 v224, 16, v41
  v_and_b32 v225, 0xffff0000, v41
  v_lshlrev_b32 v226, 16, v57
  v_and_b32 v227, 0xffff0000, v57
  v_pk_add_f32 v[224:225], v[224:225], v[226:227]
  v_mul_f32 v41, v7, v224
  v_mul_f32 v57, v7, v225
  v_lshlrev_b32 v224, 16, v42
  v_and_b32 v225, 0xffff0000, v42
  v_lshlrev_b32 v226, 16, v58
  v_and_b32 v227, 0xffff0000, v58
  v_pk_add_f32 v[224:225], v[224:225], v[226:227]
  v_mul_f32 v42, v7, v224
  v_mul_f32 v58, v7, v225
  v_lshlrev_b32 v224, 16, v43
  v_and_b32 v225, 0xffff0000, v43
  v_lshlrev_b32 v226, 16, v59
  v_and_b32 v227, 0xffff0000, v59
  v_pk_add_f32 v[224:225], v[224:225], v[226:227]
  v_mul_f32 v43, v7, v224
  v_mul_f32 v59, v7, v225
  v_lshlrev_b32 v224, 16, v44
  v_and_b32 v225, 0xffff0000, v44
  v_lshlrev_b32 v226, 16, v60
  v_and_b32 v227, 0xffff0000, v60
  v_pk_add_f32 v[224:225], v[224:225], v[226:227]
  v_mul_f32 v44, v7, v224
  v_mul_f32 v60, v7, v225
  v_lshlrev_b32 v224, 16, v45
  v_and_b32 v225, 0xffff0000, v45
  v_lshlrev_b32 v226, 16, v61
  v_and_b32 v227, 0xffff0000, v61
  v_pk_add_f32 v[224:225], v[224:225], v[226:227]
  v_mul_f32 v45, v7, v224
  v_mul_f32 v61, v7, v225
  v_lshlrev_b32 v224, 16, v46
  v_and_b32 v225, 0xffff0000, v46
  v_lshlrev_b32 v226, 16, v62
  v_and_b32 v227, 0xffff0000, v62
  v_pk_add_f32 v[224:225], v[224:225], v[226:227]
  v_mul_f32 v46, v7, v224
  v_mul_f32 v62, v7, v225
  v_lshlrev_b32 v224, 16, v47
  v_and_b32 v225, 0xffff0000, v47
  v_lshlrev_b32 v226, 16, v63
  v_and_b32 v227, 0xffff0000, v63
  v_pk_add_f32 v[224:225], v[224:225], v[226:227]
  v_mul_f32 v47, v7, v224
  v_mul_f32 v63, v7, v225
  s_cmp_lg_u32 s95, 0
  s_cbranch_scc1 WE_214
  s_cmp_lg_u32 s47, 0
  s_cbranch_scc1 ED_215
  v_mov_b32 v26, 1
  v_mov_b32 v27, 144
  s_mov_b64 exec, 1
  buffer_atomic_add v26, v27, s[8:11], 0 offen sc0
  s_waitcnt vmcnt(0)
  s_mov_b64 exec, -1
  v_readfirstlane_b32 s97, v26
  s_cmp_lg_u32 s97, 0
  s_cbranch_scc1 EC_216
  v_mov_b32 v28, 0
  v_mov_b32 v29, 0
  v_mov_b32 v30, 0
  v_mov_b32 v31, 0
  v_lshlrev_b32 v27, 4, v1
  s_mov_b32 s97, 0x7600000
  buffer_store_dwordx4 v[28:31], v27, s[4:7], s97 offen offset:0 sc1
  buffer_store_dwordx4 v[28:31], v27, s[4:7], s97 offen offset:1024 sc1
  buffer_store_dwordx4 v[28:31], v27, s[4:7], s97 offen offset:2048 sc1
  buffer_store_dwordx4 v[28:31], v27, s[4:7], s97 offen offset:3072 sc1
  s_mov_b32 s97, 0x7601000
  buffer_store_dwordx4 v[28:31], v27, s[4:7], s97 offen offset:0 sc1
  buffer_store_dwordx4 v[28:31], v27, s[4:7], s97 offen offset:1024 sc1
  buffer_store_dwordx4 v[28:31], v27, s[4:7], s97 offen offset:2048 sc1
  buffer_store_dwordx4 v[28:31], v27, s[4:7], s97 offen offset:3072 sc1
  s_mov_b32 s97, 0x7602000
  buffer_store_dwordx4 v[28:31], v27, s[4:7], s97 offen offset:0 sc1
  buffer_store_dwordx4 v[28:31], v27, s[4:7], s97 offen offset:1024 sc1
  buffer_store_dwordx4 v[28:31], v27, s[4:7], s97 offen offset:2048 sc1
  buffer_store_dwordx4 v[28:31], v27, s[4:7], s97 offen offset:3072 sc1
  s_mov_b32 s97, 0x7603000
  buffer_store_dwordx4 v[28:31], v27, s[4:7], s97 offen offset:0 sc1
  buffer_store_dwordx4 v[28:31], v27, s[4:7], s97 offen offset:1024 sc1
  buffer_store_dwordx4 v[28:31], v27, s[4:7], s97 offen offset:2048 sc1
  buffer_store_dwordx4 v[28:31], v27, s[4:7], s97 offen offset:3072 sc1
  s_mov_b32 s97, 0x7604000
  buffer_store_dwordx4 v[28:31], v27, s[4:7], s97 offen offset:0 sc1
  buffer_store_dwordx4 v[28:31], v27, s[4:7], s97 offen offset:1024 sc1
  buffer_store_dwordx4 v[28:31], v27, s[4:7], s97 offen offset:2048 sc1
  buffer_store_dwordx4 v[28:31], v27, s[4:7], s97 offen offset:3072 sc1
  s_mov_b32 s97, 0x7605000
  buffer_store_dwordx4 v[28:31], v27, s[4:7], s97 offen offset:0 sc1
  buffer_store_dwordx4 v[28:31], v27, s[4:7], s97 offen offset:1024 sc1
  buffer_store_dwordx4 v[28:31], v27, s[4:7], s97 offen offset:2048 sc1
  buffer_store_dwordx4 v[28:31], v27, s[4:7], s97 offen offset:3072 sc1
  s_mov_b32 s97, 0x7606000
  buffer_store_dwordx4 v[28:31], v27, s[4:7], s97 offen offset:0 sc1
  buffer_store_dwordx4 v[28:31], v27, s[4:7], s97 offen offset:1024 sc1
  buffer_store_dwordx4 v[28:31], v27, s[4:7], s97 offen offset:2048 sc1
  buffer_store_dwordx4 v[28:31], v27, s[4:7], s97 offen offset:3072 sc1
  s_mov_b32 s97, 0x7607000
  buffer_store_dwordx4 v[28:31], v27, s[4:7], s97 offen offset:0 sc1
  buffer_store_dwordx4 v[28:31], v27, s[4:7], s97 offen offset:1024 sc1
  buffer_store_dwordx4 v[28:31], v27, s[4:7], s97 offen offset:2048 sc1
  buffer_store_dwordx4 v[28:31], v27, s[4:7], s97 offen offset:3072 sc1
  s_waitcnt vmcnt(0)
  v_mov_b32 v26, 1
  v_mov_b32 v27, 148
  s_mov_b64 exec, 1
  buffer_store_dword v26, v27, s[8:11], 0 offen sc1
  s_mov_b64 exec, -1
EC_216:
  v_mov_b32 v21, 148
W_217:
  buffer_load_dword v20, v21, s[8:11], 0 offen sc1
  s_waitcnt vmcnt(0)
  v_readfirstlane_b32 s97, v20
  s_and_b32 s97, s97, 0x1
  s_cmp_eq_u32 s97, 0x1
  s_cbranch_scc1 WE_218
  s_add_u32 s101, s101, 1
  s_cmp_gt_u32 s101, 262144
  s_cbranch_scc1 L_abort
  s_sleep 8
  s_branch W_217
WE_218:
  s_mov_b32 s47, 1
ED_215:
  s_lshl_b32 s56, s45, 11
  s_add_u32 s56, s56, 0x7600300
  s_mov_b32 s56, 0x7600300
  v_lshlrev_b32 v24, 2, v1
  s_mov_b32 exec_lo, 0xffffffff
  s_mov_b32 exec_hi, 0x0
F_219:
  buffer_load_dword v20, v24, s[4:7], s56 offen sc1
  s_waitcnt vmcnt(0)
  v_cmp_eq_u32 vcc, 0, v20
  s_cbranch_vccz FE_220
  s_add_u32 s101, s101, 1
  s_cmp_gt_u32 s101, 262144
  s_cbranch_scc1 L_abort
  s_sleep 2
  s_branch F_219
FE_220:
  s_mov_b64 exec, -1
WE_214:
  s_barrier
  s_mov_b32 s77, 0
G_cp:
  s_lshl_b32 s56, s59, 11
  s_add_u32 s36, s58, s56
  s_add_u32 s56, s36, 0x4800000
  buffer_load_dwordx4 v[64:67], v8, s[4:7], s56 offen offset:0 sc1
  buffer_load_dwordx4 v[68:71], v8, s[4:7], s56 offen offset:1024 sc1
  buffer_load_dwordx4 v[72:75], v8, s[4:7], s56 offen offset:2048 sc1
  buffer_load_dwordx4 v[76:79], v8, s[4:7], s56 offen offset:3072 sc1
  s_add_u32 s56, s36, 0x4c00000
  buffer_load_dwordx4 v[80:83], v8, s[4:7], s56 offen offset:0 sc1
  buffer_load_dwordx4 v[84:87], v8, s[4:7], s56 offen offset:1024 sc1
  buffer_load_dwordx4 v[88:91], v8, s[4:7], s56 offen offset:2048 sc1
  buffer_load_dwordx4 v[92:95], v8, s[4:7], s56 offen offset:3072 sc1
  s_add_u32 s56, s36, 0x5000000
  buffer_load_dwordx4 v[96:99], v8, s[4:7], s56 offen offset:0 sc1
  buffer_load_dwordx4 v[100:103], v8, s[4:7], s56 offen offset:1024 sc1
  buffer_load_dwordx4 v[104:107], v8, s[4:7], s56 offen offset:2048 sc1
  buffer_load_dwordx4 v[108:111], v8, s[4:7], s56 offen offset:3072 sc1
  s_add_u32 s56, s36, 0x5400000
  buffer_load_dwordx4 v[112:115], v8, s[4:7], s56 offen offset:0 sc1
  buffer_load_dwordx4 v[116:119], v8, s[4:7], s56 offen offset:1024 sc1
  buffer_load_dwordx4 v[120:123], v8, s[4:7], s56 offen offset:2048 sc1
  buffer_load_dwordx4 v[124:127], v8, s[4:7], s56 offen offset:3072 sc1
  s_add_u32 s101, s101, 1
  s_cmp_gt_u32 s101, 262144
  s_cbranch_scc1 L_abort
  s_lshl_b32 s56, s59, 6
  s_add_u32 s56, s58, s56
  s_add_u32 s57, s56, 32768
  s_waitcnt vmcnt(0)
  v_max3_u32 v224, v64, v65, v66
  v_max_u32 v225, v67, v67
  v_max3_u32 v224, v224, v68, v69
  v_max3_u32 v225, v225, v70, v71
  v_max3_u32 v224, v224, v72, v73
  v_max3_u32 v225, v225, v74, v75
  v_max3_u32 v224, v224, v76, v77
  v_max3_u32 v225, v225, v78, v79
  v_max3_u32 v224, v224, v80, v81
  v_max3_u32 v225, v225, v82, v83
  v_max3_u32 v224, v224, v84, v85
  v_max3_u32 v225, v225, v86, v87
  v_max3_u32 v224, v224, v88, v89
  v_max3_u32 v225, v225, v90, v91
  v_max3_u32 v224, v224, v92, v93
  v_max3_u32 v225, v225, v94, v95
  v_max3_u32 v224, v224, v96, v97
  v_max3_u32 v225, v225, v98, v99
  v_max3_u32 v224, v224, v100, v101
  v_max3_u32 v225, v225, v102, v103
  v_max3_u32 v224, v224, v104, v105
  v_max3_u32 v225, v225, v106, v107
  v_max3_u32 v224, v224, v108, v109
  v_max3_u32 v225, v225, v110, v111
  v_max3_u32 v224, v224, v112, v113
  v_max3_u32 v225, v225, v114, v115
  v_max3_u32 v224, v224, v116, v117
  v_max3_u32 v225, v225, v118, v119
  v_max3_u32 v224, v224, v120, v121
  v_max3_u32 v225, v225, v122, v123
  v_max3_u32 v224, v224, v124, v125
  v_max3_u32 v225, v225, v126, v127
  v_max_u32 v224, v224, v225
  v_cmp_eq_u32 vcc, -1, v224
  s_cmp_eq_u32 s77, 0
  s_cbranch_scc1 G_cq
  s_cbranch_vccnz G_cp
G_cq:
  v_lshlrev_b32 v224, 16, v64
  v_and_b32 v225, 0xffff0000, v64
  v_lshlrev_b32 v226, 16, v80
  v_and_b32 v227, 0xffff0000, v80
  v_lshlrev_b32 v228, 16, v96
  v_and_b32 v229, 0xffff0000, v96
  v_lshlrev_b32 v230, 16, v112
  v_and_b32 v231, 0xffff0000, v112
  v_pk_add_f32 v[224:225], v[224:225], v[226:227]
  v_pk_add_f32 v[228:229], v[228:229], v[230:231]
  v_pk_add_f32 v[224:225], v[224:225], v[228:229]
  v_fma_f32 v224, v4, v224, v32
  v_fma_f32 v225, v4, v225, v48
  v_cvt_pk_bf16_f32 v232, v224, v225
  v_lshlrev_b32 v224, 16, v65
  v_and_b32 v225, 0xffff0000, v65
  v_lshlrev_b32 v226, 16, v81
  v_and_b32 v227, 0xffff0000, v81
  v_lshlrev_b32 v228, 16, v97
  v_and_b32 v229, 0xffff0000, v97
  v_lshlrev_b32 v230, 16, v113
  v_and_b32 v231, 0xffff0000, v113
  v_pk_add_f32 v[224:225], v[224:225], v[226:227]
  v_pk_add_f32 v[228:229], v[228:229], v[230:231]
  v_pk_add_f32 v[224:225], v[224:225], v[228:229]
  v_fma_f32 v224, v4, v224, v33
  v_fma_f32 v225, v4, v225, v49
  v_cvt_pk_bf16_f32 v233, v224, v225
  v_lshlrev_b32 v224, 16, v68
  v_and_b32 v225, 0xffff0000, v68
  v_lshlrev_b32 v226, 16, v84
  v_and_b32 v227, 0xffff0000, v84
  v_lshlrev_b32 v228, 16, v100
  v_and_b32 v229, 0xffff0000, v100
  v_lshlrev_b32 v230, 16, v116
  v_and_b32 v231, 0xffff0000, v116
  v_pk_add_f32 v[224:225], v[224:225], v[226:227]
  v_pk_add_f32 v[228:229], v[228:229], v[230:231]
  v_pk_add_f32 v[224:225], v[224:225], v[228:229]
  v_fma_f32 v224, v4, v224, v34
  v_fma_f32 v225, v4, v225, v50
  v_cvt_pk_bf16_f32 v234, v224, v225
  v_lshlrev_b32 v224, 16, v69
  v_and_b32 v225, 0xffff0000, v69
  v_lshlrev_b32 v226, 16, v85
  v_and_b32 v227, 0xffff0000, v85
  v_lshlrev_b32 v228, 16, v101
  v_and_b32 v229, 0xffff0000, v101
  v_lshlrev_b32 v230, 16, v117
  v_and_b32 v231, 0xffff0000, v117
  v_pk_add_f32 v[224:225], v[224:225], v[226:227]
  v_pk_add_f32 v[228:229], v[228:229], v[230:231]
  v_pk_add_f32 v[224:225], v[224:225], v[228:229]
  v_fma_f32 v224, v4, v224, v35
  v_fma_f32 v225, v4, v225, v51
  v_cvt_pk_bf16_f32 v235, v224, v225
  s_nop 1
  v_permlane16_swap_b32 v232, v234
  v_permlane16_swap_b32 v233, v235
  v_lshlrev_b32 v224, 16, v72
  v_and_b32 v225, 0xffff0000, v72
  v_lshlrev_b32 v226, 16, v88
  v_and_b32 v227, 0xffff0000, v88
  v_lshlrev_b32 v228, 16, v104
  v_and_b32 v229, 0xffff0000, v104
  v_lshlrev_b32 v230, 16, v120
  v_and_b32 v231, 0xffff0000, v120
  v_pk_add_f32 v[224:225], v[224:225], v[226:227]
  v_pk_add_f32 v[228:229], v[228:229], v[230:231]
  v_pk_add_f32 v[224:225], v[224:225], v[228:229]
  v_fma_f32 v224, v4, v224, v36
  v_fma_f32 v225, v4, v225, v52
  v_cvt_pk_bf16_f32 v236, v224, v225
  v_lshlrev_b32 v224, 16, v73
  v_and_b32 v225, 0xffff0000, v73
  v_lshlrev_b32 v226, 16, v89
  v_and_b32 v227, 0xffff0000, v89
  v_lshlrev_b32 v228, 16, v105
  v_and_b32 v229, 0xffff0000, v105
  v_lshlrev_b32 v230, 16, v121
  v_and_b32 v231, 0xffff0000, v121
  v_pk_add_f32 v[224:225], v[224:225], v[226:227]
  v_pk_add_f32 v[228:229], v[228:229], v[230:231]
  v_pk_add_f32 v[224:225], v[224:225], v[228:229]
  v_fma_f32 v224, v4, v224, v37
  v_fma_f32 v225, v4, v225, v53
  v_cvt_pk_bf16_f32 v237, v224, v225
  v_lshlrev_b32 v224, 16, v76
  v_and_b32 v225, 0xffff0000, v76
  v_lshlrev_b32 v226, 16, v92
  v_and_b32 v227, 0xffff0000, v92
  v_lshlrev_b32 v228, 16, v108
  v_and_b32 v229, 0xffff0000, v108
  v_lshlrev_b32 v230, 16, v124
  v_and_b32 v231, 0xffff0000, v124
  v_pk_add_f32 v[224:225], v[224:225], v[226:227]
  v_pk_add_f32 v[228:229], v[228:229], v[230:231]
  v_pk_add_f32 v[224:225], v[224:225], v[228:229]
  v_fma_f32 v224, v4, v224, v38
  v_fma_f32 v225, v4, v225, v54
  v_cvt_pk_bf16_f32 v238, v224, v225
  v_lshlrev_b32 v224, 16, v77
  v_and_b32 v225, 0xffff0000, v77
  v_lshlrev_b32 v226, 16, v93
  v_and_b32 v227, 0xffff0000, v93
  v_lshlrev_b32 v228, 16, v109
  v_and_b32 v229, 0xffff0000, v109
  v_lshlrev_b32 v230, 16, v125
  v_and_b32 v231, 0xffff0000, v125
  v_pk_add_f32 v[224:225], v[224:225], v[226:227]
  v_pk_add_f32 v[228:229], v[228:229], v[230:231]
  v_pk_add_f32 v[224:225], v[224:225], v[228:229]
  v_fma_f32 v224, v4, v224, v39
  v_fma_f32 v225, v4, v225, v55
  v_cvt_pk_bf16_f32 v239, v224, v225
  s_nop 1
  v_permlane16_swap_b32 v236, v238
  v_permlane16_swap_b32 v237, v239
  v_lshlrev_b32 v224, 16, v66
  v_and_b32 v225, 0xffff0000, v66
  v_lshlrev_b32 v226, 16, v82
  v_and_b32 v227, 0xffff0000, v82
  v_lshlrev_b32 v228, 16, v98
  v_and_b32 v229, 0xffff0000, v98
  v_lshlrev_b32 v230, 16, v114
  v_and_b32 v231, 0xffff0000, v114
  v_pk_add_f32 v[224:225], v[224:225], v[226:227]
  v_pk_add_f32 v[228:229], v[228:229], v[230:231]
  v_pk_add_f32 v[224:225], v[224:225], v[228:229]
  v_fma_f32 v224, v5, v224, v40
  v_fma_f32 v225, v5, v225, v56
  v_cvt_pk_bf16_f32 v240, v224, v225
  v_lshlrev_b32 v224, 16, v67
  v_and_b32 v225, 0xffff0000, v67
  v_lshlrev_b32 v226, 16, v83
  v_and_b32 v227, 0xffff0000, v83
  v_lshlrev_b32 v228, 16, v99
  v_and_b32 v229, 0xffff0000, v99
  v_lshlrev_b32 v230, 16, v115
  v_and_b32 v231, 0xffff0000, v115
  v_pk_add_f32 v[224:225], v[224:225], v[226:227]
  v_pk_add_f32 v[228:229], v[228:229], v[230:231]
  v_pk_add_f32 v[224:225], v[224:225], v[228:229]
  v_fma_f32 v224, v5, v224, v41
  v_fma_f32 v225, v5, v225, v57
  v_cvt_pk_bf16_f32 v241, v224, v225
  v_lshlrev_b32 v224, 16, v70
  v_and_b32 v225, 0xffff0000, v70
  v_lshlrev_b32 v226, 16, v86
  v_and_b32 v227, 0xffff0000, v86
  v_lshlrev_b32 v228, 16, v102
  v_and_b32 v229, 0xffff0000, v102
  v_lshlrev_b32 v230, 16, v118
  v_and_b32 v231, 0xffff0000, v118
  v_pk_add_f32 v[224:225], v[224:225], v[226:227]
  v_pk_add_f32 v[228:229], v[228:229], v[230:231]
  v_pk_add_f32 v[224:225], v[224:225], v[228:229]
  v_fma_f32 v224, v5, v224, v42
  v_fma_f32 v225, v5, v225, v58
  v_cvt_pk_bf16_f32 v242, v224, v225
  v_lshlrev_b32 v224, 16, v71
  v_and_b32 v225, 0xffff0000, v71
  v_lshlrev_b32 v226, 16, v87
  v_and_b32 v227, 0xffff0000, v87
  v_lshlrev_b32 v228, 16, v103
  v_and_b32 v229, 0xffff0000, v103
  v_lshlrev_b32 v230, 16, v119
  v_and_b32 v231, 0xffff0000, v119
  v_pk_add_f32 v[224:225], v[224:225], v[226:227]
  v_pk_add_f32 v[228:229], v[228:229], v[230:231]
  v_pk_add_f32 v[224:225], v[224:225], v[228:229]
  v_fma_f32 v224, v5, v224, v43
  v_fma_f32 v225, v5, v225, v59
  v_cvt_pk_bf16_f32 v243, v224, v225
  s_nop 1
  v_permlane16_swap_b32 v240, v242
  v_permlane16_swap_b32 v241, v243
  v_lshlrev_b32 v224, 16, v74
  v_and_b32 v225, 0xffff0000, v74
  v_lshlrev_b32 v226, 16, v90
  v_and_b32 v227, 0xffff0000, v90
  v_lshlrev_b32 v228, 16, v106
  v_and_b32 v229, 0xffff0000, v106
  v_lshlrev_b32 v230, 16, v122
  v_and_b32 v231, 0xffff0000, v122
  v_pk_add_f32 v[224:225], v[224:225], v[226:227]
  v_pk_add_f32 v[228:229], v[228:229], v[230:231]
  v_pk_add_f32 v[224:225], v[224:225], v[228:229]
  v_fma_f32 v224, v5, v224, v44
  v_fma_f32 v225, v5, v225, v60
  v_cvt_pk_bf16_f32 v244, v224, v225
  v_lshlrev_b32 v224, 16, v75
  v_and_b32 v225, 0xffff0000, v75
  v_lshlrev_b32 v226, 16, v91
  v_and_b32 v227, 0xffff0000, v91
  v_lshlrev_b32 v228, 16, v107
  v_and_b32 v229, 0xffff0000, v107
  v_lshlrev_b32 v230, 16, v123
  v_and_b32 v231, 0xffff0000, v123
  v_pk_add_f32 v[224:225], v[224:225], v[226:227]
  v_pk_add_f32 v[228:229], v[228:229], v[230:231]
  v_pk_add_f32 v[224:225], v[224:225], v[228:229]
  v_fma_f32 v224, v5, v224, v45
  v_fma_f32 v225, v5, v225, v61
  v_cvt_pk_bf16_f32 v245, v224, v225
  v_lshlrev_b32 v224, 16, v78
  v_and_b32 v225, 0xffff0000, v78
  v_lshlrev_b32 v226, 16, v94
  v_and_b32 v227, 0xffff0000, v94
  v_lshlrev_b32 v228, 16, v110
  v_and_b32 v229, 0xffff0000, v110
  v_lshlrev_b32 v230, 16, v126
  v_and_b32 v231, 0xffff0000, v126
  v_pk_add_f32 v[224:225], v[224:225], v[226:227]
  v_pk_add_f32 v[228:229], v[228:229], v[230:231]
  v_pk_add_f32 v[224:225], v[224:225], v[228:229]
  v_fma_f32 v224, v5, v224, v46
  v_fma_f32 v225, v5, v225, v62
  v_cvt_pk_bf16_f32 v246, v224, v225
  v_lshlrev_b32 v224, 16, v79
  v_and_b32 v225, 0xffff0000, v79
  v_lshlrev_b32 v226, 16, v95
  v_and_b32 v227, 0xffff0000, v95
  v_lshlrev_b32 v228, 16, v111
  v_and_b32 v229, 0xffff0000, v111
  v_lshlrev_b32 v230, 16, v127
  v_and_b32 v231, 0xffff0000, v127
  v_pk_add_f32 v[224:225], v[224:225], v[226:227]
  v_pk_add_f32 v[228:229], v[228:229], v[230:231]
  v_pk_add_f32 v[224:225], v[224:225], v[228:229]
  v_fma_f32 v224, v5, v224, v47
  v_fma_f32 v225, v5, v225, v63
  v_cvt_pk_bf16_f32 v247, v224, v225
  s_nop 1
  v_permlane16_swap_b32 v244, v246
  v_permlane16_swap_b32 v245, v247
  s_cmp_lg_u32 s77, 0
  s_cbranch_scc1 G_cs
  v_mov_b32 v21, 147464
  s_cmp_lg_u32 s95, 0
  s_cbranch_scc1 G_cw
  v_mov_b32 v22, 64
  buffer_load_dword v20, v22, s[8:11], 0 offen sc1
  s_waitcnt vmcnt(0)
  ds_write_b32 v21, v20
  s_waitcnt lgkmcnt(0)
G_cw:
  s_barrier
  ds_read_b32 v20, v21
  s_waitcnt lgkmcnt(0)
  v_readfirstlane_b32 s77, v20
  v_bfe_u32 v21, v1, 2, 2
  v_lshlrev_b32 v21, 22, v21
  v_and_b32 v22, 3, v1
  v_lshl_add_u32 v21, v22, 10, v21
  s_add_u32 s56, s36, 0x48003fc
  s_mov_b64 exec, 0xffff
G_cl:
  buffer_load_dword v20, v21, s[4:7], s56 offen sc1
  s_add_u32 s101, s101, 1
  s_cmp_gt_u32 s101, 262144
  s_cbranch_scc1 L_abort
  s_waitcnt vmcnt(0)
  v_cmp_eq_u32 vcc, -1, v20
  s_cbranch_vccnz G_cl
  s_mov_b64 exec, -1
  s_branch G_cp
G_cs:
  buffer_store_dwordx4 v[232:235], v2, s[12:15], s56 offen offset:0
  buffer_store_dwordx4 v[236:239], v2, s[12:15], s56 offen offset:64
  buffer_store_dwordx4 v[240:243], v2, s[12:15], s57 offen offset:0
  buffer_store_dwordx4 v[244:247], v2, s[12:15], s57 offen offset:64
  s_cmp_ge_u32 s77, 144
  s_cbranch_scc1 L_end
G_cend:
  s_branch G_slow
G_pfi:
  s_cmp_eq_u32 s45, 2
  s_cselect_b64 s[12:13], s[80:81], s[84:85]
  s_cmp_eq_u32 s45, 3
  s_cselect_b64 s[12:13], s[82:83], s[12:13]
  s_cmp_eq_u32 s45, 1
  s_cselect_b64 s[12:13], s[64:65], s[12:13]
  s_mov_b32 s56, 0x700000
  s_cselect_b32 s14, 0x400000, s56
  s_mov_b32 s15, 0x20000
  s_cselect_b32 s57, 0x80000, 0
  s_lshl_b32 s56, s46, 2
  s_add_u32 s56, s56, s95
  s_mul_i32 s56, s56, 114688
  s_add_u32 s56, s56, s57
  s_mov_b32 s57, 7
G_pfl:
  buffer_load_dwordx4 v[128:131], v8, s[12:15], s56 offen offset:0
  buffer_load_dwordx4 v[132:135], v8, s[12:15], s56 offen offset:1024
  buffer_load_dwordx4 v[136:139], v8, s[12:15], s56 offen offset:2048
  buffer_load_dwordx4 v[140:143], v8, s[12:15], s56 offen offset:3072
  s_add_u32 s56, s56, 4096
  buffer_load_dwordx4 v[144:147], v8, s[12:15], s56 offen offset:0
  buffer_load_dwordx4 v[148:151], v8, s[12:15], s56 offen offset:1024
  buffer_load_dwordx4 v[152:155], v8, s[12:15], s56 offen offset:2048
  buffer_load_dwordx4 v[156:159], v8, s[12:15], s56 offen offset:3072
  s_add_u32 s56, s56, 4096
  buffer_load_dwordx4 v[160:163], v8, s[12:15], s56 offen offset:0
  buffer_load_dwordx4 v[164:167], v8, s[12:15], s56 offen offset:1024
  buffer_load_dwordx4 v[168:171], v8, s[12:15], s56 offen offset:2048
  buffer_load_dwordx4 v[172:175], v8, s[12:15], s56 offen offset:3072
  s_add_u32 s56, s56, 4096
  buffer_load_dwordx4 v[176:179], v8, s[12:15], s56 offen offset:0
  buffer_load_dwordx4 v[180:183], v8, s[12:15], s56 offen offset:1024
  buffer_load_dwordx4 v[184:187], v8, s[12:15], s56 offen offset:2048
  buffer_load_dwordx4 v[188:191], v8, s[12:15], s56 offen offset:3072
  s_add_u32 s56, s56, 4096
  s_waitcnt vmcnt(16)
  s_sub_u32 s57, s57, 1
  s_cmp_lg_u32 s57, 0
  s_cbranch_scc1 G_pfl
  s_waitcnt vmcnt(0)
  s_mov_b32 s62, 1
  s_branch G_slow
G_torole:
  s_load_dwordx16 s[64:79], s[0:1], 0
  s_waitcnt lgkmcnt(0)
  s_mov_b32 s94, s45
  s_mov_b32 s96, s46
  s_branch L_chain
L_abort:
  v_mov_b32 v2, 1
  v_mov_b32 v3, 252
  s_mov_b64 exec, 1
  buffer_atomic_add v2, v3, s[8:11], 0 offen
  s_waitcnt vmcnt(0)
L_end:
  s_endpgm
.section .rodata,"a"
.p2align 6
gm_tbl:
  .long 0x30, 0x0, 0x30, 0x0, 0x30, 0x0, 0x30, 0x0
  .long 0x30, 0x136, 0x166, 0x136, 0x29c, 0x136, 0x3d2, 0x136
  .long 0x508, 0x0, 0x508, 0x0, 0x508, 0x0, 0x508, 0x0
  .long 0x508, 0x20, 0x528, 0x20, 0x548, 0x20, 0x568, 0x20
  .long 0x588, 0x90, 0x618, 0x0, 0x618, 0x0, 0x618, 0x0
  .long 0x618, 0x0, 0x618, 0x0, 0x618, 0x0, 0x618, 0x0
  .long 0x2000, 0x2100, 0x2200, 0x2300, 0x1000, 0x1100, 0x1200, 0x1300
  .long 0x0, 0x100, 0x200, 0x300, 0x2010, 0x2110, 0x2210, 0x2310
  .long 0x1010, 0x1110, 0x1210, 0x1310, 0x10, 0x110, 0x210, 0x310
  .long 0x2020, 0x2030, 0x2120, 0x2130, 0x2220, 0x2230, 0x2320, 0x2330
  .long 0x1020, 0x1030, 0x1040, 0x1120, 0x15, 0x1130, 0x1140, 0x1220
  .long 0x1230, 0x1240, 0x115, 0x1320, 0x1330, 0x1340, 0x20, 0x30
  .long 0x1, 0x40, 0x120, 0x130, 0x140, 0x220, 0x101, 0x230
  .long 0x240, 0x320, 0x330, 0x340, 0x201, 0x2040, 0x2050, 0x2060
  .long 0x2070, 0x2140, 0x301, 0x2150, 0x2160, 0x2170, 0x2240, 0x2250
  .long 0x401, 0x2260, 0x2270, 0x2340, 0x2350, 0x2360, 0x501, 0x2370
  .long 0x1050, 0x1060, 0x1070, 0x1080, 0x601, 0x1150, 0x1160, 0x1170
  .long 0x1180, 0x1250, 0x5, 0x1260, 0x1270, 0x1280, 0x1350, 0x1360
  .long 0x105, 0x1370, 0x1380, 0x50, 0x60, 0x70, 0x205, 0x80
  .long 0x150, 0x160, 0x170, 0x180, 0x305, 0x250, 0x260, 0x270
  .long 0x280, 0x350, 0x360, 0x370, 0x380, 0x2080, 0x2090, 0x20a0
  .long 0x20b0, 0x20c0, 0x2180, 0x2190, 0x21a0, 0x21b0, 0x21c0, 0x2280
  .long 0x2290, 0x22a0, 0x22b0, 0x22c0, 0x2380, 0x2390, 0x23a0, 0x23b0
  .long 0x23c0, 0x1090, 0x10a0, 0x10b0, 0x10c0, 0x1190, 0x11a0, 0x11b0
  .long 0x11c0, 0x1290, 0x12a0, 0x12b0, 0x12c0, 0x1390, 0x13a0, 0x13b0
  .long 0x13c0, 0x90, 0xa0, 0xb0, 0xc0, 0x190, 0x1a0, 0x1b0
  .long 0x1c0, 0x290, 0x2a0, 0x2b0, 0x2c0, 0x390, 0x3a0, 0x3b0
  .long 0x3c0, 0x11, 0x21, 0x31, 0x41, 0x51, 0x61, 0x71
  .long 0x111, 0x121, 0x131, 0x141, 0x151, 0x161, 0x171, 0x211
  .long 0x221, 0x231, 0x241, 0x251, 0x261, 0x271, 0x311, 0x321
  .long 0x331, 0x341, 0x351, 0x361, 0x371, 0x411, 0x421, 0x431
  .long 0x441, 0x451, 0x461, 0x471, 0x511, 0x521, 0x531, 0x541
  .long 0x551, 0x561, 0x571, 0x611, 0x621, 0x631, 0x641, 0x651
  .long 0x661, 0x671, 0x81, 0x91, 0xa1, 0xb1, 0xc1, 0xd1
  .long 0xe1, 0xf1, 0x181, 0x191, 0x1a1, 0x1b1, 0x1c1, 0x1d1
  .long 0x1e1, 0x1f1, 0x281, 0x291, 0x2a1, 0x2b1, 0x2c1, 0x2d1
  .long 0x2e1, 0x2f1, 0x20d0, 0x20e0, 0x20f0, 0x21d0, 0x21e0, 0x21f0
  .long 0x22d0, 0x22e0, 0x22f0, 0x23d0, 0x23e0, 0x23f0, 0x10d0, 0x10e0
  .long 0x10f0, 0x11d0, 0x11e0, 0x11f0, 0x12d0, 0x12e0, 0x12f0, 0x13d0
  .long 0x13e0, 0x13f0, 0xd0, 0xe0, 0xf0, 0x1d0, 0x1e0, 0x1f0
  .long 0x2d0, 0x2e0, 0x2f0, 0x3d0, 0x3e0, 0x3f0, 0x381, 0x391
  .long 0x3a1, 0x3b1, 0x3c1, 0x3d1, 0x3e1, 0x3f1, 0x481, 0x491
  .long 0x4a1, 0x4b1, 0x4c1, 0x4d1, 0x4e1, 0x4f1, 0x581, 0x591
  .long 0x5a1, 0x5b1, 0x5c1, 0x5d1, 0x5e1, 0x5f1, 0x681, 0x691
  .long 0x6a1, 0x6b1, 0x6c1, 0x6d1, 0x6e1, 0x6f1, 0x2400, 0x2500
  .long 0x2600, 0x2700, 0x1400, 0x1500, 0x1600, 0x1700, 0x400, 0x500
  .long 0x600, 0x700, 0x2410, 0x2510, 0x2610, 0x2710, 0x1410, 0x1510
  .long 0x1610, 0x1710, 0x410, 0x510, 0x610, 0x710, 0x2420, 0x2430
  .long 0x2520, 0x2530, 0x2620, 0x2630, 0x2720, 0x2730, 0x1420, 0x1430
  .long 0x1440, 0x1520, 0x215, 0x1530, 0x1540, 0x1620, 0x1630, 0x1640
  .long 0x315, 0x1720, 0x1730, 0x1740, 0x420, 0x430, 0x701, 0x440
  .long 0x520, 0x530, 0x540, 0x620, 0x801, 0x630, 0x640, 0x720
  .long 0x730, 0x740, 0x901, 0x2440, 0x2450, 0x2460, 0x2470, 0x2540
  .long 0xa01, 0x2550, 0x2560, 0x2570, 0x2640, 0x2650, 0xb01, 0x2660
  .long 0x2670, 0x2740, 0x2750, 0x2760, 0xc01, 0x2770, 0x1450, 0x1460
  .long 0x1470, 0x1480, 0xd01, 0x1550, 0x1560, 0x1570, 0x1580, 0x1650
  .long 0x405, 0x1660, 0x1670, 0x1680, 0x1750, 0x1760, 0x505, 0x1770
  .long 0x1780, 0x450, 0x460, 0x470, 0x605, 0x480, 0x550, 0x560
  .long 0x570, 0x580, 0x705, 0x650, 0x660, 0x670, 0x680, 0x750
  .long 0x760, 0x770, 0x780, 0x2480, 0x2490, 0x24a0, 0x24b0, 0x24c0
  .long 0x2580, 0x2590, 0x25a0, 0x25b0, 0x25c0, 0x2680, 0x2690, 0x26a0
  .long 0x26b0, 0x26c0, 0x2780, 0x2790, 0x27a0, 0x27b0, 0x27c0, 0x1490
  .long 0x14a0, 0x14b0, 0x14c0, 0x1590, 0x15a0, 0x15b0, 0x15c0, 0x1690
  .long 0x16a0, 0x16b0, 0x16c0, 0x1790, 0x17a0, 0x17b0, 0x17c0, 0x490
  .long 0x4a0, 0x4b0, 0x4c0, 0x590, 0x5a0, 0x5b0, 0x5c0, 0x690
  .long 0x6a0, 0x6b0, 0x6c0, 0x790, 0x7a0, 0x7b0, 0x7c0, 0x711
  .long 0x721, 0x731, 0x741, 0x751, 0x761, 0x771, 0x811, 0x821
  .long 0x831, 0x841, 0x851, 0x861, 0x871, 0x911, 0x921, 0x931
  .long 0x941, 0x951, 0x961, 0x971, 0xa11, 0xa21, 0xa31, 0xa41
  .long 0xa51, 0xa61, 0xa71, 0xb11, 0xb21, 0xb31, 0xb41, 0xb51
  .long 0xb61, 0xb71, 0xc11, 0xc21, 0xc31, 0xc41, 0xc51, 0xc61
  .long 0xc71, 0xd11, 0xd21, 0xd31, 0xd41, 0xd51, 0xd61, 0xd71
  .long 0x781, 0x791, 0x7a1, 0x7b1, 0x7c1, 0x7d1, 0x7e1, 0x7f1
  .long 0x881, 0x891, 0x8a1, 0x8b1, 0x8c1, 0x8d1, 0x8e1, 0x8f1
  .long 0x981, 0x991, 0x9a1, 0x9b1, 0x9c1, 0x9d1, 0x9e1, 0x9f1
  .long 0x24d0, 0x24e0, 0x24f0, 0x25d0, 0x25e0, 0x25f0, 0x26d0, 0x26e0
  .long 0x26f0, 0x27d0, 0x27e0, 0x27f0, 0x14d0, 0x14e0, 0x14f0, 0x15d0
  .long 0x15e0, 0x15f0, 0x16d0, 0x16e0, 0x16f0, 0x17d0, 0x17e0, 0x17f0
  .long 0x4d0, 0x4e0, 0x4f0, 0x5d0, 0x5e0, 0x5f0, 0x6d0, 0x6e0
  .long 0x6f0, 0x7d0, 0x7e0, 0x7f0, 0xa81, 0xa91, 0xaa1, 0xab1
  .long 0xac1, 0xad1, 0xae1, 0xaf1, 0xb81, 0xb91, 0xba1, 0xbb1
  .long 0xbc1, 0xbd1, 0xbe1, 0xbf1, 0xc81, 0xc91, 0xca1, 0xcb1
  .long 0xcc1, 0xcd1, 0xce1, 0xcf1, 0xd81, 0xd91, 0xda1, 0xdb1
  .long 0xdc1, 0xdd1, 0xde1, 0xdf1, 0x2800, 0x2900, 0x2a00, 0x2b00
  .long 0x1800, 0x1900, 0x1a00, 0x1b00, 0x800, 0x900, 0xa00, 0xb00
  .long 0x2810, 0x2910, 0x2a10, 0x2b10, 0x1810, 0x1910, 0x1a10, 0x1b10
  .long 0x810, 0x910, 0xa10, 0xb10, 0x2820, 0x2830, 0x2920, 0x2930
  .long 0x2a20, 0x2a30, 0x2b20, 0x2b30, 0x1820, 0x1830, 0x1840, 0x1920
  .long 0x415, 0x1930, 0x1940, 0x1a20, 0x1a30, 0x1a40, 0x515, 0x1b20
  .long 0x1b30, 0x1b40, 0x820, 0x830, 0xe01, 0x840, 0x920, 0x930
  .long 0x940, 0xa20, 0xf01, 0xa30, 0xa40, 0xb20, 0xb30, 0xb40
  .long 0x1001, 0x2840, 0x2850, 0x2860, 0x2870, 0x2940, 0x1101, 0x2950
  .long 0x2960, 0x2970, 0x2a40, 0x2a50, 0x1201, 0x2a60, 0x2a70, 0x2b40
  .long 0x2b50, 0x2b60, 0x1301, 0x2b70, 0x1850, 0x1860, 0x1870, 0x1880
  .long 0x1401, 0x1950, 0x1960, 0x1970, 0x1980, 0x1a50, 0x805, 0x1a60
  .long 0x1a70, 0x1a80, 0x1b50, 0x1b60, 0x905, 0x1b70, 0x1b80, 0x850
  .long 0x860, 0x870, 0xa05, 0x880, 0x950, 0x960, 0x970, 0x980
  .long 0xb05, 0xa50, 0xa60, 0xa70, 0xa80, 0xb50, 0xb60, 0xb70
  .long 0xb80, 0x2880, 0x2890, 0x28a0, 0x28b0, 0x28c0, 0x2980, 0x2990
  .long 0x29a0, 0x29b0, 0x29c0, 0x2a80, 0x2a90, 0x2aa0, 0x2ab0, 0x2ac0
  .long 0x2b80, 0x2b90, 0x2ba0, 0x2bb0, 0x2bc0, 0x1890, 0x18a0, 0x18b0
  .long 0x18c0, 0x1990, 0x19a0, 0x19b0, 0x19c0, 0x1a90, 0x1aa0, 0x1ab0
  .long 0x1ac0, 0x1b90, 0x1ba0, 0x1bb0, 0x1bc0, 0x890, 0x8a0, 0x8b0
  .long 0x8c0, 0x990, 0x9a0, 0x9b0, 0x9c0, 0xa90, 0xaa0, 0xab0
  .long 0xac0, 0xb90, 0xba0, 0xbb0, 0xbc0, 0xe11, 0xe21, 0xe31
  .long 0xe41, 0xe51, 0xe61, 0xe71, 0xf11, 0xf21, 0xf31, 0xf41
  .long 0xf51, 0xf61, 0xf71, 0x1011, 0x1021, 0x1031, 0x1041, 0x1051
  .long 0x1061, 0x1071, 0x1111, 0x1121, 0x1131, 0x1141, 0x1151, 0x1161
  .long 0x1171, 0x1211, 0x1221, 0x1231, 0x1241, 0x1251, 0x1261, 0x1271
  .long 0x1311, 0x1321, 0x1331, 0x1341, 0x1351, 0x1361, 0x1371, 0x1411
  .long 0x1421, 0x1431, 0x1441, 0x1451, 0x1461, 0x1471, 0xe81, 0xe91
  .long 0xea1, 0xeb1, 0xec1, 0xed1, 0xee1, 0xef1, 0xf81, 0xf91
  .long 0xfa1, 0xfb1, 0xfc1, 0xfd1, 0xfe1, 0xff1, 0x1081, 0x1091
  .long 0x10a1, 0x10b1, 0x10c1, 0x10d1, 0x10e1, 0x10f1, 0x28d0, 0x28e0
  .long 0x28f0, 0x29d0, 0x29e0, 0x29f0, 0x2ad0, 0x2ae0, 0x2af0, 0x2bd0
  .long 0x2be0, 0x2bf0, 0x18d0, 0x18e0, 0x18f0, 0x19d0, 0x19e0, 0x19f0
  .long 0x1ad0, 0x1ae0, 0x1af0, 0x1bd0, 0x1be0, 0x1bf0, 0x8d0, 0x8e0
  .long 0x8f0, 0x9d0, 0x9e0, 0x9f0, 0xad0, 0xae0, 0xaf0, 0xbd0
  .long 0xbe0, 0xbf0, 0x1181, 0x1191, 0x11a1, 0x11b1, 0x11c1, 0x11d1
  .long 0x11e1, 0x11f1, 0x1281, 0x1291, 0x12a1, 0x12b1, 0x12c1, 0x12d1
  .long 0x12e1, 0x12f1, 0x1381, 0x1391, 0x13a1, 0x13b1, 0x13c1, 0x13d1
  .long 0x13e1, 0x13f1, 0x1481, 0x1491, 0x14a1, 0x14b1, 0x14c1, 0x14d1
  .long 0x14e1, 0x14f1, 0x2c00, 0x2d00, 0x2e00, 0x2f00, 0x1c00, 0x1d00
  .long 0x1e00, 0x1f00, 0xc00, 0xd00, 0xe00, 0xf00, 0x2c10, 0x2d10
  .long 0x2e10, 0x2f10, 0x1c10, 0x1d10, 0x1e10, 0x1f10, 0xc10, 0xd10
  .long 0xe10, 0xf10, 0x2c20, 0x2c30, 0x2d20, 0x2d30, 0x2e20, 0x2e30
  .long 0x2f20, 0x2f30, 0x1c20, 0x1c30, 0x1c40, 0x1d20, 0x615, 0x1d30
  .long 0x1d40, 0x1e20, 0x1e30, 0x1e40, 0x715, 0x1f20, 0x1f30, 0x1f40
  .long 0xc20, 0xc30, 0x1501, 0xc40, 0xd20, 0xd30, 0xd40, 0xe20
  .long 0x1601, 0xe30, 0xe40, 0xf20, 0xf30, 0xf40, 0x1701, 0x2c40
  .long 0x2c50, 0x2c60, 0x2c70, 0x2d40, 0x1801, 0x2d50, 0x2d60, 0x2d70
  .long 0x2e40, 0x2e50, 0x1901, 0x2e60, 0x2e70, 0x2f40, 0x2f50, 0x2f60
  .long 0x1a01, 0x2f70, 0x1c50, 0x1c60, 0x1c70, 0x1c80, 0x1b01, 0x1d50
  .long 0x1d60, 0x1d70, 0x1d80, 0x1e50, 0xc05, 0x1e60, 0x1e70, 0x1e80
  .long 0x1f50, 0x1f60, 0xd05, 0x1f70, 0x1f80, 0xc50, 0xc60, 0xc70
  .long 0xe05, 0xc80, 0xd50, 0xd60, 0xd70, 0xd80, 0xf05, 0xe50
  .long 0xe60, 0xe70, 0xe80, 0xf50, 0xf60, 0xf70, 0xf80, 0x2c80
  .long 0x2c90, 0x2ca0, 0x2cb0, 0x2cc0, 0x2d80, 0x2d90, 0x2da0, 0x2db0
  .long 0x2dc0, 0x2e80, 0x2e90, 0x2ea0, 0x2eb0, 0x2ec0, 0x2f80, 0x2f90
  .long 0x2fa0, 0x2fb0, 0x2fc0, 0x1c90, 0x1ca0, 0x1cb0, 0x1cc0, 0x1d90
  .long 0x1da0, 0x1db0, 0x1dc0, 0x1e90, 0x1ea0, 0x1eb0, 0x1ec0, 0x1f90
  .long 0x1fa0, 0x1fb0, 0x1fc0, 0xc90, 0xca0, 0xcb0, 0xcc0, 0xd90
  .long 0xda0, 0xdb0, 0xdc0, 0xe90, 0xea0, 0xeb0, 0xec0, 0xf90
  .long 0xfa0, 0xfb0, 0xfc0, 0x1511, 0x1521, 0x1531, 0x1541, 0x1551
  .long 0x1561, 0x1571, 0x1611, 0x1621, 0x1631, 0x1641, 0x1651, 0x1661
  .long 0x1671, 0x1711, 0x1721, 0x1731, 0x1741, 0x1751, 0x1761, 0x1771
  .long 0x1811, 0x1821, 0x1831, 0x1841, 0x1851, 0x1861, 0x1871, 0x1911
  .long 0x1921, 0x1931, 0x1941, 0x1951, 0x1961, 0x1971, 0x1a11, 0x1a21
  .long 0x1a31, 0x1a41, 0x1a51, 0x1a61, 0x1a71, 0x1b11, 0x1b21, 0x1b31
  .long 0x1b41, 0x1b51, 0x1b61, 0x1b71, 0x1581, 0x1591, 0x15a1, 0x15b1
  .long 0x15c1, 0x15d1, 0x15e1, 0x15f1, 0x1681, 0x1691, 0x16a1, 0x16b1
  .long 0x16c1, 0x16d1, 0x16e1, 0x16f1, 0x1781, 0x1791, 0x17a1, 0x17b1
  .long 0x17c1, 0x17d1, 0x17e1, 0x17f1, 0x2cd0, 0x2ce0, 0x2cf0, 0x2dd0
  .long 0x2de0, 0x2df0, 0x2ed0, 0x2ee0, 0x2ef0, 0x2fd0, 0x2fe0, 0x2ff0
  .long 0x1cd0, 0x1ce0, 0x1cf0, 0x1dd0, 0x1de0, 0x1df0, 0x1ed0, 0x1ee0
  .long 0x1ef0, 0x1fd0, 0x1fe0, 0x1ff0, 0xcd0, 0xce0, 0xcf0, 0xdd0
  .long 0xde0, 0xdf0, 0xed0, 0xee0, 0xef0, 0xfd0, 0xfe0, 0xff0
  .long 0x1881, 0x1891, 0x18a1, 0x18b1, 0x18c1, 0x18d1, 0x18e1, 0x18f1
  .long 0x1981, 0x1991, 0x19a1, 0x19b1, 0x19c1, 0x19d1, 0x19e1, 0x19f1
  .long 0x1a81, 0x1a91, 0x1aa1, 0x1ab1, 0x1ac1, 0x1ad1, 0x1ae1, 0x1af1
  .long 0x1b81, 0x1b91, 0x1ba1, 0x1bb1, 0x1bc1, 0x1bd1, 0x1be1, 0x1bf1
  .long 0x2, 0x102, 0x202, 0x302, 0x22, 0x122, 0x222, 0x322
  .long 0x42, 0x142, 0x242, 0x342, 0x62, 0x162, 0x262, 0x362
  .long 0x82, 0x182, 0x282, 0x382, 0xa2, 0x1a2, 0x2a2, 0x3a2
  .long 0xc2, 0x1c2, 0x2c2, 0x3c2, 0xe2, 0x1e2, 0x2e2, 0x3e2
  .long 0x402, 0x502, 0x602, 0x702, 0x422, 0x522, 0x622, 0x722
  .long 0x442, 0x542, 0x642, 0x742, 0x462, 0x562, 0x662, 0x762
  .long 0x482, 0x582, 0x682, 0x782, 0x4a2, 0x5a2, 0x6a2, 0x7a2
  .long 0x4c2, 0x5c2, 0x6c2, 0x7c2, 0x4e2, 0x5e2, 0x6e2, 0x7e2
  .long 0x12, 0x112, 0x212, 0x312, 0x32, 0x132, 0x232, 0x332
  .long 0x52, 0x152, 0x252, 0x352, 0x72, 0x172, 0x272, 0x372
  .long 0x92, 0x192, 0x292, 0x392, 0xb2, 0x1b2, 0x2b2, 0x3b2
  .long 0xd2, 0x1d2, 0x2d2, 0x3d2, 0xf2, 0x1f2, 0x2f2, 0x3f2
  .long 0x412, 0x512, 0x612, 0x712, 0x432, 0x532, 0x632, 0x732
  .long 0x452, 0x552, 0x652, 0x752, 0x472, 0x572, 0x672, 0x772
  .long 0x492, 0x592, 0x692, 0x792, 0x4b2, 0x5b2, 0x6b2, 0x7b2
  .long 0x4d2, 0x5d2, 0x6d2, 0x7d2, 0x4f2, 0x5f2, 0x6f2, 0x7f2
  .long 0x3, 0x203, 0x403, 0x603, 0x803, 0xa03, 0xc03, 0xe03
  .long 0x1013, 0x1213, 0x1413, 0x1613, 0x1813, 0x1a13, 0x1c13, 0x1e13
  .long 0x2023, 0x2223, 0x2423, 0x2623, 0x2823, 0x2a23, 0x2c23, 0x2e23
  .long 0x3033, 0x3233, 0x3433, 0x3633, 0x3833, 0x3a33, 0x3c33, 0x3e33
  .long 0x4043, 0x4243, 0x4443, 0x4643, 0x4843, 0x4a43, 0x4c43, 0x4e43
  .long 0x5053, 0x5253, 0x5453, 0x5653, 0x5853, 0x5a53, 0x5c53, 0x5e53
  .long 0x6063, 0x6263, 0x6463, 0x6663, 0x6863, 0x6a63, 0x6c63, 0x6e63
  .long 0x7073, 0x7273, 0x7473, 0x7673, 0x7873, 0x7a73, 0x7c73, 0x7e73
  .long 0x8083, 0x8283, 0x8483, 0x8683, 0x8883, 0x8a83, 0x8c83, 0x8e83
  .long 0x9093, 0x9293, 0x9493, 0x9693, 0x9893, 0x9a93, 0x9c93, 0x9e93
  .long 0xa0a3, 0xa2a3, 0xa4a3, 0xa6a3, 0xa8a3, 0xaaa3, 0xaca3, 0xaea3
  .long 0xb0b3, 0xb2b3, 0xb4b3, 0xb6b3, 0xb8b3, 0xbab3, 0xbcb3, 0xbeb3
  .long 0xc0c3, 0xc2c3, 0xc4c3, 0xc6c3, 0xc8c3, 0xcac3, 0xccc3, 0xcec3
  .long 0xd0d3, 0xd2d3, 0xd4d3, 0xd6d3, 0xd8d3, 0xdad3, 0xdcd3, 0xded3
  .long 0xe0e3, 0xe1e3, 0xe2e3, 0xe3e3, 0xe4e3, 0xe5e3, 0xe6e3, 0xe7e3
  .long 0xe8e3, 0xe9e3, 0xeae3, 0xebe3, 0xece3, 0xede3, 0xeee3, 0xefe3
  .long 0xf0f3, 0xf1f3, 0xf2f3, 0xf3f3, 0xf4f3, 0xf5f3, 0xf6f3, 0xf7f3
  .long 0xf8f3, 0xf9f3, 0xfaf3, 0xfbf3, 0xfcf3, 0xfdf3, 0xfef3, 0xfff3
.section .rodata,"a"
.p2align 6
.amdhsa_kernel gated_mix__memory_aug_recurrent_mem_tr__glu_gated_swiglu__prompt_kernel
  .amdhsa_next_free_vgpr 512
  .amdhsa_next_free_sgpr 102
  .amdhsa_accum_offset 256
  .amdhsa_group_segment_fixed_size 0
  .amdhsa_kernarg_size 120
  .amdhsa_user_sgpr_count 2
  .amdhsa_user_sgpr_kernarg_segment_ptr 1
  .amdhsa_system_sgpr_workgroup_id_x 1
.end_amdhsa_kernel
```
